```python
import torch

def _softmax(x, axis=-1):
    return torch.softmax(x, dim=axis)

def _gelu(x):
    return torch.nn.functional.gelu(x, approximate='tanh')

def _silu(x):
    return torch.nn.functional.silu(x)

def _sigmoid(x):
    return torch.sigmoid(x)

def _layernorm(x, axis=-1, eps=1e-05):
    m = x.mean(dim=axis, keepdim=True)
    v = x.var(dim=axis, keepdim=True, unbiased=False)
    return (x - m) / torch.sqrt(v + eps)

def _scatter_add(tgt, idx, src, axis=0):
    return tgt.clone().index_add_(axis, idx, src)

def _segment_sum(src, seg, n):
    out = torch.zeros((n,) + src.shape[1:], dtype=src.dtype)
    return out.index_add_(0, seg, src)

def _pad(x, pw):
    flat = tuple((v for pair in reversed(pw) for v in pair))
    return torch.nn.functional.pad(x, flat)
kernel_name = 'parallel_sum__memory_aug_recurrent_mem_tr__moe_arch_mod__prompt'

def setup_inputs():

    _w = lambda a: (lambda t: t.to(torch.bfloat16) if t.is_floating_point() else t)(torch.as_tensor(a))

    def _A_setup():
        B, S, Dm = (1, 2048, 512)
        H, Dh = (32, 128)
        M, seg = (8, 32)
        seg = min(seg, S)
        S = S // seg * seg
        return {'x': _w((lambda *s: torch.randn(*s, dtype=torch.bfloat16) * 0.05)(B, S, Dm)), 'mem0': _w((lambda *s: torch.randn(*s, dtype=torch.bfloat16) * 1.6)(B, M, Dm)), 'Wq': _w((lambda *s: torch.randn(*s, dtype=torch.bfloat16) * 0.8)(Dm, H, Dh) * Dm ** (-0.5)), 'Wk': _w((lambda *s: torch.randn(*s, dtype=torch.bfloat16) * 0.8)(Dm, H, Dh) * Dm ** (-0.5)), 'Wv': _w((lambda *s: torch.randn(*s, dtype=torch.bfloat16) * 1.6)(Dm, H, Dh) * Dm ** (-0.5)), 'Wo': _w((lambda *s: torch.randn(*s, dtype=torch.bfloat16) * 1.6)(H, Dh, Dm) * (H * Dh) ** (-0.5)), 'seg_len': seg}
    _A_in = _A_setup()

    def _B_setup():
        B, S, D, F, C = (1, 2048, 512, 1792, 8)
        return {'x': _w((lambda *s: torch.randn(*s, dtype=torch.bfloat16) * 0.05)(B, S, D)), 'w_r': _w((lambda *s: torch.randn(*s, dtype=torch.bfloat16) * 0.05)(D)), 'w_gate': _w((lambda *s: torch.randn(*s, dtype=torch.bfloat16) * 0.05)(D, F)), 'w_up': _w((lambda *s: torch.randn(*s, dtype=torch.bfloat16) * 0.05)(D, F)), 'w_down': _w((lambda *s: torch.randn(*s, dtype=torch.bfloat16) * 0.05)(F, D))}
    _B_in = _B_setup()
    return {'A_x': _A_in['x'], 'A_mem0': _A_in['mem0'], 'A_Wq': _A_in['Wq'], 'A_Wk': _A_in['Wk'], 'A_Wv': _A_in['Wv'], 'A_Wo': _A_in['Wo'], 'A_seg_len': _A_in['seg_len'], 'B_x': _B_in['x'], 'B_w_r': _B_in['w_r'], 'B_w_gate': _B_in['w_gate'], 'B_w_up': _B_in['w_up'], 'B_w_down': _B_in['w_down']}

def reference(A_x, A_mem0, A_Wq, A_Wk, A_Wv, A_Wo, A_seg_len, B_x, B_w_r, B_w_gate, B_w_up, B_w_down):

    def _A_ref(x, mem0, Wq, Wk, Wv, Wo, seg_len):
        B, S, Dm = x.shape
        H, Dh = (Wq.shape[1], Wq.shape[2])
        M = mem0.shape[1]
        scale = Dh ** (-0.5)
        n_seg = S // seg_len
        L = M + seg_len
        idx = torch.arange(L)
        mask = (idx[:, None] < M) | (idx[:, None] >= idx[None, :])
        mem = mem0
        outs = []
        for s in range(n_seg):
            xs = x[:, s * seg_len:(s + 1) * seg_len, :].clone()
            h = torch.concatenate([mem, xs], axis=1)
            q = torch.einsum('btd,dhe->bhte', h, Wq)
            k = torch.einsum('btd,dhe->bhte', h, Wk)
            v = torch.einsum('btd,dhe->bhte', h, Wv)
            scores = torch.einsum('bhqe,bhke->bhqk', q, k) * scale
            scores = torch.where(mask[None, None], scores, -1000000000.0)
            p = _softmax(scores, axis=-1)
            o = torch.einsum('bhqk,bhke->bhqe', p, v)
            o = torch.einsum('bhte,hed->btd', o, Wo)
            mem = o[:, :M, :].clone()
            outs.append(o[:, M:, :])
        return torch.concatenate(outs, axis=1)

    def _B_ref(x, w_r, w_gate, w_up, w_down):
        B, S, D = x.shape
        C = 8
        r = x @ w_r
        idx = torch.argsort(-r, axis=-1)[:, :C]
        idx_e = (lambda x, n, axis: torch.repeat_interleave(x, n, dim=axis))(idx.reshape(B, C, 1), D, axis=2)
        x_sel = (lambda x, i, axis: torch.take_along_dim(x, i, dim=axis))(x, idx_e, axis=1)
        g = _silu(x_sel @ w_gate)
        u = x_sel @ w_up
        y = g * u @ w_down
        r_sel = _sigmoid((lambda x, i, axis: torch.take_along_dim(x, i, dim=axis))(r, idx, axis=1))
        y = y * r_sel.reshape(B, C, 1)
        b_off = (torch.arange(B) * S).reshape(B, 1)
        flat_idx = (idx + b_off).reshape(B * C)
        zero = (x * 0.0).reshape(B * S, D)
        upd = _scatter_add(zero, flat_idx, y.reshape(B * C, D), axis=0)
        return x + upd.reshape(B, S, D)
    x = A_x
    xn = _layernorm(x, axis=-1)
    return x + _A_ref(xn, A_mem0, A_Wq, A_Wk, A_Wv, A_Wo, A_seg_len) + _B_ref(xn, B_w_r, B_w_gate, B_w_up, B_w_down)
```

```asm
; @launch kernel=k23_kernel grid=(256,1,1) block=(256,1,1) lds=153856
.amdgcn_target "amdgcn-amd-amdhsa--gfx950"
.text
.globl k23_kernel
.p2align 8
.type k23_kernel,@function
k23_kernel:
    s_cmp_ge_u32 s2, 256
    s_cbranch_scc1 K3_END
    s_load_dwordx2 s[8:9], s[0:1], 104
    s_load_dwordx2 s[68:69], s[0:1], 16
    s_getreg_b32 s3, hwreg(HW_REG_XCC_ID, 0, 4)
    v_lshrrev_b32 v96, 6, v0
    s_nop 0
    v_readfirstlane_b32 s29, v96
    s_and_b32 s3, s3, 7
    s_waitcnt lgkmcnt(0)
    s_mov_b32 s12, s8
    s_and_b32 s13, s9, 0xffff
    s_mov_b32 s14, 0x100
    s_mov_b32 s15, 0x00020000
    s_mov_b32 s28, -1
    s_sub_u32 s74, s3, 1
    s_max_i32 s74, s74, 0
    s_cmp_lg_u32 s3, 0
    s_cbranch_scc1 K3_ELD
    v_mov_b32 v4, 8192
    s_cmp_lg_u32 s29, 0
    s_cbranch_scc1 K3_EL_PF
    s_mov_b64 exec, 1
    v_mov_b32 v1, 1
    buffer_atomic_add v1, off, s[12:15], 0 sc0 sc1
    s_mov_b64 exec, -1
K3_EL_PF:
    v_and_b32 v97, 63, v0
    v_lshrrev_b32 v108, 4, v97
    v_and_b32 v109, 15, v97
    v_lshlrev_b32 v110, 4, v109
    v_lshl_add_u32 v110, v108, 13, v110
    v_lshlrev_b32 v112, 2, v108
    v_xor_b32 v112, v112, v109
    v_lshlrev_b32 v112, 4, v112
    v_lshl_add_u32 v112, v108, 8, v112
    v_lshl_add_u32 v112, v96, 15, v112
    v_add_u32 v112, 18432, v112
    v_bfe_u32 v109, v97, 2, 2
    v_lshl_add_u32 v113, v108, 3, v109
    v_lshlrev_b32 v113, 8, v113
    v_xor_b32 v109, v109, v96
    v_lshl_add_u32 v113, v109, 6, v113
    v_and_b32 v109, 3, v97
    v_lshl_add_u32 v113, v109, 4, v113
    v_add_u32 v113, 18432, v113
    v_add_u32 v114, 0x10000, v113
    s_mov_b32 s60, s68
    s_and_b32 s61, s69, 0xffff
    s_mov_b32 s62, 0x400000
    s_mov_b32 s63, 0x00020000
    s_lshr_b32 s32, s2, 3
    s_and_b32 s32, s32, 31
    s_lshl_b32 s32, s32, 8
    s_lshl_b32 s34, s29, 20
    s_add_u32 s34, s34, s32
    buffer_load_dwordx4 a[0:3], v110, s[60:63], s34 offen
    s_add_u32 s34, s34, 0x8000
    buffer_load_dwordx4 a[4:7], v110, s[60:63], s34 offen
    s_add_u32 s34, s34, 0x8000
    buffer_load_dwordx4 a[8:11], v110, s[60:63], s34 offen
    s_add_u32 s34, s34, 0x8000
    buffer_load_dwordx4 a[12:15], v110, s[60:63], s34 offen
    s_add_u32 s34, s34, 0x8000
    buffer_load_dwordx4 a[16:19], v110, s[60:63], s34 offen
    s_add_u32 s34, s34, 0x8000
    buffer_load_dwordx4 a[20:23], v110, s[60:63], s34 offen
    s_add_u32 s34, s34, 0x8000
    buffer_load_dwordx4 a[24:27], v110, s[60:63], s34 offen
    s_add_u32 s34, s34, 0x8000
    buffer_load_dwordx4 a[28:31], v110, s[60:63], s34 offen
    s_add_u32 s34, s34, 0x8000
    s_cmp_lg_u32 s29, 0
    s_cbranch_scc1 K3_EL_WAIT
    s_waitcnt vmcnt(8)
    s_mov_b64 exec, 1
    v_and_b32 v1, 0xffff, v1
    ds_write_b32 v4, v1
    s_waitcnt lgkmcnt(0)
    s_mov_b64 exec, -1
K3_EL_WAIT:
    s_barrier
    ds_read_b32 v6, v4
    s_waitcnt lgkmcnt(0)
    v_readfirstlane_b32 s28, v6
    s_cmp_lt_u32 s28, 32
    s_cselect_b32 s28, s28, -1
K3_ELD:
    s_cmp_eq_u32 s28, -1
    s_cbranch_scc0 K3_CHAIN
    s_waitcnt vmcnt(0)
    s_branch WORKER
K3_CHAIN:
    s_load_dwordx2 s[6:7], s[0:1], 112
    s_load_dwordx2 s[4:5], s[0:1], 8
    s_load_dwordx8 s[68:75], s[0:1], 16
    v_lshrrev_b32 v96, 6, v0
    v_and_b32 v97, 63, v0
    s_nop 0
    v_readfirstlane_b32 s29, v96
    s_waitcnt lgkmcnt(0)
    s_mov_b32 s24, s6
    s_and_b32 s25, s7, 0xffff
    s_mov_b32 s26, 0x10000000
    s_mov_b32 s27, 0x00020000
    s_mov_b32 s20, s4
    s_and_b32 s21, s5, 0xffff
    s_mov_b32 s22, 0x2000
    s_mov_b32 s23, 0x00020000
    v_and_b32 v100, 15, v97
    v_lshrrev_b32 v101, 4, v97
    v_lshrrev_b32 v103, 2, v100
    v_lshlrev_b32 v103, 1, v103
    v_and_b32 v105, 1, v100
    v_add_u32 v103, v103, v105
    v_lshlrev_b32 v103, 10, v103
    v_lshl_add_u32 v103, v96, 8, v103
    v_lshl_add_u32 v103, v101, 5, v103
    v_bfe_u32 v105, v100, 1, 1
    v_lshl_add_u32 v103, v105, 2, v103
    buffer_load_dword v16, v103, s[20:23], 0 offen offset:0
    buffer_load_dword v17, v103, s[20:23], 0 offen offset:8
    buffer_load_dword v18, v103, s[20:23], 0 offen offset:16
    buffer_load_dword v19, v103, s[20:23], 0 offen offset:24
    buffer_load_dword v20, v103, s[20:23], 0 offen offset:128
    buffer_load_dword v21, v103, s[20:23], 0 offen offset:136
    buffer_load_dword v22, v103, s[20:23], 0 offen offset:144
    buffer_load_dword v23, v103, s[20:23], 0 offen offset:152
    v_lshlrev_b32 v98, 4, v97
    v_lshl_add_u32 v2, v96, 15, v98
    v_add_u32 v2, 0x4800, v2
    v_lshrrev_b32 v108, 4, v97
    v_and_b32 v109, 15, v97
    v_lshlrev_b32 v110, 4, v109
    v_lshl_add_u32 v110, v108, 13, v110
    v_lshlrev_b32 v112, 2, v108
    v_xor_b32 v112, v112, v109
    v_lshlrev_b32 v112, 4, v112
    v_lshl_add_u32 v112, v108, 8, v112
    v_lshl_add_u32 v112, v96, 15, v112
    v_add_u32 v112, 18432, v112
    v_bfe_u32 v109, v97, 2, 2
    v_lshl_add_u32 v113, v108, 3, v109
    v_lshlrev_b32 v113, 8, v113
    v_xor_b32 v109, v109, v96
    v_lshl_add_u32 v113, v109, 6, v113
    v_and_b32 v109, 3, v97
    v_lshl_add_u32 v113, v109, 4, v113
    v_add_u32 v113, 18432, v113
    v_add_u32 v114, 0x10000, v113
    v_lshrrev_b32 v108, 4, v97
    v_and_b32 v109, 15, v97
    v_lshlrev_b32 v111, 4, v109
    v_lshl_add_u32 v111, v108, 10, v111
    v_bfe_u32 v109, v97, 2, 2
    v_lshl_add_u32 v115, v108, 3, v109
    v_lshlrev_b32 v115, 8, v115
    v_lshl_add_u32 v115, v109, 6, v115
    v_and_b32 v109, 3, v97
    v_lshl_add_u32 v115, v109, 4, v115
    v_lshl_add_u32 v115, v96, 15, v115
    v_add_u32 v115, 0x4800, v115
    v_xor_b32 v116, 64, v115
    v_xor_b32 v117, 128, v115
    v_xor_b32 v118, 192, v115
    s_lshl_b32 s32, s28, 8
    s_lshl_b32 s33, s29, 20
    s_add_u32 s33, s32, s33
    s_mov_b32 s60, s68
    s_and_b32 s61, s69, 0xffff
    s_mov_b32 s62, 0x400000
    s_mov_b32 s63, 0x00020000
    s_mov_b32 s34, s33
    buffer_load_dwordx4 a[0:3], v110, s[60:63], s34 offen
    s_add_u32 s34, s34, 0x8000
    buffer_load_dwordx4 a[4:7], v110, s[60:63], s34 offen
    s_add_u32 s34, s34, 0x8000
    buffer_load_dwordx4 a[8:11], v110, s[60:63], s34 offen
    s_add_u32 s34, s34, 0x8000
    buffer_load_dwordx4 a[12:15], v110, s[60:63], s34 offen
    s_add_u32 s34, s34, 0x8000
    buffer_load_dwordx4 a[16:19], v110, s[60:63], s34 offen
    s_add_u32 s34, s34, 0x8000
    buffer_load_dwordx4 a[20:23], v110, s[60:63], s34 offen
    s_add_u32 s34, s34, 0x8000
    buffer_load_dwordx4 a[24:27], v110, s[60:63], s34 offen
    s_add_u32 s34, s34, 0x8000
    buffer_load_dwordx4 a[28:31], v110, s[60:63], s34 offen
    s_add_u32 s34, s34, 0x8000
    buffer_load_dwordx4 a[32:35], v110, s[60:63], s34 offen
    s_add_u32 s34, s34, 0x8000
    buffer_load_dwordx4 a[36:39], v110, s[60:63], s34 offen
    s_add_u32 s34, s34, 0x8000
    buffer_load_dwordx4 a[40:43], v110, s[60:63], s34 offen
    s_add_u32 s34, s34, 0x8000
    buffer_load_dwordx4 a[44:47], v110, s[60:63], s34 offen
    s_add_u32 s34, s34, 0x8000
    buffer_load_dwordx4 a[48:51], v110, s[60:63], s34 offen
    s_add_u32 s34, s34, 0x8000
    buffer_load_dwordx4 a[52:55], v110, s[60:63], s34 offen
    s_add_u32 s34, s34, 0x8000
    buffer_load_dwordx4 a[56:59], v110, s[60:63], s34 offen
    s_add_u32 s34, s34, 0x8000
    buffer_load_dwordx4 a[60:63], v110, s[60:63], s34 offen
    s_add_u32 s34, s34, 0x8000
    buffer_load_dwordx4 a[64:67], v110, s[60:63], s34 offen
    s_add_u32 s34, s34, 0x8000
    buffer_load_dwordx4 a[68:71], v110, s[60:63], s34 offen
    s_add_u32 s34, s34, 0x8000
    buffer_load_dwordx4 a[72:75], v110, s[60:63], s34 offen
    s_add_u32 s34, s34, 0x8000
    buffer_load_dwordx4 a[76:79], v110, s[60:63], s34 offen
    s_add_u32 s34, s34, 0x8000
    buffer_load_dwordx4 a[80:83], v110, s[60:63], s34 offen
    s_add_u32 s34, s34, 0x8000
    buffer_load_dwordx4 a[84:87], v110, s[60:63], s34 offen
    s_add_u32 s34, s34, 0x8000
    buffer_load_dwordx4 a[88:91], v110, s[60:63], s34 offen
    s_add_u32 s34, s34, 0x8000
    buffer_load_dwordx4 a[92:95], v110, s[60:63], s34 offen
    s_add_u32 s34, s34, 0x8000
    buffer_load_dwordx4 a[96:99], v110, s[60:63], s34 offen
    s_add_u32 s34, s34, 0x8000
    buffer_load_dwordx4 a[100:103], v110, s[60:63], s34 offen
    s_add_u32 s34, s34, 0x8000
    buffer_load_dwordx4 a[104:107], v110, s[60:63], s34 offen
    s_add_u32 s34, s34, 0x8000
    buffer_load_dwordx4 a[108:111], v110, s[60:63], s34 offen
    s_add_u32 s34, s34, 0x8000
    buffer_load_dwordx4 a[112:115], v110, s[60:63], s34 offen
    s_add_u32 s34, s34, 0x8000
    buffer_load_dwordx4 a[116:119], v110, s[60:63], s34 offen
    s_add_u32 s34, s34, 0x8000
    buffer_load_dwordx4 a[120:123], v110, s[60:63], s34 offen
    s_add_u32 s34, s34, 0x8000
    buffer_load_dwordx4 a[124:127], v110, s[60:63], s34 offen
    s_add_u32 s34, s34, 0x8000
    s_mov_b32 s60, s70
    s_and_b32 s61, s71, 0xffff
    s_mov_b32 s62, 0x400000
    s_mov_b32 s63, 0x00020000
    s_mov_b32 s34, s33
    buffer_load_dwordx4 a[128:131], v110, s[60:63], s34 offen
    s_add_u32 s34, s34, 0x8000
    buffer_load_dwordx4 a[132:135], v110, s[60:63], s34 offen
    s_add_u32 s34, s34, 0x8000
    buffer_load_dwordx4 a[136:139], v110, s[60:63], s34 offen
    s_add_u32 s34, s34, 0x8000
    buffer_load_dwordx4 a[140:143], v110, s[60:63], s34 offen
    s_add_u32 s34, s34, 0x8000
    buffer_load_dwordx4 a[144:147], v110, s[60:63], s34 offen
    s_add_u32 s34, s34, 0x8000
    buffer_load_dwordx4 a[148:151], v110, s[60:63], s34 offen
    s_add_u32 s34, s34, 0x8000
    buffer_load_dwordx4 a[152:155], v110, s[60:63], s34 offen
    s_add_u32 s34, s34, 0x8000
    buffer_load_dwordx4 a[156:159], v110, s[60:63], s34 offen
    s_add_u32 s34, s34, 0x8000
    buffer_load_dwordx4 a[160:163], v110, s[60:63], s34 offen
    s_add_u32 s34, s34, 0x8000
    buffer_load_dwordx4 a[164:167], v110, s[60:63], s34 offen
    s_add_u32 s34, s34, 0x8000
    buffer_load_dwordx4 a[168:171], v110, s[60:63], s34 offen
    s_add_u32 s34, s34, 0x8000
    buffer_load_dwordx4 a[172:175], v110, s[60:63], s34 offen
    s_add_u32 s34, s34, 0x8000
    buffer_load_dwordx4 a[176:179], v110, s[60:63], s34 offen
    s_add_u32 s34, s34, 0x8000
    buffer_load_dwordx4 a[180:183], v110, s[60:63], s34 offen
    s_add_u32 s34, s34, 0x8000
    buffer_load_dwordx4 a[184:187], v110, s[60:63], s34 offen
    s_add_u32 s34, s34, 0x8000
    buffer_load_dwordx4 a[188:191], v110, s[60:63], s34 offen
    s_add_u32 s34, s34, 0x8000
    buffer_load_dwordx4 a[192:195], v110, s[60:63], s34 offen
    s_add_u32 s34, s34, 0x8000
    buffer_load_dwordx4 a[196:199], v110, s[60:63], s34 offen
    s_add_u32 s34, s34, 0x8000
    buffer_load_dwordx4 a[200:203], v110, s[60:63], s34 offen
    s_add_u32 s34, s34, 0x8000
    buffer_load_dwordx4 a[204:207], v110, s[60:63], s34 offen
    s_add_u32 s34, s34, 0x8000
    buffer_load_dwordx4 a[208:211], v110, s[60:63], s34 offen
    s_add_u32 s34, s34, 0x8000
    buffer_load_dwordx4 a[212:215], v110, s[60:63], s34 offen
    s_add_u32 s34, s34, 0x8000
    buffer_load_dwordx4 a[216:219], v110, s[60:63], s34 offen
    s_add_u32 s34, s34, 0x8000
    buffer_load_dwordx4 a[220:223], v110, s[60:63], s34 offen
    s_add_u32 s34, s34, 0x8000
    buffer_load_dwordx4 a[224:227], v110, s[60:63], s34 offen
    s_add_u32 s34, s34, 0x8000
    buffer_load_dwordx4 a[228:231], v110, s[60:63], s34 offen
    s_add_u32 s34, s34, 0x8000
    buffer_load_dwordx4 a[232:235], v110, s[60:63], s34 offen
    s_add_u32 s34, s34, 0x8000
    buffer_load_dwordx4 a[236:239], v110, s[60:63], s34 offen
    s_add_u32 s34, s34, 0x8000
    buffer_load_dwordx4 a[240:243], v110, s[60:63], s34 offen
    s_add_u32 s34, s34, 0x8000
    buffer_load_dwordx4 a[244:247], v110, s[60:63], s34 offen
    s_add_u32 s34, s34, 0x8000
    buffer_load_dwordx4 a[248:251], v110, s[60:63], s34 offen
    s_add_u32 s34, s34, 0x8000
    buffer_load_dwordx4 a[252:255], v110, s[60:63], s34 offen
    s_add_u32 s34, s34, 0x8000
    s_mov_b32 s60, s72
    s_and_b32 s61, s73, 0xffff
    s_mov_b32 s62, 0x400000
    s_mov_b32 s63, 0x00020000
    s_lshl_b32 s35, s29, 20
    s_add_u32 s35, s35, s32
    buffer_load_dwordx4 v[24:27], v110, s[60:63], s35 offen
    s_add_u32 s35, s35, 0x8000
    buffer_load_dwordx4 v[28:31], v110, s[60:63], s35 offen
    s_add_u32 s35, s35, 0x8000
    buffer_load_dwordx4 v[32:35], v110, s[60:63], s35 offen
    s_add_u32 s35, s35, 0x8000
    buffer_load_dwordx4 v[36:39], v110, s[60:63], s35 offen
    s_add_u32 s35, s35, 0x8000
    buffer_load_dwordx4 v[40:43], v110, s[60:63], s35 offen
    s_add_u32 s35, s35, 0x8000
    buffer_load_dwordx4 v[44:47], v110, s[60:63], s35 offen
    s_add_u32 s35, s35, 0x8000
    buffer_load_dwordx4 v[48:51], v110, s[60:63], s35 offen
    s_add_u32 s35, s35, 0x8000
    buffer_load_dwordx4 v[52:55], v110, s[60:63], s35 offen
    s_add_u32 s35, s35, 0x8000
    buffer_load_dwordx4 v[56:59], v110, s[60:63], s35 offen
    s_add_u32 s35, s35, 0x8000
    buffer_load_dwordx4 v[60:63], v110, s[60:63], s35 offen
    s_add_u32 s35, s35, 0x8000
    buffer_load_dwordx4 v[64:67], v110, s[60:63], s35 offen
    s_add_u32 s35, s35, 0x8000
    buffer_load_dwordx4 v[68:71], v110, s[60:63], s35 offen
    s_add_u32 s35, s35, 0x8000
    buffer_load_dwordx4 v[72:75], v110, s[60:63], s35 offen
    s_add_u32 s35, s35, 0x8000
    buffer_load_dwordx4 v[76:79], v110, s[60:63], s35 offen
    s_add_u32 s35, s35, 0x8000
    buffer_load_dwordx4 v[80:83], v110, s[60:63], s35 offen
    s_add_u32 s35, s35, 0x8000
    buffer_load_dwordx4 v[84:87], v110, s[60:63], s35 offen
    s_add_u32 s35, s35, 0x8000
    s_mov_b32 s64, s74
    s_and_b32 s65, s75, 0xffff
    s_mov_b32 s66, 0x400000
    s_mov_b32 s67, 0x00020000
    s_lshl_b32 s34, s28, 17
    s_lshl_b32 s36, s29, 8
    s_add_u32 s34, s34, s36
    buffer_load_dwordx4 v[128:131], v111, s[64:67], s34 offen
    s_add_u32 s34, s34, 4096
    buffer_load_dwordx4 v[132:135], v111, s[64:67], s34 offen
    s_add_u32 s34, s34, 4096
    buffer_load_dwordx4 v[144:147], v111, s[64:67], s34 offen
    s_add_u32 s34, s34, 4096
    buffer_load_dwordx4 v[148:151], v111, s[64:67], s34 offen
    s_add_u32 s34, s34, 4096
    buffer_load_dwordx4 v[160:163], v111, s[64:67], s34 offen
    s_add_u32 s34, s34, 4096
    buffer_load_dwordx4 v[164:167], v111, s[64:67], s34 offen
    s_add_u32 s34, s34, 4096
    buffer_load_dwordx4 v[176:179], v111, s[64:67], s34 offen
    s_add_u32 s34, s34, 4096
    buffer_load_dwordx4 v[180:183], v111, s[64:67], s34 offen
    s_add_u32 s34, s34, 4096
    buffer_load_dwordx4 v[192:195], v111, s[64:67], s34 offen
    s_add_u32 s34, s34, 4096
    buffer_load_dwordx4 v[196:199], v111, s[64:67], s34 offen
    s_add_u32 s34, s34, 4096
    buffer_load_dwordx4 v[208:211], v111, s[64:67], s34 offen
    s_add_u32 s34, s34, 4096
    buffer_load_dwordx4 v[212:215], v111, s[64:67], s34 offen
    s_add_u32 s34, s34, 4096
    buffer_load_dwordx4 v[224:227], v111, s[64:67], s34 offen
    s_add_u32 s34, s34, 4096
    buffer_load_dwordx4 v[228:231], v111, s[64:67], s34 offen
    s_add_u32 s34, s34, 4096
    buffer_load_dwordx4 v[240:243], v111, s[64:67], s34 offen
    s_add_u32 s34, s34, 4096
    buffer_load_dwordx4 v[244:247], v111, s[64:67], s34 offen
    s_add_u32 s34, s34, 4096
    buffer_load_dwordx4 v[136:139], v111, s[64:67], s34 offen
    s_add_u32 s34, s34, 4096
    buffer_load_dwordx4 v[140:143], v111, s[64:67], s34 offen
    s_add_u32 s34, s34, 4096
    buffer_load_dwordx4 v[152:155], v111, s[64:67], s34 offen
    s_add_u32 s34, s34, 4096
    buffer_load_dwordx4 v[156:159], v111, s[64:67], s34 offen
    s_add_u32 s34, s34, 4096
    buffer_load_dwordx4 v[168:171], v111, s[64:67], s34 offen
    s_add_u32 s34, s34, 4096
    buffer_load_dwordx4 v[172:175], v111, s[64:67], s34 offen
    s_add_u32 s34, s34, 4096
    buffer_load_dwordx4 v[184:187], v111, s[64:67], s34 offen
    s_add_u32 s34, s34, 4096
    buffer_load_dwordx4 v[188:191], v111, s[64:67], s34 offen
    s_add_u32 s34, s34, 4096
    buffer_load_dwordx4 v[200:203], v111, s[64:67], s34 offen
    s_add_u32 s34, s34, 4096
    buffer_load_dwordx4 v[204:207], v111, s[64:67], s34 offen
    s_add_u32 s34, s34, 4096
    buffer_load_dwordx4 v[216:219], v111, s[64:67], s34 offen
    s_add_u32 s34, s34, 4096
    buffer_load_dwordx4 v[220:223], v111, s[64:67], s34 offen
    s_add_u32 s34, s34, 4096
    buffer_load_dwordx4 v[232:235], v111, s[64:67], s34 offen
    s_add_u32 s34, s34, 4096
    buffer_load_dwordx4 v[236:239], v111, s[64:67], s34 offen
    s_add_u32 s34, s34, 4096
    buffer_load_dwordx4 v[248:251], v111, s[64:67], s34 offen
    s_add_u32 s34, s34, 4096
    buffer_load_dwordx4 v[252:255], v111, s[64:67], s34 offen
    s_add_u32 s34, s34, 4096
    v_and_b32 v100, 15, v97
    v_lshrrev_b32 v101, 4, v97
    v_lshrrev_b32 v102, 2, v100
    v_and_b32 v103, 3, v100
    v_lshl_add_u32 v102, v102, 3, v103
    v_mov_b32 v104, 0x7ffffff0
    v_cmp_gt_u32 s[40:41], 8, v100
    v_cmp_gt_u32 s[42:43], 2, v101
    v_lshl_add_u32 v0, v96, 11, v98
    v_and_b32 v105, 7, v100
    v_mov_b32 v1, v98
    s_movk_i32 s32, 1536
    v_mul_lo_u32 v4, v96, s32
    v_lshl_add_u32 v106, v101, 3, v105
    v_lshl_add_u32 v4, v106, 4, v4
    v_add_u32 v4, 8192, v4
    v_lshlrev_b32 v107, 3, v97
    v_lshlrev_b32 v107, 4, v106
    v_add_u32 v107, 149504, v107
    v_cndmask_b32 v4, v107, v4, s[40:41]
    v_lshrrev_b32 v107, 3, v100
    v_lshlrev_b32 v9, 9, v107
    v_lshl_add_u32 v9, v106, 4, v9
    v_add_u32 v9, 8704, v9
    v_lshrrev_b32 v103, 1, v101
    v_lshl_add_u32 v15, v103, 3, v105
    v_lshlrev_b32 v15, 4, v15
    v_and_b32 v103, 1, v101
    v_lshl_add_u32 v103, v103, 1, v107
    v_lshl_add_u32 v15, v103, 2, v15
    v_add_u32 v15, 8192, v15
    v_lshlrev_b32 v5, 8, v102
    v_lshl_add_u32 v5, v96, 6, v5
    v_lshl_add_u32 v5, v101, 4, v5
    v_lshl_add_u32 v6, v96, 5, v102
    v_lshlrev_b32 v6, 6, v6
    v_lshl_add_u32 v6, v101, 4, v6
    v_lshlrev_b32 v7, 13, v100
    v_lshl_add_u32 v7, v96, 6, v7
    v_lshl_add_u32 v7, v101, 4, v7
    v_cndmask_b32 v7, v104, v7, s[40:41]
    v_lshl_add_u32 v8, v96, 5, v102
    v_lshlrev_b32 v8, 4, v8
    v_lshl_add_u32 v8, v101, 2, v8
    v_lshrrev_b32 v106, 1, v105
    v_lshlrev_b32 v106, 2, v106
    v_and_b32 v103, 1, v105
    v_add_u32 v106, v106, v103
    v_and_b32 v103, 1, v96
    v_lshlrev_b32 v103, 1, v103
    v_lshrrev_b32 v105, 1, v101
    v_add_u32 v103, v103, v105
    v_lshl_add_u32 v103, v103, 4, v106
    v_lshlrev_b32 v10, 4, v103
    v_lshrrev_b32 v103, 1, v96
    v_lshl_add_u32 v10, v103, 10, v10
    v_and_b32 v103, 1, v101
    v_lshl_add_u32 v10, v103, 3, v10
    v_add_u32 v10, 14336, v10
    v_lshlrev_b32 v103, 6, v101
    v_lshl_add_u32 v103, v105, 0, v103
    v_lshlrev_b32 v103, 6, v97
    v_add_u32 v103, 149504, v103
    v_cndmask_b32 v10, v103, v10, s[40:41]
    v_add_u32 v11, 14336, v98
    v_lshrrev_b32 v103, 3, v100
    v_lshl_add_u32 v103, v96, 3, v103
    v_lshlrev_b32 v12, 14, v103
    v_lshl_add_u32 v12, v101, 12, v12
    v_and_b32 v103, 7, v100
    v_lshl_add_u32 v12, v103, 4, v12
    v_lshrrev_b32 v12, 1, v12
    v_bfe_u32 v103, v97, 1, 1
    v_lshlrev_b32 v103, 1, v103
    v_lshl_add_u32 v103, v96, 2, v103
    v_and_b32 v105, 1, v101
    v_add_u32 v103, v103, v105
    v_lshlrev_b32 v13, 4, v103
    v_bfe_u32 v103, v97, 2, 1
    v_lshlrev_b32 v103, 1, v103
    v_lshrrev_b32 v105, 1, v101
    v_add_u32 v103, v103, v105
    v_lshl_add_u32 v13, v103, 2, v13
    v_and_b32 v103, 9, v97
    v_cmp_eq_u32 vcc, 0, v103
    s_nop 1
    v_cndmask_b32 v13, v104, v13, vcc
    v_bfe_u32 v105, v100, 1, 1
    v_cmp_eq_u32 vcc, 0, v105
    v_mov_b32 v103, 0xeeee
    v_mov_b32 v88, 0x4444
    v_cndmask_b32 v88, v103, v88, vcc
    v_bfe_u32 v103, v100, 1, 2
    v_and_b32 v105, 1, v100
    v_lshlrev_b32 v105, 4, v105
    v_mov_b32 v106, 0x3f80
    v_lshlrev_b32 v105, v105, v106
    v_cmp_eq_u32 vcc, v103, v101
    s_nop 1
    v_cndmask_b32 v90, 0, v105, vcc
    v_mov_b32 v91, 0
    v_mov_b32 v92, 0
    v_mov_b32 v93, v90
    s_mov_b32 s30, 0
    s_lshl_b32 s46, s28, 8
    s_lshl_b32 s48, s28, 13
    s_add_u32 s47, s48, 0x3000000
    s_add_u32 s48, s48, 0x3fc0000
    s_add_u32 s64, s46, 0x228000
    s_add_u32 s65, s46, 0x230000
    s_add_u32 s65, s65, s29
    s_mov_b32 s68, s65
    s_add_u32 s65, s29, 0x23a000
    s_lshl_b32 s66, s29, 11
    s_mov_b32 s67, 0x01010101
    s_add_u32 s49, s46, 0x5000000
    s_lshl_b32 s50, s28, 11
    s_add_u32 s50, s50, 0x53e0000
    s_mov_b32 s51, 0x240000
    s_lshl_b32 s52, s28, 8
    s_lshl_b32 s57, s28, 14
    s_add_u32 s57, s57, 0x380000
    s_add_u32 s57, s57, s66
    s_mov_b32 s54, 0x3db504f3
    s_mov_b32 s55, 0x3fb8aa3b
    s_mov_b32 s56, 0xff800000
    s_mov_b64 s[36:37], exec
    s_lshr_b32 s92, s28, 3
    s_add_u32 s92, s92, 0
    s_and_b32 s92, s92, 3
    s_lshl_b32 s92, s92, 15
    s_lshr_b32 s40, s28, 1
    s_sub_u32 s40, s40, 0
    s_and_b32 s40, s40, 3
    s_lshl_b32 s40, s40, 10
    s_lshr_b32 s93, s28, 3
    s_add_u32 s93, s93, 1
    s_and_b32 s93, s93, 3
    s_lshl_b32 s93, s93, 15
    s_lshr_b32 s41, s28, 1
    s_sub_u32 s41, s41, 1
    s_and_b32 s41, s41, 3
    s_lshl_b32 s41, s41, 10
    s_lshr_b32 s94, s28, 3
    s_add_u32 s94, s94, 2
    s_and_b32 s94, s94, 3
    s_lshl_b32 s94, s94, 15
    s_lshr_b32 s42, s28, 1
    s_sub_u32 s42, s42, 2
    s_and_b32 s42, s42, 3
    s_lshl_b32 s42, s42, 10
    s_lshr_b32 s95, s28, 3
    s_add_u32 s95, s95, 3
    s_and_b32 s95, s95, 3
    s_lshl_b32 s95, s95, 15
    s_lshr_b32 s43, s28, 1
    s_sub_u32 s43, s43, 3
    s_and_b32 s43, s43, 3
    s_lshl_b32 s43, s43, 10
    s_waitcnt vmcnt(63)
    ds_write_b128 v0, v[16:19]
    ds_write_b128 v0, v[20:23] offset:1024
    ds_write_b128 v112, a[0:3] offset:0
    ds_write_b128 v112, a[4:7] offset:1024
    ds_write_b128 v112, a[8:11] offset:2048
    ds_write_b128 v112, a[12:15] offset:3072
    ds_write_b128 v112, a[16:19] offset:4096
    ds_write_b128 v112, a[20:23] offset:5120
    ds_write_b128 v112, a[24:27] offset:6144
    ds_write_b128 v112, a[28:31] offset:7168
    ds_write_b128 v112, a[32:35] offset:8192
    ds_write_b128 v112, a[36:39] offset:9216
    ds_write_b128 v112, a[40:43] offset:10240
    ds_write_b128 v112, a[44:47] offset:11264
    ds_write_b128 v112, a[48:51] offset:12288
    ds_write_b128 v112, a[52:55] offset:13312
    ds_write_b128 v112, a[56:59] offset:14336
    ds_write_b128 v112, a[60:63] offset:15360
    ds_write_b128 v112, a[64:67] offset:16384
    ds_write_b128 v112, a[68:71] offset:17408
    ds_write_b128 v112, a[72:75] offset:18432
    ds_write_b128 v112, a[76:79] offset:19456
    ds_write_b128 v112, a[80:83] offset:20480
    ds_write_b128 v112, a[84:87] offset:21504
    ds_write_b128 v112, a[88:91] offset:22528
    ds_write_b128 v112, a[92:95] offset:23552
    ds_write_b128 v112, a[96:99] offset:24576
    ds_write_b128 v112, a[100:103] offset:25600
    ds_write_b128 v112, a[104:107] offset:26624
    ds_write_b128 v112, a[108:111] offset:27648
    ds_write_b128 v112, a[112:115] offset:28672
    ds_write_b128 v112, a[116:119] offset:29696
    ds_write_b128 v112, a[120:123] offset:30720
    ds_write_b128 v112, a[124:127] offset:31744
    s_waitcnt lgkmcnt(0)
    s_barrier
    ds_read_b64_tr_b16 a[0:1], v113 offset:0
    ds_read_b64_tr_b16 a[2:3], v113 offset:1024
    ds_read_b64_tr_b16 a[4:5], v113 offset:8192
    ds_read_b64_tr_b16 a[6:7], v113 offset:9216
    ds_read_b64_tr_b16 a[8:9], v113 offset:16384
    ds_read_b64_tr_b16 a[10:11], v113 offset:17408
    ds_read_b64_tr_b16 a[12:13], v113 offset:24576
    ds_read_b64_tr_b16 a[14:15], v113 offset:25600
    ds_read_b64_tr_b16 a[16:17], v113 offset:32768
    ds_read_b64_tr_b16 a[18:19], v113 offset:33792
    ds_read_b64_tr_b16 a[20:21], v113 offset:40960
    ds_read_b64_tr_b16 a[22:23], v113 offset:41984
    ds_read_b64_tr_b16 a[24:25], v113 offset:49152
    ds_read_b64_tr_b16 a[26:27], v113 offset:50176
    ds_read_b64_tr_b16 a[28:29], v113 offset:57344
    ds_read_b64_tr_b16 a[30:31], v113 offset:58368
    ds_read_b64_tr_b16 a[32:33], v114 offset:0
    ds_read_b64_tr_b16 a[34:35], v114 offset:1024
    ds_read_b64_tr_b16 a[36:37], v114 offset:8192
    ds_read_b64_tr_b16 a[38:39], v114 offset:9216
    ds_read_b64_tr_b16 a[40:41], v114 offset:16384
    ds_read_b64_tr_b16 a[42:43], v114 offset:17408
    ds_read_b64_tr_b16 a[44:45], v114 offset:24576
    ds_read_b64_tr_b16 a[46:47], v114 offset:25600
    ds_read_b64_tr_b16 a[48:49], v114 offset:32768
    ds_read_b64_tr_b16 a[50:51], v114 offset:33792
    ds_read_b64_tr_b16 a[52:53], v114 offset:40960
    ds_read_b64_tr_b16 a[54:55], v114 offset:41984
    ds_read_b64_tr_b16 a[56:57], v114 offset:49152
    ds_read_b64_tr_b16 a[58:59], v114 offset:50176
    ds_read_b64_tr_b16 a[60:61], v114 offset:57344
    ds_read_b64_tr_b16 a[62:63], v114 offset:58368
    ds_read_b64_tr_b16 a[64:65], v113 offset:8
    ds_read_b64_tr_b16 a[66:67], v113 offset:1032
    ds_read_b64_tr_b16 a[68:69], v113 offset:8200
    ds_read_b64_tr_b16 a[70:71], v113 offset:9224
    ds_read_b64_tr_b16 a[72:73], v113 offset:16392
    ds_read_b64_tr_b16 a[74:75], v113 offset:17416
    ds_read_b64_tr_b16 a[76:77], v113 offset:24584
    ds_read_b64_tr_b16 a[78:79], v113 offset:25608
    ds_read_b64_tr_b16 a[80:81], v113 offset:32776
    ds_read_b64_tr_b16 a[82:83], v113 offset:33800
    ds_read_b64_tr_b16 a[84:85], v113 offset:40968
    ds_read_b64_tr_b16 a[86:87], v113 offset:41992
    ds_read_b64_tr_b16 a[88:89], v113 offset:49160
    ds_read_b64_tr_b16 a[90:91], v113 offset:50184
    ds_read_b64_tr_b16 a[92:93], v113 offset:57352
    ds_read_b64_tr_b16 a[94:95], v113 offset:58376
    ds_read_b64_tr_b16 a[96:97], v114 offset:8
    ds_read_b64_tr_b16 a[98:99], v114 offset:1032
    ds_read_b64_tr_b16 a[100:101], v114 offset:8200
    ds_read_b64_tr_b16 a[102:103], v114 offset:9224
    ds_read_b64_tr_b16 a[104:105], v114 offset:16392
    ds_read_b64_tr_b16 a[106:107], v114 offset:17416
    ds_read_b64_tr_b16 a[108:109], v114 offset:24584
    ds_read_b64_tr_b16 a[110:111], v114 offset:25608
    ds_read_b64_tr_b16 a[112:113], v114 offset:32776
    ds_read_b64_tr_b16 a[114:115], v114 offset:33800
    ds_read_b64_tr_b16 a[116:117], v114 offset:40968
    ds_read_b64_tr_b16 a[118:119], v114 offset:41992
    ds_read_b64_tr_b16 a[120:121], v114 offset:49160
    ds_read_b64_tr_b16 a[122:123], v114 offset:50184
    ds_read_b64_tr_b16 a[124:125], v114 offset:57352
    ds_read_b64_tr_b16 a[126:127], v114 offset:58376
    s_waitcnt lgkmcnt(0)
    s_barrier
    s_waitcnt vmcnt(48)
    ds_write_b128 v112, a[128:131] offset:0
    ds_write_b128 v112, a[132:135] offset:1024
    ds_write_b128 v112, a[136:139] offset:2048
    ds_write_b128 v112, a[140:143] offset:3072
    ds_write_b128 v112, a[144:147] offset:4096
    ds_write_b128 v112, a[148:151] offset:5120
    ds_write_b128 v112, a[152:155] offset:6144
    ds_write_b128 v112, a[156:159] offset:7168
    ds_write_b128 v112, a[160:163] offset:8192
    ds_write_b128 v112, a[164:167] offset:9216
    ds_write_b128 v112, a[168:171] offset:10240
    ds_write_b128 v112, a[172:175] offset:11264
    ds_write_b128 v112, a[176:179] offset:12288
    ds_write_b128 v112, a[180:183] offset:13312
    ds_write_b128 v112, a[184:187] offset:14336
    ds_write_b128 v112, a[188:191] offset:15360
    ds_write_b128 v112, a[192:195] offset:16384
    ds_write_b128 v112, a[196:199] offset:17408
    ds_write_b128 v112, a[200:203] offset:18432
    ds_write_b128 v112, a[204:207] offset:19456
    ds_write_b128 v112, a[208:211] offset:20480
    ds_write_b128 v112, a[212:215] offset:21504
    ds_write_b128 v112, a[216:219] offset:22528
    ds_write_b128 v112, a[220:223] offset:23552
    ds_write_b128 v112, a[224:227] offset:24576
    ds_write_b128 v112, a[228:231] offset:25600
    ds_write_b128 v112, a[232:235] offset:26624
    ds_write_b128 v112, a[236:239] offset:27648
    ds_write_b128 v112, a[240:243] offset:28672
    ds_write_b128 v112, a[244:247] offset:29696
    ds_write_b128 v112, a[248:251] offset:30720
    ds_write_b128 v112, a[252:255] offset:31744
    s_waitcnt lgkmcnt(0)
    s_barrier
    ds_read_b64_tr_b16 a[128:129], v113 offset:0
    ds_read_b64_tr_b16 a[130:131], v113 offset:1024
    ds_read_b64_tr_b16 a[132:133], v113 offset:8192
    ds_read_b64_tr_b16 a[134:135], v113 offset:9216
    ds_read_b64_tr_b16 a[136:137], v113 offset:16384
    ds_read_b64_tr_b16 a[138:139], v113 offset:17408
    ds_read_b64_tr_b16 a[140:141], v113 offset:24576
    ds_read_b64_tr_b16 a[142:143], v113 offset:25600
    ds_read_b64_tr_b16 a[144:145], v113 offset:32768
    ds_read_b64_tr_b16 a[146:147], v113 offset:33792
    ds_read_b64_tr_b16 a[148:149], v113 offset:40960
    ds_read_b64_tr_b16 a[150:151], v113 offset:41984
    ds_read_b64_tr_b16 a[152:153], v113 offset:49152
    ds_read_b64_tr_b16 a[154:155], v113 offset:50176
    ds_read_b64_tr_b16 a[156:157], v113 offset:57344
    ds_read_b64_tr_b16 a[158:159], v113 offset:58368
    ds_read_b64_tr_b16 a[160:161], v114 offset:0
    ds_read_b64_tr_b16 a[162:163], v114 offset:1024
    ds_read_b64_tr_b16 a[164:165], v114 offset:8192
    ds_read_b64_tr_b16 a[166:167], v114 offset:9216
    ds_read_b64_tr_b16 a[168:169], v114 offset:16384
    ds_read_b64_tr_b16 a[170:171], v114 offset:17408
    ds_read_b64_tr_b16 a[172:173], v114 offset:24576
    ds_read_b64_tr_b16 a[174:175], v114 offset:25600
    ds_read_b64_tr_b16 a[176:177], v114 offset:32768
    ds_read_b64_tr_b16 a[178:179], v114 offset:33792
    ds_read_b64_tr_b16 a[180:181], v114 offset:40960
    ds_read_b64_tr_b16 a[182:183], v114 offset:41984
    ds_read_b64_tr_b16 a[184:185], v114 offset:49152
    ds_read_b64_tr_b16 a[186:187], v114 offset:50176
    ds_read_b64_tr_b16 a[188:189], v114 offset:57344
    ds_read_b64_tr_b16 a[190:191], v114 offset:58368
    ds_read_b64_tr_b16 a[192:193], v113 offset:8
    ds_read_b64_tr_b16 a[194:195], v113 offset:1032
    ds_read_b64_tr_b16 a[196:197], v113 offset:8200
    ds_read_b64_tr_b16 a[198:199], v113 offset:9224
    ds_read_b64_tr_b16 a[200:201], v113 offset:16392
    ds_read_b64_tr_b16 a[202:203], v113 offset:17416
    ds_read_b64_tr_b16 a[204:205], v113 offset:24584
    ds_read_b64_tr_b16 a[206:207], v113 offset:25608
    ds_read_b64_tr_b16 a[208:209], v113 offset:32776
    ds_read_b64_tr_b16 a[210:211], v113 offset:33800
    ds_read_b64_tr_b16 a[212:213], v113 offset:40968
    ds_read_b64_tr_b16 a[214:215], v113 offset:41992
    ds_read_b64_tr_b16 a[216:217], v113 offset:49160
    ds_read_b64_tr_b16 a[218:219], v113 offset:50184
    ds_read_b64_tr_b16 a[220:221], v113 offset:57352
    ds_read_b64_tr_b16 a[222:223], v113 offset:58376
    ds_read_b64_tr_b16 a[224:225], v114 offset:8
    ds_read_b64_tr_b16 a[226:227], v114 offset:1032
    ds_read_b64_tr_b16 a[228:229], v114 offset:8200
    ds_read_b64_tr_b16 a[230:231], v114 offset:9224
    ds_read_b64_tr_b16 a[232:233], v114 offset:16392
    ds_read_b64_tr_b16 a[234:235], v114 offset:17416
    ds_read_b64_tr_b16 a[236:237], v114 offset:24584
    ds_read_b64_tr_b16 a[238:239], v114 offset:25608
    ds_read_b64_tr_b16 a[240:241], v114 offset:32776
    ds_read_b64_tr_b16 a[242:243], v114 offset:33800
    ds_read_b64_tr_b16 a[244:245], v114 offset:40968
    ds_read_b64_tr_b16 a[246:247], v114 offset:41992
    ds_read_b64_tr_b16 a[248:249], v114 offset:49160
    ds_read_b64_tr_b16 a[250:251], v114 offset:50184
    ds_read_b64_tr_b16 a[252:253], v114 offset:57352
    ds_read_b64_tr_b16 a[254:255], v114 offset:58376
    s_waitcnt lgkmcnt(0)
    s_barrier
    s_waitcnt vmcnt(32)
    s_cmp_lg_u32 s29, 0
    s_cbranch_scc1 K3_PW1
    ds_write_b128 v2, a[0:3] offset:0
    ds_write_b128 v2, a[4:7] offset:1024
    ds_write_b128 v2, a[64:67] offset:2048
    ds_write_b128 v2, a[68:71] offset:3072
    ds_write_b128 v2, a[8:11] offset:4096
    ds_write_b128 v2, a[12:15] offset:5120
    ds_write_b128 v2, a[72:75] offset:6144
    ds_write_b128 v2, a[76:79] offset:7168
    ds_write_b128 v2, a[128:131] offset:8192
    ds_write_b128 v2, a[132:135] offset:9216
    ds_write_b128 v2, a[192:195] offset:10240
    ds_write_b128 v2, a[196:199] offset:11264
    ds_write_b128 v2, a[136:139] offset:12288
    ds_write_b128 v2, a[140:143] offset:13312
    ds_write_b128 v2, a[200:203] offset:14336
    ds_write_b128 v2, a[204:207] offset:15360
    ds_write_b128 v112, v[24:27] offset:16384
    ds_write_b128 v112, v[28:31] offset:17408
    ds_write_b128 v112, v[32:35] offset:18432
    ds_write_b128 v112, v[36:39] offset:19456
    ds_write_b128 v112, v[40:43] offset:20480
    ds_write_b128 v112, v[44:47] offset:21504
    ds_write_b128 v112, v[48:51] offset:22528
    ds_write_b128 v112, v[52:55] offset:23552
    ds_write_b128 v112, v[56:59] offset:24576
    ds_write_b128 v112, v[60:63] offset:25600
    ds_write_b128 v112, v[64:67] offset:26624
    ds_write_b128 v112, v[68:71] offset:27648
    ds_write_b128 v112, v[72:75] offset:28672
    ds_write_b128 v112, v[76:79] offset:29696
    ds_write_b128 v112, v[80:83] offset:30720
    ds_write_b128 v112, v[84:87] offset:31744
    s_waitcnt lgkmcnt(0)
    s_barrier
    ds_read_b64_tr_b16 a[0:1], v113 offset:16384
    ds_read_b64_tr_b16 a[2:3], v113 offset:17408
    ds_read_b64_tr_b16 a[64:65], v113 offset:16392
    ds_read_b64_tr_b16 a[66:67], v113 offset:17416
    ds_read_b64_tr_b16 a[4:5], v113 offset:24576
    ds_read_b64_tr_b16 a[6:7], v113 offset:25600
    ds_read_b64_tr_b16 a[68:69], v113 offset:24584
    ds_read_b64_tr_b16 a[70:71], v113 offset:25608
    ds_read_b64_tr_b16 a[8:9], v113 offset:49152
    ds_read_b64_tr_b16 a[10:11], v113 offset:50176
    ds_read_b64_tr_b16 a[72:73], v113 offset:49160
    ds_read_b64_tr_b16 a[74:75], v113 offset:50184
    ds_read_b64_tr_b16 a[12:13], v113 offset:57344
    ds_read_b64_tr_b16 a[14:15], v113 offset:58368
    ds_read_b64_tr_b16 a[76:77], v113 offset:57352
    ds_read_b64_tr_b16 a[78:79], v113 offset:58376
    ds_read_b64_tr_b16 a[128:129], v114 offset:16384
    ds_read_b64_tr_b16 a[130:131], v114 offset:17408
    ds_read_b64_tr_b16 a[192:193], v114 offset:16392
    ds_read_b64_tr_b16 a[194:195], v114 offset:17416
    ds_read_b64_tr_b16 a[132:133], v114 offset:24576
    ds_read_b64_tr_b16 a[134:135], v114 offset:25600
    ds_read_b64_tr_b16 a[196:197], v114 offset:24584
    ds_read_b64_tr_b16 a[198:199], v114 offset:25608
    ds_read_b64_tr_b16 a[136:137], v114 offset:49152
    ds_read_b64_tr_b16 a[138:139], v114 offset:50176
    ds_read_b64_tr_b16 a[200:201], v114 offset:49160
    ds_read_b64_tr_b16 a[202:203], v114 offset:50184
    ds_read_b64_tr_b16 a[140:141], v114 offset:57344
    ds_read_b64_tr_b16 a[142:143], v114 offset:58368
    ds_read_b64_tr_b16 a[204:205], v114 offset:57352
    ds_read_b64_tr_b16 a[206:207], v114 offset:58376
    s_waitcnt lgkmcnt(0)
    s_barrier
    s_branch K3_PWE
K3_PW1:
    s_cmp_lg_u32 s29, 1
    s_cbranch_scc1 K3_PW2
    ds_write_b128 v2, a[16:19] offset:0
    ds_write_b128 v2, a[20:23] offset:1024
    ds_write_b128 v2, a[80:83] offset:2048
    ds_write_b128 v2, a[84:87] offset:3072
    ds_write_b128 v2, a[24:27] offset:4096
    ds_write_b128 v2, a[28:31] offset:5120
    ds_write_b128 v2, a[88:91] offset:6144
    ds_write_b128 v2, a[92:95] offset:7168
    ds_write_b128 v2, a[144:147] offset:8192
    ds_write_b128 v2, a[148:151] offset:9216
    ds_write_b128 v2, a[208:211] offset:10240
    ds_write_b128 v2, a[212:215] offset:11264
    ds_write_b128 v2, a[152:155] offset:12288
    ds_write_b128 v2, a[156:159] offset:13312
    ds_write_b128 v2, a[216:219] offset:14336
    ds_write_b128 v2, a[220:223] offset:15360
    ds_write_b128 v112, v[24:27] offset:16384
    ds_write_b128 v112, v[28:31] offset:17408
    ds_write_b128 v112, v[32:35] offset:18432
    ds_write_b128 v112, v[36:39] offset:19456
    ds_write_b128 v112, v[40:43] offset:20480
    ds_write_b128 v112, v[44:47] offset:21504
    ds_write_b128 v112, v[48:51] offset:22528
    ds_write_b128 v112, v[52:55] offset:23552
    ds_write_b128 v112, v[56:59] offset:24576
    ds_write_b128 v112, v[60:63] offset:25600
    ds_write_b128 v112, v[64:67] offset:26624
    ds_write_b128 v112, v[68:71] offset:27648
    ds_write_b128 v112, v[72:75] offset:28672
    ds_write_b128 v112, v[76:79] offset:29696
    ds_write_b128 v112, v[80:83] offset:30720
    ds_write_b128 v112, v[84:87] offset:31744
    s_waitcnt lgkmcnt(0)
    s_barrier
    ds_read_b64_tr_b16 a[24:25], v113 offset:16384
    ds_read_b64_tr_b16 a[26:27], v113 offset:17408
    ds_read_b64_tr_b16 a[88:89], v113 offset:16392
    ds_read_b64_tr_b16 a[90:91], v113 offset:17416
    ds_read_b64_tr_b16 a[28:29], v113 offset:24576
    ds_read_b64_tr_b16 a[30:31], v113 offset:25600
    ds_read_b64_tr_b16 a[92:93], v113 offset:24584
    ds_read_b64_tr_b16 a[94:95], v113 offset:25608
    ds_read_b64_tr_b16 a[16:17], v113 offset:49152
    ds_read_b64_tr_b16 a[18:19], v113 offset:50176
    ds_read_b64_tr_b16 a[80:81], v113 offset:49160
    ds_read_b64_tr_b16 a[82:83], v113 offset:50184
    ds_read_b64_tr_b16 a[20:21], v113 offset:57344
    ds_read_b64_tr_b16 a[22:23], v113 offset:58368
    ds_read_b64_tr_b16 a[84:85], v113 offset:57352
    ds_read_b64_tr_b16 a[86:87], v113 offset:58376
    ds_read_b64_tr_b16 a[144:145], v114 offset:16384
    ds_read_b64_tr_b16 a[146:147], v114 offset:17408
    ds_read_b64_tr_b16 a[208:209], v114 offset:16392
    ds_read_b64_tr_b16 a[210:211], v114 offset:17416
    ds_read_b64_tr_b16 a[148:149], v114 offset:24576
    ds_read_b64_tr_b16 a[150:151], v114 offset:25600
    ds_read_b64_tr_b16 a[212:213], v114 offset:24584
    ds_read_b64_tr_b16 a[214:215], v114 offset:25608
    ds_read_b64_tr_b16 a[152:153], v114 offset:49152
    ds_read_b64_tr_b16 a[154:155], v114 offset:50176
    ds_read_b64_tr_b16 a[216:217], v114 offset:49160
    ds_read_b64_tr_b16 a[218:219], v114 offset:50184
    ds_read_b64_tr_b16 a[156:157], v114 offset:57344
    ds_read_b64_tr_b16 a[158:159], v114 offset:58368
    ds_read_b64_tr_b16 a[220:221], v114 offset:57352
    ds_read_b64_tr_b16 a[222:223], v114 offset:58376
    s_waitcnt lgkmcnt(0)
    s_barrier
    s_branch K3_PWE
K3_PW2:
    s_cmp_lg_u32 s29, 2
    s_cbranch_scc1 K3_PW3
    ds_write_b128 v2, a[32:35] offset:0
    ds_write_b128 v2, a[36:39] offset:1024
    ds_write_b128 v2, a[96:99] offset:2048
    ds_write_b128 v2, a[100:103] offset:3072
    ds_write_b128 v2, a[40:43] offset:4096
    ds_write_b128 v2, a[44:47] offset:5120
    ds_write_b128 v2, a[104:107] offset:6144
    ds_write_b128 v2, a[108:111] offset:7168
    ds_write_b128 v2, a[160:163] offset:8192
    ds_write_b128 v2, a[164:167] offset:9216
    ds_write_b128 v2, a[224:227] offset:10240
    ds_write_b128 v2, a[228:231] offset:11264
    ds_write_b128 v2, a[168:171] offset:12288
    ds_write_b128 v2, a[172:175] offset:13312
    ds_write_b128 v2, a[232:235] offset:14336
    ds_write_b128 v2, a[236:239] offset:15360
    ds_write_b128 v112, v[24:27] offset:16384
    ds_write_b128 v112, v[28:31] offset:17408
    ds_write_b128 v112, v[32:35] offset:18432
    ds_write_b128 v112, v[36:39] offset:19456
    ds_write_b128 v112, v[40:43] offset:20480
    ds_write_b128 v112, v[44:47] offset:21504
    ds_write_b128 v112, v[48:51] offset:22528
    ds_write_b128 v112, v[52:55] offset:23552
    ds_write_b128 v112, v[56:59] offset:24576
    ds_write_b128 v112, v[60:63] offset:25600
    ds_write_b128 v112, v[64:67] offset:26624
    ds_write_b128 v112, v[68:71] offset:27648
    ds_write_b128 v112, v[72:75] offset:28672
    ds_write_b128 v112, v[76:79] offset:29696
    ds_write_b128 v112, v[80:83] offset:30720
    ds_write_b128 v112, v[84:87] offset:31744
    s_waitcnt lgkmcnt(0)
    s_barrier
    ds_read_b64_tr_b16 a[40:41], v113 offset:16384
    ds_read_b64_tr_b16 a[42:43], v113 offset:17408
    ds_read_b64_tr_b16 a[104:105], v113 offset:16392
    ds_read_b64_tr_b16 a[106:107], v113 offset:17416
    ds_read_b64_tr_b16 a[44:45], v113 offset:24576
    ds_read_b64_tr_b16 a[46:47], v113 offset:25600
    ds_read_b64_tr_b16 a[108:109], v113 offset:24584
    ds_read_b64_tr_b16 a[110:111], v113 offset:25608
    ds_read_b64_tr_b16 a[160:161], v113 offset:49152
    ds_read_b64_tr_b16 a[162:163], v113 offset:50176
    ds_read_b64_tr_b16 a[224:225], v113 offset:49160
    ds_read_b64_tr_b16 a[226:227], v113 offset:50184
    ds_read_b64_tr_b16 a[164:165], v113 offset:57344
    ds_read_b64_tr_b16 a[166:167], v113 offset:58368
    ds_read_b64_tr_b16 a[228:229], v113 offset:57352
    ds_read_b64_tr_b16 a[230:231], v113 offset:58376
    ds_read_b64_tr_b16 a[32:33], v114 offset:16384
    ds_read_b64_tr_b16 a[34:35], v114 offset:17408
    ds_read_b64_tr_b16 a[96:97], v114 offset:16392
    ds_read_b64_tr_b16 a[98:99], v114 offset:17416
    ds_read_b64_tr_b16 a[36:37], v114 offset:24576
    ds_read_b64_tr_b16 a[38:39], v114 offset:25600
    ds_read_b64_tr_b16 a[100:101], v114 offset:24584
    ds_read_b64_tr_b16 a[102:103], v114 offset:25608
    ds_read_b64_tr_b16 a[168:169], v114 offset:49152
    ds_read_b64_tr_b16 a[170:171], v114 offset:50176
    ds_read_b64_tr_b16 a[232:233], v114 offset:49160
    ds_read_b64_tr_b16 a[234:235], v114 offset:50184
    ds_read_b64_tr_b16 a[172:173], v114 offset:57344
    ds_read_b64_tr_b16 a[174:175], v114 offset:58368
    ds_read_b64_tr_b16 a[236:237], v114 offset:57352
    ds_read_b64_tr_b16 a[238:239], v114 offset:58376
    s_waitcnt lgkmcnt(0)
    s_barrier
    s_branch K3_PWE
K3_PW3:
    ds_write_b128 v2, a[48:51] offset:0
    ds_write_b128 v2, a[52:55] offset:1024
    ds_write_b128 v2, a[112:115] offset:2048
    ds_write_b128 v2, a[116:119] offset:3072
    ds_write_b128 v2, a[56:59] offset:4096
    ds_write_b128 v2, a[60:63] offset:5120
    ds_write_b128 v2, a[120:123] offset:6144
    ds_write_b128 v2, a[124:127] offset:7168
    ds_write_b128 v2, a[176:179] offset:8192
    ds_write_b128 v2, a[180:183] offset:9216
    ds_write_b128 v2, a[240:243] offset:10240
    ds_write_b128 v2, a[244:247] offset:11264
    ds_write_b128 v2, a[184:187] offset:12288
    ds_write_b128 v2, a[188:191] offset:13312
    ds_write_b128 v2, a[248:251] offset:14336
    ds_write_b128 v2, a[252:255] offset:15360
    ds_write_b128 v112, v[24:27] offset:16384
    ds_write_b128 v112, v[28:31] offset:17408
    ds_write_b128 v112, v[32:35] offset:18432
    ds_write_b128 v112, v[36:39] offset:19456
    ds_write_b128 v112, v[40:43] offset:20480
    ds_write_b128 v112, v[44:47] offset:21504
    ds_write_b128 v112, v[48:51] offset:22528
    ds_write_b128 v112, v[52:55] offset:23552
    ds_write_b128 v112, v[56:59] offset:24576
    ds_write_b128 v112, v[60:63] offset:25600
    ds_write_b128 v112, v[64:67] offset:26624
    ds_write_b128 v112, v[68:71] offset:27648
    ds_write_b128 v112, v[72:75] offset:28672
    ds_write_b128 v112, v[76:79] offset:29696
    ds_write_b128 v112, v[80:83] offset:30720
    ds_write_b128 v112, v[84:87] offset:31744
    s_waitcnt lgkmcnt(0)
    s_barrier
    ds_read_b64_tr_b16 a[56:57], v113 offset:16384
    ds_read_b64_tr_b16 a[58:59], v113 offset:17408
    ds_read_b64_tr_b16 a[120:121], v113 offset:16392
    ds_read_b64_tr_b16 a[122:123], v113 offset:17416
    ds_read_b64_tr_b16 a[60:61], v113 offset:24576
    ds_read_b64_tr_b16 a[62:63], v113 offset:25600
    ds_read_b64_tr_b16 a[124:125], v113 offset:24584
    ds_read_b64_tr_b16 a[126:127], v113 offset:25608
    ds_read_b64_tr_b16 a[176:177], v113 offset:49152
    ds_read_b64_tr_b16 a[178:179], v113 offset:50176
    ds_read_b64_tr_b16 a[240:241], v113 offset:49160
    ds_read_b64_tr_b16 a[242:243], v113 offset:50184
    ds_read_b64_tr_b16 a[180:181], v113 offset:57344
    ds_read_b64_tr_b16 a[182:183], v113 offset:58368
    ds_read_b64_tr_b16 a[244:245], v113 offset:57352
    ds_read_b64_tr_b16 a[246:247], v113 offset:58376
    ds_read_b64_tr_b16 a[184:185], v114 offset:16384
    ds_read_b64_tr_b16 a[186:187], v114 offset:17408
    ds_read_b64_tr_b16 a[248:249], v114 offset:16392
    ds_read_b64_tr_b16 a[250:251], v114 offset:17416
    ds_read_b64_tr_b16 a[188:189], v114 offset:24576
    ds_read_b64_tr_b16 a[190:191], v114 offset:25600
    ds_read_b64_tr_b16 a[252:253], v114 offset:24584
    ds_read_b64_tr_b16 a[254:255], v114 offset:25608
    ds_read_b64_tr_b16 a[48:49], v114 offset:49152
    ds_read_b64_tr_b16 a[50:51], v114 offset:50176
    ds_read_b64_tr_b16 a[112:113], v114 offset:49160
    ds_read_b64_tr_b16 a[114:115], v114 offset:50184
    ds_read_b64_tr_b16 a[52:53], v114 offset:57344
    ds_read_b64_tr_b16 a[54:55], v114 offset:58368
    ds_read_b64_tr_b16 a[116:117], v114 offset:57352
    ds_read_b64_tr_b16 a[118:119], v114 offset:58376
    s_waitcnt lgkmcnt(0)
    s_barrier
K3_PWE:
    buffer_load_dword v120, off, s[12:15], 0 offset:240 sc1
    buffer_load_dword v121, off, s[12:15], 0 sc1
    buffer_load_dwordx4 v[24:27], v110, s[60:63], s35 offen
    s_add_u32 s35, s35, 0x8000
    buffer_load_dwordx4 v[28:31], v110, s[60:63], s35 offen
    s_add_u32 s35, s35, 0x8000
    buffer_load_dwordx4 v[32:35], v110, s[60:63], s35 offen
    s_add_u32 s35, s35, 0x8000
    buffer_load_dwordx4 v[36:39], v110, s[60:63], s35 offen
    s_add_u32 s35, s35, 0x8000
    buffer_load_dwordx4 v[40:43], v110, s[60:63], s35 offen
    s_add_u32 s35, s35, 0x8000
    buffer_load_dwordx4 v[44:47], v110, s[60:63], s35 offen
    s_add_u32 s35, s35, 0x8000
    buffer_load_dwordx4 v[48:51], v110, s[60:63], s35 offen
    s_add_u32 s35, s35, 0x8000
    buffer_load_dwordx4 v[52:55], v110, s[60:63], s35 offen
    s_add_u32 s35, s35, 0x8000
    buffer_load_dwordx4 v[56:59], v110, s[60:63], s35 offen
    s_add_u32 s35, s35, 0x8000
    buffer_load_dwordx4 v[60:63], v110, s[60:63], s35 offen
    s_add_u32 s35, s35, 0x8000
    buffer_load_dwordx4 v[64:67], v110, s[60:63], s35 offen
    s_add_u32 s35, s35, 0x8000
    buffer_load_dwordx4 v[68:71], v110, s[60:63], s35 offen
    s_add_u32 s35, s35, 0x8000
    buffer_load_dwordx4 v[72:75], v110, s[60:63], s35 offen
    s_add_u32 s35, s35, 0x8000
    buffer_load_dwordx4 v[76:79], v110, s[60:63], s35 offen
    s_add_u32 s35, s35, 0x8000
    buffer_load_dwordx4 v[80:83], v110, s[60:63], s35 offen
    s_add_u32 s35, s35, 0x8000
    buffer_load_dwordx4 v[84:87], v110, s[60:63], s35 offen
    s_add_u32 s35, s35, 0x8000
    s_waitcnt vmcnt(34)
    ds_write_b128 v112, v[128:131] offset:16384
    ds_write_b128 v112, v[132:135] offset:17408
    ds_write_b128 v112, v[144:147] offset:18432
    ds_write_b128 v112, v[148:151] offset:19456
    ds_write_b128 v112, v[160:163] offset:20480
    ds_write_b128 v112, v[164:167] offset:21504
    ds_write_b128 v112, v[176:179] offset:22528
    ds_write_b128 v112, v[180:183] offset:23552
    ds_write_b128 v112, v[192:195] offset:24576
    ds_write_b128 v112, v[196:199] offset:25600
    ds_write_b128 v112, v[208:211] offset:26624
    ds_write_b128 v112, v[212:215] offset:27648
    ds_write_b128 v112, v[224:227] offset:28672
    ds_write_b128 v112, v[228:231] offset:29696
    ds_write_b128 v112, v[240:243] offset:30720
    ds_write_b128 v112, v[244:247] offset:31744
    s_waitcnt lgkmcnt(0)
    ds_read_b64_tr_b16 v[128:129], v115 offset:16384
    ds_read_b64_tr_b16 v[130:131], v115 offset:17408
    ds_read_b64_tr_b16 v[132:133], v115 offset:24576
    ds_read_b64_tr_b16 v[134:135], v115 offset:25600
    ds_read_b64_tr_b16 v[144:145], v115 offset:16392
    ds_read_b64_tr_b16 v[146:147], v115 offset:17416
    ds_read_b64_tr_b16 v[148:149], v115 offset:24584
    ds_read_b64_tr_b16 v[150:151], v115 offset:25608
    ds_read_b64_tr_b16 v[160:161], v116 offset:16384
    ds_read_b64_tr_b16 v[162:163], v116 offset:17408
    ds_read_b64_tr_b16 v[164:165], v116 offset:24576
    ds_read_b64_tr_b16 v[166:167], v116 offset:25600
    ds_read_b64_tr_b16 v[176:177], v116 offset:16392
    ds_read_b64_tr_b16 v[178:179], v116 offset:17416
    ds_read_b64_tr_b16 v[180:181], v116 offset:24584
    ds_read_b64_tr_b16 v[182:183], v116 offset:25608
    ds_read_b64_tr_b16 v[192:193], v117 offset:16384
    ds_read_b64_tr_b16 v[194:195], v117 offset:17408
    ds_read_b64_tr_b16 v[196:197], v117 offset:24576
    ds_read_b64_tr_b16 v[198:199], v117 offset:25600
    ds_read_b64_tr_b16 v[208:209], v117 offset:16392
    ds_read_b64_tr_b16 v[210:211], v117 offset:17416
    ds_read_b64_tr_b16 v[212:213], v117 offset:24584
    ds_read_b64_tr_b16 v[214:215], v117 offset:25608
    ds_read_b64_tr_b16 v[224:225], v118 offset:16384
    ds_read_b64_tr_b16 v[226:227], v118 offset:17408
    ds_read_b64_tr_b16 v[228:229], v118 offset:24576
    ds_read_b64_tr_b16 v[230:231], v118 offset:25600
    ds_read_b64_tr_b16 v[240:241], v118 offset:16392
    ds_read_b64_tr_b16 v[242:243], v118 offset:17416
    ds_read_b64_tr_b16 v[244:245], v118 offset:24584
    ds_read_b64_tr_b16 v[246:247], v118 offset:25608
    s_waitcnt lgkmcnt(0)
    s_waitcnt vmcnt(18)
    ds_write_b128 v112, v[136:139] offset:16384
    ds_write_b128 v112, v[140:143] offset:17408
    ds_write_b128 v112, v[152:155] offset:18432
    ds_write_b128 v112, v[156:159] offset:19456
    ds_write_b128 v112, v[168:171] offset:20480
    ds_write_b128 v112, v[172:175] offset:21504
    ds_write_b128 v112, v[184:187] offset:22528
    ds_write_b128 v112, v[188:191] offset:23552
    ds_write_b128 v112, v[200:203] offset:24576
    ds_write_b128 v112, v[204:207] offset:25600
    ds_write_b128 v112, v[216:219] offset:26624
    ds_write_b128 v112, v[220:223] offset:27648
    ds_write_b128 v112, v[232:235] offset:28672
    ds_write_b128 v112, v[236:239] offset:29696
    ds_write_b128 v112, v[248:251] offset:30720
    ds_write_b128 v112, v[252:255] offset:31744
    s_waitcnt lgkmcnt(0)
    ds_read_b64_tr_b16 v[136:137], v115 offset:16384
    ds_read_b64_tr_b16 v[138:139], v115 offset:17408
    ds_read_b64_tr_b16 v[140:141], v115 offset:24576
    ds_read_b64_tr_b16 v[142:143], v115 offset:25600
    ds_read_b64_tr_b16 v[152:153], v115 offset:16392
    ds_read_b64_tr_b16 v[154:155], v115 offset:17416
    ds_read_b64_tr_b16 v[156:157], v115 offset:24584
    ds_read_b64_tr_b16 v[158:159], v115 offset:25608
    ds_read_b64_tr_b16 v[168:169], v116 offset:16384
    ds_read_b64_tr_b16 v[170:171], v116 offset:17408
    ds_read_b64_tr_b16 v[172:173], v116 offset:24576
    ds_read_b64_tr_b16 v[174:175], v116 offset:25600
    ds_read_b64_tr_b16 v[184:185], v116 offset:16392
    ds_read_b64_tr_b16 v[186:187], v116 offset:17416
    ds_read_b64_tr_b16 v[188:189], v116 offset:24584
    ds_read_b64_tr_b16 v[190:191], v116 offset:25608
    ds_read_b64_tr_b16 v[200:201], v117 offset:16384
    ds_read_b64_tr_b16 v[202:203], v117 offset:17408
    ds_read_b64_tr_b16 v[204:205], v117 offset:24576
    ds_read_b64_tr_b16 v[206:207], v117 offset:25600
    ds_read_b64_tr_b16 v[216:217], v117 offset:16392
    ds_read_b64_tr_b16 v[218:219], v117 offset:17416
    ds_read_b64_tr_b16 v[220:221], v117 offset:24584
    ds_read_b64_tr_b16 v[222:223], v117 offset:25608
    ds_read_b64_tr_b16 v[232:233], v118 offset:16384
    ds_read_b64_tr_b16 v[234:235], v118 offset:17408
    ds_read_b64_tr_b16 v[236:237], v118 offset:24576
    ds_read_b64_tr_b16 v[238:239], v118 offset:25600
    ds_read_b64_tr_b16 v[248:249], v118 offset:16392
    ds_read_b64_tr_b16 v[250:251], v118 offset:17416
    ds_read_b64_tr_b16 v[252:253], v118 offset:24584
    ds_read_b64_tr_b16 v[254:255], v118 offset:25608
    s_waitcnt lgkmcnt(0)
    s_waitcnt vmcnt(0)
    s_mov_b32 s31, 0
    s_branch K3_PI1
K3_PI0:
    buffer_load_dword v120, off, s[12:15], 0 offset:240 sc1
    buffer_load_dword v121, off, s[12:15], 0 sc1
    s_waitcnt vmcnt(0)
K3_PI1:
    v_readfirstlane_b32 s32, v120
    v_readfirstlane_b32 s33, v121
    s_add_u32 s31, s31, 1
    s_cmp_gt_u32 s31, 0x40000
    s_cbranch_scc1 K3_END
    s_cmp_lg_u32 s32, 21
    s_cbranch_scc1 K3_PI0
    s_and_b32 s34, s33, 0xffff
    s_cmp_lt_u32 s34, 32
    s_cbranch_scc1 K3_PI0
    s_lshr_b32 s10, s33, 16
    s_lshl_b32 s64, s28, 8
    s_add_u32 s64, s64, 0x228000
    buffer_load_dword v120, off, s[24:27], s64 sc1
    ds_write_b128 v112, v[24:27] offset:16384
    ds_write_b128 v112, v[28:31] offset:17408
    ds_write_b128 v112, v[32:35] offset:18432
    ds_write_b128 v112, v[36:39] offset:19456
    ds_write_b128 v112, v[40:43] offset:20480
    ds_write_b128 v112, v[44:47] offset:21504
    ds_write_b128 v112, v[48:51] offset:22528
    ds_write_b128 v112, v[52:55] offset:23552
    ds_write_b128 v112, v[56:59] offset:24576
    ds_write_b128 v112, v[60:63] offset:25600
    ds_write_b128 v112, v[64:67] offset:26624
    ds_write_b128 v112, v[68:71] offset:27648
    ds_write_b128 v112, v[72:75] offset:28672
    ds_write_b128 v112, v[76:79] offset:29696
    ds_write_b128 v112, v[80:83] offset:30720
    ds_write_b128 v112, v[84:87] offset:31744
    s_waitcnt lgkmcnt(0)
    s_barrier
    ds_read_b64_tr_b16 v[24:25], v113 offset:16384
    ds_read_b64_tr_b16 v[26:27], v113 offset:17408
    ds_read_b64_tr_b16 v[28:29], v113 offset:16392
    ds_read_b64_tr_b16 v[30:31], v113 offset:17416
    ds_read_b64_tr_b16 v[32:33], v113 offset:24576
    ds_read_b64_tr_b16 v[34:35], v113 offset:25600
    ds_read_b64_tr_b16 v[36:37], v113 offset:24584
    ds_read_b64_tr_b16 v[38:39], v113 offset:25608
    ds_read_b64_tr_b16 v[40:41], v113 offset:49152
    ds_read_b64_tr_b16 v[42:43], v113 offset:50176
    ds_read_b64_tr_b16 v[44:45], v113 offset:49160
    ds_read_b64_tr_b16 v[46:47], v113 offset:50184
    ds_read_b64_tr_b16 v[48:49], v113 offset:57344
    ds_read_b64_tr_b16 v[50:51], v113 offset:58368
    ds_read_b64_tr_b16 v[52:53], v113 offset:57352
    ds_read_b64_tr_b16 v[54:55], v113 offset:58376
    ds_read_b64_tr_b16 v[56:57], v114 offset:16384
    ds_read_b64_tr_b16 v[58:59], v114 offset:17408
    ds_read_b64_tr_b16 v[60:61], v114 offset:16392
    ds_read_b64_tr_b16 v[62:63], v114 offset:17416
    ds_read_b64_tr_b16 v[64:65], v114 offset:24576
    ds_read_b64_tr_b16 v[66:67], v114 offset:25600
    ds_read_b64_tr_b16 v[68:69], v114 offset:24584
    ds_read_b64_tr_b16 v[70:71], v114 offset:25608
    ds_read_b64_tr_b16 v[72:73], v114 offset:49152
    ds_read_b64_tr_b16 v[74:75], v114 offset:50176
    ds_read_b64_tr_b16 v[76:77], v114 offset:49160
    ds_read_b64_tr_b16 v[78:79], v114 offset:50184
    ds_read_b64_tr_b16 v[80:81], v114 offset:57344
    ds_read_b64_tr_b16 v[82:83], v114 offset:58368
    ds_read_b64_tr_b16 v[84:85], v114 offset:57352
    ds_read_b64_tr_b16 v[86:87], v114 offset:58376
    s_waitcnt lgkmcnt(0)
    s_barrier
    ds_write_b128 v2, v[24:27] offset:16384
    ds_write_b128 v2, v[28:31] offset:18432
    ds_write_b128 v2, v[32:35] offset:17408
    ds_write_b128 v2, v[36:39] offset:19456
    ds_write_b128 v2, v[40:43] offset:20480
    ds_write_b128 v2, v[44:47] offset:22528
    ds_write_b128 v2, v[48:51] offset:21504
    ds_write_b128 v2, v[52:55] offset:23552
    ds_write_b128 v2, v[56:59] offset:24576
    ds_write_b128 v2, v[60:63] offset:26624
    ds_write_b128 v2, v[64:67] offset:25600
    ds_write_b128 v2, v[68:71] offset:27648
    ds_write_b128 v2, v[72:75] offset:28672
    ds_write_b128 v2, v[76:79] offset:30720
    ds_write_b128 v2, v[80:83] offset:29696
    ds_write_b128 v2, v[84:87] offset:31744
    s_mov_b32 s31, 0
    s_waitcnt vmcnt(0)
    s_branch K3_PF1
K3_PF0:
    buffer_load_dword v120, off, s[24:27], s64 sc1
    s_waitcnt vmcnt(0)
K3_PF1:
    v_readfirstlane_b32 s32, v120
    s_add_u32 s31, s31, 1
    s_cmp_gt_u32 s31, 0x40000
    s_cbranch_scc1 K3_END
    s_cmp_lg_u32 s32, s67
    s_cbranch_scc1 K3_PF0
    buffer_load_dwordx4 v[72:75], v5, s[24:27], s47 offen sc1
    buffer_load_dwordx4 v[76:79], v5, s[24:27], s47 offen offset:1024 sc1
    s_add_u32 s64, s64, 4
    buffer_load_dword v3, off, s[24:27], s64 sc1
    v_mov_b64 v[94:95], -1
    v_mov_b32 v89, 1
    v_mov_b64 v[124:125], -1
    v_mov_b64 v[126:127], -1
    v_mov_b64 v[48:49], 0
    v_mov_b64 v[50:51], 0
    v_mov_b64 v[52:53], 0
    v_mov_b64 v[54:55], 0
    v_mov_b64 v[56:57], 0
    v_mov_b64 v[58:59], 0
    v_mov_b64 v[60:61], 0
    v_mov_b64 v[62:63], 0
    v_mov_b64 v[64:65], 0
    v_mov_b64 v[66:67], 0
    v_mov_b64 v[68:69], 0
    v_mov_b64 v[70:71], 0
    s_and_b32 s32, s30, 1
    s_lshl_b32 s32, s32, 19
    s_lshl_b32 s33, s28, 6
    s_add_u32 s59, s32, s33
    s_add_u32 s59, s59, 0x300000
    s_lshl_b32 s33, s28, 13
    s_add_u32 s57, s32, s33
    s_add_u32 s57, s57, 0x300000
    s_add_u32 s57, s57, s66
    s_lshr_b32 s92, s30, 1
    s_and_b32 s92, s92, 1
    s_add_u32 s50, s50, 0x10000
    s_add_u32 s48, s48, 0x40000
    s_add_u32 s47, s47, 0x40000
    s_waitcnt lgkmcnt(0)
    s_barrier
    s_cmp_eq_u32 s10, 0
    s_cbranch_scc0 K3_GOB
    s_cmp_eq_u32 s29, 0
    s_cbranch_scc1 K3_PROJ_A0
    s_cmp_eq_u32 s29, 1
    s_cbranch_scc1 K3_PROJ_A1
    s_cmp_eq_u32 s29, 2
    s_cbranch_scc1 K3_PROJ_A2
    s_branch K3_PROJ_A3
K3_GOB:
    s_cmp_eq_u32 s29, 0
    s_cbranch_scc1 K3_PROJ_B0
    s_cmp_eq_u32 s29, 1
    s_cbranch_scc1 K3_PROJ_B1
    s_cmp_eq_u32 s29, 2
    s_cbranch_scc1 K3_PROJ_B2
    s_branch K3_PROJ_B3
K3_STEP_A0:
    s_nop 7
    s_nop 7
    s_nop 7
    s_nop 7
    s_nop 7
    s_nop 7
    s_nop 7
    s_mov_b32 s31, 0
    buffer_load_dwordx4 v[16:19], v0, s[24:27], s51 offen sc1
    buffer_load_dwordx4 v[20:23], v0, s[24:27], s51 offen offset:1024 sc1
    s_and_b32 s32, s30, 1
    s_lshl_b32 s32, s32, 19
    s_lshl_b32 s33, s28, 6
    s_add_u32 s59, s32, s33
    s_add_u32 s59, s59, 0x300000
    s_lshl_b32 s33, s28, 13
    s_add_u32 s57, s32, s33
    s_add_u32 s57, s57, 0x300000
    s_add_u32 s57, s57, s66
    s_lshr_b32 s92, s30, 1
    s_and_b32 s92, s92, 1
    s_add_u32 s50, s50, 0x10000
    s_add_u32 s48, s48, 0x40000
    s_add_u32 s47, s47, 0x40000
    ds_read_b128 v[24:27], v2 offset:0
    ds_read_b128 v[28:31], v2 offset:1024
    ds_read_b128 v[32:35], v2 offset:2048
    ds_read_b128 v[36:39], v2 offset:3072
    ds_read_b128 v[40:43], v2 offset:4096
    ds_read_b128 v[44:47], v2 offset:5120
    ds_read_b128 v[120:123], v2 offset:6144
    ds_read_b128 v[124:127], v2 offset:7168
    ds_read_b128 v[96:99], v2 offset:8192
    ds_read_b128 v[100:103], v2 offset:9216
    ds_read_b128 v[104:107], v2 offset:10240
    ds_read_b128 v[108:111], v2 offset:11264
    ds_read_b128 v[112:115], v2 offset:12288
    ds_read_b128 v[116:119], v2 offset:13312
    ds_read_b128 v[80:83], v2 offset:14336
    ds_read_b128 v[84:87], v2 offset:15360
K3_PM_A0_L:
    s_waitcnt vmcnt(0) lgkmcnt(0)
    v_max3_u32 v14, v16, v17, v18
    v_max3_u32 v14, v14, v19, v20
    v_max3_u32 v14, v14, v21, v22
    v_max_u32 v14, v14, v23
    v_cmp_eq_u32 vcc, -1, v14
    s_add_u32 s31, s31, 1
    s_cbranch_vccz K3_PM_A0_D
    s_mov_b64 exec, vcc
    buffer_load_dwordx4 v[16:19], v0, s[24:27], s51 offen sc1
    buffer_load_dwordx4 v[20:23], v0, s[24:27], s51 offen offset:1024 sc1
    s_cmp_gt_u32 s31, 0x40000
    s_cbranch_scc0 K3_PM_A0_L
    s_branch K3_END
K3_PM_A0_D:
    s_mov_b64 exec, -1
    ds_write_b128 v0, v[16:19]
    ds_write_b128 v0, v[20:23] offset:1024
K3_OWN_A0:
    v_smfmac_f32_16x16x64_bf16 v[48:51], v[16:19], v[24:31], v88
    v_smfmac_f32_16x16x64_bf16 v[52:55], v[16:19], v[32:39], v88
    v_smfmac_f32_16x16x64_bf16 v[48:51], v[20:23], v[40:47], v88
    v_smfmac_f32_16x16x64_bf16 v[52:55], v[20:23], v[120:127], v88
    s_waitcnt lgkmcnt(0)
    s_barrier
    ds_read_b128 v[24:27], v1 offset:2048
    ds_read_b128 v[28:31], v1 offset:3072
    ds_read_b128 v[32:35], v1 offset:4096
    ds_read_b128 v[36:39], v1 offset:5120
    ds_read_b128 v[40:43], v1 offset:6144
    ds_read_b128 v[44:47], v1 offset:7168
    v_smfmac_f32_16x16x64_bf16 v[56:59], v[16:19], v[96:103], v88
    v_smfmac_f32_16x16x64_bf16 v[60:63], v[16:19], v[104:111], v88
    v_smfmac_f32_16x16x64_bf16 v[56:59], v[20:23], v[112:119], v88
    v_smfmac_f32_16x16x64_bf16 v[60:63], v[20:23], v[80:87], v88
    v_smfmac_f32_16x16x64_bf16 v[64:67], v[16:19], a[0:7], v88
    v_smfmac_f32_16x16x64_bf16 v[68:71], v[16:19], a[64:71], v88
    s_waitcnt lgkmcnt(5)
    v_smfmac_f32_16x16x64_bf16 v[48:51], v[24:27], a[16:23], v88
    s_nop 1
    v_smfmac_f32_16x16x64_bf16 v[52:55], v[24:27], a[80:87], v88
    buffer_store_dword v94, v8, s[24:27], s50 offen sc1
    s_waitcnt lgkmcnt(4)
    v_smfmac_f32_16x16x64_bf16 v[48:51], v[28:31], a[24:31], v88
    s_nop 1
    v_smfmac_f32_16x16x64_bf16 v[52:55], v[28:31], a[88:95], v88
    buffer_store_dword v95, v8, s[24:27], s50 offen offset:64 sc1
    s_waitcnt lgkmcnt(3)
    v_smfmac_f32_16x16x64_bf16 v[48:51], v[32:35], a[32:39], v88
    s_nop 1
    v_smfmac_f32_16x16x64_bf16 v[52:55], v[32:35], a[96:103], v88
    buffer_load_dwordx4 v[80:83], v6, s[24:27], s48 offen sc1
    s_waitcnt lgkmcnt(2)
    v_smfmac_f32_16x16x64_bf16 v[48:51], v[36:39], a[40:47], v88
    s_nop 1
    v_smfmac_f32_16x16x64_bf16 v[52:55], v[36:39], a[104:111], v88
    buffer_load_dwordx4 v[84:87], v6, s[24:27], s48 offen offset:256 sc1
    s_waitcnt lgkmcnt(1)
    v_smfmac_f32_16x16x64_bf16 v[48:51], v[40:43], a[48:55], v88
    s_nop 1
    v_smfmac_f32_16x16x64_bf16 v[52:55], v[40:43], a[112:119], v88
    s_nop 0
    s_waitcnt lgkmcnt(0)
    v_smfmac_f32_16x16x64_bf16 v[48:51], v[44:47], a[56:63], v88
    s_nop 1
    v_smfmac_f32_16x16x64_bf16 v[52:55], v[44:47], a[120:127], v88
    s_waitcnt vmcnt(4)
    s_nop 0
    v_smfmac_f32_16x16x64_bf16 v[56:59], v[24:27], a[144:151], v88
    ds_read_b128 v[96:99], v2 offset:20480
    ds_read_b128 v[100:103], v2 offset:21504
    v_smfmac_f32_16x16x64_bf16 v[60:63], v[24:27], a[208:215], v88
    ds_read_b128 v[104:107], v2 offset:22528
    ds_read_b128 v[108:111], v2 offset:23552
    v_smfmac_f32_16x16x64_bf16 v[56:59], v[28:31], a[152:159], v88
    v_add_f32 v48, v48, v50
    v_add_f32 v49, v49, v51
    v_smfmac_f32_16x16x64_bf16 v[60:63], v[28:31], a[216:223], v88
    v_add_f32 v52, v52, v54
    v_add_f32 v53, v53, v55
    v_smfmac_f32_16x16x64_bf16 v[56:59], v[32:35], a[160:167], v88
    v_cvt_pk_bf16_f32 v50, v48, v49
    v_cvt_pk_bf16_f32 v51, v52, v53
    v_smfmac_f32_16x16x64_bf16 v[60:63], v[32:35], a[224:231], v88
    ds_read_b128 v[112:115], v2 offset:24576
    ds_read_b128 v[116:119], v2 offset:25600
    v_mfma_f32_16x16x16_bf16 v[52:55], v[50:51], v[90:91], 0
    v_readfirstlane_b32 s69, v3
    s_nop 1
    v_mfma_f32_16x16x16_bf16 v[120:123], v[50:51], v[92:93], 0
    s_nop 2
    v_smfmac_f32_16x16x64_bf16 v[56:59], v[36:39], a[168:175], v88
    v_cvt_pk_bf16_f32 v52, v52, v53
    v_cvt_pk_bf16_f32 v53, v54, v55
    v_smfmac_f32_16x16x64_bf16 v[60:63], v[36:39], a[232:239], v88
    s_nop 0
    v_cvt_pk_bf16_f32 v54, v120, v121
    v_smfmac_f32_16x16x64_bf16 v[56:59], v[40:43], a[176:183], v88
    v_cvt_pk_bf16_f32 v55, v122, v123
    s_nop 0
    v_smfmac_f32_16x16x64_bf16 v[60:63], v[40:43], a[240:247], v88
    s_nop 1
    v_smfmac_f32_16x16x64_bf16 v[56:59], v[44:47], a[184:191], v88
    s_cmp_eq_u32 s69, s67
    s_cbranch_scc0 K3_PFSLOW_A0
K3_PFOK_A0:
    v_smfmac_f32_16x16x64_bf16 v[60:63], v[44:47], a[248:255], v88
    s_nop 1
    v_mfma_f32_16x16x32_bf16 v[48:51], v[72:75], v[52:55], 0
    s_nop 2
    v_mfma_f32_16x16x32_bf16 v[120:123], v[76:79], v[52:55], 0
    s_nop 4
    v_add_f32 v56, v56, v58
    v_add_f32 v57, v57, v59
    v_add_f32 v60, v60, v62
    v_add_f32 v61, v61, v63
    v_cvt_pk_bf16_f32 v58, v56, v57
    v_cvt_pk_bf16_f32 v59, v60, v61
    ds_write_b128 v4, v[48:51] offset:512
    ds_write_b128 v4, v[120:123] offset:1024
    v_mfma_f32_16x16x16_bf16 v[60:63], v[58:59], v[90:91], 0
    v_mfma_f32_16x16x16_bf16 v[48:51], v[58:59], v[92:93], 0
    s_waitcnt lgkmcnt(6)
    v_smfmac_f32_16x16x64_bf16 v[64:67], v[28:31], v[96:103], v88
    ds_read_b128 v[96:99], v2 offset:26624
    ds_read_b128 v[100:103], v2 offset:27648
    s_waitcnt lgkmcnt(6)
    v_smfmac_f32_16x16x64_bf16 v[68:71], v[28:31], v[104:111], v88
    ds_read_b128 v[104:107], v2 offset:28672
    ds_read_b128 v[108:111], v2 offset:29696
    s_nop 1
    v_cvt_pk_bf16_f32 v124, v60, v61
    v_cvt_pk_bf16_f32 v125, v62, v63
    v_cvt_pk_bf16_f32 v126, v48, v49
    v_cvt_pk_bf16_f32 v127, v50, v51
    s_nop 1
    v_mfma_f32_16x16x32_bf16 v[56:59], v[124:127], v[52:55], 0
    v_smfmac_f32_16x16x64_bf16 v[64:67], v[24:27], a[8:15], v88
    v_smfmac_f32_16x16x64_bf16 v[68:71], v[24:27], a[72:79], v88
    s_nop 5
    ds_write_b128 v4, v[56:59]
    v_smfmac_f32_16x16x64_bf16 v[64:67], v[32:35], a[128:135], v88
    v_smfmac_f32_16x16x64_bf16 v[68:71], v[32:35], a[192:199], v88
    buffer_load_dwordx4 v[72:75], v5, s[24:27], s47 offen sc1
    buffer_load_dwordx4 v[76:79], v5, s[24:27], s47 offen offset:1024 sc1
    s_add_u32 s64, s64, 4
    buffer_load_dword v3, off, s[24:27], s64 sc1
    s_waitcnt lgkmcnt(0)
    s_barrier
    ds_read_b128 v[48:51], v9 offset:0
    ds_read_b128 v[52:55], v9 offset:1536
    ds_read_b128 v[56:59], v9 offset:3072
    ds_read_b128 v[60:63], v9 offset:4608
    ds_read_b32 v120, v15 offset:0
    ds_read_b32 v121, v15 offset:1536
    ds_read_b32 v122, v15 offset:3072
    ds_read_b32 v123, v15 offset:4608
    buffer_store_dwordx4 v[124:127], v7, s[24:27], s49 offen sc1
    v_smfmac_f32_16x16x64_bf16 v[64:67], v[36:39], v[112:119], v88
    ds_read_b128 v[112:115], v2 offset:30720
    ds_read_b128 v[116:119], v2 offset:31744
    v_smfmac_f32_16x16x64_bf16 v[68:71], v[36:39], v[96:103], v88
    ds_read_b128 v[96:99], v2 offset:16384
    ds_read_b128 v[100:103], v2 offset:17408
    s_waitcnt vmcnt(6)
    v_mov_b32 v14, 1
    s_mov_b64 exec, 1
    buffer_store_byte v14, off, s[24:27], s65 sc1
    s_mov_b64 exec, s[36:37]
    s_mov_b32 s65, s68
    s_add_u32 s68, s68, 4
    s_waitcnt lgkmcnt(8)
    v_pk_add_f32 v[48:49], v[48:49], v[52:53]
    v_pk_add_f32 v[50:51], v[50:51], v[54:55]
    v_pk_add_f32 v[56:57], v[56:57], v[60:61]
    v_pk_add_f32 v[58:59], v[58:59], v[62:63]
    s_waitcnt lgkmcnt(4)
    v_pk_add_f32 v[120:121], v[120:121], v[122:123]
    v_pk_add_f32 v[48:49], v[48:49], v[56:57]
    v_pk_add_f32 v[50:51], v[50:51], v[58:59]
    v_add_f32 v52, v120, v121
    v_cvt_pk_bf16_f32 v56, v48, v49
    v_cvt_pk_bf16_f32 v57, v50, v51
    v_cvt_pk_bf16_f32 v58, v52, v52
    v_lshlrev_b32 v48, 16, v56
    v_and_b32 v49, 0xffff0000, v56
    v_lshlrev_b32 v50, 16, v57
    v_and_b32 v51, 0xffff0000, v57
    v_lshlrev_b32 v52, 16, v58
    v_pk_mul_f32 v[48:49], v[48:49], s[54:55] op_sel_hi:[1,0]
    v_pk_mul_f32 v[50:51], v[50:51], s[54:55] op_sel_hi:[1,0]
    v_mul_f32 v52, s54, v52
    v_cvt_pk_bf16_f32 v56, v48, v49
    v_cvt_pk_bf16_f32 v57, v50, v51
    v_cvt_pk_bf16_f32 v58, v52, v52
    v_lshlrev_b32 v48, 16, v56
    v_and_b32 v49, 0xffff0000, v56
    v_lshlrev_b32 v50, 16, v57
    v_and_b32 v51, 0xffff0000, v57
    v_lshlrev_b32 v52, 16, v58
    v_max3_f32 v14, v48, v49, v50
    v_max3_f32 v14, v14, v51, v52
    v_smfmac_f32_16x16x64_bf16 v[64:67], v[44:47], v[104:111], v88
    ds_read_b128 v[104:107], v2 offset:18432
    ds_read_b128 v[108:111], v2 offset:19456
    s_nop 0
    v_max_f32_dpp v14, v14, v14 row_ror:8 row_mask:0xf bank_mask:0xf
    v_mov_b32 v56, v14
    s_waitcnt lgkmcnt(4)
    v_smfmac_f32_16x16x64_bf16 v[68:71], v[44:47], v[112:119], v88
    s_nop 0
    v_permlane16_swap_b32 v14, v56
    v_max_f32 v14, v14, v56
    v_mov_b32 v56, v14
    s_waitcnt lgkmcnt(2)
    v_smfmac_f32_16x16x64_bf16 v[64:67], v[20:23], v[96:103], v88
    s_nop 0
    v_permlane32_swap_b32 v14, v56
    v_max_f32 v14, v14, v56
    v_mul_f32 v14, s55, v14
    v_pk_fma_f32 v[48:49], v[48:49], s[54:55], v[14:15] op_sel:[0,1,0] op_sel_hi:[1,1,0] neg_lo:[0,0,1] neg_hi:[0,0,1]
    v_pk_fma_f32 v[50:51], v[50:51], s[54:55], v[14:15] op_sel:[0,1,0] op_sel_hi:[1,1,0] neg_lo:[0,0,1] neg_hi:[0,0,1]
    v_fma_f32 v52, v52, s55, -v14
    v_exp_f32 v48, v48
    v_exp_f32 v49, v49
    v_exp_f32 v50, v50
    v_exp_f32 v51, v51
    v_exp_f32 v52, v52
    v_mov_b32 v125, 0
    v_mov_b32 v126, 0
    v_add_f32 v14, v48, v49
    v_add_f32 v56, v50, v51
    v_add_f32 v14, v14, v52
    v_add_f32 v14, v14, v56
    s_waitcnt lgkmcnt(0)
    v_smfmac_f32_16x16x64_bf16 v[68:71], v[20:23], v[104:111], v88
    s_nop 0
    v_add_f32_dpp v14, v14, v14 row_ror:8 row_mask:0xf bank_mask:0xf
    v_mov_b32 v56, v14
    v_smfmac_f32_16x16x64_bf16 v[64:67], v[40:43], a[136:143], v88
    s_nop 0
    v_permlane16_swap_b32 v14, v56
    v_add_f32 v14, v14, v56
    v_mov_b32 v56, v14
    v_smfmac_f32_16x16x64_bf16 v[68:71], v[40:43], a[200:207], v88
    s_nop 0
    v_permlane32_swap_b32 v14, v56
    v_add_f32 v14, v14, v56
    v_rcp_f32 v14, v14
    s_nop 0
    v_pk_mul_f32 v[48:49], v[48:49], v[14:15] op_sel_hi:[1,0]
    v_pk_mul_f32 v[50:51], v[50:51], v[14:15] op_sel_hi:[1,0]
    v_mul_f32 v52, v52, v14
    v_cvt_pk_bf16_f32 v120, v48, v49
    v_cvt_pk_bf16_f32 v121, v50, v51
    v_mov_b32_dpp v53, v52 row_ror:8 row_mask:0xf bank_mask:0xf
    v_mov_b32_dpp v122, v120 row_ror:8 row_mask:0xf bank_mask:0xf
    v_mov_b32_dpp v123, v121 row_ror:8 row_mask:0xf bank_mask:0xf
    v_cvt_pk_bf16_f32 v124, v52, v53
    v_cvt_pk_bf16_f32 v127, v52, v53
    s_waitcnt vmcnt(5)
    v_mfma_f32_16x16x32_bf16 v[96:99], v[80:83], v[120:123], 0
    v_add_f32 v64, v64, v66
    v_add_f32 v65, v65, v67
    v_mfma_f32_16x16x32_bf16 v[100:103], v[84:87], v[120:123], 0
    v_add_f32 v68, v68, v70
    v_add_f32 v69, v69, v71
    v_cvt_pk_bf16_f32 v94, v64, v65
    v_cvt_pk_bf16_f32 v95, v68, v69
    s_cmp_eq_u32 s30, 63
    s_cbranch_scc1 K3_LAST_A0
    v_mfma_f32_16x16x16_bf16 v[96:99], v[94:95], v[124:125], v[96:99]
    v_mfma_f32_16x16x16_bf16 v[100:103], v[94:95], v[126:127], v[100:103]
    v_mov_b64 v[16:17], 0
    v_mov_b64 v[18:19], 0
    v_mov_b64 v[20:21], 0
    v_mov_b64 v[22:23], 0
    v_mov_b64 v[24:25], 0
    v_mov_b64 v[26:27], 0
    v_mov_b64 v[28:29], 0
    v_mov_b64 v[30:31], 0
    v_cvt_pk_bf16_f32 v104, v96, v97
    v_cvt_pk_bf16_f32 v106, v98, v99
    v_cvt_pk_bf16_f32 v105, v100, v101
    v_cvt_pk_bf16_f32 v107, v102, v103
    ds_write2_b64 v10, v[104:105], v[106:107] offset0:0 offset1:4
    v_mov_b64 v[32:33], 0
    v_mov_b64 v[34:35], 0
    v_mov_b64 v[36:37], 0
    v_mov_b64 v[38:39], 0
    s_waitcnt lgkmcnt(0)
    s_barrier
    ds_read_b128 v[108:111], v11
    ds_read_b128 v[112:115], v11 offset:1024
    v_mov_b64 v[40:41], 0
    v_mov_b64 v[42:43], 0
    v_mov_b64 v[44:45], 0
    v_mov_b64 v[46:47], 0
    s_waitcnt lgkmcnt(0)
    v_smfmac_f32_16x16x64_bf16 v[16:19], v[108:111], v[128:135], v88
    s_nop 2
    v_smfmac_f32_16x16x64_bf16 v[20:23], v[108:111], v[144:151], v88
    s_nop 2
    v_smfmac_f32_16x16x64_bf16 v[16:19], v[112:115], v[136:143], v88
    s_nop 2
    v_smfmac_f32_16x16x64_bf16 v[20:23], v[112:115], v[152:159], v88
    v_smfmac_f32_16x16x64_bf16 v[24:27], v[108:111], v[160:167], v88
    s_nop 2
    v_smfmac_f32_16x16x64_bf16 v[28:31], v[108:111], v[176:183], v88
    v_add_f32 v16, v16, v18
    v_add_f32 v17, v17, v19
    v_smfmac_f32_16x16x64_bf16 v[24:27], v[112:115], v[168:175], v88
    v_add_f32 v18, v20, v22
    v_add_f32 v19, v21, v23
    v_smfmac_f32_16x16x64_bf16 v[28:31], v[112:115], v[184:191], v88
    v_cvt_pk_f16_f32 v16, v16, v17
    v_cvt_pk_f16_f32 v17, v18, v19
    v_smfmac_f32_16x16x64_bf16 v[32:35], v[108:111], v[192:199], v88
    v_and_or_b32 v16, v16, -2, s92
    buffer_store_dwordx2 v[16:17], v12, s[24:27], s59 offen sc0
    s_add_u32 s59, s59, 16384
    v_smfmac_f32_16x16x64_bf16 v[36:39], v[108:111], v[208:215], v88
    v_add_f32 v24, v24, v26
    v_add_f32 v25, v25, v27
    v_smfmac_f32_16x16x64_bf16 v[32:35], v[112:115], v[200:207], v88
    v_add_f32 v26, v28, v30
    v_add_f32 v27, v29, v31
    v_smfmac_f32_16x16x64_bf16 v[36:39], v[112:115], v[216:223], v88
    v_cvt_pk_f16_f32 v24, v24, v25
    v_cvt_pk_f16_f32 v25, v26, v27
    v_smfmac_f32_16x16x64_bf16 v[40:43], v[108:111], v[224:231], v88
    v_and_or_b32 v24, v24, -2, s92
    buffer_store_dwordx2 v[24:25], v12, s[24:27], s59 offen sc0
    s_add_u32 s59, s59, 16384
    v_smfmac_f32_16x16x64_bf16 v[44:47], v[108:111], v[240:247], v88
    v_add_f32 v32, v32, v34
    v_add_f32 v33, v33, v35
    v_smfmac_f32_16x16x64_bf16 v[40:43], v[112:115], v[232:239], v88
    v_add_f32 v34, v36, v38
    v_add_f32 v35, v37, v39
    v_smfmac_f32_16x16x64_bf16 v[44:47], v[112:115], v[248:255], v88
    v_cvt_pk_f16_f32 v32, v32, v33
    v_cvt_pk_f16_f32 v33, v34, v35
    v_and_or_b32 v32, v32, -2, s92
    buffer_store_dwordx2 v[32:33], v12, s[24:27], s59 offen sc0
    s_add_u32 s59, s59, 16384
    s_nop 0
    s_nop 1
    v_pk_add_f32 v[40:41], v[40:41], v[42:43]
    v_pk_add_f32 v[42:43], v[44:45], v[46:47]
    v_cvt_pk_f16_f32 v40, v40, v41
    v_cvt_pk_f16_f32 v41, v42, v43
    v_and_or_b32 v40, v40, -2, s92
    buffer_store_dwordx2 v[40:41], v12, s[24:27], s59 offen sc0
    s_nop 7
    s_nop 7
    s_nop 7
    s_nop 7
    s_mov_b32 s31, 0
    v_lshrrev_b32 v31, 1, v1
    buffer_load_dwordx2 v[16:17], v31, s[24:27], s57 offen offset:0 sc1
    buffer_load_dwordx2 v[18:19], v31, s[24:27], s57 offen offset:512 sc1
    buffer_load_dwordx2 v[20:21], v31, s[24:27], s57 offen offset:1024 sc1
    buffer_load_dwordx2 v[22:23], v31, s[24:27], s57 offen offset:1536 sc1
    s_add_u32 s51, s51, 8192
    s_add_u32 s58, s51, s52
    v_bfe_u32 v100, v1, 6, 2
    s_movk_i32 s33, 0x3c00
    v_and_b32 v101, 1, v100
    v_lshlrev_b32 v101, 4, v101
    v_lshlrev_b32 v101, v101, s33
    v_cmp_gt_u32 vcc, 2, v100
    s_nop 1
    v_cndmask_b32 v96, 0, v101, vcc
    v_cndmask_b32 v97, v101, 0, vcc
    v_mov_b32 v98, v96
    v_mov_b32 v99, v97
    s_cmp_lg_u32 s92, 0
    s_cbranch_scc1 K3_PP_A0_L1
K3_PP_A0_L0:
    s_waitcnt vmcnt(0)
    v_mfma_f32_16x16x32_f16 v[120:123], v[96:99], v[16:19], 0
    v_mfma_f32_16x16x32_f16 v[120:123], v[96:99], v[20:23], v[120:123]
    v_or3_b32 v14, v16, v18, v20
    v_bitop3_b32 v14, v14, v22, 1 bitop3:0xa8
    v_cmp_ne_u32 vcc, 0, v14
    s_add_u32 s31, s31, 1
    s_cbranch_vccz K3_PP_A0_D
    s_mov_b64 exec, vcc
    buffer_load_dwordx2 v[16:17], v31, s[24:27], s57 offen offset:0 sc1
    buffer_load_dwordx2 v[18:19], v31, s[24:27], s57 offen offset:512 sc1
    buffer_load_dwordx2 v[20:21], v31, s[24:27], s57 offen offset:1024 sc1
    buffer_load_dwordx2 v[22:23], v31, s[24:27], s57 offen offset:1536 sc1
    s_cmp_gt_u32 s31, 0x40000
    s_cbranch_scc0 K3_PP_A0_L0
    s_branch K3_END
K3_PP_A0_L1:
    s_waitcnt vmcnt(0)
    v_mfma_f32_16x16x32_f16 v[120:123], v[96:99], v[16:19], 0
    v_mfma_f32_16x16x32_f16 v[120:123], v[96:99], v[20:23], v[120:123]
    v_bitop3_b32 v14, v16, v18, v20 bitop3:0x80
    v_bitop3_b32 v14, v14, v22, 1 bitop3:0x2a
    v_cmp_ne_u32 vcc, 0, v14
    s_add_u32 s31, s31, 1
    s_cbranch_vccz K3_PP_A0_D
    s_mov_b64 exec, vcc
    buffer_load_dwordx2 v[16:17], v31, s[24:27], s57 offen offset:0 sc1
    buffer_load_dwordx2 v[18:19], v31, s[24:27], s57 offen offset:512 sc1
    buffer_load_dwordx2 v[20:21], v31, s[24:27], s57 offen offset:1024 sc1
    buffer_load_dwordx2 v[22:23], v31, s[24:27], s57 offen offset:1536 sc1
    s_cmp_gt_u32 s31, 0x40000
    s_cbranch_scc0 K3_PP_A0_L1
    s_branch K3_END
K3_PP_A0_D:
    s_mov_b64 exec, -1
    s_nop 0
    s_nop 1
    v_add_f32_dpp v120, v120, v120 row_ror:8 row_mask:0xf bank_mask:0xf
    v_mov_b32 v14, -2
    s_nop 0
    v_mov_b32_dpp v121, v120 quad_perm:[1,0,3,2] row_mask:0xf bank_mask:0xf
    v_cvt_pk_bf16_f32 v120, v120, v121
    v_min_u32 v120, v120, v14
    buffer_store_dword v120, v13, s[24:27], s58 offen sc0
    v_mov_b64 v[48:49], 0
    v_mov_b64 v[50:51], 0
    v_mov_b64 v[52:53], 0
    v_mov_b64 v[54:55], 0
    v_mov_b64 v[56:57], 0
    v_mov_b64 v[58:59], 0
    v_mov_b64 v[60:61], 0
    v_mov_b64 v[62:63], 0
    v_mov_b64 v[64:65], 0
    v_mov_b64 v[66:67], 0
    v_mov_b64 v[68:69], 0
    v_mov_b64 v[70:71], 0
    s_add_u32 s30, s30, 1
    s_add_u32 s49, s49, 0x10000
    s_branch K3_STEP_A0
K3_PROJ_A0:
    ds_read_b128 v[16:19], v1 offset:0
    ds_read_b128 v[20:23], v1 offset:1024
    ds_read_b128 v[24:27], v2 offset:0
    ds_read_b128 v[28:31], v2 offset:1024
    ds_read_b128 v[32:35], v2 offset:2048
    ds_read_b128 v[36:39], v2 offset:3072
    ds_read_b128 v[40:43], v2 offset:4096
    ds_read_b128 v[44:47], v2 offset:5120
    ds_read_b128 v[120:123], v2 offset:6144
    ds_read_b128 v[124:127], v2 offset:7168
    ds_read_b128 v[96:99], v2 offset:8192
    ds_read_b128 v[100:103], v2 offset:9216
    ds_read_b128 v[104:107], v2 offset:10240
    ds_read_b128 v[108:111], v2 offset:11264
    ds_read_b128 v[112:115], v2 offset:12288
    ds_read_b128 v[116:119], v2 offset:13312
    ds_read_b128 v[80:83], v2 offset:14336
    ds_read_b128 v[84:87], v2 offset:15360
    s_waitcnt lgkmcnt(0)
    s_branch K3_OWN_A0
K3_LAST_A0:
    s_add_u32 s50, s50, 0x10000
    buffer_store_dword v94, v8, s[24:27], s50 offen sc1
    buffer_store_dword v95, v8, s[24:27], s50 offen offset:64 sc1
    s_waitcnt vmcnt(0)
    v_mov_b32 v14, 1
    s_mov_b64 exec, 1
    buffer_store_byte v14, off, s[24:27], s65 sc1
    s_endpgm
K3_PFSLOW_A0:
    s_cmp_eq_u32 s30, 63
    s_cbranch_scc1 K3_PFOK_A0
    s_mov_b32 s31, 0
K3_PFS2_A0:
    buffer_load_dword v3, off, s[24:27], s64 sc1
    s_waitcnt vmcnt(0)
    v_readfirstlane_b32 s32, v3
    s_add_u32 s31, s31, 1
    s_cmp_gt_u32 s31, 0x40000
    s_cbranch_scc1 K3_END
    s_cmp_lg_u32 s32, s67
    s_cbranch_scc1 K3_PFS2_A0
    s_branch K3_PFOK_A0
K3_STEP_A1:
    s_nop 7
    s_nop 7
    s_nop 7
    s_nop 7
    s_nop 7
    s_nop 7
    s_nop 7
    s_mov_b32 s31, 0
    buffer_load_dwordx4 v[24:27], v0, s[24:27], s51 offen sc1
    buffer_load_dwordx4 v[28:31], v0, s[24:27], s51 offen offset:1024 sc1
    s_and_b32 s32, s30, 1
    s_lshl_b32 s32, s32, 19
    s_lshl_b32 s33, s28, 6
    s_add_u32 s59, s32, s33
    s_add_u32 s59, s59, 0x300000
    s_lshl_b32 s33, s28, 13
    s_add_u32 s57, s32, s33
    s_add_u32 s57, s57, 0x300000
    s_add_u32 s57, s57, s66
    s_lshr_b32 s92, s30, 1
    s_and_b32 s92, s92, 1
    s_add_u32 s50, s50, 0x10000
    s_add_u32 s48, s48, 0x40000
    s_add_u32 s47, s47, 0x40000
    ds_read_b128 v[16:19], v2 offset:0
    ds_read_b128 v[20:23], v2 offset:1024
    ds_read_b128 v[32:35], v2 offset:2048
    ds_read_b128 v[36:39], v2 offset:3072
    ds_read_b128 v[40:43], v2 offset:4096
    ds_read_b128 v[44:47], v2 offset:5120
    ds_read_b128 v[120:123], v2 offset:6144
    ds_read_b128 v[124:127], v2 offset:7168
    ds_read_b128 v[96:99], v2 offset:8192
    ds_read_b128 v[100:103], v2 offset:9216
    ds_read_b128 v[104:107], v2 offset:10240
    ds_read_b128 v[108:111], v2 offset:11264
    ds_read_b128 v[112:115], v2 offset:12288
    ds_read_b128 v[116:119], v2 offset:13312
    ds_read_b128 v[80:83], v2 offset:14336
    ds_read_b128 v[84:87], v2 offset:15360
K3_PM_A1_L:
    s_waitcnt vmcnt(0) lgkmcnt(0)
    v_max3_u32 v14, v24, v25, v26
    v_max3_u32 v14, v14, v27, v28
    v_max3_u32 v14, v14, v29, v30
    v_max_u32 v14, v14, v31
    v_cmp_eq_u32 vcc, -1, v14
    s_add_u32 s31, s31, 1
    s_cbranch_vccz K3_PM_A1_D
    s_mov_b64 exec, vcc
    buffer_load_dwordx4 v[24:27], v0, s[24:27], s51 offen sc1
    buffer_load_dwordx4 v[28:31], v0, s[24:27], s51 offen offset:1024 sc1
    s_cmp_gt_u32 s31, 0x40000
    s_cbranch_scc0 K3_PM_A1_L
    s_branch K3_END
K3_PM_A1_D:
    s_mov_b64 exec, -1
    ds_write_b128 v0, v[24:27]
    ds_write_b128 v0, v[28:31] offset:1024
K3_OWN_A1:
    v_smfmac_f32_16x16x64_bf16 v[48:51], v[24:27], v[16:23], v88
    v_smfmac_f32_16x16x64_bf16 v[52:55], v[24:27], v[32:39], v88
    v_smfmac_f32_16x16x64_bf16 v[48:51], v[28:31], v[40:47], v88
    v_smfmac_f32_16x16x64_bf16 v[52:55], v[28:31], v[120:127], v88
    s_waitcnt lgkmcnt(0)
    s_barrier
    ds_read_b128 v[32:35], v1 offset:4096
    ds_read_b128 v[36:39], v1 offset:5120
    ds_read_b128 v[40:43], v1 offset:6144
    ds_read_b128 v[44:47], v1 offset:7168
    ds_read_b128 v[16:19], v1 offset:0
    ds_read_b128 v[20:23], v1 offset:1024
    v_smfmac_f32_16x16x64_bf16 v[56:59], v[24:27], v[96:103], v88
    v_smfmac_f32_16x16x64_bf16 v[60:63], v[24:27], v[104:111], v88
    v_smfmac_f32_16x16x64_bf16 v[56:59], v[28:31], v[112:119], v88
    v_smfmac_f32_16x16x64_bf16 v[60:63], v[28:31], v[80:87], v88
    v_smfmac_f32_16x16x64_bf16 v[64:67], v[24:27], a[16:23], v88
    v_smfmac_f32_16x16x64_bf16 v[68:71], v[24:27], a[80:87], v88
    s_waitcnt lgkmcnt(5)
    v_smfmac_f32_16x16x64_bf16 v[48:51], v[32:35], a[32:39], v88
    s_nop 1
    v_smfmac_f32_16x16x64_bf16 v[52:55], v[32:35], a[96:103], v88
    buffer_store_dword v94, v8, s[24:27], s50 offen sc1
    s_waitcnt lgkmcnt(4)
    v_smfmac_f32_16x16x64_bf16 v[48:51], v[36:39], a[40:47], v88
    s_nop 1
    v_smfmac_f32_16x16x64_bf16 v[52:55], v[36:39], a[104:111], v88
    buffer_store_dword v95, v8, s[24:27], s50 offen offset:64 sc1
    s_waitcnt lgkmcnt(3)
    v_smfmac_f32_16x16x64_bf16 v[48:51], v[40:43], a[48:55], v88
    s_nop 1
    v_smfmac_f32_16x16x64_bf16 v[52:55], v[40:43], a[112:119], v88
    buffer_load_dwordx4 v[80:83], v6, s[24:27], s48 offen sc1
    s_waitcnt lgkmcnt(2)
    v_smfmac_f32_16x16x64_bf16 v[48:51], v[44:47], a[56:63], v88
    s_nop 1
    v_smfmac_f32_16x16x64_bf16 v[52:55], v[44:47], a[120:127], v88
    buffer_load_dwordx4 v[84:87], v6, s[24:27], s48 offen offset:256 sc1
    s_waitcnt lgkmcnt(1)
    v_smfmac_f32_16x16x64_bf16 v[48:51], v[16:19], a[0:7], v88
    s_nop 1
    v_smfmac_f32_16x16x64_bf16 v[52:55], v[16:19], a[64:71], v88
    s_nop 0
    s_waitcnt lgkmcnt(0)
    v_smfmac_f32_16x16x64_bf16 v[48:51], v[20:23], a[8:15], v88
    s_nop 1
    v_smfmac_f32_16x16x64_bf16 v[52:55], v[20:23], a[72:79], v88
    s_waitcnt vmcnt(4)
    s_nop 0
    v_smfmac_f32_16x16x64_bf16 v[56:59], v[32:35], a[160:167], v88
    ds_read_b128 v[96:99], v2 offset:24576
    ds_read_b128 v[100:103], v2 offset:25600
    v_smfmac_f32_16x16x64_bf16 v[60:63], v[32:35], a[224:231], v88
    ds_read_b128 v[104:107], v2 offset:26624
    ds_read_b128 v[108:111], v2 offset:27648
    v_smfmac_f32_16x16x64_bf16 v[56:59], v[36:39], a[168:175], v88
    v_add_f32 v48, v48, v50
    v_add_f32 v49, v49, v51
    v_smfmac_f32_16x16x64_bf16 v[60:63], v[36:39], a[232:239], v88
    v_add_f32 v52, v52, v54
    v_add_f32 v53, v53, v55
    v_smfmac_f32_16x16x64_bf16 v[56:59], v[40:43], a[176:183], v88
    v_cvt_pk_bf16_f32 v50, v48, v49
    v_cvt_pk_bf16_f32 v51, v52, v53
    v_smfmac_f32_16x16x64_bf16 v[60:63], v[40:43], a[240:247], v88
    ds_read_b128 v[112:115], v2 offset:28672
    ds_read_b128 v[116:119], v2 offset:29696
    v_mfma_f32_16x16x16_bf16 v[52:55], v[50:51], v[90:91], 0
    v_readfirstlane_b32 s69, v3
    s_nop 1
    v_mfma_f32_16x16x16_bf16 v[120:123], v[50:51], v[92:93], 0
    s_nop 2
    v_smfmac_f32_16x16x64_bf16 v[56:59], v[44:47], a[184:191], v88
    v_cvt_pk_bf16_f32 v52, v52, v53
    v_cvt_pk_bf16_f32 v53, v54, v55
    v_smfmac_f32_16x16x64_bf16 v[60:63], v[44:47], a[248:255], v88
    s_nop 0
    v_cvt_pk_bf16_f32 v54, v120, v121
    v_smfmac_f32_16x16x64_bf16 v[56:59], v[16:19], a[128:135], v88
    v_cvt_pk_bf16_f32 v55, v122, v123
    s_nop 0
    v_smfmac_f32_16x16x64_bf16 v[60:63], v[16:19], a[192:199], v88
    s_nop 1
    v_smfmac_f32_16x16x64_bf16 v[56:59], v[20:23], a[136:143], v88
    s_cmp_eq_u32 s69, s67
    s_cbranch_scc0 K3_PFSLOW_A1
K3_PFOK_A1:
    v_smfmac_f32_16x16x64_bf16 v[60:63], v[20:23], a[200:207], v88
    s_nop 1
    v_mfma_f32_16x16x32_bf16 v[48:51], v[72:75], v[52:55], 0
    s_nop 2
    v_mfma_f32_16x16x32_bf16 v[120:123], v[76:79], v[52:55], 0
    s_nop 4
    v_add_f32 v56, v56, v58
    v_add_f32 v57, v57, v59
    v_add_f32 v60, v60, v62
    v_add_f32 v61, v61, v63
    v_cvt_pk_bf16_f32 v58, v56, v57
    v_cvt_pk_bf16_f32 v59, v60, v61
    ds_write_b128 v4, v[48:51] offset:512
    ds_write_b128 v4, v[120:123] offset:1024
    v_mfma_f32_16x16x16_bf16 v[60:63], v[58:59], v[90:91], 0
    v_mfma_f32_16x16x16_bf16 v[48:51], v[58:59], v[92:93], 0
    s_waitcnt lgkmcnt(6)
    v_smfmac_f32_16x16x64_bf16 v[64:67], v[36:39], v[96:103], v88
    ds_read_b128 v[96:99], v2 offset:30720
    ds_read_b128 v[100:103], v2 offset:31744
    s_waitcnt lgkmcnt(6)
    v_smfmac_f32_16x16x64_bf16 v[68:71], v[36:39], v[104:111], v88
    ds_read_b128 v[104:107], v2 offset:16384
    ds_read_b128 v[108:111], v2 offset:17408
    s_nop 1
    v_cvt_pk_bf16_f32 v124, v60, v61
    v_cvt_pk_bf16_f32 v125, v62, v63
    v_cvt_pk_bf16_f32 v126, v48, v49
    v_cvt_pk_bf16_f32 v127, v50, v51
    s_nop 1
    v_mfma_f32_16x16x32_bf16 v[56:59], v[124:127], v[52:55], 0
    v_smfmac_f32_16x16x64_bf16 v[64:67], v[16:19], a[24:31], v88
    v_smfmac_f32_16x16x64_bf16 v[68:71], v[16:19], a[88:95], v88
    s_nop 5
    ds_write_b128 v4, v[56:59]
    v_smfmac_f32_16x16x64_bf16 v[64:67], v[32:35], a[144:151], v88
    v_smfmac_f32_16x16x64_bf16 v[68:71], v[32:35], a[208:215], v88
    buffer_load_dwordx4 v[72:75], v5, s[24:27], s47 offen sc1
    buffer_load_dwordx4 v[76:79], v5, s[24:27], s47 offen offset:1024 sc1
    s_add_u32 s64, s64, 4
    buffer_load_dword v3, off, s[24:27], s64 sc1
    s_waitcnt lgkmcnt(0)
    s_barrier
    ds_read_b128 v[48:51], v9 offset:0
    ds_read_b128 v[52:55], v9 offset:1536
    ds_read_b128 v[56:59], v9 offset:3072
    ds_read_b128 v[60:63], v9 offset:4608
    ds_read_b32 v120, v15 offset:0
    ds_read_b32 v121, v15 offset:1536
    ds_read_b32 v122, v15 offset:3072
    ds_read_b32 v123, v15 offset:4608
    buffer_store_dwordx4 v[124:127], v7, s[24:27], s49 offen sc1
    v_smfmac_f32_16x16x64_bf16 v[64:67], v[44:47], v[112:119], v88
    ds_read_b128 v[112:115], v2 offset:18432
    ds_read_b128 v[116:119], v2 offset:19456
    v_smfmac_f32_16x16x64_bf16 v[68:71], v[44:47], v[96:103], v88
    ds_read_b128 v[96:99], v2 offset:20480
    ds_read_b128 v[100:103], v2 offset:21504
    s_waitcnt vmcnt(6)
    v_mov_b32 v14, 1
    s_mov_b64 exec, 1
    buffer_store_byte v14, off, s[24:27], s65 sc1
    s_mov_b64 exec, s[36:37]
    s_mov_b32 s65, s68
    s_add_u32 s68, s68, 4
    s_waitcnt lgkmcnt(8)
    v_pk_add_f32 v[48:49], v[48:49], v[52:53]
    v_pk_add_f32 v[50:51], v[50:51], v[54:55]
    v_pk_add_f32 v[56:57], v[56:57], v[60:61]
    v_pk_add_f32 v[58:59], v[58:59], v[62:63]
    s_waitcnt lgkmcnt(4)
    v_pk_add_f32 v[120:121], v[120:121], v[122:123]
    v_pk_add_f32 v[48:49], v[48:49], v[56:57]
    v_pk_add_f32 v[50:51], v[50:51], v[58:59]
    v_add_f32 v52, v120, v121
    v_cvt_pk_bf16_f32 v56, v48, v49
    v_cvt_pk_bf16_f32 v57, v50, v51
    v_cvt_pk_bf16_f32 v58, v52, v52
    v_lshlrev_b32 v48, 16, v56
    v_and_b32 v49, 0xffff0000, v56
    v_lshlrev_b32 v50, 16, v57
    v_and_b32 v51, 0xffff0000, v57
    v_lshlrev_b32 v52, 16, v58
    v_pk_mul_f32 v[48:49], v[48:49], s[54:55] op_sel_hi:[1,0]
    v_pk_mul_f32 v[50:51], v[50:51], s[54:55] op_sel_hi:[1,0]
    v_mul_f32 v52, s54, v52
    v_cvt_pk_bf16_f32 v56, v48, v49
    v_cvt_pk_bf16_f32 v57, v50, v51
    v_cvt_pk_bf16_f32 v58, v52, v52
    v_lshlrev_b32 v48, 16, v56
    v_and_b32 v49, 0xffff0000, v56
    v_lshlrev_b32 v50, 16, v57
    v_and_b32 v51, 0xffff0000, v57
    v_lshlrev_b32 v52, 16, v58
    v_max3_f32 v14, v48, v49, v50
    v_max3_f32 v14, v14, v51, v52
    v_smfmac_f32_16x16x64_bf16 v[64:67], v[20:23], v[104:111], v88
    ds_read_b128 v[104:107], v2 offset:22528
    ds_read_b128 v[108:111], v2 offset:23552
    s_nop 0
    v_max_f32_dpp v14, v14, v14 row_ror:8 row_mask:0xf bank_mask:0xf
    v_mov_b32 v56, v14
    s_waitcnt lgkmcnt(4)
    v_smfmac_f32_16x16x64_bf16 v[68:71], v[20:23], v[112:119], v88
    s_nop 0
    v_permlane16_swap_b32 v14, v56
    v_max_f32 v14, v14, v56
    v_mov_b32 v56, v14
    s_waitcnt lgkmcnt(2)
    v_smfmac_f32_16x16x64_bf16 v[64:67], v[28:31], v[96:103], v88
    s_nop 0
    v_permlane32_swap_b32 v14, v56
    v_max_f32 v14, v14, v56
    v_mul_f32 v14, s55, v14
    v_pk_fma_f32 v[48:49], v[48:49], s[54:55], v[14:15] op_sel:[0,1,0] op_sel_hi:[1,1,0] neg_lo:[0,0,1] neg_hi:[0,0,1]
    v_pk_fma_f32 v[50:51], v[50:51], s[54:55], v[14:15] op_sel:[0,1,0] op_sel_hi:[1,1,0] neg_lo:[0,0,1] neg_hi:[0,0,1]
    v_fma_f32 v52, v52, s55, -v14
    v_exp_f32 v48, v48
    v_exp_f32 v49, v49
    v_exp_f32 v50, v50
    v_exp_f32 v51, v51
    v_exp_f32 v52, v52
    v_mov_b32 v125, 0
    v_mov_b32 v126, 0
    v_add_f32 v14, v48, v49
    v_add_f32 v56, v50, v51
    v_add_f32 v14, v14, v52
    v_add_f32 v14, v14, v56
    s_waitcnt lgkmcnt(0)
    v_smfmac_f32_16x16x64_bf16 v[68:71], v[28:31], v[104:111], v88
    s_nop 0
    v_add_f32_dpp v14, v14, v14 row_ror:8 row_mask:0xf bank_mask:0xf
    v_mov_b32 v56, v14
    v_smfmac_f32_16x16x64_bf16 v[64:67], v[40:43], a[152:159], v88
    s_nop 0
    v_permlane16_swap_b32 v14, v56
    v_add_f32 v14, v14, v56
    v_mov_b32 v56, v14
    v_smfmac_f32_16x16x64_bf16 v[68:71], v[40:43], a[216:223], v88
    s_nop 0
    v_permlane32_swap_b32 v14, v56
    v_add_f32 v14, v14, v56
    v_rcp_f32 v14, v14
    s_nop 0
    v_pk_mul_f32 v[48:49], v[48:49], v[14:15] op_sel_hi:[1,0]
    v_pk_mul_f32 v[50:51], v[50:51], v[14:15] op_sel_hi:[1,0]
    v_mul_f32 v52, v52, v14
    v_cvt_pk_bf16_f32 v120, v48, v49
    v_cvt_pk_bf16_f32 v121, v50, v51
    v_mov_b32_dpp v53, v52 row_ror:8 row_mask:0xf bank_mask:0xf
    v_mov_b32_dpp v122, v120 row_ror:8 row_mask:0xf bank_mask:0xf
    v_mov_b32_dpp v123, v121 row_ror:8 row_mask:0xf bank_mask:0xf
    v_cvt_pk_bf16_f32 v124, v52, v53
    v_cvt_pk_bf16_f32 v127, v52, v53
    s_waitcnt vmcnt(5)
    v_mfma_f32_16x16x32_bf16 v[96:99], v[80:83], v[120:123], 0
    v_add_f32 v64, v64, v66
    v_add_f32 v65, v65, v67
    v_mfma_f32_16x16x32_bf16 v[100:103], v[84:87], v[120:123], 0
    v_add_f32 v68, v68, v70
    v_add_f32 v69, v69, v71
    v_cvt_pk_bf16_f32 v94, v64, v65
    v_cvt_pk_bf16_f32 v95, v68, v69
    s_cmp_eq_u32 s30, 63
    s_cbranch_scc1 K3_LAST_A1
    v_mfma_f32_16x16x16_bf16 v[96:99], v[94:95], v[124:125], v[96:99]
    v_mfma_f32_16x16x16_bf16 v[100:103], v[94:95], v[126:127], v[100:103]
    v_mov_b64 v[16:17], 0
    v_mov_b64 v[18:19], 0
    v_mov_b64 v[20:21], 0
    v_mov_b64 v[22:23], 0
    v_mov_b64 v[24:25], 0
    v_mov_b64 v[26:27], 0
    v_mov_b64 v[28:29], 0
    v_mov_b64 v[30:31], 0
    v_cvt_pk_bf16_f32 v104, v96, v97
    v_cvt_pk_bf16_f32 v106, v98, v99
    v_cvt_pk_bf16_f32 v105, v100, v101
    v_cvt_pk_bf16_f32 v107, v102, v103
    ds_write2_b64 v10, v[104:105], v[106:107] offset0:0 offset1:4
    v_mov_b64 v[32:33], 0
    v_mov_b64 v[34:35], 0
    v_mov_b64 v[36:37], 0
    v_mov_b64 v[38:39], 0
    s_waitcnt lgkmcnt(0)
    s_barrier
    ds_read_b128 v[108:111], v11
    ds_read_b128 v[112:115], v11 offset:1024
    v_mov_b64 v[40:41], 0
    v_mov_b64 v[42:43], 0
    v_mov_b64 v[44:45], 0
    v_mov_b64 v[46:47], 0
    s_waitcnt lgkmcnt(0)
    v_smfmac_f32_16x16x64_bf16 v[16:19], v[108:111], v[128:135], v88
    s_nop 2
    v_smfmac_f32_16x16x64_bf16 v[20:23], v[108:111], v[144:151], v88
    s_nop 2
    v_smfmac_f32_16x16x64_bf16 v[16:19], v[112:115], v[136:143], v88
    s_nop 2
    v_smfmac_f32_16x16x64_bf16 v[20:23], v[112:115], v[152:159], v88
    v_smfmac_f32_16x16x64_bf16 v[24:27], v[108:111], v[160:167], v88
    s_nop 2
    v_smfmac_f32_16x16x64_bf16 v[28:31], v[108:111], v[176:183], v88
    v_add_f32 v16, v16, v18
    v_add_f32 v17, v17, v19
    v_smfmac_f32_16x16x64_bf16 v[24:27], v[112:115], v[168:175], v88
    v_add_f32 v18, v20, v22
    v_add_f32 v19, v21, v23
    v_smfmac_f32_16x16x64_bf16 v[28:31], v[112:115], v[184:191], v88
    v_cvt_pk_f16_f32 v16, v16, v17
    v_cvt_pk_f16_f32 v17, v18, v19
    v_smfmac_f32_16x16x64_bf16 v[32:35], v[108:111], v[192:199], v88
    v_and_or_b32 v16, v16, -2, s92
    buffer_store_dwordx2 v[16:17], v12, s[24:27], s59 offen sc0
    s_add_u32 s59, s59, 16384
    v_smfmac_f32_16x16x64_bf16 v[36:39], v[108:111], v[208:215], v88
    v_add_f32 v24, v24, v26
    v_add_f32 v25, v25, v27
    v_smfmac_f32_16x16x64_bf16 v[32:35], v[112:115], v[200:207], v88
    v_add_f32 v26, v28, v30
    v_add_f32 v27, v29, v31
    v_smfmac_f32_16x16x64_bf16 v[36:39], v[112:115], v[216:223], v88
    v_cvt_pk_f16_f32 v24, v24, v25
    v_cvt_pk_f16_f32 v25, v26, v27
    v_smfmac_f32_16x16x64_bf16 v[40:43], v[108:111], v[224:231], v88
    v_and_or_b32 v24, v24, -2, s92
    buffer_store_dwordx2 v[24:25], v12, s[24:27], s59 offen sc0
    s_add_u32 s59, s59, 16384
    v_smfmac_f32_16x16x64_bf16 v[44:47], v[108:111], v[240:247], v88
    v_add_f32 v32, v32, v34
    v_add_f32 v33, v33, v35
    v_smfmac_f32_16x16x64_bf16 v[40:43], v[112:115], v[232:239], v88
    v_add_f32 v34, v36, v38
    v_add_f32 v35, v37, v39
    v_smfmac_f32_16x16x64_bf16 v[44:47], v[112:115], v[248:255], v88
    v_cvt_pk_f16_f32 v32, v32, v33
    v_cvt_pk_f16_f32 v33, v34, v35
    v_and_or_b32 v32, v32, -2, s92
    buffer_store_dwordx2 v[32:33], v12, s[24:27], s59 offen sc0
    s_add_u32 s59, s59, 16384
    s_nop 0
    s_nop 1
    v_pk_add_f32 v[40:41], v[40:41], v[42:43]
    v_pk_add_f32 v[42:43], v[44:45], v[46:47]
    v_cvt_pk_f16_f32 v40, v40, v41
    v_cvt_pk_f16_f32 v41, v42, v43
    v_and_or_b32 v40, v40, -2, s92
    buffer_store_dwordx2 v[40:41], v12, s[24:27], s59 offen sc0
    s_nop 7
    s_nop 7
    s_nop 7
    s_nop 7
    s_mov_b32 s31, 0
    v_lshrrev_b32 v31, 1, v1
    buffer_load_dwordx2 v[16:17], v31, s[24:27], s57 offen offset:0 sc1
    buffer_load_dwordx2 v[18:19], v31, s[24:27], s57 offen offset:512 sc1
    buffer_load_dwordx2 v[20:21], v31, s[24:27], s57 offen offset:1024 sc1
    buffer_load_dwordx2 v[22:23], v31, s[24:27], s57 offen offset:1536 sc1
    s_add_u32 s51, s51, 8192
    s_add_u32 s58, s51, s52
    v_bfe_u32 v100, v1, 6, 2
    s_movk_i32 s33, 0x3c00
    v_and_b32 v101, 1, v100
    v_lshlrev_b32 v101, 4, v101
    v_lshlrev_b32 v101, v101, s33
    v_cmp_gt_u32 vcc, 2, v100
    s_nop 1
    v_cndmask_b32 v96, 0, v101, vcc
    v_cndmask_b32 v97, v101, 0, vcc
    v_mov_b32 v98, v96
    v_mov_b32 v99, v97
    s_cmp_lg_u32 s92, 0
    s_cbranch_scc1 K3_PP_A1_L1
K3_PP_A1_L0:
    s_waitcnt vmcnt(0)
    v_mfma_f32_16x16x32_f16 v[120:123], v[96:99], v[16:19], 0
    v_mfma_f32_16x16x32_f16 v[120:123], v[96:99], v[20:23], v[120:123]
    v_or3_b32 v14, v16, v18, v20
    v_bitop3_b32 v14, v14, v22, 1 bitop3:0xa8
    v_cmp_ne_u32 vcc, 0, v14
    s_add_u32 s31, s31, 1
    s_cbranch_vccz K3_PP_A1_D
    s_mov_b64 exec, vcc
    buffer_load_dwordx2 v[16:17], v31, s[24:27], s57 offen offset:0 sc1
    buffer_load_dwordx2 v[18:19], v31, s[24:27], s57 offen offset:512 sc1
    buffer_load_dwordx2 v[20:21], v31, s[24:27], s57 offen offset:1024 sc1
    buffer_load_dwordx2 v[22:23], v31, s[24:27], s57 offen offset:1536 sc1
    s_cmp_gt_u32 s31, 0x40000
    s_cbranch_scc0 K3_PP_A1_L0
    s_branch K3_END
K3_PP_A1_L1:
    s_waitcnt vmcnt(0)
    v_mfma_f32_16x16x32_f16 v[120:123], v[96:99], v[16:19], 0
    v_mfma_f32_16x16x32_f16 v[120:123], v[96:99], v[20:23], v[120:123]
    v_bitop3_b32 v14, v16, v18, v20 bitop3:0x80
    v_bitop3_b32 v14, v14, v22, 1 bitop3:0x2a
    v_cmp_ne_u32 vcc, 0, v14
    s_add_u32 s31, s31, 1
    s_cbranch_vccz K3_PP_A1_D
    s_mov_b64 exec, vcc
    buffer_load_dwordx2 v[16:17], v31, s[24:27], s57 offen offset:0 sc1
    buffer_load_dwordx2 v[18:19], v31, s[24:27], s57 offen offset:512 sc1
    buffer_load_dwordx2 v[20:21], v31, s[24:27], s57 offen offset:1024 sc1
    buffer_load_dwordx2 v[22:23], v31, s[24:27], s57 offen offset:1536 sc1
    s_cmp_gt_u32 s31, 0x40000
    s_cbranch_scc0 K3_PP_A1_L1
    s_branch K3_END
K3_PP_A1_D:
    s_mov_b64 exec, -1
    s_nop 0
    s_nop 1
    v_add_f32_dpp v120, v120, v120 row_ror:8 row_mask:0xf bank_mask:0xf
    v_mov_b32 v14, -2
    s_nop 0
    v_mov_b32_dpp v121, v120 quad_perm:[1,0,3,2] row_mask:0xf bank_mask:0xf
    v_cvt_pk_bf16_f32 v120, v120, v121
    v_min_u32 v120, v120, v14
    buffer_store_dword v120, v13, s[24:27], s58 offen sc0
    v_mov_b64 v[48:49], 0
    v_mov_b64 v[50:51], 0
    v_mov_b64 v[52:53], 0
    v_mov_b64 v[54:55], 0
    v_mov_b64 v[56:57], 0
    v_mov_b64 v[58:59], 0
    v_mov_b64 v[60:61], 0
    v_mov_b64 v[62:63], 0
    v_mov_b64 v[64:65], 0
    v_mov_b64 v[66:67], 0
    v_mov_b64 v[68:69], 0
    v_mov_b64 v[70:71], 0
    s_add_u32 s30, s30, 1
    s_add_u32 s49, s49, 0x10000
    s_branch K3_STEP_A1
K3_PROJ_A1:
    ds_read_b128 v[24:27], v1 offset:2048
    ds_read_b128 v[28:31], v1 offset:3072
    ds_read_b128 v[16:19], v2 offset:0
    ds_read_b128 v[20:23], v2 offset:1024
    ds_read_b128 v[32:35], v2 offset:2048
    ds_read_b128 v[36:39], v2 offset:3072
    ds_read_b128 v[40:43], v2 offset:4096
    ds_read_b128 v[44:47], v2 offset:5120
    ds_read_b128 v[120:123], v2 offset:6144
    ds_read_b128 v[124:127], v2 offset:7168
    ds_read_b128 v[96:99], v2 offset:8192
    ds_read_b128 v[100:103], v2 offset:9216
    ds_read_b128 v[104:107], v2 offset:10240
    ds_read_b128 v[108:111], v2 offset:11264
    ds_read_b128 v[112:115], v2 offset:12288
    ds_read_b128 v[116:119], v2 offset:13312
    ds_read_b128 v[80:83], v2 offset:14336
    ds_read_b128 v[84:87], v2 offset:15360
    s_waitcnt lgkmcnt(0)
    s_branch K3_OWN_A1
K3_LAST_A1:
    s_add_u32 s50, s50, 0x10000
    buffer_store_dword v94, v8, s[24:27], s50 offen sc1
    buffer_store_dword v95, v8, s[24:27], s50 offen offset:64 sc1
    s_waitcnt vmcnt(0)
    v_mov_b32 v14, 1
    s_mov_b64 exec, 1
    buffer_store_byte v14, off, s[24:27], s65 sc1
    s_endpgm
K3_PFSLOW_A1:
    s_cmp_eq_u32 s30, 63
    s_cbranch_scc1 K3_PFOK_A1
    s_mov_b32 s31, 0
K3_PFS2_A1:
    buffer_load_dword v3, off, s[24:27], s64 sc1
    s_waitcnt vmcnt(0)
    v_readfirstlane_b32 s32, v3
    s_add_u32 s31, s31, 1
    s_cmp_gt_u32 s31, 0x40000
    s_cbranch_scc1 K3_END
    s_cmp_lg_u32 s32, s67
    s_cbranch_scc1 K3_PFS2_A1
    s_branch K3_PFOK_A1
K3_STEP_A2:
    s_nop 7
    s_nop 7
    s_nop 7
    s_nop 7
    s_nop 7
    s_nop 7
    s_nop 7
    s_mov_b32 s31, 0
    buffer_load_dwordx4 v[32:35], v0, s[24:27], s51 offen sc1
    buffer_load_dwordx4 v[36:39], v0, s[24:27], s51 offen offset:1024 sc1
    s_and_b32 s32, s30, 1
    s_lshl_b32 s32, s32, 19
    s_lshl_b32 s33, s28, 6
    s_add_u32 s59, s32, s33
    s_add_u32 s59, s59, 0x300000
    s_lshl_b32 s33, s28, 13
    s_add_u32 s57, s32, s33
    s_add_u32 s57, s57, 0x300000
    s_add_u32 s57, s57, s66
    s_lshr_b32 s92, s30, 1
    s_and_b32 s92, s92, 1
    s_add_u32 s50, s50, 0x10000
    s_add_u32 s48, s48, 0x40000
    s_add_u32 s47, s47, 0x40000
    ds_read_b128 v[16:19], v2 offset:0
    ds_read_b128 v[20:23], v2 offset:1024
    ds_read_b128 v[24:27], v2 offset:2048
    ds_read_b128 v[28:31], v2 offset:3072
    ds_read_b128 v[40:43], v2 offset:4096
    ds_read_b128 v[44:47], v2 offset:5120
    ds_read_b128 v[120:123], v2 offset:6144
    ds_read_b128 v[124:127], v2 offset:7168
    ds_read_b128 v[96:99], v2 offset:8192
    ds_read_b128 v[100:103], v2 offset:9216
    ds_read_b128 v[104:107], v2 offset:10240
    ds_read_b128 v[108:111], v2 offset:11264
    ds_read_b128 v[112:115], v2 offset:12288
    ds_read_b128 v[116:119], v2 offset:13312
    ds_read_b128 v[80:83], v2 offset:14336
    ds_read_b128 v[84:87], v2 offset:15360
K3_PM_A2_L:
    s_waitcnt vmcnt(0) lgkmcnt(0)
    v_max3_u32 v14, v32, v33, v34
    v_max3_u32 v14, v14, v35, v36
    v_max3_u32 v14, v14, v37, v38
    v_max_u32 v14, v14, v39
    v_cmp_eq_u32 vcc, -1, v14
    s_add_u32 s31, s31, 1
    s_cbranch_vccz K3_PM_A2_D
    s_mov_b64 exec, vcc
    buffer_load_dwordx4 v[32:35], v0, s[24:27], s51 offen sc1
    buffer_load_dwordx4 v[36:39], v0, s[24:27], s51 offen offset:1024 sc1
    s_cmp_gt_u32 s31, 0x40000
    s_cbranch_scc0 K3_PM_A2_L
    s_branch K3_END
K3_PM_A2_D:
    s_mov_b64 exec, -1
    ds_write_b128 v0, v[32:35]
    ds_write_b128 v0, v[36:39] offset:1024
K3_OWN_A2:
    v_smfmac_f32_16x16x64_bf16 v[48:51], v[32:35], v[16:23], v88
    v_smfmac_f32_16x16x64_bf16 v[52:55], v[32:35], v[24:31], v88
    v_smfmac_f32_16x16x64_bf16 v[48:51], v[36:39], v[40:47], v88
    v_smfmac_f32_16x16x64_bf16 v[52:55], v[36:39], v[120:127], v88
    s_waitcnt lgkmcnt(0)
    s_barrier
    ds_read_b128 v[40:43], v1 offset:6144
    ds_read_b128 v[44:47], v1 offset:7168
    ds_read_b128 v[16:19], v1 offset:0
    ds_read_b128 v[20:23], v1 offset:1024
    ds_read_b128 v[24:27], v1 offset:2048
    ds_read_b128 v[28:31], v1 offset:3072
    v_smfmac_f32_16x16x64_bf16 v[56:59], v[32:35], v[96:103], v88
    v_smfmac_f32_16x16x64_bf16 v[60:63], v[32:35], v[104:111], v88
    v_smfmac_f32_16x16x64_bf16 v[56:59], v[36:39], v[112:119], v88
    v_smfmac_f32_16x16x64_bf16 v[60:63], v[36:39], v[80:87], v88
    v_smfmac_f32_16x16x64_bf16 v[64:67], v[32:35], a[32:39], v88
    v_smfmac_f32_16x16x64_bf16 v[68:71], v[32:35], a[96:103], v88
    s_waitcnt lgkmcnt(5)
    v_smfmac_f32_16x16x64_bf16 v[48:51], v[40:43], a[48:55], v88
    s_nop 1
    v_smfmac_f32_16x16x64_bf16 v[52:55], v[40:43], a[112:119], v88
    buffer_store_dword v94, v8, s[24:27], s50 offen sc1
    s_waitcnt lgkmcnt(4)
    v_smfmac_f32_16x16x64_bf16 v[48:51], v[44:47], a[56:63], v88
    s_nop 1
    v_smfmac_f32_16x16x64_bf16 v[52:55], v[44:47], a[120:127], v88
    buffer_store_dword v95, v8, s[24:27], s50 offen offset:64 sc1
    s_waitcnt lgkmcnt(3)
    v_smfmac_f32_16x16x64_bf16 v[48:51], v[16:19], a[0:7], v88
    s_nop 1
    v_smfmac_f32_16x16x64_bf16 v[52:55], v[16:19], a[64:71], v88
    buffer_load_dwordx4 v[80:83], v6, s[24:27], s48 offen sc1
    s_waitcnt lgkmcnt(2)
    v_smfmac_f32_16x16x64_bf16 v[48:51], v[20:23], a[8:15], v88
    s_nop 1
    v_smfmac_f32_16x16x64_bf16 v[52:55], v[20:23], a[72:79], v88
    buffer_load_dwordx4 v[84:87], v6, s[24:27], s48 offen offset:256 sc1
    s_waitcnt lgkmcnt(1)
    v_smfmac_f32_16x16x64_bf16 v[48:51], v[24:27], a[16:23], v88
    s_nop 1
    v_smfmac_f32_16x16x64_bf16 v[52:55], v[24:27], a[80:87], v88
    s_nop 0
    s_waitcnt lgkmcnt(0)
    v_smfmac_f32_16x16x64_bf16 v[48:51], v[28:31], a[24:31], v88
    s_nop 1
    v_smfmac_f32_16x16x64_bf16 v[52:55], v[28:31], a[88:95], v88
    s_waitcnt vmcnt(4)
    s_nop 0
    v_smfmac_f32_16x16x64_bf16 v[56:59], v[40:43], a[176:183], v88
    ds_read_b128 v[96:99], v2 offset:28672
    ds_read_b128 v[100:103], v2 offset:29696
    v_smfmac_f32_16x16x64_bf16 v[60:63], v[40:43], a[240:247], v88
    ds_read_b128 v[104:107], v2 offset:30720
    ds_read_b128 v[108:111], v2 offset:31744
    v_smfmac_f32_16x16x64_bf16 v[56:59], v[44:47], a[184:191], v88
    v_add_f32 v48, v48, v50
    v_add_f32 v49, v49, v51
    v_smfmac_f32_16x16x64_bf16 v[60:63], v[44:47], a[248:255], v88
    v_add_f32 v52, v52, v54
    v_add_f32 v53, v53, v55
    v_smfmac_f32_16x16x64_bf16 v[56:59], v[16:19], a[128:135], v88
    v_cvt_pk_bf16_f32 v50, v48, v49
    v_cvt_pk_bf16_f32 v51, v52, v53
    v_smfmac_f32_16x16x64_bf16 v[60:63], v[16:19], a[192:199], v88
    ds_read_b128 v[112:115], v2 offset:16384
    ds_read_b128 v[116:119], v2 offset:17408
    v_mfma_f32_16x16x16_bf16 v[52:55], v[50:51], v[90:91], 0
    v_readfirstlane_b32 s69, v3
    s_nop 1
    v_mfma_f32_16x16x16_bf16 v[120:123], v[50:51], v[92:93], 0
    s_nop 2
    v_smfmac_f32_16x16x64_bf16 v[56:59], v[20:23], a[136:143], v88
    v_cvt_pk_bf16_f32 v52, v52, v53
    v_cvt_pk_bf16_f32 v53, v54, v55
    v_smfmac_f32_16x16x64_bf16 v[60:63], v[20:23], a[200:207], v88
    s_nop 0
    v_cvt_pk_bf16_f32 v54, v120, v121
    v_smfmac_f32_16x16x64_bf16 v[56:59], v[24:27], a[144:151], v88
    v_cvt_pk_bf16_f32 v55, v122, v123
    s_nop 0
    v_smfmac_f32_16x16x64_bf16 v[60:63], v[24:27], a[208:215], v88
    s_nop 1
    v_smfmac_f32_16x16x64_bf16 v[56:59], v[28:31], a[152:159], v88
    s_cmp_eq_u32 s69, s67
    s_cbranch_scc0 K3_PFSLOW_A2
K3_PFOK_A2:
    v_smfmac_f32_16x16x64_bf16 v[60:63], v[28:31], a[216:223], v88
    s_nop 1
    v_mfma_f32_16x16x32_bf16 v[48:51], v[72:75], v[52:55], 0
    s_nop 2
    v_mfma_f32_16x16x32_bf16 v[120:123], v[76:79], v[52:55], 0
    s_nop 4
    v_add_f32 v56, v56, v58
    v_add_f32 v57, v57, v59
    v_add_f32 v60, v60, v62
    v_add_f32 v61, v61, v63
    v_cvt_pk_bf16_f32 v58, v56, v57
    v_cvt_pk_bf16_f32 v59, v60, v61
    ds_write_b128 v4, v[48:51] offset:512
    ds_write_b128 v4, v[120:123] offset:1024
    v_mfma_f32_16x16x16_bf16 v[60:63], v[58:59], v[90:91], 0
    v_mfma_f32_16x16x16_bf16 v[48:51], v[58:59], v[92:93], 0
    s_waitcnt lgkmcnt(6)
    v_smfmac_f32_16x16x64_bf16 v[64:67], v[44:47], v[96:103], v88
    ds_read_b128 v[96:99], v2 offset:18432
    ds_read_b128 v[100:103], v2 offset:19456
    s_waitcnt lgkmcnt(6)
    v_smfmac_f32_16x16x64_bf16 v[68:71], v[44:47], v[104:111], v88
    ds_read_b128 v[104:107], v2 offset:20480
    ds_read_b128 v[108:111], v2 offset:21504
    s_nop 1
    v_cvt_pk_bf16_f32 v124, v60, v61
    v_cvt_pk_bf16_f32 v125, v62, v63
    v_cvt_pk_bf16_f32 v126, v48, v49
    v_cvt_pk_bf16_f32 v127, v50, v51
    s_nop 1
    v_mfma_f32_16x16x32_bf16 v[56:59], v[124:127], v[52:55], 0
    v_smfmac_f32_16x16x64_bf16 v[64:67], v[16:19], a[40:47], v88
    v_smfmac_f32_16x16x64_bf16 v[68:71], v[16:19], a[104:111], v88
    s_nop 5
    ds_write_b128 v4, v[56:59]
    v_smfmac_f32_16x16x64_bf16 v[64:67], v[24:27], a[160:167], v88
    v_smfmac_f32_16x16x64_bf16 v[68:71], v[24:27], a[224:231], v88
    buffer_load_dwordx4 v[72:75], v5, s[24:27], s47 offen sc1
    buffer_load_dwordx4 v[76:79], v5, s[24:27], s47 offen offset:1024 sc1
    s_add_u32 s64, s64, 4
    buffer_load_dword v3, off, s[24:27], s64 sc1
    s_waitcnt lgkmcnt(0)
    s_barrier
    ds_read_b128 v[48:51], v9 offset:0
    ds_read_b128 v[52:55], v9 offset:1536
    ds_read_b128 v[56:59], v9 offset:3072
    ds_read_b128 v[60:63], v9 offset:4608
    ds_read_b32 v120, v15 offset:0
    ds_read_b32 v121, v15 offset:1536
    ds_read_b32 v122, v15 offset:3072
    ds_read_b32 v123, v15 offset:4608
    buffer_store_dwordx4 v[124:127], v7, s[24:27], s49 offen sc1
    v_smfmac_f32_16x16x64_bf16 v[64:67], v[20:23], v[112:119], v88
    ds_read_b128 v[112:115], v2 offset:22528
    ds_read_b128 v[116:119], v2 offset:23552
    v_smfmac_f32_16x16x64_bf16 v[68:71], v[20:23], v[96:103], v88
    ds_read_b128 v[96:99], v2 offset:24576
    ds_read_b128 v[100:103], v2 offset:25600
    s_waitcnt vmcnt(6)
    v_mov_b32 v14, 1
    s_mov_b64 exec, 1
    buffer_store_byte v14, off, s[24:27], s65 sc1
    s_mov_b64 exec, s[36:37]
    s_mov_b32 s65, s68
    s_add_u32 s68, s68, 4
    s_waitcnt lgkmcnt(8)
    v_pk_add_f32 v[48:49], v[48:49], v[52:53]
    v_pk_add_f32 v[50:51], v[50:51], v[54:55]
    v_pk_add_f32 v[56:57], v[56:57], v[60:61]
    v_pk_add_f32 v[58:59], v[58:59], v[62:63]
    s_waitcnt lgkmcnt(4)
    v_pk_add_f32 v[120:121], v[120:121], v[122:123]
    v_pk_add_f32 v[48:49], v[48:49], v[56:57]
    v_pk_add_f32 v[50:51], v[50:51], v[58:59]
    v_add_f32 v52, v120, v121
    v_cvt_pk_bf16_f32 v56, v48, v49
    v_cvt_pk_bf16_f32 v57, v50, v51
    v_cvt_pk_bf16_f32 v58, v52, v52
    v_lshlrev_b32 v48, 16, v56
    v_and_b32 v49, 0xffff0000, v56
    v_lshlrev_b32 v50, 16, v57
    v_and_b32 v51, 0xffff0000, v57
    v_lshlrev_b32 v52, 16, v58
    v_pk_mul_f32 v[48:49], v[48:49], s[54:55] op_sel_hi:[1,0]
    v_pk_mul_f32 v[50:51], v[50:51], s[54:55] op_sel_hi:[1,0]
    v_mul_f32 v52, s54, v52
    v_cvt_pk_bf16_f32 v56, v48, v49
    v_cvt_pk_bf16_f32 v57, v50, v51
    v_cvt_pk_bf16_f32 v58, v52, v52
    v_lshlrev_b32 v48, 16, v56
    v_and_b32 v49, 0xffff0000, v56
    v_lshlrev_b32 v50, 16, v57
    v_and_b32 v51, 0xffff0000, v57
    v_lshlrev_b32 v52, 16, v58
    v_max3_f32 v14, v48, v49, v50
    v_max3_f32 v14, v14, v51, v52
    v_smfmac_f32_16x16x64_bf16 v[64:67], v[28:31], v[104:111], v88
    ds_read_b128 v[104:107], v2 offset:26624
    ds_read_b128 v[108:111], v2 offset:27648
    s_nop 0
    v_max_f32_dpp v14, v14, v14 row_ror:8 row_mask:0xf bank_mask:0xf
    v_mov_b32 v56, v14
    s_waitcnt lgkmcnt(4)
    v_smfmac_f32_16x16x64_bf16 v[68:71], v[28:31], v[112:119], v88
    s_nop 0
    v_permlane16_swap_b32 v14, v56
    v_max_f32 v14, v14, v56
    v_mov_b32 v56, v14
    s_waitcnt lgkmcnt(2)
    v_smfmac_f32_16x16x64_bf16 v[64:67], v[36:39], v[96:103], v88
    s_nop 0
    v_permlane32_swap_b32 v14, v56
    v_max_f32 v14, v14, v56
    v_mul_f32 v14, s55, v14
    v_pk_fma_f32 v[48:49], v[48:49], s[54:55], v[14:15] op_sel:[0,1,0] op_sel_hi:[1,1,0] neg_lo:[0,0,1] neg_hi:[0,0,1]
    v_pk_fma_f32 v[50:51], v[50:51], s[54:55], v[14:15] op_sel:[0,1,0] op_sel_hi:[1,1,0] neg_lo:[0,0,1] neg_hi:[0,0,1]
    v_fma_f32 v52, v52, s55, -v14
    v_exp_f32 v48, v48
    v_exp_f32 v49, v49
    v_exp_f32 v50, v50
    v_exp_f32 v51, v51
    v_exp_f32 v52, v52
    v_mov_b32 v125, 0
    v_mov_b32 v126, 0
    v_add_f32 v14, v48, v49
    v_add_f32 v56, v50, v51
    v_add_f32 v14, v14, v52
    v_add_f32 v14, v14, v56
    s_waitcnt lgkmcnt(0)
    v_smfmac_f32_16x16x64_bf16 v[68:71], v[36:39], v[104:111], v88
    s_nop 0
    v_add_f32_dpp v14, v14, v14 row_ror:8 row_mask:0xf bank_mask:0xf
    v_mov_b32 v56, v14
    v_smfmac_f32_16x16x64_bf16 v[64:67], v[40:43], a[168:175], v88
    s_nop 0
    v_permlane16_swap_b32 v14, v56
    v_add_f32 v14, v14, v56
    v_mov_b32 v56, v14
    v_smfmac_f32_16x16x64_bf16 v[68:71], v[40:43], a[232:239], v88
    s_nop 0
    v_permlane32_swap_b32 v14, v56
    v_add_f32 v14, v14, v56
    v_rcp_f32 v14, v14
    s_nop 0
    v_pk_mul_f32 v[48:49], v[48:49], v[14:15] op_sel_hi:[1,0]
    v_pk_mul_f32 v[50:51], v[50:51], v[14:15] op_sel_hi:[1,0]
    v_mul_f32 v52, v52, v14
    v_cvt_pk_bf16_f32 v120, v48, v49
    v_cvt_pk_bf16_f32 v121, v50, v51
    v_mov_b32_dpp v53, v52 row_ror:8 row_mask:0xf bank_mask:0xf
    v_mov_b32_dpp v122, v120 row_ror:8 row_mask:0xf bank_mask:0xf
    v_mov_b32_dpp v123, v121 row_ror:8 row_mask:0xf bank_mask:0xf
    v_cvt_pk_bf16_f32 v124, v52, v53
    v_cvt_pk_bf16_f32 v127, v52, v53
    s_waitcnt vmcnt(5)
    v_mfma_f32_16x16x32_bf16 v[96:99], v[80:83], v[120:123], 0
    v_add_f32 v64, v64, v66
    v_add_f32 v65, v65, v67
    v_mfma_f32_16x16x32_bf16 v[100:103], v[84:87], v[120:123], 0
    v_add_f32 v68, v68, v70
    v_add_f32 v69, v69, v71
    v_cvt_pk_bf16_f32 v94, v64, v65
    v_cvt_pk_bf16_f32 v95, v68, v69
    s_cmp_eq_u32 s30, 63
    s_cbranch_scc1 K3_LAST_A2
    v_mfma_f32_16x16x16_bf16 v[96:99], v[94:95], v[124:125], v[96:99]
    v_mfma_f32_16x16x16_bf16 v[100:103], v[94:95], v[126:127], v[100:103]
    v_mov_b64 v[16:17], 0
    v_mov_b64 v[18:19], 0
    v_mov_b64 v[20:21], 0
    v_mov_b64 v[22:23], 0
    v_mov_b64 v[24:25], 0
    v_mov_b64 v[26:27], 0
    v_mov_b64 v[28:29], 0
    v_mov_b64 v[30:31], 0
    v_cvt_pk_bf16_f32 v104, v96, v97
    v_cvt_pk_bf16_f32 v106, v98, v99
    v_cvt_pk_bf16_f32 v105, v100, v101
    v_cvt_pk_bf16_f32 v107, v102, v103
    ds_write2_b64 v10, v[104:105], v[106:107] offset0:0 offset1:4
    v_mov_b64 v[32:33], 0
    v_mov_b64 v[34:35], 0
    v_mov_b64 v[36:37], 0
    v_mov_b64 v[38:39], 0
    s_waitcnt lgkmcnt(0)
    s_barrier
    ds_read_b128 v[108:111], v11
    ds_read_b128 v[112:115], v11 offset:1024
    v_mov_b64 v[40:41], 0
    v_mov_b64 v[42:43], 0
    v_mov_b64 v[44:45], 0
    v_mov_b64 v[46:47], 0
    s_waitcnt lgkmcnt(0)
    v_smfmac_f32_16x16x64_bf16 v[16:19], v[108:111], v[128:135], v88
    s_nop 2
    v_smfmac_f32_16x16x64_bf16 v[20:23], v[108:111], v[144:151], v88
    s_nop 2
    v_smfmac_f32_16x16x64_bf16 v[16:19], v[112:115], v[136:143], v88
    s_nop 2
    v_smfmac_f32_16x16x64_bf16 v[20:23], v[112:115], v[152:159], v88
    v_smfmac_f32_16x16x64_bf16 v[24:27], v[108:111], v[160:167], v88
    s_nop 2
    v_smfmac_f32_16x16x64_bf16 v[28:31], v[108:111], v[176:183], v88
    v_add_f32 v16, v16, v18
    v_add_f32 v17, v17, v19
    v_smfmac_f32_16x16x64_bf16 v[24:27], v[112:115], v[168:175], v88
    v_add_f32 v18, v20, v22
    v_add_f32 v19, v21, v23
    v_smfmac_f32_16x16x64_bf16 v[28:31], v[112:115], v[184:191], v88
    v_cvt_pk_f16_f32 v16, v16, v17
    v_cvt_pk_f16_f32 v17, v18, v19
    v_smfmac_f32_16x16x64_bf16 v[32:35], v[108:111], v[192:199], v88
    v_and_or_b32 v16, v16, -2, s92
    buffer_store_dwordx2 v[16:17], v12, s[24:27], s59 offen sc0
    s_add_u32 s59, s59, 16384
    v_smfmac_f32_16x16x64_bf16 v[36:39], v[108:111], v[208:215], v88
    v_add_f32 v24, v24, v26
    v_add_f32 v25, v25, v27
    v_smfmac_f32_16x16x64_bf16 v[32:35], v[112:115], v[200:207], v88
    v_add_f32 v26, v28, v30
    v_add_f32 v27, v29, v31
    v_smfmac_f32_16x16x64_bf16 v[36:39], v[112:115], v[216:223], v88
    v_cvt_pk_f16_f32 v24, v24, v25
    v_cvt_pk_f16_f32 v25, v26, v27
    v_smfmac_f32_16x16x64_bf16 v[40:43], v[108:111], v[224:231], v88
    v_and_or_b32 v24, v24, -2, s92
    buffer_store_dwordx2 v[24:25], v12, s[24:27], s59 offen sc0
    s_add_u32 s59, s59, 16384
    v_smfmac_f32_16x16x64_bf16 v[44:47], v[108:111], v[240:247], v88
    v_add_f32 v32, v32, v34
    v_add_f32 v33, v33, v35
    v_smfmac_f32_16x16x64_bf16 v[40:43], v[112:115], v[232:239], v88
    v_add_f32 v34, v36, v38
    v_add_f32 v35, v37, v39
    v_smfmac_f32_16x16x64_bf16 v[44:47], v[112:115], v[248:255], v88
    v_cvt_pk_f16_f32 v32, v32, v33
    v_cvt_pk_f16_f32 v33, v34, v35
    v_and_or_b32 v32, v32, -2, s92
    buffer_store_dwordx2 v[32:33], v12, s[24:27], s59 offen sc0
    s_add_u32 s59, s59, 16384
    s_nop 0
    s_nop 1
    v_pk_add_f32 v[40:41], v[40:41], v[42:43]
    v_pk_add_f32 v[42:43], v[44:45], v[46:47]
    v_cvt_pk_f16_f32 v40, v40, v41
    v_cvt_pk_f16_f32 v41, v42, v43
    v_and_or_b32 v40, v40, -2, s92
    buffer_store_dwordx2 v[40:41], v12, s[24:27], s59 offen sc0
    s_nop 7
    s_nop 7
    s_nop 7
    s_nop 7
    s_mov_b32 s31, 0
    v_lshrrev_b32 v31, 1, v1
    buffer_load_dwordx2 v[16:17], v31, s[24:27], s57 offen offset:0 sc1
    buffer_load_dwordx2 v[18:19], v31, s[24:27], s57 offen offset:512 sc1
    buffer_load_dwordx2 v[20:21], v31, s[24:27], s57 offen offset:1024 sc1
    buffer_load_dwordx2 v[22:23], v31, s[24:27], s57 offen offset:1536 sc1
    s_add_u32 s51, s51, 8192
    s_add_u32 s58, s51, s52
    v_bfe_u32 v100, v1, 6, 2
    s_movk_i32 s33, 0x3c00
    v_and_b32 v101, 1, v100
    v_lshlrev_b32 v101, 4, v101
    v_lshlrev_b32 v101, v101, s33
    v_cmp_gt_u32 vcc, 2, v100
    s_nop 1
    v_cndmask_b32 v96, 0, v101, vcc
    v_cndmask_b32 v97, v101, 0, vcc
    v_mov_b32 v98, v96
    v_mov_b32 v99, v97
    s_cmp_lg_u32 s92, 0
    s_cbranch_scc1 K3_PP_A2_L1
K3_PP_A2_L0:
    s_waitcnt vmcnt(0)
    v_mfma_f32_16x16x32_f16 v[120:123], v[96:99], v[16:19], 0
    v_mfma_f32_16x16x32_f16 v[120:123], v[96:99], v[20:23], v[120:123]
    v_or3_b32 v14, v16, v18, v20
    v_bitop3_b32 v14, v14, v22, 1 bitop3:0xa8
    v_cmp_ne_u32 vcc, 0, v14
    s_add_u32 s31, s31, 1
    s_cbranch_vccz K3_PP_A2_D
    s_mov_b64 exec, vcc
    buffer_load_dwordx2 v[16:17], v31, s[24:27], s57 offen offset:0 sc1
    buffer_load_dwordx2 v[18:19], v31, s[24:27], s57 offen offset:512 sc1
    buffer_load_dwordx2 v[20:21], v31, s[24:27], s57 offen offset:1024 sc1
    buffer_load_dwordx2 v[22:23], v31, s[24:27], s57 offen offset:1536 sc1
    s_cmp_gt_u32 s31, 0x40000
    s_cbranch_scc0 K3_PP_A2_L0
    s_branch K3_END
K3_PP_A2_L1:
    s_waitcnt vmcnt(0)
    v_mfma_f32_16x16x32_f16 v[120:123], v[96:99], v[16:19], 0
    v_mfma_f32_16x16x32_f16 v[120:123], v[96:99], v[20:23], v[120:123]
    v_bitop3_b32 v14, v16, v18, v20 bitop3:0x80
    v_bitop3_b32 v14, v14, v22, 1 bitop3:0x2a
    v_cmp_ne_u32 vcc, 0, v14
    s_add_u32 s31, s31, 1
    s_cbranch_vccz K3_PP_A2_D
    s_mov_b64 exec, vcc
    buffer_load_dwordx2 v[16:17], v31, s[24:27], s57 offen offset:0 sc1
    buffer_load_dwordx2 v[18:19], v31, s[24:27], s57 offen offset:512 sc1
    buffer_load_dwordx2 v[20:21], v31, s[24:27], s57 offen offset:1024 sc1
    buffer_load_dwordx2 v[22:23], v31, s[24:27], s57 offen offset:1536 sc1
    s_cmp_gt_u32 s31, 0x40000
    s_cbranch_scc0 K3_PP_A2_L1
    s_branch K3_END
K3_PP_A2_D:
    s_mov_b64 exec, -1
    s_nop 0
    s_nop 1
    v_add_f32_dpp v120, v120, v120 row_ror:8 row_mask:0xf bank_mask:0xf
    v_mov_b32 v14, -2
    s_nop 0
    v_mov_b32_dpp v121, v120 quad_perm:[1,0,3,2] row_mask:0xf bank_mask:0xf
    v_cvt_pk_bf16_f32 v120, v120, v121
    v_min_u32 v120, v120, v14
    buffer_store_dword v120, v13, s[24:27], s58 offen sc0
    v_mov_b64 v[48:49], 0
    v_mov_b64 v[50:51], 0
    v_mov_b64 v[52:53], 0
    v_mov_b64 v[54:55], 0
    v_mov_b64 v[56:57], 0
    v_mov_b64 v[58:59], 0
    v_mov_b64 v[60:61], 0
    v_mov_b64 v[62:63], 0
    v_mov_b64 v[64:65], 0
    v_mov_b64 v[66:67], 0
    v_mov_b64 v[68:69], 0
    v_mov_b64 v[70:71], 0
    s_add_u32 s30, s30, 1
    s_add_u32 s49, s49, 0x10000
    s_branch K3_STEP_A2
K3_PROJ_A2:
    ds_read_b128 v[32:35], v1 offset:4096
    ds_read_b128 v[36:39], v1 offset:5120
    ds_read_b128 v[16:19], v2 offset:0
    ds_read_b128 v[20:23], v2 offset:1024
    ds_read_b128 v[24:27], v2 offset:2048
    ds_read_b128 v[28:31], v2 offset:3072
    ds_read_b128 v[40:43], v2 offset:4096
    ds_read_b128 v[44:47], v2 offset:5120
    ds_read_b128 v[120:123], v2 offset:6144
    ds_read_b128 v[124:127], v2 offset:7168
    ds_read_b128 v[96:99], v2 offset:8192
    ds_read_b128 v[100:103], v2 offset:9216
    ds_read_b128 v[104:107], v2 offset:10240
    ds_read_b128 v[108:111], v2 offset:11264
    ds_read_b128 v[112:115], v2 offset:12288
    ds_read_b128 v[116:119], v2 offset:13312
    ds_read_b128 v[80:83], v2 offset:14336
    ds_read_b128 v[84:87], v2 offset:15360
    s_waitcnt lgkmcnt(0)
    s_branch K3_OWN_A2
K3_LAST_A2:
    s_add_u32 s50, s50, 0x10000
    buffer_store_dword v94, v8, s[24:27], s50 offen sc1
    buffer_store_dword v95, v8, s[24:27], s50 offen offset:64 sc1
    s_waitcnt vmcnt(0)
    v_mov_b32 v14, 1
    s_mov_b64 exec, 1
    buffer_store_byte v14, off, s[24:27], s65 sc1
    s_endpgm
K3_PFSLOW_A2:
    s_cmp_eq_u32 s30, 63
    s_cbranch_scc1 K3_PFOK_A2
    s_mov_b32 s31, 0
K3_PFS2_A2:
    buffer_load_dword v3, off, s[24:27], s64 sc1
    s_waitcnt vmcnt(0)
    v_readfirstlane_b32 s32, v3
    s_add_u32 s31, s31, 1
    s_cmp_gt_u32 s31, 0x40000
    s_cbranch_scc1 K3_END
    s_cmp_lg_u32 s32, s67
    s_cbranch_scc1 K3_PFS2_A2
    s_branch K3_PFOK_A2
K3_STEP_A3:
    s_nop 7
    s_nop 7
    s_nop 7
    s_nop 7
    s_nop 7
    s_nop 7
    s_nop 7
    s_mov_b32 s31, 0
    buffer_load_dwordx4 v[40:43], v0, s[24:27], s51 offen sc1
    buffer_load_dwordx4 v[44:47], v0, s[24:27], s51 offen offset:1024 sc1
    s_and_b32 s32, s30, 1
    s_lshl_b32 s32, s32, 19
    s_lshl_b32 s33, s28, 6
    s_add_u32 s59, s32, s33
    s_add_u32 s59, s59, 0x300000
    s_lshl_b32 s33, s28, 13
    s_add_u32 s57, s32, s33
    s_add_u32 s57, s57, 0x300000
    s_add_u32 s57, s57, s66
    s_lshr_b32 s92, s30, 1
    s_and_b32 s92, s92, 1
    s_add_u32 s50, s50, 0x10000
    s_add_u32 s48, s48, 0x40000
    s_add_u32 s47, s47, 0x40000
    ds_read_b128 v[16:19], v2 offset:0
    ds_read_b128 v[20:23], v2 offset:1024
    ds_read_b128 v[24:27], v2 offset:2048
    ds_read_b128 v[28:31], v2 offset:3072
    ds_read_b128 v[32:35], v2 offset:4096
    ds_read_b128 v[36:39], v2 offset:5120
    ds_read_b128 v[120:123], v2 offset:6144
    ds_read_b128 v[124:127], v2 offset:7168
    ds_read_b128 v[96:99], v2 offset:8192
    ds_read_b128 v[100:103], v2 offset:9216
    ds_read_b128 v[104:107], v2 offset:10240
    ds_read_b128 v[108:111], v2 offset:11264
    ds_read_b128 v[112:115], v2 offset:12288
    ds_read_b128 v[116:119], v2 offset:13312
    ds_read_b128 v[80:83], v2 offset:14336
    ds_read_b128 v[84:87], v2 offset:15360
K3_PM_A3_L:
    s_waitcnt vmcnt(0) lgkmcnt(0)
    v_max3_u32 v14, v40, v41, v42
    v_max3_u32 v14, v14, v43, v44
    v_max3_u32 v14, v14, v45, v46
    v_max_u32 v14, v14, v47
    v_cmp_eq_u32 vcc, -1, v14
    s_add_u32 s31, s31, 1
    s_cbranch_vccz K3_PM_A3_D
    s_mov_b64 exec, vcc
    buffer_load_dwordx4 v[40:43], v0, s[24:27], s51 offen sc1
    buffer_load_dwordx4 v[44:47], v0, s[24:27], s51 offen offset:1024 sc1
    s_cmp_gt_u32 s31, 0x40000
    s_cbranch_scc0 K3_PM_A3_L
    s_branch K3_END
K3_PM_A3_D:
    s_mov_b64 exec, -1
    ds_write_b128 v0, v[40:43]
    ds_write_b128 v0, v[44:47] offset:1024
K3_OWN_A3:
    v_smfmac_f32_16x16x64_bf16 v[48:51], v[40:43], v[16:23], v88
    v_smfmac_f32_16x16x64_bf16 v[52:55], v[40:43], v[24:31], v88
    v_smfmac_f32_16x16x64_bf16 v[48:51], v[44:47], v[32:39], v88
    v_smfmac_f32_16x16x64_bf16 v[52:55], v[44:47], v[120:127], v88
    s_waitcnt lgkmcnt(0)
    s_barrier
    ds_read_b128 v[16:19], v1 offset:0
    ds_read_b128 v[20:23], v1 offset:1024
    ds_read_b128 v[24:27], v1 offset:2048
    ds_read_b128 v[28:31], v1 offset:3072
    ds_read_b128 v[32:35], v1 offset:4096
    ds_read_b128 v[36:39], v1 offset:5120
    v_smfmac_f32_16x16x64_bf16 v[56:59], v[40:43], v[96:103], v88
    v_smfmac_f32_16x16x64_bf16 v[60:63], v[40:43], v[104:111], v88
    v_smfmac_f32_16x16x64_bf16 v[56:59], v[44:47], v[112:119], v88
    v_smfmac_f32_16x16x64_bf16 v[60:63], v[44:47], v[80:87], v88
    v_smfmac_f32_16x16x64_bf16 v[64:67], v[40:43], a[48:55], v88
    v_smfmac_f32_16x16x64_bf16 v[68:71], v[40:43], a[112:119], v88
    s_waitcnt lgkmcnt(5)
    v_smfmac_f32_16x16x64_bf16 v[48:51], v[16:19], a[0:7], v88
    s_nop 1
    v_smfmac_f32_16x16x64_bf16 v[52:55], v[16:19], a[64:71], v88
    buffer_store_dword v94, v8, s[24:27], s50 offen sc1
    s_waitcnt lgkmcnt(4)
    v_smfmac_f32_16x16x64_bf16 v[48:51], v[20:23], a[8:15], v88
    s_nop 1
    v_smfmac_f32_16x16x64_bf16 v[52:55], v[20:23], a[72:79], v88
    buffer_store_dword v95, v8, s[24:27], s50 offen offset:64 sc1
    s_waitcnt lgkmcnt(3)
    v_smfmac_f32_16x16x64_bf16 v[48:51], v[24:27], a[16:23], v88
    s_nop 1
    v_smfmac_f32_16x16x64_bf16 v[52:55], v[24:27], a[80:87], v88
    buffer_load_dwordx4 v[80:83], v6, s[24:27], s48 offen sc1
    s_waitcnt lgkmcnt(2)
    v_smfmac_f32_16x16x64_bf16 v[48:51], v[28:31], a[24:31], v88
    s_nop 1
    v_smfmac_f32_16x16x64_bf16 v[52:55], v[28:31], a[88:95], v88
    buffer_load_dwordx4 v[84:87], v6, s[24:27], s48 offen offset:256 sc1
    s_waitcnt lgkmcnt(1)
    v_smfmac_f32_16x16x64_bf16 v[48:51], v[32:35], a[32:39], v88
    s_nop 1
    v_smfmac_f32_16x16x64_bf16 v[52:55], v[32:35], a[96:103], v88
    s_nop 0
    s_waitcnt lgkmcnt(0)
    v_smfmac_f32_16x16x64_bf16 v[48:51], v[36:39], a[40:47], v88
    s_nop 1
    v_smfmac_f32_16x16x64_bf16 v[52:55], v[36:39], a[104:111], v88
    s_waitcnt vmcnt(4)
    s_nop 0
    v_smfmac_f32_16x16x64_bf16 v[56:59], v[16:19], a[128:135], v88
    ds_read_b128 v[96:99], v2 offset:16384
    ds_read_b128 v[100:103], v2 offset:17408
    v_smfmac_f32_16x16x64_bf16 v[60:63], v[16:19], a[192:199], v88
    ds_read_b128 v[104:107], v2 offset:18432
    ds_read_b128 v[108:111], v2 offset:19456
    v_smfmac_f32_16x16x64_bf16 v[56:59], v[20:23], a[136:143], v88
    v_add_f32 v48, v48, v50
    v_add_f32 v49, v49, v51
    v_smfmac_f32_16x16x64_bf16 v[60:63], v[20:23], a[200:207], v88
    v_add_f32 v52, v52, v54
    v_add_f32 v53, v53, v55
    v_smfmac_f32_16x16x64_bf16 v[56:59], v[24:27], a[144:151], v88
    v_cvt_pk_bf16_f32 v50, v48, v49
    v_cvt_pk_bf16_f32 v51, v52, v53
    v_smfmac_f32_16x16x64_bf16 v[60:63], v[24:27], a[208:215], v88
    ds_read_b128 v[112:115], v2 offset:20480
    ds_read_b128 v[116:119], v2 offset:21504
    v_mfma_f32_16x16x16_bf16 v[52:55], v[50:51], v[90:91], 0
    v_readfirstlane_b32 s69, v3
    s_nop 1
    v_mfma_f32_16x16x16_bf16 v[120:123], v[50:51], v[92:93], 0
    s_nop 2
    v_smfmac_f32_16x16x64_bf16 v[56:59], v[28:31], a[152:159], v88
    v_cvt_pk_bf16_f32 v52, v52, v53
    v_cvt_pk_bf16_f32 v53, v54, v55
    v_smfmac_f32_16x16x64_bf16 v[60:63], v[28:31], a[216:223], v88
    s_nop 0
    v_cvt_pk_bf16_f32 v54, v120, v121
    v_smfmac_f32_16x16x64_bf16 v[56:59], v[32:35], a[160:167], v88
    v_cvt_pk_bf16_f32 v55, v122, v123
    s_nop 0
    v_smfmac_f32_16x16x64_bf16 v[60:63], v[32:35], a[224:231], v88
    s_nop 1
    v_smfmac_f32_16x16x64_bf16 v[56:59], v[36:39], a[168:175], v88
    s_cmp_eq_u32 s69, s67
    s_cbranch_scc0 K3_PFSLOW_A3
K3_PFOK_A3:
    v_smfmac_f32_16x16x64_bf16 v[60:63], v[36:39], a[232:239], v88
    s_nop 1
    v_mfma_f32_16x16x32_bf16 v[48:51], v[72:75], v[52:55], 0
    s_nop 2
    v_mfma_f32_16x16x32_bf16 v[120:123], v[76:79], v[52:55], 0
    s_nop 4
    v_add_f32 v56, v56, v58
    v_add_f32 v57, v57, v59
    v_add_f32 v60, v60, v62
    v_add_f32 v61, v61, v63
    v_cvt_pk_bf16_f32 v58, v56, v57
    v_cvt_pk_bf16_f32 v59, v60, v61
    ds_write_b128 v4, v[48:51] offset:512
    ds_write_b128 v4, v[120:123] offset:1024
    v_mfma_f32_16x16x16_bf16 v[60:63], v[58:59], v[90:91], 0
    v_mfma_f32_16x16x16_bf16 v[48:51], v[58:59], v[92:93], 0
    s_waitcnt lgkmcnt(6)
    v_smfmac_f32_16x16x64_bf16 v[64:67], v[20:23], v[96:103], v88
    ds_read_b128 v[96:99], v2 offset:22528
    ds_read_b128 v[100:103], v2 offset:23552
    s_waitcnt lgkmcnt(6)
    v_smfmac_f32_16x16x64_bf16 v[68:71], v[20:23], v[104:111], v88
    ds_read_b128 v[104:107], v2 offset:24576
    ds_read_b128 v[108:111], v2 offset:25600
    s_nop 1
    v_cvt_pk_bf16_f32 v124, v60, v61
    v_cvt_pk_bf16_f32 v125, v62, v63
    v_cvt_pk_bf16_f32 v126, v48, v49
    v_cvt_pk_bf16_f32 v127, v50, v51
    s_nop 1
    v_mfma_f32_16x16x32_bf16 v[56:59], v[124:127], v[52:55], 0
    v_smfmac_f32_16x16x64_bf16 v[64:67], v[16:19], a[56:63], v88
    v_smfmac_f32_16x16x64_bf16 v[68:71], v[16:19], a[120:127], v88
    s_nop 5
    ds_write_b128 v4, v[56:59]
    v_smfmac_f32_16x16x64_bf16 v[64:67], v[24:27], a[176:183], v88
    v_smfmac_f32_16x16x64_bf16 v[68:71], v[24:27], a[240:247], v88
    buffer_load_dwordx4 v[72:75], v5, s[24:27], s47 offen sc1
    buffer_load_dwordx4 v[76:79], v5, s[24:27], s47 offen offset:1024 sc1
    s_add_u32 s64, s64, 4
    buffer_load_dword v3, off, s[24:27], s64 sc1
    s_waitcnt lgkmcnt(0)
    s_barrier
    ds_read_b128 v[48:51], v9 offset:0
    ds_read_b128 v[52:55], v9 offset:1536
    ds_read_b128 v[56:59], v9 offset:3072
    ds_read_b128 v[60:63], v9 offset:4608
    ds_read_b32 v120, v15 offset:0
    ds_read_b32 v121, v15 offset:1536
    ds_read_b32 v122, v15 offset:3072
    ds_read_b32 v123, v15 offset:4608
    buffer_store_dwordx4 v[124:127], v7, s[24:27], s49 offen sc1
    v_smfmac_f32_16x16x64_bf16 v[64:67], v[28:31], v[112:119], v88
    ds_read_b128 v[112:115], v2 offset:26624
    ds_read_b128 v[116:119], v2 offset:27648
    v_smfmac_f32_16x16x64_bf16 v[68:71], v[28:31], v[96:103], v88
    ds_read_b128 v[96:99], v2 offset:28672
    ds_read_b128 v[100:103], v2 offset:29696
    s_waitcnt vmcnt(6)
    v_mov_b32 v14, 1
    s_mov_b64 exec, 1
    buffer_store_byte v14, off, s[24:27], s65 sc1
    s_mov_b64 exec, s[36:37]
    s_mov_b32 s65, s68
    s_add_u32 s68, s68, 4
    s_waitcnt lgkmcnt(8)
    v_pk_add_f32 v[48:49], v[48:49], v[52:53]
    v_pk_add_f32 v[50:51], v[50:51], v[54:55]
    v_pk_add_f32 v[56:57], v[56:57], v[60:61]
    v_pk_add_f32 v[58:59], v[58:59], v[62:63]
    s_waitcnt lgkmcnt(4)
    v_pk_add_f32 v[120:121], v[120:121], v[122:123]
    v_pk_add_f32 v[48:49], v[48:49], v[56:57]
    v_pk_add_f32 v[50:51], v[50:51], v[58:59]
    v_add_f32 v52, v120, v121
    v_cvt_pk_bf16_f32 v56, v48, v49
    v_cvt_pk_bf16_f32 v57, v50, v51
    v_cvt_pk_bf16_f32 v58, v52, v52
    v_lshlrev_b32 v48, 16, v56
    v_and_b32 v49, 0xffff0000, v56
    v_lshlrev_b32 v50, 16, v57
    v_and_b32 v51, 0xffff0000, v57
    v_lshlrev_b32 v52, 16, v58
    v_pk_mul_f32 v[48:49], v[48:49], s[54:55] op_sel_hi:[1,0]
    v_pk_mul_f32 v[50:51], v[50:51], s[54:55] op_sel_hi:[1,0]
    v_mul_f32 v52, s54, v52
    v_cvt_pk_bf16_f32 v56, v48, v49
    v_cvt_pk_bf16_f32 v57, v50, v51
    v_cvt_pk_bf16_f32 v58, v52, v52
    v_lshlrev_b32 v48, 16, v56
    v_and_b32 v49, 0xffff0000, v56
    v_lshlrev_b32 v50, 16, v57
    v_and_b32 v51, 0xffff0000, v57
    v_lshlrev_b32 v52, 16, v58
    v_max3_f32 v14, v48, v49, v50
    v_max3_f32 v14, v14, v51, v52
    v_smfmac_f32_16x16x64_bf16 v[64:67], v[36:39], v[104:111], v88
    ds_read_b128 v[104:107], v2 offset:30720
    ds_read_b128 v[108:111], v2 offset:31744
    s_nop 0
    v_max_f32_dpp v14, v14, v14 row_ror:8 row_mask:0xf bank_mask:0xf
    v_mov_b32 v56, v14
    s_waitcnt lgkmcnt(4)
    v_smfmac_f32_16x16x64_bf16 v[68:71], v[36:39], v[112:119], v88
    s_nop 0
    v_permlane16_swap_b32 v14, v56
    v_max_f32 v14, v14, v56
    v_mov_b32 v56, v14
    s_waitcnt lgkmcnt(2)
    v_smfmac_f32_16x16x64_bf16 v[64:67], v[44:47], v[96:103], v88
    s_nop 0
    v_permlane32_swap_b32 v14, v56
    v_max_f32 v14, v14, v56
    v_mul_f32 v14, s55, v14
    v_pk_fma_f32 v[48:49], v[48:49], s[54:55], v[14:15] op_sel:[0,1,0] op_sel_hi:[1,1,0] neg_lo:[0,0,1] neg_hi:[0,0,1]
    v_pk_fma_f32 v[50:51], v[50:51], s[54:55], v[14:15] op_sel:[0,1,0] op_sel_hi:[1,1,0] neg_lo:[0,0,1] neg_hi:[0,0,1]
    v_fma_f32 v52, v52, s55, -v14
    v_exp_f32 v48, v48
    v_exp_f32 v49, v49
    v_exp_f32 v50, v50
    v_exp_f32 v51, v51
    v_exp_f32 v52, v52
    v_mov_b32 v125, 0
    v_mov_b32 v126, 0
    v_add_f32 v14, v48, v49
    v_add_f32 v56, v50, v51
    v_add_f32 v14, v14, v52
    v_add_f32 v14, v14, v56
    s_waitcnt lgkmcnt(0)
    v_smfmac_f32_16x16x64_bf16 v[68:71], v[44:47], v[104:111], v88
    s_nop 0
    v_add_f32_dpp v14, v14, v14 row_ror:8 row_mask:0xf bank_mask:0xf
    v_mov_b32 v56, v14
    v_smfmac_f32_16x16x64_bf16 v[64:67], v[32:35], a[184:191], v88
    s_nop 0
    v_permlane16_swap_b32 v14, v56
    v_add_f32 v14, v14, v56
    v_mov_b32 v56, v14
    v_smfmac_f32_16x16x64_bf16 v[68:71], v[32:35], a[248:255], v88
    s_nop 0
    v_permlane32_swap_b32 v14, v56
    v_add_f32 v14, v14, v56
    v_rcp_f32 v14, v14
    s_nop 0
    v_pk_mul_f32 v[48:49], v[48:49], v[14:15] op_sel_hi:[1,0]
    v_pk_mul_f32 v[50:51], v[50:51], v[14:15] op_sel_hi:[1,0]
    v_mul_f32 v52, v52, v14
    v_cvt_pk_bf16_f32 v120, v48, v49
    v_cvt_pk_bf16_f32 v121, v50, v51
    v_mov_b32_dpp v53, v52 row_ror:8 row_mask:0xf bank_mask:0xf
    v_mov_b32_dpp v122, v120 row_ror:8 row_mask:0xf bank_mask:0xf
    v_mov_b32_dpp v123, v121 row_ror:8 row_mask:0xf bank_mask:0xf
    v_cvt_pk_bf16_f32 v124, v52, v53
    v_cvt_pk_bf16_f32 v127, v52, v53
    s_waitcnt vmcnt(5)
    v_mfma_f32_16x16x32_bf16 v[96:99], v[80:83], v[120:123], 0
    v_add_f32 v64, v64, v66
    v_add_f32 v65, v65, v67
    v_mfma_f32_16x16x32_bf16 v[100:103], v[84:87], v[120:123], 0
    v_add_f32 v68, v68, v70
    v_add_f32 v69, v69, v71
    v_cvt_pk_bf16_f32 v94, v64, v65
    v_cvt_pk_bf16_f32 v95, v68, v69
    s_cmp_eq_u32 s30, 63
    s_cbranch_scc1 K3_LAST_A3
    v_mfma_f32_16x16x16_bf16 v[96:99], v[94:95], v[124:125], v[96:99]
    v_mfma_f32_16x16x16_bf16 v[100:103], v[94:95], v[126:127], v[100:103]
    v_mov_b64 v[16:17], 0
    v_mov_b64 v[18:19], 0
    v_mov_b64 v[20:21], 0
    v_mov_b64 v[22:23], 0
    v_mov_b64 v[24:25], 0
    v_mov_b64 v[26:27], 0
    v_mov_b64 v[28:29], 0
    v_mov_b64 v[30:31], 0
    v_cvt_pk_bf16_f32 v104, v96, v97
    v_cvt_pk_bf16_f32 v106, v98, v99
    v_cvt_pk_bf16_f32 v105, v100, v101
    v_cvt_pk_bf16_f32 v107, v102, v103
    ds_write2_b64 v10, v[104:105], v[106:107] offset0:0 offset1:4
    v_mov_b64 v[32:33], 0
    v_mov_b64 v[34:35], 0
    v_mov_b64 v[36:37], 0
    v_mov_b64 v[38:39], 0
    s_waitcnt lgkmcnt(0)
    s_barrier
    ds_read_b128 v[108:111], v11
    ds_read_b128 v[112:115], v11 offset:1024
    v_mov_b64 v[40:41], 0
    v_mov_b64 v[42:43], 0
    v_mov_b64 v[44:45], 0
    v_mov_b64 v[46:47], 0
    s_waitcnt lgkmcnt(0)
    v_smfmac_f32_16x16x64_bf16 v[16:19], v[108:111], v[128:135], v88
    s_nop 2
    v_smfmac_f32_16x16x64_bf16 v[20:23], v[108:111], v[144:151], v88
    s_nop 2
    v_smfmac_f32_16x16x64_bf16 v[16:19], v[112:115], v[136:143], v88
    s_nop 2
    v_smfmac_f32_16x16x64_bf16 v[20:23], v[112:115], v[152:159], v88
    v_smfmac_f32_16x16x64_bf16 v[24:27], v[108:111], v[160:167], v88
    s_nop 2
    v_smfmac_f32_16x16x64_bf16 v[28:31], v[108:111], v[176:183], v88
    v_add_f32 v16, v16, v18
    v_add_f32 v17, v17, v19
    v_smfmac_f32_16x16x64_bf16 v[24:27], v[112:115], v[168:175], v88
    v_add_f32 v18, v20, v22
    v_add_f32 v19, v21, v23
    v_smfmac_f32_16x16x64_bf16 v[28:31], v[112:115], v[184:191], v88
    v_cvt_pk_f16_f32 v16, v16, v17
    v_cvt_pk_f16_f32 v17, v18, v19
    v_smfmac_f32_16x16x64_bf16 v[32:35], v[108:111], v[192:199], v88
    v_and_or_b32 v16, v16, -2, s92
    buffer_store_dwordx2 v[16:17], v12, s[24:27], s59 offen sc0
    s_add_u32 s59, s59, 16384
    v_smfmac_f32_16x16x64_bf16 v[36:39], v[108:111], v[208:215], v88
    v_add_f32 v24, v24, v26
    v_add_f32 v25, v25, v27
    v_smfmac_f32_16x16x64_bf16 v[32:35], v[112:115], v[200:207], v88
    v_add_f32 v26, v28, v30
    v_add_f32 v27, v29, v31
    v_smfmac_f32_16x16x64_bf16 v[36:39], v[112:115], v[216:223], v88
    v_cvt_pk_f16_f32 v24, v24, v25
    v_cvt_pk_f16_f32 v25, v26, v27
    v_smfmac_f32_16x16x64_bf16 v[40:43], v[108:111], v[224:231], v88
    v_and_or_b32 v24, v24, -2, s92
    buffer_store_dwordx2 v[24:25], v12, s[24:27], s59 offen sc0
    s_add_u32 s59, s59, 16384
    v_smfmac_f32_16x16x64_bf16 v[44:47], v[108:111], v[240:247], v88
    v_add_f32 v32, v32, v34
    v_add_f32 v33, v33, v35
    v_smfmac_f32_16x16x64_bf16 v[40:43], v[112:115], v[232:239], v88
    v_add_f32 v34, v36, v38
    v_add_f32 v35, v37, v39
    v_smfmac_f32_16x16x64_bf16 v[44:47], v[112:115], v[248:255], v88
    v_cvt_pk_f16_f32 v32, v32, v33
    v_cvt_pk_f16_f32 v33, v34, v35
    v_and_or_b32 v32, v32, -2, s92
    buffer_store_dwordx2 v[32:33], v12, s[24:27], s59 offen sc0
    s_add_u32 s59, s59, 16384
    s_nop 0
    s_nop 1
    v_pk_add_f32 v[40:41], v[40:41], v[42:43]
    v_pk_add_f32 v[42:43], v[44:45], v[46:47]
    v_cvt_pk_f16_f32 v40, v40, v41
    v_cvt_pk_f16_f32 v41, v42, v43
    v_and_or_b32 v40, v40, -2, s92
    buffer_store_dwordx2 v[40:41], v12, s[24:27], s59 offen sc0
    s_nop 7
    s_nop 7
    s_nop 7
    s_nop 7
    s_mov_b32 s31, 0
    v_lshrrev_b32 v31, 1, v1
    buffer_load_dwordx2 v[16:17], v31, s[24:27], s57 offen offset:0 sc1
    buffer_load_dwordx2 v[18:19], v31, s[24:27], s57 offen offset:512 sc1
    buffer_load_dwordx2 v[20:21], v31, s[24:27], s57 offen offset:1024 sc1
    buffer_load_dwordx2 v[22:23], v31, s[24:27], s57 offen offset:1536 sc1
    s_add_u32 s51, s51, 8192
    s_add_u32 s58, s51, s52
    v_bfe_u32 v100, v1, 6, 2
    s_movk_i32 s33, 0x3c00
    v_and_b32 v101, 1, v100
    v_lshlrev_b32 v101, 4, v101
    v_lshlrev_b32 v101, v101, s33
    v_cmp_gt_u32 vcc, 2, v100
    s_nop 1
    v_cndmask_b32 v96, 0, v101, vcc
    v_cndmask_b32 v97, v101, 0, vcc
    v_mov_b32 v98, v96
    v_mov_b32 v99, v97
    s_cmp_lg_u32 s92, 0
    s_cbranch_scc1 K3_PP_A3_L1
K3_PP_A3_L0:
    s_waitcnt vmcnt(0)
    v_mfma_f32_16x16x32_f16 v[120:123], v[96:99], v[16:19], 0
    v_mfma_f32_16x16x32_f16 v[120:123], v[96:99], v[20:23], v[120:123]
    v_or3_b32 v14, v16, v18, v20
    v_bitop3_b32 v14, v14, v22, 1 bitop3:0xa8
    v_cmp_ne_u32 vcc, 0, v14
    s_add_u32 s31, s31, 1
    s_cbranch_vccz K3_PP_A3_D
    s_mov_b64 exec, vcc
    buffer_load_dwordx2 v[16:17], v31, s[24:27], s57 offen offset:0 sc1
    buffer_load_dwordx2 v[18:19], v31, s[24:27], s57 offen offset:512 sc1
    buffer_load_dwordx2 v[20:21], v31, s[24:27], s57 offen offset:1024 sc1
    buffer_load_dwordx2 v[22:23], v31, s[24:27], s57 offen offset:1536 sc1
    s_cmp_gt_u32 s31, 0x40000
    s_cbranch_scc0 K3_PP_A3_L0
    s_branch K3_END
K3_PP_A3_L1:
    s_waitcnt vmcnt(0)
    v_mfma_f32_16x16x32_f16 v[120:123], v[96:99], v[16:19], 0
    v_mfma_f32_16x16x32_f16 v[120:123], v[96:99], v[20:23], v[120:123]
    v_bitop3_b32 v14, v16, v18, v20 bitop3:0x80
    v_bitop3_b32 v14, v14, v22, 1 bitop3:0x2a
    v_cmp_ne_u32 vcc, 0, v14
    s_add_u32 s31, s31, 1
    s_cbranch_vccz K3_PP_A3_D
    s_mov_b64 exec, vcc
    buffer_load_dwordx2 v[16:17], v31, s[24:27], s57 offen offset:0 sc1
    buffer_load_dwordx2 v[18:19], v31, s[24:27], s57 offen offset:512 sc1
    buffer_load_dwordx2 v[20:21], v31, s[24:27], s57 offen offset:1024 sc1
    buffer_load_dwordx2 v[22:23], v31, s[24:27], s57 offen offset:1536 sc1
    s_cmp_gt_u32 s31, 0x40000
    s_cbranch_scc0 K3_PP_A3_L1
    s_branch K3_END
K3_PP_A3_D:
    s_mov_b64 exec, -1
    s_nop 0
    s_nop 1
    v_add_f32_dpp v120, v120, v120 row_ror:8 row_mask:0xf bank_mask:0xf
    v_mov_b32 v14, -2
    s_nop 0
    v_mov_b32_dpp v121, v120 quad_perm:[1,0,3,2] row_mask:0xf bank_mask:0xf
    v_cvt_pk_bf16_f32 v120, v120, v121
    v_min_u32 v120, v120, v14
    buffer_store_dword v120, v13, s[24:27], s58 offen sc0
    v_mov_b64 v[48:49], 0
    v_mov_b64 v[50:51], 0
    v_mov_b64 v[52:53], 0
    v_mov_b64 v[54:55], 0
    v_mov_b64 v[56:57], 0
    v_mov_b64 v[58:59], 0
    v_mov_b64 v[60:61], 0
    v_mov_b64 v[62:63], 0
    v_mov_b64 v[64:65], 0
    v_mov_b64 v[66:67], 0
    v_mov_b64 v[68:69], 0
    v_mov_b64 v[70:71], 0
    s_add_u32 s30, s30, 1
    s_add_u32 s49, s49, 0x10000
    s_branch K3_STEP_A3
K3_PROJ_A3:
    ds_read_b128 v[40:43], v1 offset:6144
    ds_read_b128 v[44:47], v1 offset:7168
    ds_read_b128 v[16:19], v2 offset:0
    ds_read_b128 v[20:23], v2 offset:1024
    ds_read_b128 v[24:27], v2 offset:2048
    ds_read_b128 v[28:31], v2 offset:3072
    ds_read_b128 v[32:35], v2 offset:4096
    ds_read_b128 v[36:39], v2 offset:5120
    ds_read_b128 v[120:123], v2 offset:6144
    ds_read_b128 v[124:127], v2 offset:7168
    ds_read_b128 v[96:99], v2 offset:8192
    ds_read_b128 v[100:103], v2 offset:9216
    ds_read_b128 v[104:107], v2 offset:10240
    ds_read_b128 v[108:111], v2 offset:11264
    ds_read_b128 v[112:115], v2 offset:12288
    ds_read_b128 v[116:119], v2 offset:13312
    ds_read_b128 v[80:83], v2 offset:14336
    ds_read_b128 v[84:87], v2 offset:15360
    s_waitcnt lgkmcnt(0)
    s_branch K3_OWN_A3
K3_LAST_A3:
    s_add_u32 s50, s50, 0x10000
    buffer_store_dword v94, v8, s[24:27], s50 offen sc1
    buffer_store_dword v95, v8, s[24:27], s50 offen offset:64 sc1
    s_waitcnt vmcnt(0)
    v_mov_b32 v14, 1
    s_mov_b64 exec, 1
    buffer_store_byte v14, off, s[24:27], s65 sc1
    s_endpgm
K3_PFSLOW_A3:
    s_cmp_eq_u32 s30, 63
    s_cbranch_scc1 K3_PFOK_A3
    s_mov_b32 s31, 0
K3_PFS2_A3:
    buffer_load_dword v3, off, s[24:27], s64 sc1
    s_waitcnt vmcnt(0)
    v_readfirstlane_b32 s32, v3
    s_add_u32 s31, s31, 1
    s_cmp_gt_u32 s31, 0x40000
    s_cbranch_scc1 K3_END
    s_cmp_lg_u32 s32, s67
    s_cbranch_scc1 K3_PFS2_A3
    s_branch K3_PFOK_A3
K3_STEP_B0:
    s_nop 7
    s_nop 7
    s_nop 7
    s_nop 7
    s_nop 7
    s_nop 7
    s_nop 7
    s_mov_b32 s31, 0
    buffer_load_dwordx4 v[16:19], v0, s[24:27], s51 offen sc1
    buffer_load_dwordx4 v[20:23], v0, s[24:27], s51 offen offset:1024 sc1
    s_and_b32 s32, s30, 1
    s_lshl_b32 s32, s32, 19
    s_lshl_b32 s33, s28, 6
    s_add_u32 s59, s32, s33
    s_add_u32 s59, s59, 0x300000
    s_lshl_b32 s33, s28, 13
    s_add_u32 s57, s32, s33
    s_add_u32 s57, s57, 0x300000
    s_add_u32 s57, s57, s66
    s_lshr_b32 s92, s30, 1
    s_and_b32 s92, s92, 1
    s_add_u32 s50, s50, 0x10000
    s_add_u32 s48, s48, 0x40000
    s_add_u32 s47, s47, 0x40000
    ds_read_b128 v[24:27], v2 offset:0
    ds_read_b128 v[28:31], v2 offset:1024
    ds_read_b128 v[32:35], v2 offset:2048
    ds_read_b128 v[36:39], v2 offset:3072
    ds_read_b128 v[40:43], v2 offset:4096
    ds_read_b128 v[44:47], v2 offset:5120
    ds_read_b128 v[120:123], v2 offset:6144
    ds_read_b128 v[124:127], v2 offset:7168
    ds_read_b128 v[96:99], v2 offset:8192
    ds_read_b128 v[100:103], v2 offset:9216
    ds_read_b128 v[104:107], v2 offset:10240
    ds_read_b128 v[108:111], v2 offset:11264
    ds_read_b128 v[112:115], v2 offset:12288
    ds_read_b128 v[116:119], v2 offset:13312
    ds_read_b128 v[80:83], v2 offset:14336
    ds_read_b128 v[84:87], v2 offset:15360
K3_PM_B0_L:
    s_waitcnt vmcnt(0) lgkmcnt(0)
    v_max3_u32 v14, v16, v17, v18
    v_max3_u32 v14, v14, v19, v20
    v_max3_u32 v14, v14, v21, v22
    v_max_u32 v14, v14, v23
    v_cmp_eq_u32 vcc, -1, v14
    s_add_u32 s31, s31, 1
    s_cbranch_vccz K3_PM_B0_D
    s_mov_b64 exec, vcc
    buffer_load_dwordx4 v[16:19], v0, s[24:27], s51 offen sc1
    buffer_load_dwordx4 v[20:23], v0, s[24:27], s51 offen offset:1024 sc1
    s_cmp_gt_u32 s31, 0x40000
    s_cbranch_scc0 K3_PM_B0_L
    s_branch K3_END
K3_PM_B0_D:
    s_mov_b64 exec, -1
    ds_write_b128 v0, v[16:19]
    ds_write_b128 v0, v[20:23] offset:1024
K3_OWN_B0:
    v_smfmac_f32_16x16x64_bf16 v[48:51], v[16:19], v[24:31], v88
    v_smfmac_f32_16x16x64_bf16 v[52:55], v[16:19], v[32:39], v88
    v_smfmac_f32_16x16x64_bf16 v[48:51], v[20:23], v[40:47], v88
    v_smfmac_f32_16x16x64_bf16 v[52:55], v[20:23], v[120:127], v88
    s_waitcnt lgkmcnt(0)
    s_barrier
    ds_read_b128 v[24:27], v1 offset:2048
    ds_read_b128 v[28:31], v1 offset:3072
    ds_read_b128 v[32:35], v1 offset:4096
    ds_read_b128 v[36:39], v1 offset:5120
    ds_read_b128 v[40:43], v1 offset:6144
    ds_read_b128 v[44:47], v1 offset:7168
    v_smfmac_f32_16x16x64_bf16 v[56:59], v[16:19], v[96:103], v88
    v_smfmac_f32_16x16x64_bf16 v[60:63], v[16:19], v[104:111], v88
    v_smfmac_f32_16x16x64_bf16 v[56:59], v[20:23], v[112:119], v88
    v_smfmac_f32_16x16x64_bf16 v[60:63], v[20:23], v[80:87], v88
    v_smfmac_f32_16x16x64_bf16 v[64:67], v[16:19], a[0:7], v88
    v_smfmac_f32_16x16x64_bf16 v[68:71], v[16:19], a[64:71], v88
    s_waitcnt lgkmcnt(5)
    v_smfmac_f32_16x16x64_bf16 v[48:51], v[24:27], a[16:23], v88
    s_nop 1
    v_smfmac_f32_16x16x64_bf16 v[52:55], v[24:27], a[80:87], v88
    buffer_store_dword v94, v8, s[24:27], s50 offen sc1
    s_waitcnt lgkmcnt(4)
    v_smfmac_f32_16x16x64_bf16 v[48:51], v[28:31], a[24:31], v88
    s_nop 1
    v_smfmac_f32_16x16x64_bf16 v[52:55], v[28:31], a[88:95], v88
    buffer_store_dword v95, v8, s[24:27], s50 offen offset:64 sc1
    s_waitcnt lgkmcnt(3)
    v_smfmac_f32_16x16x64_bf16 v[48:51], v[32:35], a[32:39], v88
    s_nop 1
    v_smfmac_f32_16x16x64_bf16 v[52:55], v[32:35], a[96:103], v88
    buffer_load_dwordx4 v[80:83], v6, s[24:27], s48 offen sc1
    s_waitcnt lgkmcnt(2)
    v_smfmac_f32_16x16x64_bf16 v[48:51], v[36:39], a[40:47], v88
    s_nop 1
    v_smfmac_f32_16x16x64_bf16 v[52:55], v[36:39], a[104:111], v88
    buffer_load_dwordx4 v[84:87], v6, s[24:27], s48 offen offset:256 sc1
    s_waitcnt lgkmcnt(1)
    v_smfmac_f32_16x16x64_bf16 v[48:51], v[40:43], a[48:55], v88
    s_nop 1
    v_smfmac_f32_16x16x64_bf16 v[52:55], v[40:43], a[112:119], v88
    s_nop 0
    s_waitcnt lgkmcnt(0)
    v_smfmac_f32_16x16x64_bf16 v[48:51], v[44:47], a[56:63], v88
    s_nop 1
    v_smfmac_f32_16x16x64_bf16 v[52:55], v[44:47], a[120:127], v88
    s_waitcnt vmcnt(4)
    s_nop 0
    v_smfmac_f32_16x16x64_bf16 v[56:59], v[24:27], a[144:151], v88
    ds_read_b128 v[96:99], v2 offset:20480
    ds_read_b128 v[100:103], v2 offset:21504
    v_smfmac_f32_16x16x64_bf16 v[60:63], v[24:27], a[208:215], v88
    ds_read_b128 v[104:107], v2 offset:22528
    ds_read_b128 v[108:111], v2 offset:23552
    v_smfmac_f32_16x16x64_bf16 v[56:59], v[28:31], a[152:159], v88
    v_add_f32 v48, v48, v50
    v_add_f32 v49, v49, v51
    v_smfmac_f32_16x16x64_bf16 v[60:63], v[28:31], a[216:223], v88
    v_add_f32 v52, v52, v54
    v_add_f32 v53, v53, v55
    v_smfmac_f32_16x16x64_bf16 v[56:59], v[32:35], a[160:167], v88
    v_cvt_pk_bf16_f32 v50, v48, v49
    v_cvt_pk_bf16_f32 v51, v52, v53
    v_smfmac_f32_16x16x64_bf16 v[60:63], v[32:35], a[224:231], v88
    ds_read_b128 v[112:115], v2 offset:24576
    ds_read_b128 v[116:119], v2 offset:25600
    v_mfma_f32_16x16x16_bf16 v[52:55], v[50:51], v[90:91], 0
    v_readfirstlane_b32 s69, v3
    s_nop 1
    v_mfma_f32_16x16x16_bf16 v[120:123], v[50:51], v[92:93], 0
    s_nop 2
    v_smfmac_f32_16x16x64_bf16 v[56:59], v[36:39], a[168:175], v88
    v_cvt_pk_bf16_f32 v52, v52, v53
    v_cvt_pk_bf16_f32 v53, v54, v55
    v_smfmac_f32_16x16x64_bf16 v[60:63], v[36:39], a[232:239], v88
    s_nop 0
    v_cvt_pk_bf16_f32 v54, v120, v121
    v_smfmac_f32_16x16x64_bf16 v[56:59], v[40:43], a[176:183], v88
    v_cvt_pk_bf16_f32 v55, v122, v123
    s_nop 0
    v_smfmac_f32_16x16x64_bf16 v[60:63], v[40:43], a[240:247], v88
    s_nop 1
    v_smfmac_f32_16x16x64_bf16 v[56:59], v[44:47], a[184:191], v88
    s_cmp_eq_u32 s69, s67
    s_cbranch_scc0 K3_PFSLOW_B0
K3_PFOK_B0:
    v_smfmac_f32_16x16x64_bf16 v[60:63], v[44:47], a[248:255], v88
    s_nop 1
    v_mfma_f32_16x16x32_bf16 v[48:51], v[72:75], v[52:55], 0
    s_nop 2
    v_mfma_f32_16x16x32_bf16 v[120:123], v[76:79], v[52:55], 0
    s_nop 4
    v_add_f32 v56, v56, v58
    v_add_f32 v57, v57, v59
    v_add_f32 v60, v60, v62
    v_add_f32 v61, v61, v63
    v_cvt_pk_bf16_f32 v58, v56, v57
    v_cvt_pk_bf16_f32 v59, v60, v61
    ds_write_b128 v4, v[48:51] offset:512
    ds_write_b128 v4, v[120:123] offset:1024
    v_mfma_f32_16x16x16_bf16 v[60:63], v[58:59], v[90:91], 0
    v_mfma_f32_16x16x16_bf16 v[48:51], v[58:59], v[92:93], 0
    s_waitcnt lgkmcnt(6)
    v_smfmac_f32_16x16x64_bf16 v[64:67], v[28:31], v[96:103], v88
    ds_read_b128 v[96:99], v2 offset:26624
    ds_read_b128 v[100:103], v2 offset:27648
    s_waitcnt lgkmcnt(6)
    v_smfmac_f32_16x16x64_bf16 v[68:71], v[28:31], v[104:111], v88
    ds_read_b128 v[104:107], v2 offset:28672
    ds_read_b128 v[108:111], v2 offset:29696
    s_nop 1
    v_cvt_pk_bf16_f32 v124, v60, v61
    v_cvt_pk_bf16_f32 v125, v62, v63
    v_cvt_pk_bf16_f32 v126, v48, v49
    v_cvt_pk_bf16_f32 v127, v50, v51
    s_nop 1
    v_mfma_f32_16x16x32_bf16 v[56:59], v[124:127], v[52:55], 0
    v_smfmac_f32_16x16x64_bf16 v[64:67], v[24:27], a[8:15], v88
    v_smfmac_f32_16x16x64_bf16 v[68:71], v[24:27], a[72:79], v88
    s_nop 5
    ds_write_b128 v4, v[56:59]
    v_smfmac_f32_16x16x64_bf16 v[64:67], v[32:35], a[128:135], v88
    v_smfmac_f32_16x16x64_bf16 v[68:71], v[32:35], a[192:199], v88
    buffer_load_dwordx4 v[72:75], v5, s[24:27], s47 offen sc1
    buffer_load_dwordx4 v[76:79], v5, s[24:27], s47 offen offset:1024 sc1
    s_add_u32 s64, s64, 4
    buffer_load_dword v3, off, s[24:27], s64 sc1
    s_waitcnt lgkmcnt(0)
    s_barrier
    ds_read_b128 v[48:51], v9 offset:0
    ds_read_b128 v[52:55], v9 offset:1536
    ds_read_b128 v[56:59], v9 offset:3072
    ds_read_b128 v[60:63], v9 offset:4608
    ds_read_b32 v120, v15 offset:0
    ds_read_b32 v121, v15 offset:1536
    ds_read_b32 v122, v15 offset:3072
    ds_read_b32 v123, v15 offset:4608
    buffer_store_dwordx4 v[124:127], v7, s[24:27], s49 offen sc1
    v_smfmac_f32_16x16x64_bf16 v[64:67], v[36:39], v[112:119], v88
    ds_read_b128 v[112:115], v2 offset:30720
    ds_read_b128 v[116:119], v2 offset:31744
    v_smfmac_f32_16x16x64_bf16 v[68:71], v[36:39], v[96:103], v88
    ds_read_b128 v[96:99], v2 offset:16384
    ds_read_b128 v[100:103], v2 offset:17408
    s_waitcnt vmcnt(6)
    v_mov_b32 v14, 1
    s_mov_b64 exec, 1
    buffer_store_byte v14, off, s[24:27], s65 sc1
    s_mov_b64 exec, s[36:37]
    s_mov_b32 s65, s68
    s_add_u32 s68, s68, 4
    s_waitcnt lgkmcnt(8)
    v_pk_add_f32 v[48:49], v[48:49], v[52:53]
    v_pk_add_f32 v[50:51], v[50:51], v[54:55]
    v_pk_add_f32 v[56:57], v[56:57], v[60:61]
    v_pk_add_f32 v[58:59], v[58:59], v[62:63]
    s_waitcnt lgkmcnt(4)
    v_pk_add_f32 v[120:121], v[120:121], v[122:123]
    v_pk_add_f32 v[48:49], v[48:49], v[56:57]
    v_pk_add_f32 v[50:51], v[50:51], v[58:59]
    v_add_f32 v52, v120, v121
    v_cvt_pk_bf16_f32 v56, v48, v49
    v_cvt_pk_bf16_f32 v57, v50, v51
    v_cvt_pk_bf16_f32 v58, v52, v52
    v_lshlrev_b32 v48, 16, v56
    v_and_b32 v49, 0xffff0000, v56
    v_lshlrev_b32 v50, 16, v57
    v_and_b32 v51, 0xffff0000, v57
    v_lshlrev_b32 v52, 16, v58
    v_pk_mul_f32 v[48:49], v[48:49], s[54:55] op_sel_hi:[1,0]
    v_pk_mul_f32 v[50:51], v[50:51], s[54:55] op_sel_hi:[1,0]
    v_mul_f32 v52, s54, v52
    v_cvt_pk_bf16_f32 v56, v48, v49
    v_cvt_pk_bf16_f32 v57, v50, v51
    v_cvt_pk_bf16_f32 v58, v52, v52
    v_lshlrev_b32 v48, 16, v56
    v_and_b32 v49, 0xffff0000, v56
    v_lshlrev_b32 v50, 16, v57
    v_and_b32 v51, 0xffff0000, v57
    v_lshlrev_b32 v52, 16, v58
    v_max3_f32 v14, v48, v49, v50
    v_max3_f32 v14, v14, v51, v52
    v_smfmac_f32_16x16x64_bf16 v[64:67], v[44:47], v[104:111], v88
    ds_read_b128 v[104:107], v2 offset:18432
    ds_read_b128 v[108:111], v2 offset:19456
    s_nop 0
    v_max_f32_dpp v14, v14, v14 row_ror:8 row_mask:0xf bank_mask:0xf
    v_mov_b32 v56, v14
    s_waitcnt lgkmcnt(4)
    v_smfmac_f32_16x16x64_bf16 v[68:71], v[44:47], v[112:119], v88
    s_nop 0
    v_permlane16_swap_b32 v14, v56
    v_max_f32 v14, v14, v56
    v_mov_b32 v56, v14
    s_waitcnt lgkmcnt(2)
    v_smfmac_f32_16x16x64_bf16 v[64:67], v[20:23], v[96:103], v88
    s_nop 0
    v_permlane32_swap_b32 v14, v56
    v_max_f32 v14, v14, v56
    v_mul_f32 v14, s55, v14
    v_pk_fma_f32 v[48:49], v[48:49], s[54:55], v[14:15] op_sel:[0,1,0] op_sel_hi:[1,1,0] neg_lo:[0,0,1] neg_hi:[0,0,1]
    v_pk_fma_f32 v[50:51], v[50:51], s[54:55], v[14:15] op_sel:[0,1,0] op_sel_hi:[1,1,0] neg_lo:[0,0,1] neg_hi:[0,0,1]
    v_fma_f32 v52, v52, s55, -v14
    v_exp_f32 v48, v48
    v_exp_f32 v49, v49
    v_exp_f32 v50, v50
    v_exp_f32 v51, v51
    v_exp_f32 v52, v52
    v_mov_b32 v125, 0
    v_mov_b32 v126, 0
    v_add_f32 v14, v48, v49
    v_add_f32 v56, v50, v51
    v_add_f32 v14, v14, v52
    v_add_f32 v14, v14, v56
    s_waitcnt lgkmcnt(0)
    v_smfmac_f32_16x16x64_bf16 v[68:71], v[20:23], v[104:111], v88
    s_nop 0
    v_add_f32_dpp v14, v14, v14 row_ror:8 row_mask:0xf bank_mask:0xf
    v_mov_b32 v56, v14
    v_smfmac_f32_16x16x64_bf16 v[64:67], v[40:43], a[136:143], v88
    s_nop 0
    v_permlane16_swap_b32 v14, v56
    v_add_f32 v14, v14, v56
    v_mov_b32 v56, v14
    v_smfmac_f32_16x16x64_bf16 v[68:71], v[40:43], a[200:207], v88
    s_nop 0
    v_permlane32_swap_b32 v14, v56
    v_add_f32 v14, v14, v56
    v_rcp_f32 v14, v14
    s_nop 0
    v_pk_mul_f32 v[48:49], v[48:49], v[14:15] op_sel_hi:[1,0]
    v_pk_mul_f32 v[50:51], v[50:51], v[14:15] op_sel_hi:[1,0]
    v_mul_f32 v52, v52, v14
    v_cvt_pk_bf16_f32 v120, v48, v49
    v_cvt_pk_bf16_f32 v121, v50, v51
    v_mov_b32_dpp v53, v52 row_ror:8 row_mask:0xf bank_mask:0xf
    v_mov_b32_dpp v122, v120 row_ror:8 row_mask:0xf bank_mask:0xf
    v_mov_b32_dpp v123, v121 row_ror:8 row_mask:0xf bank_mask:0xf
    v_cvt_pk_bf16_f32 v124, v52, v53
    v_cvt_pk_bf16_f32 v127, v52, v53
    s_waitcnt vmcnt(5)
    v_mfma_f32_16x16x32_bf16 v[96:99], v[80:83], v[120:123], 0
    v_add_f32 v64, v64, v66
    v_add_f32 v65, v65, v67
    v_mfma_f32_16x16x32_bf16 v[100:103], v[84:87], v[120:123], 0
    v_add_f32 v68, v68, v70
    v_add_f32 v69, v69, v71
    v_cvt_pk_bf16_f32 v94, v64, v65
    v_cvt_pk_bf16_f32 v95, v68, v69
    s_cmp_eq_u32 s30, 63
    s_cbranch_scc1 K3_LAST_B0
    v_mfma_f32_16x16x16_bf16 v[96:99], v[94:95], v[124:125], v[96:99]
    v_mfma_f32_16x16x16_bf16 v[100:103], v[94:95], v[126:127], v[100:103]
    v_mov_b64 v[16:17], 0
    v_mov_b64 v[18:19], 0
    v_mov_b64 v[20:21], 0
    v_mov_b64 v[22:23], 0
    v_mov_b64 v[24:25], 0
    v_mov_b64 v[26:27], 0
    v_mov_b64 v[28:29], 0
    v_mov_b64 v[30:31], 0
    v_cvt_pk_bf16_f32 v104, v96, v97
    v_cvt_pk_bf16_f32 v106, v98, v99
    v_cvt_pk_bf16_f32 v105, v100, v101
    v_cvt_pk_bf16_f32 v107, v102, v103
    ds_write2_b64 v10, v[104:105], v[106:107] offset0:0 offset1:4
    v_mov_b64 v[32:33], 0
    v_mov_b64 v[34:35], 0
    v_mov_b64 v[36:37], 0
    v_mov_b64 v[38:39], 0
    s_waitcnt lgkmcnt(0)
    s_barrier
    ds_read_b128 v[108:111], v11
    ds_read_b128 v[112:115], v11 offset:1024
    v_mov_b64 v[40:41], 0
    v_mov_b64 v[42:43], 0
    v_mov_b64 v[44:45], 0
    v_mov_b64 v[46:47], 0
    s_waitcnt lgkmcnt(0)
    v_smfmac_f32_16x16x64_bf16 v[16:19], v[108:111], v[128:135], v88
    s_nop 2
    v_smfmac_f32_16x16x64_bf16 v[20:23], v[108:111], v[144:151], v88
    s_nop 2
    v_smfmac_f32_16x16x64_bf16 v[16:19], v[112:115], v[136:143], v88
    s_nop 2
    v_smfmac_f32_16x16x64_bf16 v[20:23], v[112:115], v[152:159], v88
    v_smfmac_f32_16x16x64_bf16 v[24:27], v[108:111], v[160:167], v88
    s_nop 2
    v_smfmac_f32_16x16x64_bf16 v[28:31], v[108:111], v[176:183], v88
    v_add_f32 v16, v16, v18
    v_add_f32 v17, v17, v19
    v_smfmac_f32_16x16x64_bf16 v[24:27], v[112:115], v[168:175], v88
    v_add_f32 v18, v20, v22
    v_add_f32 v19, v21, v23
    v_smfmac_f32_16x16x64_bf16 v[28:31], v[112:115], v[184:191], v88
    v_cvt_pk_f16_f32 v16, v16, v17
    v_cvt_pk_f16_f32 v17, v18, v19
    v_smfmac_f32_16x16x64_bf16 v[32:35], v[108:111], v[192:199], v88
    v_and_or_b32 v16, v16, -2, s92
    buffer_store_dwordx2 v[16:17], v12, s[24:27], s59 offen sc1
    s_add_u32 s59, s59, 16384
    v_smfmac_f32_16x16x64_bf16 v[36:39], v[108:111], v[208:215], v88
    v_add_f32 v24, v24, v26
    v_add_f32 v25, v25, v27
    v_smfmac_f32_16x16x64_bf16 v[32:35], v[112:115], v[200:207], v88
    v_add_f32 v26, v28, v30
    v_add_f32 v27, v29, v31
    v_smfmac_f32_16x16x64_bf16 v[36:39], v[112:115], v[216:223], v88
    v_cvt_pk_f16_f32 v24, v24, v25
    v_cvt_pk_f16_f32 v25, v26, v27
    v_smfmac_f32_16x16x64_bf16 v[40:43], v[108:111], v[224:231], v88
    v_and_or_b32 v24, v24, -2, s92
    buffer_store_dwordx2 v[24:25], v12, s[24:27], s59 offen sc1
    s_add_u32 s59, s59, 16384
    v_smfmac_f32_16x16x64_bf16 v[44:47], v[108:111], v[240:247], v88
    v_add_f32 v32, v32, v34
    v_add_f32 v33, v33, v35
    v_smfmac_f32_16x16x64_bf16 v[40:43], v[112:115], v[232:239], v88
    v_add_f32 v34, v36, v38
    v_add_f32 v35, v37, v39
    v_smfmac_f32_16x16x64_bf16 v[44:47], v[112:115], v[248:255], v88
    v_cvt_pk_f16_f32 v32, v32, v33
    v_cvt_pk_f16_f32 v33, v34, v35
    v_and_or_b32 v32, v32, -2, s92
    buffer_store_dwordx2 v[32:33], v12, s[24:27], s59 offen sc1
    s_add_u32 s59, s59, 16384
    s_nop 0
    s_nop 1
    v_pk_add_f32 v[40:41], v[40:41], v[42:43]
    v_pk_add_f32 v[42:43], v[44:45], v[46:47]
    v_cvt_pk_f16_f32 v40, v40, v41
    v_cvt_pk_f16_f32 v41, v42, v43
    v_and_or_b32 v40, v40, -2, s92
    buffer_store_dwordx2 v[40:41], v12, s[24:27], s59 offen sc1
    s_nop 7
    s_nop 7
    s_nop 7
    s_nop 7
    s_mov_b32 s31, 0
    v_lshrrev_b32 v31, 1, v1
    buffer_load_dwordx2 v[16:17], v31, s[24:27], s57 offen offset:0 sc1
    buffer_load_dwordx2 v[18:19], v31, s[24:27], s57 offen offset:512 sc1
    buffer_load_dwordx2 v[20:21], v31, s[24:27], s57 offen offset:1024 sc1
    buffer_load_dwordx2 v[22:23], v31, s[24:27], s57 offen offset:1536 sc1
    s_add_u32 s51, s51, 8192
    s_add_u32 s58, s51, s52
    v_bfe_u32 v100, v1, 6, 2
    s_movk_i32 s33, 0x3c00
    v_and_b32 v101, 1, v100
    v_lshlrev_b32 v101, 4, v101
    v_lshlrev_b32 v101, v101, s33
    v_cmp_gt_u32 vcc, 2, v100
    s_nop 1
    v_cndmask_b32 v96, 0, v101, vcc
    v_cndmask_b32 v97, v101, 0, vcc
    v_mov_b32 v98, v96
    v_mov_b32 v99, v97
    s_cmp_lg_u32 s92, 0
    s_cbranch_scc1 K3_PP_B0_L1
K3_PP_B0_L0:
    s_waitcnt vmcnt(0)
    v_mfma_f32_16x16x32_f16 v[120:123], v[96:99], v[16:19], 0
    v_mfma_f32_16x16x32_f16 v[120:123], v[96:99], v[20:23], v[120:123]
    v_or3_b32 v14, v16, v18, v20
    v_bitop3_b32 v14, v14, v22, 1 bitop3:0xa8
    v_cmp_ne_u32 vcc, 0, v14
    s_add_u32 s31, s31, 1
    s_cbranch_vccz K3_PP_B0_D
    s_mov_b64 exec, vcc
    buffer_load_dwordx2 v[16:17], v31, s[24:27], s57 offen offset:0 sc1
    buffer_load_dwordx2 v[18:19], v31, s[24:27], s57 offen offset:512 sc1
    buffer_load_dwordx2 v[20:21], v31, s[24:27], s57 offen offset:1024 sc1
    buffer_load_dwordx2 v[22:23], v31, s[24:27], s57 offen offset:1536 sc1
    s_cmp_gt_u32 s31, 0x40000
    s_cbranch_scc0 K3_PP_B0_L0
    s_branch K3_END
K3_PP_B0_L1:
    s_waitcnt vmcnt(0)
    v_mfma_f32_16x16x32_f16 v[120:123], v[96:99], v[16:19], 0
    v_mfma_f32_16x16x32_f16 v[120:123], v[96:99], v[20:23], v[120:123]
    v_bitop3_b32 v14, v16, v18, v20 bitop3:0x80
    v_bitop3_b32 v14, v14, v22, 1 bitop3:0x2a
    v_cmp_ne_u32 vcc, 0, v14
    s_add_u32 s31, s31, 1
    s_cbranch_vccz K3_PP_B0_D
    s_mov_b64 exec, vcc
    buffer_load_dwordx2 v[16:17], v31, s[24:27], s57 offen offset:0 sc1
    buffer_load_dwordx2 v[18:19], v31, s[24:27], s57 offen offset:512 sc1
    buffer_load_dwordx2 v[20:21], v31, s[24:27], s57 offen offset:1024 sc1
    buffer_load_dwordx2 v[22:23], v31, s[24:27], s57 offen offset:1536 sc1
    s_cmp_gt_u32 s31, 0x40000
    s_cbranch_scc0 K3_PP_B0_L1
    s_branch K3_END
K3_PP_B0_D:
    s_mov_b64 exec, -1
    s_nop 0
    s_nop 1
    v_add_f32_dpp v120, v120, v120 row_ror:8 row_mask:0xf bank_mask:0xf
    v_mov_b32 v14, -2
    s_nop 0
    v_mov_b32_dpp v121, v120 quad_perm:[1,0,3,2] row_mask:0xf bank_mask:0xf
    v_cvt_pk_bf16_f32 v120, v120, v121
    v_min_u32 v120, v120, v14
    buffer_store_dword v120, v13, s[24:27], s58 offen sc1
    v_mov_b64 v[48:49], 0
    v_mov_b64 v[50:51], 0
    v_mov_b64 v[52:53], 0
    v_mov_b64 v[54:55], 0
    v_mov_b64 v[56:57], 0
    v_mov_b64 v[58:59], 0
    v_mov_b64 v[60:61], 0
    v_mov_b64 v[62:63], 0
    v_mov_b64 v[64:65], 0
    v_mov_b64 v[66:67], 0
    v_mov_b64 v[68:69], 0
    v_mov_b64 v[70:71], 0
    s_add_u32 s30, s30, 1
    s_add_u32 s49, s49, 0x10000
    s_branch K3_STEP_B0
K3_PROJ_B0:
    ds_read_b128 v[16:19], v1 offset:0
    ds_read_b128 v[20:23], v1 offset:1024
    ds_read_b128 v[24:27], v2 offset:0
    ds_read_b128 v[28:31], v2 offset:1024
    ds_read_b128 v[32:35], v2 offset:2048
    ds_read_b128 v[36:39], v2 offset:3072
    ds_read_b128 v[40:43], v2 offset:4096
    ds_read_b128 v[44:47], v2 offset:5120
    ds_read_b128 v[120:123], v2 offset:6144
    ds_read_b128 v[124:127], v2 offset:7168
    ds_read_b128 v[96:99], v2 offset:8192
    ds_read_b128 v[100:103], v2 offset:9216
    ds_read_b128 v[104:107], v2 offset:10240
    ds_read_b128 v[108:111], v2 offset:11264
    ds_read_b128 v[112:115], v2 offset:12288
    ds_read_b128 v[116:119], v2 offset:13312
    ds_read_b128 v[80:83], v2 offset:14336
    ds_read_b128 v[84:87], v2 offset:15360
    s_waitcnt lgkmcnt(0)
    s_branch K3_OWN_B0
K3_LAST_B0:
    s_add_u32 s50, s50, 0x10000
    buffer_store_dword v94, v8, s[24:27], s50 offen sc1
    buffer_store_dword v95, v8, s[24:27], s50 offen offset:64 sc1
    s_waitcnt vmcnt(0)
    v_mov_b32 v14, 1
    s_mov_b64 exec, 1
    buffer_store_byte v14, off, s[24:27], s65 sc1
    s_endpgm
K3_PFSLOW_B0:
    s_cmp_eq_u32 s30, 63
    s_cbranch_scc1 K3_PFOK_B0
    s_mov_b32 s31, 0
K3_PFS2_B0:
    buffer_load_dword v3, off, s[24:27], s64 sc1
    s_waitcnt vmcnt(0)
    v_readfirstlane_b32 s32, v3
    s_add_u32 s31, s31, 1
    s_cmp_gt_u32 s31, 0x40000
    s_cbranch_scc1 K3_END
    s_cmp_lg_u32 s32, s67
    s_cbranch_scc1 K3_PFS2_B0
    s_branch K3_PFOK_B0
K3_STEP_B1:
    s_nop 7
    s_nop 7
    s_nop 7
    s_nop 7
    s_nop 7
    s_nop 7
    s_nop 7
    s_mov_b32 s31, 0
    buffer_load_dwordx4 v[24:27], v0, s[24:27], s51 offen sc1
    buffer_load_dwordx4 v[28:31], v0, s[24:27], s51 offen offset:1024 sc1
    s_and_b32 s32, s30, 1
    s_lshl_b32 s32, s32, 19
    s_lshl_b32 s33, s28, 6
    s_add_u32 s59, s32, s33
    s_add_u32 s59, s59, 0x300000
    s_lshl_b32 s33, s28, 13
    s_add_u32 s57, s32, s33
    s_add_u32 s57, s57, 0x300000
    s_add_u32 s57, s57, s66
    s_lshr_b32 s92, s30, 1
    s_and_b32 s92, s92, 1
    s_add_u32 s50, s50, 0x10000
    s_add_u32 s48, s48, 0x40000
    s_add_u32 s47, s47, 0x40000
    ds_read_b128 v[16:19], v2 offset:0
    ds_read_b128 v[20:23], v2 offset:1024
    ds_read_b128 v[32:35], v2 offset:2048
    ds_read_b128 v[36:39], v2 offset:3072
    ds_read_b128 v[40:43], v2 offset:4096
    ds_read_b128 v[44:47], v2 offset:5120
    ds_read_b128 v[120:123], v2 offset:6144
    ds_read_b128 v[124:127], v2 offset:7168
    ds_read_b128 v[96:99], v2 offset:8192
    ds_read_b128 v[100:103], v2 offset:9216
    ds_read_b128 v[104:107], v2 offset:10240
    ds_read_b128 v[108:111], v2 offset:11264
    ds_read_b128 v[112:115], v2 offset:12288
    ds_read_b128 v[116:119], v2 offset:13312
    ds_read_b128 v[80:83], v2 offset:14336
    ds_read_b128 v[84:87], v2 offset:15360
K3_PM_B1_L:
    s_waitcnt vmcnt(0) lgkmcnt(0)
    v_max3_u32 v14, v24, v25, v26
    v_max3_u32 v14, v14, v27, v28
    v_max3_u32 v14, v14, v29, v30
    v_max_u32 v14, v14, v31
    v_cmp_eq_u32 vcc, -1, v14
    s_add_u32 s31, s31, 1
    s_cbranch_vccz K3_PM_B1_D
    s_mov_b64 exec, vcc
    buffer_load_dwordx4 v[24:27], v0, s[24:27], s51 offen sc1
    buffer_load_dwordx4 v[28:31], v0, s[24:27], s51 offen offset:1024 sc1
    s_cmp_gt_u32 s31, 0x40000
    s_cbranch_scc0 K3_PM_B1_L
    s_branch K3_END
K3_PM_B1_D:
    s_mov_b64 exec, -1
    ds_write_b128 v0, v[24:27]
    ds_write_b128 v0, v[28:31] offset:1024
K3_OWN_B1:
    v_smfmac_f32_16x16x64_bf16 v[48:51], v[24:27], v[16:23], v88
    v_smfmac_f32_16x16x64_bf16 v[52:55], v[24:27], v[32:39], v88
    v_smfmac_f32_16x16x64_bf16 v[48:51], v[28:31], v[40:47], v88
    v_smfmac_f32_16x16x64_bf16 v[52:55], v[28:31], v[120:127], v88
    s_waitcnt lgkmcnt(0)
    s_barrier
    ds_read_b128 v[32:35], v1 offset:4096
    ds_read_b128 v[36:39], v1 offset:5120
    ds_read_b128 v[40:43], v1 offset:6144
    ds_read_b128 v[44:47], v1 offset:7168
    ds_read_b128 v[16:19], v1 offset:0
    ds_read_b128 v[20:23], v1 offset:1024
    v_smfmac_f32_16x16x64_bf16 v[56:59], v[24:27], v[96:103], v88
    v_smfmac_f32_16x16x64_bf16 v[60:63], v[24:27], v[104:111], v88
    v_smfmac_f32_16x16x64_bf16 v[56:59], v[28:31], v[112:119], v88
    v_smfmac_f32_16x16x64_bf16 v[60:63], v[28:31], v[80:87], v88
    v_smfmac_f32_16x16x64_bf16 v[64:67], v[24:27], a[16:23], v88
    v_smfmac_f32_16x16x64_bf16 v[68:71], v[24:27], a[80:87], v88
    s_waitcnt lgkmcnt(5)
    v_smfmac_f32_16x16x64_bf16 v[48:51], v[32:35], a[32:39], v88
    s_nop 1
    v_smfmac_f32_16x16x64_bf16 v[52:55], v[32:35], a[96:103], v88
    buffer_store_dword v94, v8, s[24:27], s50 offen sc1
    s_waitcnt lgkmcnt(4)
    v_smfmac_f32_16x16x64_bf16 v[48:51], v[36:39], a[40:47], v88
    s_nop 1
    v_smfmac_f32_16x16x64_bf16 v[52:55], v[36:39], a[104:111], v88
    buffer_store_dword v95, v8, s[24:27], s50 offen offset:64 sc1
    s_waitcnt lgkmcnt(3)
    v_smfmac_f32_16x16x64_bf16 v[48:51], v[40:43], a[48:55], v88
    s_nop 1
    v_smfmac_f32_16x16x64_bf16 v[52:55], v[40:43], a[112:119], v88
    buffer_load_dwordx4 v[80:83], v6, s[24:27], s48 offen sc1
    s_waitcnt lgkmcnt(2)
    v_smfmac_f32_16x16x64_bf16 v[48:51], v[44:47], a[56:63], v88
    s_nop 1
    v_smfmac_f32_16x16x64_bf16 v[52:55], v[44:47], a[120:127], v88
    buffer_load_dwordx4 v[84:87], v6, s[24:27], s48 offen offset:256 sc1
    s_waitcnt lgkmcnt(1)
    v_smfmac_f32_16x16x64_bf16 v[48:51], v[16:19], a[0:7], v88
    s_nop 1
    v_smfmac_f32_16x16x64_bf16 v[52:55], v[16:19], a[64:71], v88
    s_nop 0
    s_waitcnt lgkmcnt(0)
    v_smfmac_f32_16x16x64_bf16 v[48:51], v[20:23], a[8:15], v88
    s_nop 1
    v_smfmac_f32_16x16x64_bf16 v[52:55], v[20:23], a[72:79], v88
    s_waitcnt vmcnt(4)
    s_nop 0
    v_smfmac_f32_16x16x64_bf16 v[56:59], v[32:35], a[160:167], v88
    ds_read_b128 v[96:99], v2 offset:24576
    ds_read_b128 v[100:103], v2 offset:25600
    v_smfmac_f32_16x16x64_bf16 v[60:63], v[32:35], a[224:231], v88
    ds_read_b128 v[104:107], v2 offset:26624
    ds_read_b128 v[108:111], v2 offset:27648
    v_smfmac_f32_16x16x64_bf16 v[56:59], v[36:39], a[168:175], v88
    v_add_f32 v48, v48, v50
    v_add_f32 v49, v49, v51
    v_smfmac_f32_16x16x64_bf16 v[60:63], v[36:39], a[232:239], v88
    v_add_f32 v52, v52, v54
    v_add_f32 v53, v53, v55
    v_smfmac_f32_16x16x64_bf16 v[56:59], v[40:43], a[176:183], v88
    v_cvt_pk_bf16_f32 v50, v48, v49
    v_cvt_pk_bf16_f32 v51, v52, v53
    v_smfmac_f32_16x16x64_bf16 v[60:63], v[40:43], a[240:247], v88
    ds_read_b128 v[112:115], v2 offset:28672
    ds_read_b128 v[116:119], v2 offset:29696
    v_mfma_f32_16x16x16_bf16 v[52:55], v[50:51], v[90:91], 0
    v_readfirstlane_b32 s69, v3
    s_nop 1
    v_mfma_f32_16x16x16_bf16 v[120:123], v[50:51], v[92:93], 0
    s_nop 2
    v_smfmac_f32_16x16x64_bf16 v[56:59], v[44:47], a[184:191], v88
    v_cvt_pk_bf16_f32 v52, v52, v53
    v_cvt_pk_bf16_f32 v53, v54, v55
    v_smfmac_f32_16x16x64_bf16 v[60:63], v[44:47], a[248:255], v88
    s_nop 0
    v_cvt_pk_bf16_f32 v54, v120, v121
    v_smfmac_f32_16x16x64_bf16 v[56:59], v[16:19], a[128:135], v88
    v_cvt_pk_bf16_f32 v55, v122, v123
    s_nop 0
    v_smfmac_f32_16x16x64_bf16 v[60:63], v[16:19], a[192:199], v88
    s_nop 1
    v_smfmac_f32_16x16x64_bf16 v[56:59], v[20:23], a[136:143], v88
    s_cmp_eq_u32 s69, s67
    s_cbranch_scc0 K3_PFSLOW_B1
K3_PFOK_B1:
    v_smfmac_f32_16x16x64_bf16 v[60:63], v[20:23], a[200:207], v88
    s_nop 1
    v_mfma_f32_16x16x32_bf16 v[48:51], v[72:75], v[52:55], 0
    s_nop 2
    v_mfma_f32_16x16x32_bf16 v[120:123], v[76:79], v[52:55], 0
    s_nop 4
    v_add_f32 v56, v56, v58
    v_add_f32 v57, v57, v59
    v_add_f32 v60, v60, v62
    v_add_f32 v61, v61, v63
    v_cvt_pk_bf16_f32 v58, v56, v57
    v_cvt_pk_bf16_f32 v59, v60, v61
    ds_write_b128 v4, v[48:51] offset:512
    ds_write_b128 v4, v[120:123] offset:1024
    v_mfma_f32_16x16x16_bf16 v[60:63], v[58:59], v[90:91], 0
    v_mfma_f32_16x16x16_bf16 v[48:51], v[58:59], v[92:93], 0
    s_waitcnt lgkmcnt(6)
    v_smfmac_f32_16x16x64_bf16 v[64:67], v[36:39], v[96:103], v88
    ds_read_b128 v[96:99], v2 offset:30720
    ds_read_b128 v[100:103], v2 offset:31744
    s_waitcnt lgkmcnt(6)
    v_smfmac_f32_16x16x64_bf16 v[68:71], v[36:39], v[104:111], v88
    ds_read_b128 v[104:107], v2 offset:16384
    ds_read_b128 v[108:111], v2 offset:17408
    s_nop 1
    v_cvt_pk_bf16_f32 v124, v60, v61
    v_cvt_pk_bf16_f32 v125, v62, v63
    v_cvt_pk_bf16_f32 v126, v48, v49
    v_cvt_pk_bf16_f32 v127, v50, v51
    s_nop 1
    v_mfma_f32_16x16x32_bf16 v[56:59], v[124:127], v[52:55], 0
    v_smfmac_f32_16x16x64_bf16 v[64:67], v[16:19], a[24:31], v88
    v_smfmac_f32_16x16x64_bf16 v[68:71], v[16:19], a[88:95], v88
    s_nop 5
    ds_write_b128 v4, v[56:59]
    v_smfmac_f32_16x16x64_bf16 v[64:67], v[32:35], a[144:151], v88
    v_smfmac_f32_16x16x64_bf16 v[68:71], v[32:35], a[208:215], v88
    buffer_load_dwordx4 v[72:75], v5, s[24:27], s47 offen sc1
    buffer_load_dwordx4 v[76:79], v5, s[24:27], s47 offen offset:1024 sc1
    s_add_u32 s64, s64, 4
    buffer_load_dword v3, off, s[24:27], s64 sc1
    s_waitcnt lgkmcnt(0)
    s_barrier
    ds_read_b128 v[48:51], v9 offset:0
    ds_read_b128 v[52:55], v9 offset:1536
    ds_read_b128 v[56:59], v9 offset:3072
    ds_read_b128 v[60:63], v9 offset:4608
    ds_read_b32 v120, v15 offset:0
    ds_read_b32 v121, v15 offset:1536
    ds_read_b32 v122, v15 offset:3072
    ds_read_b32 v123, v15 offset:4608
    buffer_store_dwordx4 v[124:127], v7, s[24:27], s49 offen sc1
    v_smfmac_f32_16x16x64_bf16 v[64:67], v[44:47], v[112:119], v88
    ds_read_b128 v[112:115], v2 offset:18432
    ds_read_b128 v[116:119], v2 offset:19456
    v_smfmac_f32_16x16x64_bf16 v[68:71], v[44:47], v[96:103], v88
    ds_read_b128 v[96:99], v2 offset:20480
    ds_read_b128 v[100:103], v2 offset:21504
    s_waitcnt vmcnt(6)
    v_mov_b32 v14, 1
    s_mov_b64 exec, 1
    buffer_store_byte v14, off, s[24:27], s65 sc1
    s_mov_b64 exec, s[36:37]
    s_mov_b32 s65, s68
    s_add_u32 s68, s68, 4
    s_waitcnt lgkmcnt(8)
    v_pk_add_f32 v[48:49], v[48:49], v[52:53]
    v_pk_add_f32 v[50:51], v[50:51], v[54:55]
    v_pk_add_f32 v[56:57], v[56:57], v[60:61]
    v_pk_add_f32 v[58:59], v[58:59], v[62:63]
    s_waitcnt lgkmcnt(4)
    v_pk_add_f32 v[120:121], v[120:121], v[122:123]
    v_pk_add_f32 v[48:49], v[48:49], v[56:57]
    v_pk_add_f32 v[50:51], v[50:51], v[58:59]
    v_add_f32 v52, v120, v121
    v_cvt_pk_bf16_f32 v56, v48, v49
    v_cvt_pk_bf16_f32 v57, v50, v51
    v_cvt_pk_bf16_f32 v58, v52, v52
    v_lshlrev_b32 v48, 16, v56
    v_and_b32 v49, 0xffff0000, v56
    v_lshlrev_b32 v50, 16, v57
    v_and_b32 v51, 0xffff0000, v57
    v_lshlrev_b32 v52, 16, v58
    v_pk_mul_f32 v[48:49], v[48:49], s[54:55] op_sel_hi:[1,0]
    v_pk_mul_f32 v[50:51], v[50:51], s[54:55] op_sel_hi:[1,0]
    v_mul_f32 v52, s54, v52
    v_cvt_pk_bf16_f32 v56, v48, v49
    v_cvt_pk_bf16_f32 v57, v50, v51
    v_cvt_pk_bf16_f32 v58, v52, v52
    v_lshlrev_b32 v48, 16, v56
    v_and_b32 v49, 0xffff0000, v56
    v_lshlrev_b32 v50, 16, v57
    v_and_b32 v51, 0xffff0000, v57
    v_lshlrev_b32 v52, 16, v58
    v_max3_f32 v14, v48, v49, v50
    v_max3_f32 v14, v14, v51, v52
    v_smfmac_f32_16x16x64_bf16 v[64:67], v[20:23], v[104:111], v88
    ds_read_b128 v[104:107], v2 offset:22528
    ds_read_b128 v[108:111], v2 offset:23552
    s_nop 0
    v_max_f32_dpp v14, v14, v14 row_ror:8 row_mask:0xf bank_mask:0xf
    v_mov_b32 v56, v14
    s_waitcnt lgkmcnt(4)
    v_smfmac_f32_16x16x64_bf16 v[68:71], v[20:23], v[112:119], v88
    s_nop 0
    v_permlane16_swap_b32 v14, v56
    v_max_f32 v14, v14, v56
    v_mov_b32 v56, v14
    s_waitcnt lgkmcnt(2)
    v_smfmac_f32_16x16x64_bf16 v[64:67], v[28:31], v[96:103], v88
    s_nop 0
    v_permlane32_swap_b32 v14, v56
    v_max_f32 v14, v14, v56
    v_mul_f32 v14, s55, v14
    v_pk_fma_f32 v[48:49], v[48:49], s[54:55], v[14:15] op_sel:[0,1,0] op_sel_hi:[1,1,0] neg_lo:[0,0,1] neg_hi:[0,0,1]
    v_pk_fma_f32 v[50:51], v[50:51], s[54:55], v[14:15] op_sel:[0,1,0] op_sel_hi:[1,1,0] neg_lo:[0,0,1] neg_hi:[0,0,1]
    v_fma_f32 v52, v52, s55, -v14
    v_exp_f32 v48, v48
    v_exp_f32 v49, v49
    v_exp_f32 v50, v50
    v_exp_f32 v51, v51
    v_exp_f32 v52, v52
    v_mov_b32 v125, 0
    v_mov_b32 v126, 0
    v_add_f32 v14, v48, v49
    v_add_f32 v56, v50, v51
    v_add_f32 v14, v14, v52
    v_add_f32 v14, v14, v56
    s_waitcnt lgkmcnt(0)
    v_smfmac_f32_16x16x64_bf16 v[68:71], v[28:31], v[104:111], v88
    s_nop 0
    v_add_f32_dpp v14, v14, v14 row_ror:8 row_mask:0xf bank_mask:0xf
    v_mov_b32 v56, v14
    v_smfmac_f32_16x16x64_bf16 v[64:67], v[40:43], a[152:159], v88
    s_nop 0
    v_permlane16_swap_b32 v14, v56
    v_add_f32 v14, v14, v56
    v_mov_b32 v56, v14
    v_smfmac_f32_16x16x64_bf16 v[68:71], v[40:43], a[216:223], v88
    s_nop 0
    v_permlane32_swap_b32 v14, v56
    v_add_f32 v14, v14, v56
    v_rcp_f32 v14, v14
    s_nop 0
    v_pk_mul_f32 v[48:49], v[48:49], v[14:15] op_sel_hi:[1,0]
    v_pk_mul_f32 v[50:51], v[50:51], v[14:15] op_sel_hi:[1,0]
    v_mul_f32 v52, v52, v14
    v_cvt_pk_bf16_f32 v120, v48, v49
    v_cvt_pk_bf16_f32 v121, v50, v51
    v_mov_b32_dpp v53, v52 row_ror:8 row_mask:0xf bank_mask:0xf
    v_mov_b32_dpp v122, v120 row_ror:8 row_mask:0xf bank_mask:0xf
    v_mov_b32_dpp v123, v121 row_ror:8 row_mask:0xf bank_mask:0xf
    v_cvt_pk_bf16_f32 v124, v52, v53
    v_cvt_pk_bf16_f32 v127, v52, v53
    s_waitcnt vmcnt(5)
    v_mfma_f32_16x16x32_bf16 v[96:99], v[80:83], v[120:123], 0
    v_add_f32 v64, v64, v66
    v_add_f32 v65, v65, v67
    v_mfma_f32_16x16x32_bf16 v[100:103], v[84:87], v[120:123], 0
    v_add_f32 v68, v68, v70
    v_add_f32 v69, v69, v71
    v_cvt_pk_bf16_f32 v94, v64, v65
    v_cvt_pk_bf16_f32 v95, v68, v69
    s_cmp_eq_u32 s30, 63
    s_cbranch_scc1 K3_LAST_B1
    v_mfma_f32_16x16x16_bf16 v[96:99], v[94:95], v[124:125], v[96:99]
    v_mfma_f32_16x16x16_bf16 v[100:103], v[94:95], v[126:127], v[100:103]
    v_mov_b64 v[16:17], 0
    v_mov_b64 v[18:19], 0
    v_mov_b64 v[20:21], 0
    v_mov_b64 v[22:23], 0
    v_mov_b64 v[24:25], 0
    v_mov_b64 v[26:27], 0
    v_mov_b64 v[28:29], 0
    v_mov_b64 v[30:31], 0
    v_cvt_pk_bf16_f32 v104, v96, v97
    v_cvt_pk_bf16_f32 v106, v98, v99
    v_cvt_pk_bf16_f32 v105, v100, v101
    v_cvt_pk_bf16_f32 v107, v102, v103
    ds_write2_b64 v10, v[104:105], v[106:107] offset0:0 offset1:4
    v_mov_b64 v[32:33], 0
    v_mov_b64 v[34:35], 0
    v_mov_b64 v[36:37], 0
    v_mov_b64 v[38:39], 0
    s_waitcnt lgkmcnt(0)
    s_barrier
    ds_read_b128 v[108:111], v11
    ds_read_b128 v[112:115], v11 offset:1024
    v_mov_b64 v[40:41], 0
    v_mov_b64 v[42:43], 0
    v_mov_b64 v[44:45], 0
    v_mov_b64 v[46:47], 0
    s_waitcnt lgkmcnt(0)
    v_smfmac_f32_16x16x64_bf16 v[16:19], v[108:111], v[128:135], v88
    s_nop 2
    v_smfmac_f32_16x16x64_bf16 v[20:23], v[108:111], v[144:151], v88
    s_nop 2
    v_smfmac_f32_16x16x64_bf16 v[16:19], v[112:115], v[136:143], v88
    s_nop 2
    v_smfmac_f32_16x16x64_bf16 v[20:23], v[112:115], v[152:159], v88
    v_smfmac_f32_16x16x64_bf16 v[24:27], v[108:111], v[160:167], v88
    s_nop 2
    v_smfmac_f32_16x16x64_bf16 v[28:31], v[108:111], v[176:183], v88
    v_add_f32 v16, v16, v18
    v_add_f32 v17, v17, v19
    v_smfmac_f32_16x16x64_bf16 v[24:27], v[112:115], v[168:175], v88
    v_add_f32 v18, v20, v22
    v_add_f32 v19, v21, v23
    v_smfmac_f32_16x16x64_bf16 v[28:31], v[112:115], v[184:191], v88
    v_cvt_pk_f16_f32 v16, v16, v17
    v_cvt_pk_f16_f32 v17, v18, v19
    v_smfmac_f32_16x16x64_bf16 v[32:35], v[108:111], v[192:199], v88
    v_and_or_b32 v16, v16, -2, s92
    buffer_store_dwordx2 v[16:17], v12, s[24:27], s59 offen sc1
    s_add_u32 s59, s59, 16384
    v_smfmac_f32_16x16x64_bf16 v[36:39], v[108:111], v[208:215], v88
    v_add_f32 v24, v24, v26
    v_add_f32 v25, v25, v27
    v_smfmac_f32_16x16x64_bf16 v[32:35], v[112:115], v[200:207], v88
    v_add_f32 v26, v28, v30
    v_add_f32 v27, v29, v31
    v_smfmac_f32_16x16x64_bf16 v[36:39], v[112:115], v[216:223], v88
    v_cvt_pk_f16_f32 v24, v24, v25
    v_cvt_pk_f16_f32 v25, v26, v27
    v_smfmac_f32_16x16x64_bf16 v[40:43], v[108:111], v[224:231], v88
    v_and_or_b32 v24, v24, -2, s92
    buffer_store_dwordx2 v[24:25], v12, s[24:27], s59 offen sc1
    s_add_u32 s59, s59, 16384
    v_smfmac_f32_16x16x64_bf16 v[44:47], v[108:111], v[240:247], v88
    v_add_f32 v32, v32, v34
    v_add_f32 v33, v33, v35
    v_smfmac_f32_16x16x64_bf16 v[40:43], v[112:115], v[232:239], v88
    v_add_f32 v34, v36, v38
    v_add_f32 v35, v37, v39
    v_smfmac_f32_16x16x64_bf16 v[44:47], v[112:115], v[248:255], v88
    v_cvt_pk_f16_f32 v32, v32, v33
    v_cvt_pk_f16_f32 v33, v34, v35
    v_and_or_b32 v32, v32, -2, s92
    buffer_store_dwordx2 v[32:33], v12, s[24:27], s59 offen sc1
    s_add_u32 s59, s59, 16384
    s_nop 0
    s_nop 1
    v_pk_add_f32 v[40:41], v[40:41], v[42:43]
    v_pk_add_f32 v[42:43], v[44:45], v[46:47]
    v_cvt_pk_f16_f32 v40, v40, v41
    v_cvt_pk_f16_f32 v41, v42, v43
    v_and_or_b32 v40, v40, -2, s92
    buffer_store_dwordx2 v[40:41], v12, s[24:27], s59 offen sc1
    s_nop 7
    s_nop 7
    s_nop 7
    s_nop 7
    s_mov_b32 s31, 0
    v_lshrrev_b32 v31, 1, v1
    buffer_load_dwordx2 v[16:17], v31, s[24:27], s57 offen offset:0 sc1
    buffer_load_dwordx2 v[18:19], v31, s[24:27], s57 offen offset:512 sc1
    buffer_load_dwordx2 v[20:21], v31, s[24:27], s57 offen offset:1024 sc1
    buffer_load_dwordx2 v[22:23], v31, s[24:27], s57 offen offset:1536 sc1
    s_add_u32 s51, s51, 8192
    s_add_u32 s58, s51, s52
    v_bfe_u32 v100, v1, 6, 2
    s_movk_i32 s33, 0x3c00
    v_and_b32 v101, 1, v100
    v_lshlrev_b32 v101, 4, v101
    v_lshlrev_b32 v101, v101, s33
    v_cmp_gt_u32 vcc, 2, v100
    s_nop 1
    v_cndmask_b32 v96, 0, v101, vcc
    v_cndmask_b32 v97, v101, 0, vcc
    v_mov_b32 v98, v96
    v_mov_b32 v99, v97
    s_cmp_lg_u32 s92, 0
    s_cbranch_scc1 K3_PP_B1_L1
K3_PP_B1_L0:
    s_waitcnt vmcnt(0)
    v_mfma_f32_16x16x32_f16 v[120:123], v[96:99], v[16:19], 0
    v_mfma_f32_16x16x32_f16 v[120:123], v[96:99], v[20:23], v[120:123]
    v_or3_b32 v14, v16, v18, v20
    v_bitop3_b32 v14, v14, v22, 1 bitop3:0xa8
    v_cmp_ne_u32 vcc, 0, v14
    s_add_u32 s31, s31, 1
    s_cbranch_vccz K3_PP_B1_D
    s_mov_b64 exec, vcc
    buffer_load_dwordx2 v[16:17], v31, s[24:27], s57 offen offset:0 sc1
    buffer_load_dwordx2 v[18:19], v31, s[24:27], s57 offen offset:512 sc1
    buffer_load_dwordx2 v[20:21], v31, s[24:27], s57 offen offset:1024 sc1
    buffer_load_dwordx2 v[22:23], v31, s[24:27], s57 offen offset:1536 sc1
    s_cmp_gt_u32 s31, 0x40000
    s_cbranch_scc0 K3_PP_B1_L0
    s_branch K3_END
K3_PP_B1_L1:
    s_waitcnt vmcnt(0)
    v_mfma_f32_16x16x32_f16 v[120:123], v[96:99], v[16:19], 0
    v_mfma_f32_16x16x32_f16 v[120:123], v[96:99], v[20:23], v[120:123]
    v_bitop3_b32 v14, v16, v18, v20 bitop3:0x80
    v_bitop3_b32 v14, v14, v22, 1 bitop3:0x2a
    v_cmp_ne_u32 vcc, 0, v14
    s_add_u32 s31, s31, 1
    s_cbranch_vccz K3_PP_B1_D
    s_mov_b64 exec, vcc
    buffer_load_dwordx2 v[16:17], v31, s[24:27], s57 offen offset:0 sc1
    buffer_load_dwordx2 v[18:19], v31, s[24:27], s57 offen offset:512 sc1
    buffer_load_dwordx2 v[20:21], v31, s[24:27], s57 offen offset:1024 sc1
    buffer_load_dwordx2 v[22:23], v31, s[24:27], s57 offen offset:1536 sc1
    s_cmp_gt_u32 s31, 0x40000
    s_cbranch_scc0 K3_PP_B1_L1
    s_branch K3_END
K3_PP_B1_D:
    s_mov_b64 exec, -1
    s_nop 0
    s_nop 1
    v_add_f32_dpp v120, v120, v120 row_ror:8 row_mask:0xf bank_mask:0xf
    v_mov_b32 v14, -2
    s_nop 0
    v_mov_b32_dpp v121, v120 quad_perm:[1,0,3,2] row_mask:0xf bank_mask:0xf
    v_cvt_pk_bf16_f32 v120, v120, v121
    v_min_u32 v120, v120, v14
    buffer_store_dword v120, v13, s[24:27], s58 offen sc1
    v_mov_b64 v[48:49], 0
    v_mov_b64 v[50:51], 0
    v_mov_b64 v[52:53], 0
    v_mov_b64 v[54:55], 0
    v_mov_b64 v[56:57], 0
    v_mov_b64 v[58:59], 0
    v_mov_b64 v[60:61], 0
    v_mov_b64 v[62:63], 0
    v_mov_b64 v[64:65], 0
    v_mov_b64 v[66:67], 0
    v_mov_b64 v[68:69], 0
    v_mov_b64 v[70:71], 0
    s_add_u32 s30, s30, 1
    s_add_u32 s49, s49, 0x10000
    s_branch K3_STEP_B1
K3_PROJ_B1:
    ds_read_b128 v[24:27], v1 offset:2048
    ds_read_b128 v[28:31], v1 offset:3072
    ds_read_b128 v[16:19], v2 offset:0
    ds_read_b128 v[20:23], v2 offset:1024
    ds_read_b128 v[32:35], v2 offset:2048
    ds_read_b128 v[36:39], v2 offset:3072
    ds_read_b128 v[40:43], v2 offset:4096
    ds_read_b128 v[44:47], v2 offset:5120
    ds_read_b128 v[120:123], v2 offset:6144
    ds_read_b128 v[124:127], v2 offset:7168
    ds_read_b128 v[96:99], v2 offset:8192
    ds_read_b128 v[100:103], v2 offset:9216
    ds_read_b128 v[104:107], v2 offset:10240
    ds_read_b128 v[108:111], v2 offset:11264
    ds_read_b128 v[112:115], v2 offset:12288
    ds_read_b128 v[116:119], v2 offset:13312
    ds_read_b128 v[80:83], v2 offset:14336
    ds_read_b128 v[84:87], v2 offset:15360
    s_waitcnt lgkmcnt(0)
    s_branch K3_OWN_B1
K3_LAST_B1:
    s_add_u32 s50, s50, 0x10000
    buffer_store_dword v94, v8, s[24:27], s50 offen sc1
    buffer_store_dword v95, v8, s[24:27], s50 offen offset:64 sc1
    s_waitcnt vmcnt(0)
    v_mov_b32 v14, 1
    s_mov_b64 exec, 1
    buffer_store_byte v14, off, s[24:27], s65 sc1
    s_endpgm
K3_PFSLOW_B1:
    s_cmp_eq_u32 s30, 63
    s_cbranch_scc1 K3_PFOK_B1
    s_mov_b32 s31, 0
K3_PFS2_B1:
    buffer_load_dword v3, off, s[24:27], s64 sc1
    s_waitcnt vmcnt(0)
    v_readfirstlane_b32 s32, v3
    s_add_u32 s31, s31, 1
    s_cmp_gt_u32 s31, 0x40000
    s_cbranch_scc1 K3_END
    s_cmp_lg_u32 s32, s67
    s_cbranch_scc1 K3_PFS2_B1
    s_branch K3_PFOK_B1
K3_STEP_B2:
    s_nop 7
    s_nop 7
    s_nop 7
    s_nop 7
    s_nop 7
    s_nop 7
    s_nop 7
    s_mov_b32 s31, 0
    buffer_load_dwordx4 v[32:35], v0, s[24:27], s51 offen sc1
    buffer_load_dwordx4 v[36:39], v0, s[24:27], s51 offen offset:1024 sc1
    s_and_b32 s32, s30, 1
    s_lshl_b32 s32, s32, 19
    s_lshl_b32 s33, s28, 6
    s_add_u32 s59, s32, s33
    s_add_u32 s59, s59, 0x300000
    s_lshl_b32 s33, s28, 13
    s_add_u32 s57, s32, s33
    s_add_u32 s57, s57, 0x300000
    s_add_u32 s57, s57, s66
    s_lshr_b32 s92, s30, 1
    s_and_b32 s92, s92, 1
    s_add_u32 s50, s50, 0x10000
    s_add_u32 s48, s48, 0x40000
    s_add_u32 s47, s47, 0x40000
    ds_read_b128 v[16:19], v2 offset:0
    ds_read_b128 v[20:23], v2 offset:1024
    ds_read_b128 v[24:27], v2 offset:2048
    ds_read_b128 v[28:31], v2 offset:3072
    ds_read_b128 v[40:43], v2 offset:4096
    ds_read_b128 v[44:47], v2 offset:5120
    ds_read_b128 v[120:123], v2 offset:6144
    ds_read_b128 v[124:127], v2 offset:7168
    ds_read_b128 v[96:99], v2 offset:8192
    ds_read_b128 v[100:103], v2 offset:9216
    ds_read_b128 v[104:107], v2 offset:10240
    ds_read_b128 v[108:111], v2 offset:11264
    ds_read_b128 v[112:115], v2 offset:12288
    ds_read_b128 v[116:119], v2 offset:13312
    ds_read_b128 v[80:83], v2 offset:14336
    ds_read_b128 v[84:87], v2 offset:15360
K3_PM_B2_L:
    s_waitcnt vmcnt(0) lgkmcnt(0)
    v_max3_u32 v14, v32, v33, v34
    v_max3_u32 v14, v14, v35, v36
    v_max3_u32 v14, v14, v37, v38
    v_max_u32 v14, v14, v39
    v_cmp_eq_u32 vcc, -1, v14
    s_add_u32 s31, s31, 1
    s_cbranch_vccz K3_PM_B2_D
    s_mov_b64 exec, vcc
    buffer_load_dwordx4 v[32:35], v0, s[24:27], s51 offen sc1
    buffer_load_dwordx4 v[36:39], v0, s[24:27], s51 offen offset:1024 sc1
    s_cmp_gt_u32 s31, 0x40000
    s_cbranch_scc0 K3_PM_B2_L
    s_branch K3_END
K3_PM_B2_D:
    s_mov_b64 exec, -1
    ds_write_b128 v0, v[32:35]
    ds_write_b128 v0, v[36:39] offset:1024
K3_OWN_B2:
    v_smfmac_f32_16x16x64_bf16 v[48:51], v[32:35], v[16:23], v88
    v_smfmac_f32_16x16x64_bf16 v[52:55], v[32:35], v[24:31], v88
    v_smfmac_f32_16x16x64_bf16 v[48:51], v[36:39], v[40:47], v88
    v_smfmac_f32_16x16x64_bf16 v[52:55], v[36:39], v[120:127], v88
    s_waitcnt lgkmcnt(0)
    s_barrier
    ds_read_b128 v[40:43], v1 offset:6144
    ds_read_b128 v[44:47], v1 offset:7168
    ds_read_b128 v[16:19], v1 offset:0
    ds_read_b128 v[20:23], v1 offset:1024
    ds_read_b128 v[24:27], v1 offset:2048
    ds_read_b128 v[28:31], v1 offset:3072
    v_smfmac_f32_16x16x64_bf16 v[56:59], v[32:35], v[96:103], v88
    v_smfmac_f32_16x16x64_bf16 v[60:63], v[32:35], v[104:111], v88
    v_smfmac_f32_16x16x64_bf16 v[56:59], v[36:39], v[112:119], v88
    v_smfmac_f32_16x16x64_bf16 v[60:63], v[36:39], v[80:87], v88
    v_smfmac_f32_16x16x64_bf16 v[64:67], v[32:35], a[32:39], v88
    v_smfmac_f32_16x16x64_bf16 v[68:71], v[32:35], a[96:103], v88
    s_waitcnt lgkmcnt(5)
    v_smfmac_f32_16x16x64_bf16 v[48:51], v[40:43], a[48:55], v88
    s_nop 1
    v_smfmac_f32_16x16x64_bf16 v[52:55], v[40:43], a[112:119], v88
    buffer_store_dword v94, v8, s[24:27], s50 offen sc1
    s_waitcnt lgkmcnt(4)
    v_smfmac_f32_16x16x64_bf16 v[48:51], v[44:47], a[56:63], v88
    s_nop 1
    v_smfmac_f32_16x16x64_bf16 v[52:55], v[44:47], a[120:127], v88
    buffer_store_dword v95, v8, s[24:27], s50 offen offset:64 sc1
    s_waitcnt lgkmcnt(3)
    v_smfmac_f32_16x16x64_bf16 v[48:51], v[16:19], a[0:7], v88
    s_nop 1
    v_smfmac_f32_16x16x64_bf16 v[52:55], v[16:19], a[64:71], v88
    buffer_load_dwordx4 v[80:83], v6, s[24:27], s48 offen sc1
    s_waitcnt lgkmcnt(2)
    v_smfmac_f32_16x16x64_bf16 v[48:51], v[20:23], a[8:15], v88
    s_nop 1
    v_smfmac_f32_16x16x64_bf16 v[52:55], v[20:23], a[72:79], v88
    buffer_load_dwordx4 v[84:87], v6, s[24:27], s48 offen offset:256 sc1
    s_waitcnt lgkmcnt(1)
    v_smfmac_f32_16x16x64_bf16 v[48:51], v[24:27], a[16:23], v88
    s_nop 1
    v_smfmac_f32_16x16x64_bf16 v[52:55], v[24:27], a[80:87], v88
    s_nop 0
    s_waitcnt lgkmcnt(0)
    v_smfmac_f32_16x16x64_bf16 v[48:51], v[28:31], a[24:31], v88
    s_nop 1
    v_smfmac_f32_16x16x64_bf16 v[52:55], v[28:31], a[88:95], v88
    s_waitcnt vmcnt(4)
    s_nop 0
    v_smfmac_f32_16x16x64_bf16 v[56:59], v[40:43], a[176:183], v88
    ds_read_b128 v[96:99], v2 offset:28672
    ds_read_b128 v[100:103], v2 offset:29696
    v_smfmac_f32_16x16x64_bf16 v[60:63], v[40:43], a[240:247], v88
    ds_read_b128 v[104:107], v2 offset:30720
    ds_read_b128 v[108:111], v2 offset:31744
    v_smfmac_f32_16x16x64_bf16 v[56:59], v[44:47], a[184:191], v88
    v_add_f32 v48, v48, v50
    v_add_f32 v49, v49, v51
    v_smfmac_f32_16x16x64_bf16 v[60:63], v[44:47], a[248:255], v88
    v_add_f32 v52, v52, v54
    v_add_f32 v53, v53, v55
    v_smfmac_f32_16x16x64_bf16 v[56:59], v[16:19], a[128:135], v88
    v_cvt_pk_bf16_f32 v50, v48, v49
    v_cvt_pk_bf16_f32 v51, v52, v53
    v_smfmac_f32_16x16x64_bf16 v[60:63], v[16:19], a[192:199], v88
    ds_read_b128 v[112:115], v2 offset:16384
    ds_read_b128 v[116:119], v2 offset:17408
    v_mfma_f32_16x16x16_bf16 v[52:55], v[50:51], v[90:91], 0
    v_readfirstlane_b32 s69, v3
    s_nop 1
    v_mfma_f32_16x16x16_bf16 v[120:123], v[50:51], v[92:93], 0
    s_nop 2
    v_smfmac_f32_16x16x64_bf16 v[56:59], v[20:23], a[136:143], v88
    v_cvt_pk_bf16_f32 v52, v52, v53
    v_cvt_pk_bf16_f32 v53, v54, v55
    v_smfmac_f32_16x16x64_bf16 v[60:63], v[20:23], a[200:207], v88
    s_nop 0
    v_cvt_pk_bf16_f32 v54, v120, v121
    v_smfmac_f32_16x16x64_bf16 v[56:59], v[24:27], a[144:151], v88
    v_cvt_pk_bf16_f32 v55, v122, v123
    s_nop 0
    v_smfmac_f32_16x16x64_bf16 v[60:63], v[24:27], a[208:215], v88
    s_nop 1
    v_smfmac_f32_16x16x64_bf16 v[56:59], v[28:31], a[152:159], v88
    s_cmp_eq_u32 s69, s67
    s_cbranch_scc0 K3_PFSLOW_B2
K3_PFOK_B2:
    v_smfmac_f32_16x16x64_bf16 v[60:63], v[28:31], a[216:223], v88
    s_nop 1
    v_mfma_f32_16x16x32_bf16 v[48:51], v[72:75], v[52:55], 0
    s_nop 2
    v_mfma_f32_16x16x32_bf16 v[120:123], v[76:79], v[52:55], 0
    s_nop 4
    v_add_f32 v56, v56, v58
    v_add_f32 v57, v57, v59
    v_add_f32 v60, v60, v62
    v_add_f32 v61, v61, v63
    v_cvt_pk_bf16_f32 v58, v56, v57
    v_cvt_pk_bf16_f32 v59, v60, v61
    ds_write_b128 v4, v[48:51] offset:512
    ds_write_b128 v4, v[120:123] offset:1024
    v_mfma_f32_16x16x16_bf16 v[60:63], v[58:59], v[90:91], 0
    v_mfma_f32_16x16x16_bf16 v[48:51], v[58:59], v[92:93], 0
    s_waitcnt lgkmcnt(6)
    v_smfmac_f32_16x16x64_bf16 v[64:67], v[44:47], v[96:103], v88
    ds_read_b128 v[96:99], v2 offset:18432
    ds_read_b128 v[100:103], v2 offset:19456
    s_waitcnt lgkmcnt(6)
    v_smfmac_f32_16x16x64_bf16 v[68:71], v[44:47], v[104:111], v88
    ds_read_b128 v[104:107], v2 offset:20480
    ds_read_b128 v[108:111], v2 offset:21504
    s_nop 1
    v_cvt_pk_bf16_f32 v124, v60, v61
    v_cvt_pk_bf16_f32 v125, v62, v63
    v_cvt_pk_bf16_f32 v126, v48, v49
    v_cvt_pk_bf16_f32 v127, v50, v51
    s_nop 1
    v_mfma_f32_16x16x32_bf16 v[56:59], v[124:127], v[52:55], 0
    v_smfmac_f32_16x16x64_bf16 v[64:67], v[16:19], a[40:47], v88
    v_smfmac_f32_16x16x64_bf16 v[68:71], v[16:19], a[104:111], v88
    s_nop 5
    ds_write_b128 v4, v[56:59]
    v_smfmac_f32_16x16x64_bf16 v[64:67], v[24:27], a[160:167], v88
    v_smfmac_f32_16x16x64_bf16 v[68:71], v[24:27], a[224:231], v88
    buffer_load_dwordx4 v[72:75], v5, s[24:27], s47 offen sc1
    buffer_load_dwordx4 v[76:79], v5, s[24:27], s47 offen offset:1024 sc1
    s_add_u32 s64, s64, 4
    buffer_load_dword v3, off, s[24:27], s64 sc1
    s_waitcnt lgkmcnt(0)
    s_barrier
    ds_read_b128 v[48:51], v9 offset:0
    ds_read_b128 v[52:55], v9 offset:1536
    ds_read_b128 v[56:59], v9 offset:3072
    ds_read_b128 v[60:63], v9 offset:4608
    ds_read_b32 v120, v15 offset:0
    ds_read_b32 v121, v15 offset:1536
    ds_read_b32 v122, v15 offset:3072
    ds_read_b32 v123, v15 offset:4608
    buffer_store_dwordx4 v[124:127], v7, s[24:27], s49 offen sc1
    v_smfmac_f32_16x16x64_bf16 v[64:67], v[20:23], v[112:119], v88
    ds_read_b128 v[112:115], v2 offset:22528
    ds_read_b128 v[116:119], v2 offset:23552
    v_smfmac_f32_16x16x64_bf16 v[68:71], v[20:23], v[96:103], v88
    ds_read_b128 v[96:99], v2 offset:24576
    ds_read_b128 v[100:103], v2 offset:25600
    s_waitcnt vmcnt(6)
    v_mov_b32 v14, 1
    s_mov_b64 exec, 1
    buffer_store_byte v14, off, s[24:27], s65 sc1
    s_mov_b64 exec, s[36:37]
    s_mov_b32 s65, s68
    s_add_u32 s68, s68, 4
    s_waitcnt lgkmcnt(8)
    v_pk_add_f32 v[48:49], v[48:49], v[52:53]
    v_pk_add_f32 v[50:51], v[50:51], v[54:55]
    v_pk_add_f32 v[56:57], v[56:57], v[60:61]
    v_pk_add_f32 v[58:59], v[58:59], v[62:63]
    s_waitcnt lgkmcnt(4)
    v_pk_add_f32 v[120:121], v[120:121], v[122:123]
    v_pk_add_f32 v[48:49], v[48:49], v[56:57]
    v_pk_add_f32 v[50:51], v[50:51], v[58:59]
    v_add_f32 v52, v120, v121
    v_cvt_pk_bf16_f32 v56, v48, v49
    v_cvt_pk_bf16_f32 v57, v50, v51
    v_cvt_pk_bf16_f32 v58, v52, v52
    v_lshlrev_b32 v48, 16, v56
    v_and_b32 v49, 0xffff0000, v56
    v_lshlrev_b32 v50, 16, v57
    v_and_b32 v51, 0xffff0000, v57
    v_lshlrev_b32 v52, 16, v58
    v_pk_mul_f32 v[48:49], v[48:49], s[54:55] op_sel_hi:[1,0]
    v_pk_mul_f32 v[50:51], v[50:51], s[54:55] op_sel_hi:[1,0]
    v_mul_f32 v52, s54, v52
    v_cvt_pk_bf16_f32 v56, v48, v49
    v_cvt_pk_bf16_f32 v57, v50, v51
    v_cvt_pk_bf16_f32 v58, v52, v52
    v_lshlrev_b32 v48, 16, v56
    v_and_b32 v49, 0xffff0000, v56
    v_lshlrev_b32 v50, 16, v57
    v_and_b32 v51, 0xffff0000, v57
    v_lshlrev_b32 v52, 16, v58
    v_max3_f32 v14, v48, v49, v50
    v_max3_f32 v14, v14, v51, v52
    v_smfmac_f32_16x16x64_bf16 v[64:67], v[28:31], v[104:111], v88
    ds_read_b128 v[104:107], v2 offset:26624
    ds_read_b128 v[108:111], v2 offset:27648
    s_nop 0
    v_max_f32_dpp v14, v14, v14 row_ror:8 row_mask:0xf bank_mask:0xf
    v_mov_b32 v56, v14
    s_waitcnt lgkmcnt(4)
    v_smfmac_f32_16x16x64_bf16 v[68:71], v[28:31], v[112:119], v88
    s_nop 0
    v_permlane16_swap_b32 v14, v56
    v_max_f32 v14, v14, v56
    v_mov_b32 v56, v14
    s_waitcnt lgkmcnt(2)
    v_smfmac_f32_16x16x64_bf16 v[64:67], v[36:39], v[96:103], v88
    s_nop 0
    v_permlane32_swap_b32 v14, v56
    v_max_f32 v14, v14, v56
    v_mul_f32 v14, s55, v14
    v_pk_fma_f32 v[48:49], v[48:49], s[54:55], v[14:15] op_sel:[0,1,0] op_sel_hi:[1,1,0] neg_lo:[0,0,1] neg_hi:[0,0,1]
    v_pk_fma_f32 v[50:51], v[50:51], s[54:55], v[14:15] op_sel:[0,1,0] op_sel_hi:[1,1,0] neg_lo:[0,0,1] neg_hi:[0,0,1]
    v_fma_f32 v52, v52, s55, -v14
    v_exp_f32 v48, v48
    v_exp_f32 v49, v49
    v_exp_f32 v50, v50
    v_exp_f32 v51, v51
    v_exp_f32 v52, v52
    v_mov_b32 v125, 0
    v_mov_b32 v126, 0
    v_add_f32 v14, v48, v49
    v_add_f32 v56, v50, v51
    v_add_f32 v14, v14, v52
    v_add_f32 v14, v14, v56
    s_waitcnt lgkmcnt(0)
    v_smfmac_f32_16x16x64_bf16 v[68:71], v[36:39], v[104:111], v88
    s_nop 0
    v_add_f32_dpp v14, v14, v14 row_ror:8 row_mask:0xf bank_mask:0xf
    v_mov_b32 v56, v14
    v_smfmac_f32_16x16x64_bf16 v[64:67], v[40:43], a[168:175], v88
    s_nop 0
    v_permlane16_swap_b32 v14, v56
    v_add_f32 v14, v14, v56
    v_mov_b32 v56, v14
    v_smfmac_f32_16x16x64_bf16 v[68:71], v[40:43], a[232:239], v88
    s_nop 0
    v_permlane32_swap_b32 v14, v56
    v_add_f32 v14, v14, v56
    v_rcp_f32 v14, v14
    s_nop 0
    v_pk_mul_f32 v[48:49], v[48:49], v[14:15] op_sel_hi:[1,0]
    v_pk_mul_f32 v[50:51], v[50:51], v[14:15] op_sel_hi:[1,0]
    v_mul_f32 v52, v52, v14
    v_cvt_pk_bf16_f32 v120, v48, v49
    v_cvt_pk_bf16_f32 v121, v50, v51
    v_mov_b32_dpp v53, v52 row_ror:8 row_mask:0xf bank_mask:0xf
    v_mov_b32_dpp v122, v120 row_ror:8 row_mask:0xf bank_mask:0xf
    v_mov_b32_dpp v123, v121 row_ror:8 row_mask:0xf bank_mask:0xf
    v_cvt_pk_bf16_f32 v124, v52, v53
    v_cvt_pk_bf16_f32 v127, v52, v53
    s_waitcnt vmcnt(5)
    v_mfma_f32_16x16x32_bf16 v[96:99], v[80:83], v[120:123], 0
    v_add_f32 v64, v64, v66
    v_add_f32 v65, v65, v67
    v_mfma_f32_16x16x32_bf16 v[100:103], v[84:87], v[120:123], 0
    v_add_f32 v68, v68, v70
    v_add_f32 v69, v69, v71
    v_cvt_pk_bf16_f32 v94, v64, v65
    v_cvt_pk_bf16_f32 v95, v68, v69
    s_cmp_eq_u32 s30, 63
    s_cbranch_scc1 K3_LAST_B2
    v_mfma_f32_16x16x16_bf16 v[96:99], v[94:95], v[124:125], v[96:99]
    v_mfma_f32_16x16x16_bf16 v[100:103], v[94:95], v[126:127], v[100:103]
    v_mov_b64 v[16:17], 0
    v_mov_b64 v[18:19], 0
    v_mov_b64 v[20:21], 0
    v_mov_b64 v[22:23], 0
    v_mov_b64 v[24:25], 0
    v_mov_b64 v[26:27], 0
    v_mov_b64 v[28:29], 0
    v_mov_b64 v[30:31], 0
    v_cvt_pk_bf16_f32 v104, v96, v97
    v_cvt_pk_bf16_f32 v106, v98, v99
    v_cvt_pk_bf16_f32 v105, v100, v101
    v_cvt_pk_bf16_f32 v107, v102, v103
    ds_write2_b64 v10, v[104:105], v[106:107] offset0:0 offset1:4
    v_mov_b64 v[32:33], 0
    v_mov_b64 v[34:35], 0
    v_mov_b64 v[36:37], 0
    v_mov_b64 v[38:39], 0
    s_waitcnt lgkmcnt(0)
    s_barrier
    ds_read_b128 v[108:111], v11
    ds_read_b128 v[112:115], v11 offset:1024
    v_mov_b64 v[40:41], 0
    v_mov_b64 v[42:43], 0
    v_mov_b64 v[44:45], 0
    v_mov_b64 v[46:47], 0
    s_waitcnt lgkmcnt(0)
    v_smfmac_f32_16x16x64_bf16 v[16:19], v[108:111], v[128:135], v88
    s_nop 2
    v_smfmac_f32_16x16x64_bf16 v[20:23], v[108:111], v[144:151], v88
    s_nop 2
    v_smfmac_f32_16x16x64_bf16 v[16:19], v[112:115], v[136:143], v88
    s_nop 2
    v_smfmac_f32_16x16x64_bf16 v[20:23], v[112:115], v[152:159], v88
    v_smfmac_f32_16x16x64_bf16 v[24:27], v[108:111], v[160:167], v88
    s_nop 2
    v_smfmac_f32_16x16x64_bf16 v[28:31], v[108:111], v[176:183], v88
    v_add_f32 v16, v16, v18
    v_add_f32 v17, v17, v19
    v_smfmac_f32_16x16x64_bf16 v[24:27], v[112:115], v[168:175], v88
    v_add_f32 v18, v20, v22
    v_add_f32 v19, v21, v23
    v_smfmac_f32_16x16x64_bf16 v[28:31], v[112:115], v[184:191], v88
    v_cvt_pk_f16_f32 v16, v16, v17
    v_cvt_pk_f16_f32 v17, v18, v19
    v_smfmac_f32_16x16x64_bf16 v[32:35], v[108:111], v[192:199], v88
    v_and_or_b32 v16, v16, -2, s92
    buffer_store_dwordx2 v[16:17], v12, s[24:27], s59 offen sc1
    s_add_u32 s59, s59, 16384
    v_smfmac_f32_16x16x64_bf16 v[36:39], v[108:111], v[208:215], v88
    v_add_f32 v24, v24, v26
    v_add_f32 v25, v25, v27
    v_smfmac_f32_16x16x64_bf16 v[32:35], v[112:115], v[200:207], v88
    v_add_f32 v26, v28, v30
    v_add_f32 v27, v29, v31
    v_smfmac_f32_16x16x64_bf16 v[36:39], v[112:115], v[216:223], v88
    v_cvt_pk_f16_f32 v24, v24, v25
    v_cvt_pk_f16_f32 v25, v26, v27
    v_smfmac_f32_16x16x64_bf16 v[40:43], v[108:111], v[224:231], v88
    v_and_or_b32 v24, v24, -2, s92
    buffer_store_dwordx2 v[24:25], v12, s[24:27], s59 offen sc1
    s_add_u32 s59, s59, 16384
    v_smfmac_f32_16x16x64_bf16 v[44:47], v[108:111], v[240:247], v88
    v_add_f32 v32, v32, v34
    v_add_f32 v33, v33, v35
    v_smfmac_f32_16x16x64_bf16 v[40:43], v[112:115], v[232:239], v88
    v_add_f32 v34, v36, v38
    v_add_f32 v35, v37, v39
    v_smfmac_f32_16x16x64_bf16 v[44:47], v[112:115], v[248:255], v88
    v_cvt_pk_f16_f32 v32, v32, v33
    v_cvt_pk_f16_f32 v33, v34, v35
    v_and_or_b32 v32, v32, -2, s92
    buffer_store_dwordx2 v[32:33], v12, s[24:27], s59 offen sc1
    s_add_u32 s59, s59, 16384
    s_nop 0
    s_nop 1
    v_pk_add_f32 v[40:41], v[40:41], v[42:43]
    v_pk_add_f32 v[42:43], v[44:45], v[46:47]
    v_cvt_pk_f16_f32 v40, v40, v41
    v_cvt_pk_f16_f32 v41, v42, v43
    v_and_or_b32 v40, v40, -2, s92
    buffer_store_dwordx2 v[40:41], v12, s[24:27], s59 offen sc1
    s_nop 7
    s_nop 7
    s_nop 7
    s_nop 7
    s_mov_b32 s31, 0
    v_lshrrev_b32 v31, 1, v1
    buffer_load_dwordx2 v[16:17], v31, s[24:27], s57 offen offset:0 sc1
    buffer_load_dwordx2 v[18:19], v31, s[24:27], s57 offen offset:512 sc1
    buffer_load_dwordx2 v[20:21], v31, s[24:27], s57 offen offset:1024 sc1
    buffer_load_dwordx2 v[22:23], v31, s[24:27], s57 offen offset:1536 sc1
    s_add_u32 s51, s51, 8192
    s_add_u32 s58, s51, s52
    v_bfe_u32 v100, v1, 6, 2
    s_movk_i32 s33, 0x3c00
    v_and_b32 v101, 1, v100
    v_lshlrev_b32 v101, 4, v101
    v_lshlrev_b32 v101, v101, s33
    v_cmp_gt_u32 vcc, 2, v100
    s_nop 1
    v_cndmask_b32 v96, 0, v101, vcc
    v_cndmask_b32 v97, v101, 0, vcc
    v_mov_b32 v98, v96
    v_mov_b32 v99, v97
    s_cmp_lg_u32 s92, 0
    s_cbranch_scc1 K3_PP_B2_L1
K3_PP_B2_L0:
    s_waitcnt vmcnt(0)
    v_mfma_f32_16x16x32_f16 v[120:123], v[96:99], v[16:19], 0
    v_mfma_f32_16x16x32_f16 v[120:123], v[96:99], v[20:23], v[120:123]
    v_or3_b32 v14, v16, v18, v20
    v_bitop3_b32 v14, v14, v22, 1 bitop3:0xa8
    v_cmp_ne_u32 vcc, 0, v14
    s_add_u32 s31, s31, 1
    s_cbranch_vccz K3_PP_B2_D
    s_mov_b64 exec, vcc
    buffer_load_dwordx2 v[16:17], v31, s[24:27], s57 offen offset:0 sc1
    buffer_load_dwordx2 v[18:19], v31, s[24:27], s57 offen offset:512 sc1
    buffer_load_dwordx2 v[20:21], v31, s[24:27], s57 offen offset:1024 sc1
    buffer_load_dwordx2 v[22:23], v31, s[24:27], s57 offen offset:1536 sc1
    s_cmp_gt_u32 s31, 0x40000
    s_cbranch_scc0 K3_PP_B2_L0
    s_branch K3_END
K3_PP_B2_L1:
    s_waitcnt vmcnt(0)
    v_mfma_f32_16x16x32_f16 v[120:123], v[96:99], v[16:19], 0
    v_mfma_f32_16x16x32_f16 v[120:123], v[96:99], v[20:23], v[120:123]
    v_bitop3_b32 v14, v16, v18, v20 bitop3:0x80
    v_bitop3_b32 v14, v14, v22, 1 bitop3:0x2a
    v_cmp_ne_u32 vcc, 0, v14
    s_add_u32 s31, s31, 1
    s_cbranch_vccz K3_PP_B2_D
    s_mov_b64 exec, vcc
    buffer_load_dwordx2 v[16:17], v31, s[24:27], s57 offen offset:0 sc1
    buffer_load_dwordx2 v[18:19], v31, s[24:27], s57 offen offset:512 sc1
    buffer_load_dwordx2 v[20:21], v31, s[24:27], s57 offen offset:1024 sc1
    buffer_load_dwordx2 v[22:23], v31, s[24:27], s57 offen offset:1536 sc1
    s_cmp_gt_u32 s31, 0x40000
    s_cbranch_scc0 K3_PP_B2_L1
    s_branch K3_END
K3_PP_B2_D:
    s_mov_b64 exec, -1
    s_nop 0
    s_nop 1
    v_add_f32_dpp v120, v120, v120 row_ror:8 row_mask:0xf bank_mask:0xf
    v_mov_b32 v14, -2
    s_nop 0
    v_mov_b32_dpp v121, v120 quad_perm:[1,0,3,2] row_mask:0xf bank_mask:0xf
    v_cvt_pk_bf16_f32 v120, v120, v121
    v_min_u32 v120, v120, v14
    buffer_store_dword v120, v13, s[24:27], s58 offen sc1
    v_mov_b64 v[48:49], 0
    v_mov_b64 v[50:51], 0
    v_mov_b64 v[52:53], 0
    v_mov_b64 v[54:55], 0
    v_mov_b64 v[56:57], 0
    v_mov_b64 v[58:59], 0
    v_mov_b64 v[60:61], 0
    v_mov_b64 v[62:63], 0
    v_mov_b64 v[64:65], 0
    v_mov_b64 v[66:67], 0
    v_mov_b64 v[68:69], 0
    v_mov_b64 v[70:71], 0
    s_add_u32 s30, s30, 1
    s_add_u32 s49, s49, 0x10000
    s_branch K3_STEP_B2
K3_PROJ_B2:
    ds_read_b128 v[32:35], v1 offset:4096
    ds_read_b128 v[36:39], v1 offset:5120
    ds_read_b128 v[16:19], v2 offset:0
    ds_read_b128 v[20:23], v2 offset:1024
    ds_read_b128 v[24:27], v2 offset:2048
    ds_read_b128 v[28:31], v2 offset:3072
    ds_read_b128 v[40:43], v2 offset:4096
    ds_read_b128 v[44:47], v2 offset:5120
    ds_read_b128 v[120:123], v2 offset:6144
    ds_read_b128 v[124:127], v2 offset:7168
    ds_read_b128 v[96:99], v2 offset:8192
    ds_read_b128 v[100:103], v2 offset:9216
    ds_read_b128 v[104:107], v2 offset:10240
    ds_read_b128 v[108:111], v2 offset:11264
    ds_read_b128 v[112:115], v2 offset:12288
    ds_read_b128 v[116:119], v2 offset:13312
    ds_read_b128 v[80:83], v2 offset:14336
    ds_read_b128 v[84:87], v2 offset:15360
    s_waitcnt lgkmcnt(0)
    s_branch K3_OWN_B2
K3_LAST_B2:
    s_add_u32 s50, s50, 0x10000
    buffer_store_dword v94, v8, s[24:27], s50 offen sc1
    buffer_store_dword v95, v8, s[24:27], s50 offen offset:64 sc1
    s_waitcnt vmcnt(0)
    v_mov_b32 v14, 1
    s_mov_b64 exec, 1
    buffer_store_byte v14, off, s[24:27], s65 sc1
    s_endpgm
K3_PFSLOW_B2:
    s_cmp_eq_u32 s30, 63
    s_cbranch_scc1 K3_PFOK_B2
    s_mov_b32 s31, 0
K3_PFS2_B2:
    buffer_load_dword v3, off, s[24:27], s64 sc1
    s_waitcnt vmcnt(0)
    v_readfirstlane_b32 s32, v3
    s_add_u32 s31, s31, 1
    s_cmp_gt_u32 s31, 0x40000
    s_cbranch_scc1 K3_END
    s_cmp_lg_u32 s32, s67
    s_cbranch_scc1 K3_PFS2_B2
    s_branch K3_PFOK_B2
K3_STEP_B3:
    s_nop 7
    s_nop 7
    s_nop 7
    s_nop 7
    s_nop 7
    s_nop 7
    s_nop 7
    s_mov_b32 s31, 0
    buffer_load_dwordx4 v[40:43], v0, s[24:27], s51 offen sc1
    buffer_load_dwordx4 v[44:47], v0, s[24:27], s51 offen offset:1024 sc1
    s_and_b32 s32, s30, 1
    s_lshl_b32 s32, s32, 19
    s_lshl_b32 s33, s28, 6
    s_add_u32 s59, s32, s33
    s_add_u32 s59, s59, 0x300000
    s_lshl_b32 s33, s28, 13
    s_add_u32 s57, s32, s33
    s_add_u32 s57, s57, 0x300000
    s_add_u32 s57, s57, s66
    s_lshr_b32 s92, s30, 1
    s_and_b32 s92, s92, 1
    s_add_u32 s50, s50, 0x10000
    s_add_u32 s48, s48, 0x40000
    s_add_u32 s47, s47, 0x40000
    ds_read_b128 v[16:19], v2 offset:0
    ds_read_b128 v[20:23], v2 offset:1024
    ds_read_b128 v[24:27], v2 offset:2048
    ds_read_b128 v[28:31], v2 offset:3072
    ds_read_b128 v[32:35], v2 offset:4096
    ds_read_b128 v[36:39], v2 offset:5120
    ds_read_b128 v[120:123], v2 offset:6144
    ds_read_b128 v[124:127], v2 offset:7168
    ds_read_b128 v[96:99], v2 offset:8192
    ds_read_b128 v[100:103], v2 offset:9216
    ds_read_b128 v[104:107], v2 offset:10240
    ds_read_b128 v[108:111], v2 offset:11264
    ds_read_b128 v[112:115], v2 offset:12288
    ds_read_b128 v[116:119], v2 offset:13312
    ds_read_b128 v[80:83], v2 offset:14336
    ds_read_b128 v[84:87], v2 offset:15360
K3_PM_B3_L:
    s_waitcnt vmcnt(0) lgkmcnt(0)
    v_max3_u32 v14, v40, v41, v42
    v_max3_u32 v14, v14, v43, v44
    v_max3_u32 v14, v14, v45, v46
    v_max_u32 v14, v14, v47
    v_cmp_eq_u32 vcc, -1, v14
    s_add_u32 s31, s31, 1
    s_cbranch_vccz K3_PM_B3_D
    s_mov_b64 exec, vcc
    buffer_load_dwordx4 v[40:43], v0, s[24:27], s51 offen sc1
    buffer_load_dwordx4 v[44:47], v0, s[24:27], s51 offen offset:1024 sc1
    s_cmp_gt_u32 s31, 0x40000
    s_cbranch_scc0 K3_PM_B3_L
    s_branch K3_END
K3_PM_B3_D:
    s_mov_b64 exec, -1
    ds_write_b128 v0, v[40:43]
    ds_write_b128 v0, v[44:47] offset:1024
K3_OWN_B3:
    v_smfmac_f32_16x16x64_bf16 v[48:51], v[40:43], v[16:23], v88
    v_smfmac_f32_16x16x64_bf16 v[52:55], v[40:43], v[24:31], v88
    v_smfmac_f32_16x16x64_bf16 v[48:51], v[44:47], v[32:39], v88
    v_smfmac_f32_16x16x64_bf16 v[52:55], v[44:47], v[120:127], v88
    s_waitcnt lgkmcnt(0)
    s_barrier
    ds_read_b128 v[16:19], v1 offset:0
    ds_read_b128 v[20:23], v1 offset:1024
    ds_read_b128 v[24:27], v1 offset:2048
    ds_read_b128 v[28:31], v1 offset:3072
    ds_read_b128 v[32:35], v1 offset:4096
    ds_read_b128 v[36:39], v1 offset:5120
    v_smfmac_f32_16x16x64_bf16 v[56:59], v[40:43], v[96:103], v88
    v_smfmac_f32_16x16x64_bf16 v[60:63], v[40:43], v[104:111], v88
    v_smfmac_f32_16x16x64_bf16 v[56:59], v[44:47], v[112:119], v88
    v_smfmac_f32_16x16x64_bf16 v[60:63], v[44:47], v[80:87], v88
    v_smfmac_f32_16x16x64_bf16 v[64:67], v[40:43], a[48:55], v88
    v_smfmac_f32_16x16x64_bf16 v[68:71], v[40:43], a[112:119], v88
    s_waitcnt lgkmcnt(5)
    v_smfmac_f32_16x16x64_bf16 v[48:51], v[16:19], a[0:7], v88
    s_nop 1
    v_smfmac_f32_16x16x64_bf16 v[52:55], v[16:19], a[64:71], v88
    buffer_store_dword v94, v8, s[24:27], s50 offen sc1
    s_waitcnt lgkmcnt(4)
    v_smfmac_f32_16x16x64_bf16 v[48:51], v[20:23], a[8:15], v88
    s_nop 1
    v_smfmac_f32_16x16x64_bf16 v[52:55], v[20:23], a[72:79], v88
    buffer_store_dword v95, v8, s[24:27], s50 offen offset:64 sc1
    s_waitcnt lgkmcnt(3)
    v_smfmac_f32_16x16x64_bf16 v[48:51], v[24:27], a[16:23], v88
    s_nop 1
    v_smfmac_f32_16x16x64_bf16 v[52:55], v[24:27], a[80:87], v88
    buffer_load_dwordx4 v[80:83], v6, s[24:27], s48 offen sc1
    s_waitcnt lgkmcnt(2)
    v_smfmac_f32_16x16x64_bf16 v[48:51], v[28:31], a[24:31], v88
    s_nop 1
    v_smfmac_f32_16x16x64_bf16 v[52:55], v[28:31], a[88:95], v88
    buffer_load_dwordx4 v[84:87], v6, s[24:27], s48 offen offset:256 sc1
    s_waitcnt lgkmcnt(1)
    v_smfmac_f32_16x16x64_bf16 v[48:51], v[32:35], a[32:39], v88
    s_nop 1
    v_smfmac_f32_16x16x64_bf16 v[52:55], v[32:35], a[96:103], v88
    s_nop 0
    s_waitcnt lgkmcnt(0)
    v_smfmac_f32_16x16x64_bf16 v[48:51], v[36:39], a[40:47], v88
    s_nop 1
    v_smfmac_f32_16x16x64_bf16 v[52:55], v[36:39], a[104:111], v88
    s_waitcnt vmcnt(4)
    s_nop 0
    v_smfmac_f32_16x16x64_bf16 v[56:59], v[16:19], a[128:135], v88
    ds_read_b128 v[96:99], v2 offset:16384
    ds_read_b128 v[100:103], v2 offset:17408
    v_smfmac_f32_16x16x64_bf16 v[60:63], v[16:19], a[192:199], v88
    ds_read_b128 v[104:107], v2 offset:18432
    ds_read_b128 v[108:111], v2 offset:19456
    v_smfmac_f32_16x16x64_bf16 v[56:59], v[20:23], a[136:143], v88
    v_add_f32 v48, v48, v50
    v_add_f32 v49, v49, v51
    v_smfmac_f32_16x16x64_bf16 v[60:63], v[20:23], a[200:207], v88
    v_add_f32 v52, v52, v54
    v_add_f32 v53, v53, v55
    v_smfmac_f32_16x16x64_bf16 v[56:59], v[24:27], a[144:151], v88
    v_cvt_pk_bf16_f32 v50, v48, v49
    v_cvt_pk_bf16_f32 v51, v52, v53
    v_smfmac_f32_16x16x64_bf16 v[60:63], v[24:27], a[208:215], v88
    ds_read_b128 v[112:115], v2 offset:20480
    ds_read_b128 v[116:119], v2 offset:21504
    v_mfma_f32_16x16x16_bf16 v[52:55], v[50:51], v[90:91], 0
    v_readfirstlane_b32 s69, v3
    s_nop 1
    v_mfma_f32_16x16x16_bf16 v[120:123], v[50:51], v[92:93], 0
    s_nop 2
    v_smfmac_f32_16x16x64_bf16 v[56:59], v[28:31], a[152:159], v88
    v_cvt_pk_bf16_f32 v52, v52, v53
    v_cvt_pk_bf16_f32 v53, v54, v55
    v_smfmac_f32_16x16x64_bf16 v[60:63], v[28:31], a[216:223], v88
    s_nop 0
    v_cvt_pk_bf16_f32 v54, v120, v121
    v_smfmac_f32_16x16x64_bf16 v[56:59], v[32:35], a[160:167], v88
    v_cvt_pk_bf16_f32 v55, v122, v123
    s_nop 0
    v_smfmac_f32_16x16x64_bf16 v[60:63], v[32:35], a[224:231], v88
    s_nop 1
    v_smfmac_f32_16x16x64_bf16 v[56:59], v[36:39], a[168:175], v88
    s_cmp_eq_u32 s69, s67
    s_cbranch_scc0 K3_PFSLOW_B3
K3_PFOK_B3:
    v_smfmac_f32_16x16x64_bf16 v[60:63], v[36:39], a[232:239], v88
    s_nop 1
    v_mfma_f32_16x16x32_bf16 v[48:51], v[72:75], v[52:55], 0
    s_nop 2
    v_mfma_f32_16x16x32_bf16 v[120:123], v[76:79], v[52:55], 0
    s_nop 4
    v_add_f32 v56, v56, v58
    v_add_f32 v57, v57, v59
    v_add_f32 v60, v60, v62
    v_add_f32 v61, v61, v63
    v_cvt_pk_bf16_f32 v58, v56, v57
    v_cvt_pk_bf16_f32 v59, v60, v61
    ds_write_b128 v4, v[48:51] offset:512
    ds_write_b128 v4, v[120:123] offset:1024
    v_mfma_f32_16x16x16_bf16 v[60:63], v[58:59], v[90:91], 0
    v_mfma_f32_16x16x16_bf16 v[48:51], v[58:59], v[92:93], 0
    s_waitcnt lgkmcnt(6)
    v_smfmac_f32_16x16x64_bf16 v[64:67], v[20:23], v[96:103], v88
    ds_read_b128 v[96:99], v2 offset:22528
    ds_read_b128 v[100:103], v2 offset:23552
    s_waitcnt lgkmcnt(6)
    v_smfmac_f32_16x16x64_bf16 v[68:71], v[20:23], v[104:111], v88
    ds_read_b128 v[104:107], v2 offset:24576
    ds_read_b128 v[108:111], v2 offset:25600
    s_nop 1
    v_cvt_pk_bf16_f32 v124, v60, v61
    v_cvt_pk_bf16_f32 v125, v62, v63
    v_cvt_pk_bf16_f32 v126, v48, v49
    v_cvt_pk_bf16_f32 v127, v50, v51
    s_nop 1
    v_mfma_f32_16x16x32_bf16 v[56:59], v[124:127], v[52:55], 0
    v_smfmac_f32_16x16x64_bf16 v[64:67], v[16:19], a[56:63], v88
    v_smfmac_f32_16x16x64_bf16 v[68:71], v[16:19], a[120:127], v88
    s_nop 5
    ds_write_b128 v4, v[56:59]
    v_smfmac_f32_16x16x64_bf16 v[64:67], v[24:27], a[176:183], v88
    v_smfmac_f32_16x16x64_bf16 v[68:71], v[24:27], a[240:247], v88
    buffer_load_dwordx4 v[72:75], v5, s[24:27], s47 offen sc1
    buffer_load_dwordx4 v[76:79], v5, s[24:27], s47 offen offset:1024 sc1
    s_add_u32 s64, s64, 4
    buffer_load_dword v3, off, s[24:27], s64 sc1
    s_waitcnt lgkmcnt(0)
    s_barrier
    ds_read_b128 v[48:51], v9 offset:0
    ds_read_b128 v[52:55], v9 offset:1536
    ds_read_b128 v[56:59], v9 offset:3072
    ds_read_b128 v[60:63], v9 offset:4608
    ds_read_b32 v120, v15 offset:0
    ds_read_b32 v121, v15 offset:1536
    ds_read_b32 v122, v15 offset:3072
    ds_read_b32 v123, v15 offset:4608
    buffer_store_dwordx4 v[124:127], v7, s[24:27], s49 offen sc1
    v_smfmac_f32_16x16x64_bf16 v[64:67], v[28:31], v[112:119], v88
    ds_read_b128 v[112:115], v2 offset:26624
    ds_read_b128 v[116:119], v2 offset:27648
    v_smfmac_f32_16x16x64_bf16 v[68:71], v[28:31], v[96:103], v88
    ds_read_b128 v[96:99], v2 offset:28672
    ds_read_b128 v[100:103], v2 offset:29696
    s_waitcnt vmcnt(6)
    v_mov_b32 v14, 1
    s_mov_b64 exec, 1
    buffer_store_byte v14, off, s[24:27], s65 sc1
    s_mov_b64 exec, s[36:37]
    s_mov_b32 s65, s68
    s_add_u32 s68, s68, 4
    s_waitcnt lgkmcnt(8)
    v_pk_add_f32 v[48:49], v[48:49], v[52:53]
    v_pk_add_f32 v[50:51], v[50:51], v[54:55]
    v_pk_add_f32 v[56:57], v[56:57], v[60:61]
    v_pk_add_f32 v[58:59], v[58:59], v[62:63]
    s_waitcnt lgkmcnt(4)
    v_pk_add_f32 v[120:121], v[120:121], v[122:123]
    v_pk_add_f32 v[48:49], v[48:49], v[56:57]
    v_pk_add_f32 v[50:51], v[50:51], v[58:59]
    v_add_f32 v52, v120, v121
    v_cvt_pk_bf16_f32 v56, v48, v49
    v_cvt_pk_bf16_f32 v57, v50, v51
    v_cvt_pk_bf16_f32 v58, v52, v52
    v_lshlrev_b32 v48, 16, v56
    v_and_b32 v49, 0xffff0000, v56
    v_lshlrev_b32 v50, 16, v57
    v_and_b32 v51, 0xffff0000, v57
    v_lshlrev_b32 v52, 16, v58
    v_pk_mul_f32 v[48:49], v[48:49], s[54:55] op_sel_hi:[1,0]
    v_pk_mul_f32 v[50:51], v[50:51], s[54:55] op_sel_hi:[1,0]
    v_mul_f32 v52, s54, v52
    v_cvt_pk_bf16_f32 v56, v48, v49
    v_cvt_pk_bf16_f32 v57, v50, v51
    v_cvt_pk_bf16_f32 v58, v52, v52
    v_lshlrev_b32 v48, 16, v56
    v_and_b32 v49, 0xffff0000, v56
    v_lshlrev_b32 v50, 16, v57
    v_and_b32 v51, 0xffff0000, v57
    v_lshlrev_b32 v52, 16, v58
    v_max3_f32 v14, v48, v49, v50
    v_max3_f32 v14, v14, v51, v52
    v_smfmac_f32_16x16x64_bf16 v[64:67], v[36:39], v[104:111], v88
    ds_read_b128 v[104:107], v2 offset:30720
    ds_read_b128 v[108:111], v2 offset:31744
    s_nop 0
    v_max_f32_dpp v14, v14, v14 row_ror:8 row_mask:0xf bank_mask:0xf
    v_mov_b32 v56, v14
    s_waitcnt lgkmcnt(4)
    v_smfmac_f32_16x16x64_bf16 v[68:71], v[36:39], v[112:119], v88
    s_nop 0
    v_permlane16_swap_b32 v14, v56
    v_max_f32 v14, v14, v56
    v_mov_b32 v56, v14
    s_waitcnt lgkmcnt(2)
    v_smfmac_f32_16x16x64_bf16 v[64:67], v[44:47], v[96:103], v88
    s_nop 0
    v_permlane32_swap_b32 v14, v56
    v_max_f32 v14, v14, v56
    v_mul_f32 v14, s55, v14
    v_pk_fma_f32 v[48:49], v[48:49], s[54:55], v[14:15] op_sel:[0,1,0] op_sel_hi:[1,1,0] neg_lo:[0,0,1] neg_hi:[0,0,1]
    v_pk_fma_f32 v[50:51], v[50:51], s[54:55], v[14:15] op_sel:[0,1,0] op_sel_hi:[1,1,0] neg_lo:[0,0,1] neg_hi:[0,0,1]
    v_fma_f32 v52, v52, s55, -v14
    v_exp_f32 v48, v48
    v_exp_f32 v49, v49
    v_exp_f32 v50, v50
    v_exp_f32 v51, v51
    v_exp_f32 v52, v52
    v_mov_b32 v125, 0
    v_mov_b32 v126, 0
    v_add_f32 v14, v48, v49
    v_add_f32 v56, v50, v51
    v_add_f32 v14, v14, v52
    v_add_f32 v14, v14, v56
    s_waitcnt lgkmcnt(0)
    v_smfmac_f32_16x16x64_bf16 v[68:71], v[44:47], v[104:111], v88
    s_nop 0
    v_add_f32_dpp v14, v14, v14 row_ror:8 row_mask:0xf bank_mask:0xf
    v_mov_b32 v56, v14
    v_smfmac_f32_16x16x64_bf16 v[64:67], v[32:35], a[184:191], v88
    s_nop 0
    v_permlane16_swap_b32 v14, v56
    v_add_f32 v14, v14, v56
    v_mov_b32 v56, v14
    v_smfmac_f32_16x16x64_bf16 v[68:71], v[32:35], a[248:255], v88
    s_nop 0
    v_permlane32_swap_b32 v14, v56
    v_add_f32 v14, v14, v56
    v_rcp_f32 v14, v14
    s_nop 0
    v_pk_mul_f32 v[48:49], v[48:49], v[14:15] op_sel_hi:[1,0]
    v_pk_mul_f32 v[50:51], v[50:51], v[14:15] op_sel_hi:[1,0]
    v_mul_f32 v52, v52, v14
    v_cvt_pk_bf16_f32 v120, v48, v49
    v_cvt_pk_bf16_f32 v121, v50, v51
    v_mov_b32_dpp v53, v52 row_ror:8 row_mask:0xf bank_mask:0xf
    v_mov_b32_dpp v122, v120 row_ror:8 row_mask:0xf bank_mask:0xf
    v_mov_b32_dpp v123, v121 row_ror:8 row_mask:0xf bank_mask:0xf
    v_cvt_pk_bf16_f32 v124, v52, v53
    v_cvt_pk_bf16_f32 v127, v52, v53
    s_waitcnt vmcnt(5)
    v_mfma_f32_16x16x32_bf16 v[96:99], v[80:83], v[120:123], 0
    v_add_f32 v64, v64, v66
    v_add_f32 v65, v65, v67
    v_mfma_f32_16x16x32_bf16 v[100:103], v[84:87], v[120:123], 0
    v_add_f32 v68, v68, v70
    v_add_f32 v69, v69, v71
    v_cvt_pk_bf16_f32 v94, v64, v65
    v_cvt_pk_bf16_f32 v95, v68, v69
    s_cmp_eq_u32 s30, 63
    s_cbranch_scc1 K3_LAST_B3
    v_mfma_f32_16x16x16_bf16 v[96:99], v[94:95], v[124:125], v[96:99]
    v_mfma_f32_16x16x16_bf16 v[100:103], v[94:95], v[126:127], v[100:103]
    v_mov_b64 v[16:17], 0
    v_mov_b64 v[18:19], 0
    v_mov_b64 v[20:21], 0
    v_mov_b64 v[22:23], 0
    v_mov_b64 v[24:25], 0
    v_mov_b64 v[26:27], 0
    v_mov_b64 v[28:29], 0
    v_mov_b64 v[30:31], 0
    v_cvt_pk_bf16_f32 v104, v96, v97
    v_cvt_pk_bf16_f32 v106, v98, v99
    v_cvt_pk_bf16_f32 v105, v100, v101
    v_cvt_pk_bf16_f32 v107, v102, v103
    ds_write2_b64 v10, v[104:105], v[106:107] offset0:0 offset1:4
    v_mov_b64 v[32:33], 0
    v_mov_b64 v[34:35], 0
    v_mov_b64 v[36:37], 0
    v_mov_b64 v[38:39], 0
    s_waitcnt lgkmcnt(0)
    s_barrier
    ds_read_b128 v[108:111], v11
    ds_read_b128 v[112:115], v11 offset:1024
    v_mov_b64 v[40:41], 0
    v_mov_b64 v[42:43], 0
    v_mov_b64 v[44:45], 0
    v_mov_b64 v[46:47], 0
    s_waitcnt lgkmcnt(0)
    v_smfmac_f32_16x16x64_bf16 v[16:19], v[108:111], v[128:135], v88
    s_nop 2
    v_smfmac_f32_16x16x64_bf16 v[20:23], v[108:111], v[144:151], v88
    s_nop 2
    v_smfmac_f32_16x16x64_bf16 v[16:19], v[112:115], v[136:143], v88
    s_nop 2
    v_smfmac_f32_16x16x64_bf16 v[20:23], v[112:115], v[152:159], v88
    v_smfmac_f32_16x16x64_bf16 v[24:27], v[108:111], v[160:167], v88
    s_nop 2
    v_smfmac_f32_16x16x64_bf16 v[28:31], v[108:111], v[176:183], v88
    v_add_f32 v16, v16, v18
    v_add_f32 v17, v17, v19
    v_smfmac_f32_16x16x64_bf16 v[24:27], v[112:115], v[168:175], v88
    v_add_f32 v18, v20, v22
    v_add_f32 v19, v21, v23
    v_smfmac_f32_16x16x64_bf16 v[28:31], v[112:115], v[184:191], v88
    v_cvt_pk_f16_f32 v16, v16, v17
    v_cvt_pk_f16_f32 v17, v18, v19
    v_smfmac_f32_16x16x64_bf16 v[32:35], v[108:111], v[192:199], v88
    v_and_or_b32 v16, v16, -2, s92
    buffer_store_dwordx2 v[16:17], v12, s[24:27], s59 offen sc1
    s_add_u32 s59, s59, 16384
    v_smfmac_f32_16x16x64_bf16 v[36:39], v[108:111], v[208:215], v88
    v_add_f32 v24, v24, v26
    v_add_f32 v25, v25, v27
    v_smfmac_f32_16x16x64_bf16 v[32:35], v[112:115], v[200:207], v88
    v_add_f32 v26, v28, v30
    v_add_f32 v27, v29, v31
    v_smfmac_f32_16x16x64_bf16 v[36:39], v[112:115], v[216:223], v88
    v_cvt_pk_f16_f32 v24, v24, v25
    v_cvt_pk_f16_f32 v25, v26, v27
    v_smfmac_f32_16x16x64_bf16 v[40:43], v[108:111], v[224:231], v88
    v_and_or_b32 v24, v24, -2, s92
    buffer_store_dwordx2 v[24:25], v12, s[24:27], s59 offen sc1
    s_add_u32 s59, s59, 16384
    v_smfmac_f32_16x16x64_bf16 v[44:47], v[108:111], v[240:247], v88
    v_add_f32 v32, v32, v34
    v_add_f32 v33, v33, v35
    v_smfmac_f32_16x16x64_bf16 v[40:43], v[112:115], v[232:239], v88
    v_add_f32 v34, v36, v38
    v_add_f32 v35, v37, v39
    v_smfmac_f32_16x16x64_bf16 v[44:47], v[112:115], v[248:255], v88
    v_cvt_pk_f16_f32 v32, v32, v33
    v_cvt_pk_f16_f32 v33, v34, v35
    v_and_or_b32 v32, v32, -2, s92
    buffer_store_dwordx2 v[32:33], v12, s[24:27], s59 offen sc1
    s_add_u32 s59, s59, 16384
    s_nop 0
    s_nop 1
    v_pk_add_f32 v[40:41], v[40:41], v[42:43]
    v_pk_add_f32 v[42:43], v[44:45], v[46:47]
    v_cvt_pk_f16_f32 v40, v40, v41
    v_cvt_pk_f16_f32 v41, v42, v43
    v_and_or_b32 v40, v40, -2, s92
    buffer_store_dwordx2 v[40:41], v12, s[24:27], s59 offen sc1
    s_nop 7
    s_nop 7
    s_nop 7
    s_nop 7
    s_mov_b32 s31, 0
    v_lshrrev_b32 v31, 1, v1
    buffer_load_dwordx2 v[16:17], v31, s[24:27], s57 offen offset:0 sc1
    buffer_load_dwordx2 v[18:19], v31, s[24:27], s57 offen offset:512 sc1
    buffer_load_dwordx2 v[20:21], v31, s[24:27], s57 offen offset:1024 sc1
    buffer_load_dwordx2 v[22:23], v31, s[24:27], s57 offen offset:1536 sc1
    s_add_u32 s51, s51, 8192
    s_add_u32 s58, s51, s52
    v_bfe_u32 v100, v1, 6, 2
    s_movk_i32 s33, 0x3c00
    v_and_b32 v101, 1, v100
    v_lshlrev_b32 v101, 4, v101
    v_lshlrev_b32 v101, v101, s33
    v_cmp_gt_u32 vcc, 2, v100
    s_nop 1
    v_cndmask_b32 v96, 0, v101, vcc
    v_cndmask_b32 v97, v101, 0, vcc
    v_mov_b32 v98, v96
    v_mov_b32 v99, v97
    s_cmp_lg_u32 s92, 0
    s_cbranch_scc1 K3_PP_B3_L1
K3_PP_B3_L0:
    s_waitcnt vmcnt(0)
    v_mfma_f32_16x16x32_f16 v[120:123], v[96:99], v[16:19], 0
    v_mfma_f32_16x16x32_f16 v[120:123], v[96:99], v[20:23], v[120:123]
    v_or3_b32 v14, v16, v18, v20
    v_bitop3_b32 v14, v14, v22, 1 bitop3:0xa8
    v_cmp_ne_u32 vcc, 0, v14
    s_add_u32 s31, s31, 1
    s_cbranch_vccz K3_PP_B3_D
    s_mov_b64 exec, vcc
    buffer_load_dwordx2 v[16:17], v31, s[24:27], s57 offen offset:0 sc1
    buffer_load_dwordx2 v[18:19], v31, s[24:27], s57 offen offset:512 sc1
    buffer_load_dwordx2 v[20:21], v31, s[24:27], s57 offen offset:1024 sc1
    buffer_load_dwordx2 v[22:23], v31, s[24:27], s57 offen offset:1536 sc1
    s_cmp_gt_u32 s31, 0x40000
    s_cbranch_scc0 K3_PP_B3_L0
    s_branch K3_END
K3_PP_B3_L1:
    s_waitcnt vmcnt(0)
    v_mfma_f32_16x16x32_f16 v[120:123], v[96:99], v[16:19], 0
    v_mfma_f32_16x16x32_f16 v[120:123], v[96:99], v[20:23], v[120:123]
    v_bitop3_b32 v14, v16, v18, v20 bitop3:0x80
    v_bitop3_b32 v14, v14, v22, 1 bitop3:0x2a
    v_cmp_ne_u32 vcc, 0, v14
    s_add_u32 s31, s31, 1
    s_cbranch_vccz K3_PP_B3_D
    s_mov_b64 exec, vcc
    buffer_load_dwordx2 v[16:17], v31, s[24:27], s57 offen offset:0 sc1
    buffer_load_dwordx2 v[18:19], v31, s[24:27], s57 offen offset:512 sc1
    buffer_load_dwordx2 v[20:21], v31, s[24:27], s57 offen offset:1024 sc1
    buffer_load_dwordx2 v[22:23], v31, s[24:27], s57 offen offset:1536 sc1
    s_cmp_gt_u32 s31, 0x40000
    s_cbranch_scc0 K3_PP_B3_L1
    s_branch K3_END
K3_PP_B3_D:
    s_mov_b64 exec, -1
    s_nop 0
    s_nop 1
    v_add_f32_dpp v120, v120, v120 row_ror:8 row_mask:0xf bank_mask:0xf
    v_mov_b32 v14, -2
    s_nop 0
    v_mov_b32_dpp v121, v120 quad_perm:[1,0,3,2] row_mask:0xf bank_mask:0xf
    v_cvt_pk_bf16_f32 v120, v120, v121
    v_min_u32 v120, v120, v14
    buffer_store_dword v120, v13, s[24:27], s58 offen sc1
    v_mov_b64 v[48:49], 0
    v_mov_b64 v[50:51], 0
    v_mov_b64 v[52:53], 0
    v_mov_b64 v[54:55], 0
    v_mov_b64 v[56:57], 0
    v_mov_b64 v[58:59], 0
    v_mov_b64 v[60:61], 0
    v_mov_b64 v[62:63], 0
    v_mov_b64 v[64:65], 0
    v_mov_b64 v[66:67], 0
    v_mov_b64 v[68:69], 0
    v_mov_b64 v[70:71], 0
    s_add_u32 s30, s30, 1
    s_add_u32 s49, s49, 0x10000
    s_branch K3_STEP_B3
K3_PROJ_B3:
    ds_read_b128 v[40:43], v1 offset:6144
    ds_read_b128 v[44:47], v1 offset:7168
    ds_read_b128 v[16:19], v2 offset:0
    ds_read_b128 v[20:23], v2 offset:1024
    ds_read_b128 v[24:27], v2 offset:2048
    ds_read_b128 v[28:31], v2 offset:3072
    ds_read_b128 v[32:35], v2 offset:4096
    ds_read_b128 v[36:39], v2 offset:5120
    ds_read_b128 v[120:123], v2 offset:6144
    ds_read_b128 v[124:127], v2 offset:7168
    ds_read_b128 v[96:99], v2 offset:8192
    ds_read_b128 v[100:103], v2 offset:9216
    ds_read_b128 v[104:107], v2 offset:10240
    ds_read_b128 v[108:111], v2 offset:11264
    ds_read_b128 v[112:115], v2 offset:12288
    ds_read_b128 v[116:119], v2 offset:13312
    ds_read_b128 v[80:83], v2 offset:14336
    ds_read_b128 v[84:87], v2 offset:15360
    s_waitcnt lgkmcnt(0)
    s_branch K3_OWN_B3
K3_LAST_B3:
    s_add_u32 s50, s50, 0x10000
    buffer_store_dword v94, v8, s[24:27], s50 offen sc1
    buffer_store_dword v95, v8, s[24:27], s50 offen offset:64 sc1
    s_waitcnt vmcnt(0)
    v_mov_b32 v14, 1
    s_mov_b64 exec, 1
    buffer_store_byte v14, off, s[24:27], s65 sc1
    s_endpgm
K3_PFSLOW_B3:
    s_cmp_eq_u32 s30, 63
    s_cbranch_scc1 K3_PFOK_B3
    s_mov_b32 s31, 0
K3_PFS2_B3:
    buffer_load_dword v3, off, s[24:27], s64 sc1
    s_waitcnt vmcnt(0)
    v_readfirstlane_b32 s32, v3
    s_add_u32 s31, s31, 1
    s_cmp_gt_u32 s31, 0x40000
    s_cbranch_scc1 K3_END
    s_cmp_lg_u32 s32, s67
    s_cbranch_scc1 K3_PFS2_B3
    s_branch K3_PFOK_B3
K3_END:
    s_endpgm
WORKER:
    s_load_dwordx2 s[6:7], s[0:1], 112
    s_load_dwordx2 s[4:5], s[0:1], 0
    s_load_dwordx2 s[8:9], s[0:1], 96
    v_lshrrev_b32 v2, 6, v0
    v_and_b32 v1, 63, v0
    v_mov_b32 v30, 0
    s_waitcnt lgkmcnt(0)
    s_mov_b32 s24, s6
    s_and_b32 s25, s7, 0xffff
    s_mov_b32 s26, 0x10000000
    s_mov_b32 s27, 0x00020000
    s_mov_b32 s16, s4
    s_and_b32 s17, s5, 0xffff
    s_mov_b32 s18, 0x200000
    s_mov_b32 s19, 0x00020000
    s_mov_b32 s20, s8
    s_and_b32 s21, s9, 0xffff
    s_mov_b32 s22, 0x200000
    s_mov_b32 s23, 0x00020000
    s_mov_b32 s73, -2
    s_mov_b32 s79, s3
    s_mov_b32 s78, 0
W_LOOP:
    s_barrier
    s_cmp_lg_u32 s29, 0
    s_cbranch_scc1 W_L2
    s_mov_b64 exec, 1
W_Q0:
    s_cmp_eq_u32 s73, -2
    s_cbranch_scc0 W_Q00
    s_mov_b32 s73, -1
    s_cmp_eq_u32 s79, 0
    s_cbranch_scc1 W_Q00
    s_mov_b32 s30, s74
    s_lshr_b32 s31, s2, 3
    s_and_b32 s31, s31, 31
    s_cmp_lg_u32 s79, 1
    s_cbranch_scc1 W_URG0
    s_add_u32 s32, s31, 0x20000
    v_mov_b32 v28, s32
    s_branch W_QW
W_URG0:
    s_cmp_lt_u32 s30, 4
    s_cselect_b32 s32, 5, 4
    s_mul_i32 s33, s30, s32
    s_cselect_b32 s34, 0, 4
    s_add_u32 s33, s33, s34
    s_add_u32 s33, s33, s31
    s_cmp_lt_u32 s31, s32
    s_cbranch_scc1 W_URG1
    s_cmp_lg_u32 s31, s32
    s_cbranch_scc1 W_Q00
    s_cmp_gt_u32 s30, 5
    s_cbranch_scc1 W_Q00
    s_sub_u32 s33, s30, 1
W_URG1:
    s_add_u32 s32, s33, 65568
    v_mov_b32 v28, s32
    s_branch W_QW
W_Q00:
    s_cmp_eq_u32 s73, -1
    s_cbranch_scc0 W_Q0R
    v_mov_b32 v28, 1
    buffer_atomic_add v28, off, s[12:15], 0 offset:196 sc0 sc1
    buffer_load_dword v29, off, s[12:15], 0 sc1
    s_waitcnt vmcnt(0)
    v_readfirstlane_b32 s31, v28
    s_cmp_lt_u32 s31, 195
    s_cbranch_scc0 W_Q0c
    s_add_u32 s32, s31, 131104
    v_mov_b32 v28, s32
    s_branch W_QW
W_Q0c:
    s_mov_b32 s73, 0
    v_readfirstlane_b32 s31, v29
    s_and_b32 s31, s31, 0xffff
    s_cmp_ge_u32 s31, 32
    s_cbranch_scc1 W_Q0R
    v_mov_b32 v28, 0x10001
    buffer_atomic_add v28, off, s[12:15], 0 sc0 sc1
    s_waitcnt vmcnt(0)
    v_readfirstlane_b32 s31, v28
    s_and_b32 s31, s31, 0xffff
    s_cmp_ge_u32 s31, 32
    s_cbranch_scc1 W_Q0R
    s_add_u32 s32, s31, 0x30000
    v_mov_b32 v28, s32
    s_branch W_QW
W_Q0R:
    s_cmp_ge_u32 s73, 7
    s_cbranch_scc1 W_QM
    s_mov_b32 s79, 0x7f
    s_cmp_eq_u32 s73, 0
    s_cbranch_scc1 W_QT
    buffer_load_dwordx4 v[32:35], off, s[12:15], 0 offset:208 sc1
    buffer_load_dwordx4 v[36:39], off, s[12:15], 0 offset:224 sc1
    s_mov_b32 s79, 0
    s_waitcnt vmcnt(0)
    v_readfirstlane_b32 s32, v32
    s_cmp_lt_u32 s32, 85
    s_cselect_b32 s32, 1, 0
    s_or_b32 s79, s79, s32
    v_readfirstlane_b32 s32, v33
    s_cmp_lt_u32 s32, 85
    s_cselect_b32 s32, 2, 0
    s_or_b32 s79, s79, s32
    v_readfirstlane_b32 s32, v34
    s_cmp_lt_u32 s32, 85
    s_cselect_b32 s32, 4, 0
    s_or_b32 s79, s79, s32
    v_readfirstlane_b32 s32, v35
    s_cmp_lt_u32 s32, 85
    s_cselect_b32 s32, 8, 0
    s_or_b32 s79, s79, s32
    v_readfirstlane_b32 s32, v36
    s_cmp_lt_u32 s32, 68
    s_cselect_b32 s32, 16, 0
    s_or_b32 s79, s79, s32
    v_readfirstlane_b32 s32, v37
    s_cmp_lt_u32 s32, 68
    s_cselect_b32 s32, 32, 0
    s_or_b32 s79, s79, s32
    v_readfirstlane_b32 s32, v38
    s_cmp_lt_u32 s32, 68
    s_cselect_b32 s32, 64, 0
    s_or_b32 s79, s79, s32
W_QT:
    s_cmp_ge_u32 s73, 7
    s_cbranch_scc1 W_QM
    s_add_u32 s30, s74, s73
    s_cmp_ge_u32 s30, 7
    s_cbranch_scc0 W_Q1
    s_sub_u32 s30, s30, 7
W_Q1:
    s_lshr_b32 s31, s79, s30
    s_bitcmp1_b32 s31, 0
    s_cbranch_scc1 W_Q1b
    s_add_u32 s73, s73, 1
    s_branch W_QT
W_Q1b:
    s_lshl_b32 s31, s30, 2
    v_mov_b32 v28, 1
    buffer_atomic_add v28, off, s[12:15], s31 offset:208 sc0 sc1
    s_waitcnt vmcnt(0)
    v_readfirstlane_b32 s31, v28
    s_cmp_lt_u32 s30, 4
    s_cbranch_scc0 W_Q4
    s_cmp_ge_u32 s31, 85
    s_cbranch_scc1 W_QN
    s_mul_i32 s32, s31, 205
    s_lshr_b32 s32, s32, 10
    s_mul_i32 s33, s32, 5
    s_sub_u32 s33, s31, s33
    s_mul_i32 s34, s30, 5
    s_add_u32 s33, s33, s34
    s_branch W_QP
W_Q4:
    s_cmp_ge_u32 s31, 68
    s_cbranch_scc1 W_QN
    s_lshr_b32 s32, s31, 2
    s_and_b32 s33, s31, 3
    s_lshl_b32 s34, s30, 2
    s_add_u32 s33, s33, s34
    s_add_u32 s33, s33, 4
W_QP:
    s_cmp_lg_u32 s32, 3
    s_cbranch_scc1 W_QP0
    s_mov_b32 s32, 0
    s_branch W_QP2
W_QP0:
    s_cmp_lt_u32 s32, 3
    s_cselect_b32 s35, 2, 1
    s_add_u32 s32, s32, s35
    s_cmp_lt_u32 s32, 16
    s_cbranch_scc1 W_QP2
    s_bitcmp1_b32 s78, 3
    s_cbranch_scc1 W_QF1
    s_mov_b32 s31, 0
PD_1:
    s_cmp_eq_u32 s31, 0
    s_cbranch_scc1 PB_2
    s_sleep 8
PB_2:
    buffer_load_dword v24, off, s[12:15], 0 offset:240 sc1
    s_add_u32 s31, s31, 1
    s_cmp_gt_u32 s31, 0x200000
    s_cbranch_scc1 W_EXIT
    s_waitcnt vmcnt(0)
    v_readfirstlane_b32 s70, v24
    s_cmp_lg_u32 s70, 21
    s_cbranch_scc1 PD_1
    s_or_b32 s78, s78, 8
W_QF1:
    s_sub_u32 s32, s32, 16
    s_lshl_b32 s34, s33, 8
    s_lshl_b32 s35, s32, 4
    s_add_u32 s34, s34, s35
    s_add_u32 s34, s34, 0x228000
    buffer_load_dwordx4 v[32:35], off, s[24:27], s34 sc1
    s_waitcnt vmcnt(0)
    v_and_b32 v32, v32, v33
    v_and_b32 v34, v34, v35
    v_and_b32 v32, v32, v34
    s_nop 0
    v_readfirstlane_b32 s34, v32
    s_cmp_eq_u32 s34, 0x01010101
    s_cbranch_scc1 W_Q0R
    s_cmp_eq_u32 s32, 1
    s_cbranch_scc1 W_QP2
    s_add_u32 s32, s33, 0x20000
    v_mov_b32 v28, s32
    s_branch W_QW
W_QP2:
    s_lshl_b32 s32, s32, 5
    s_add_u32 s32, s32, s33
    s_add_u32 s32, s32, 0x10000
    v_mov_b32 v28, s32
    s_branch W_QW
W_QN:
    s_add_u32 s73, s73, 1
    s_branch W_Q0R
W_QM:
    v_mov_b32 v28, 1
    buffer_atomic_add v28, off, s[12:15], 0 offset:192 sc0 sc1
    s_waitcnt vmcnt(0)
W_QW:
    ds_write_b32 v30, v28
    s_waitcnt lgkmcnt(0)
    s_mov_b64 exec, -1
W_L2:
    s_barrier
    ds_read_b32 v28, v30
    s_waitcnt lgkmcnt(0)
    v_readfirstlane_b32 s30, v28
    s_cmp_ge_u32 s30, 0x30000
    s_cbranch_scc0 W_DV
    s_sub_u32 s28, s30, 0x30000
    s_branch K3_CHAIN
W_DV:
    s_cmp_ge_u32 s30, 0x20000
    s_cbranch_scc0 W_D00
    s_sub_u32 s30, s30, 0x20000
    s_cmp_lt_u32 s30, 32
    s_cbranch_scc1 W_P0
    s_cmp_lt_u32 s30, 32
    s_cbranch_scc0 DQ_3
    s_sub_u32 s30, s30, 32
    s_branch W_PFW
DQ_3:
    s_cmp_lt_u32 s30, 36
    s_cbranch_scc0 DQ_4
    s_sub_u32 s30, s30, 32
    s_branch W_LN
DQ_4:
    s_cmp_lt_u32 s30, 57
    s_cbranch_scc0 DQ_5
    s_sub_u32 s30, s30, 36
    s_branch W_INIT
DQ_5:
    s_cmp_lt_u32 s30, 117
    s_cbranch_scc0 DQ_6
    s_sub_u32 s30, s30, 53
    s_branch W_LN
DQ_6:
    s_cmp_lt_u32 s30, 131
    s_cbranch_scc0 DQ_7
    s_sub_u32 s30, s30, 117
    s_branch W_F1
DQ_7:
    s_cmp_lt_u32 s30, 159
    s_cbranch_scc0 DQ_8
    s_sub_u32 s30, s30, 131
    s_branch W_PKD
DQ_8:
    s_cmp_lt_u32 s30, 163
    s_cbranch_scc0 DQ_9
    s_sub_u32 s30, s30, 159
    s_branch W_F2
DQ_9:
    s_cmp_lt_u32 s30, 227
    s_cbranch_scc0 DQ_10
    s_sub_u32 s30, s30, 163
    s_branch W_PKO
DQ_10:
W_D00:
    s_cmp_ge_u32 s30, 0x10000
    s_cbranch_scc0 W_D0
    s_sub_u32 s30, s30, 0x10000
    s_branch W_P
W_D0:
    s_bitcmp1_b32 s78, 0
    s_cbranch_scc1 W_D02
    s_cmp_lg_u32 s29, 0
    s_cbranch_scc1 W0_11
    s_mov_b32 s31, 0
PD_12:
    s_cmp_eq_u32 s31, 0
    s_cbranch_scc1 PB_13
    s_sleep 8
PB_13:
    buffer_load_dword v24, off, s[12:15], 0 offset:240 sc1
    s_add_u32 s31, s31, 1
    s_cmp_gt_u32 s31, 0x200000
    s_cbranch_scc1 W_EXIT
    s_waitcnt vmcnt(0)
    v_readfirstlane_b32 s70, v24
    s_cmp_lg_u32 s70, 21
    s_cbranch_scc1 PD_12
W0_11:
    s_barrier
    s_or_b32 s78, s78, 1
W_D02:
    s_cmp_ge_u32 s30, 1216
    s_cbranch_scc1 W_EXIT
    s_mov_b32 s69, 0
    s_cmp_lt_u32 s30, 928
    s_cbranch_scc0 W_D5
    s_and_b32 s32, s30, 15
    s_lshr_b32 s30, s30, 4
    s_cmp_lt_u32 s30, 2
    s_cbranch_scc1 W_A
    s_sub_u32 s69, s30, 1
    s_branch W_A
W_D5:
    s_cmp_lt_u32 s30, 944
    s_cbranch_scc0 DT_14
    s_sub_u32 s32, s30, 928
    s_mov_b32 s30, 56
    s_branch W_GB
DT_14:
    s_cmp_lt_u32 s30, 960
    s_cbranch_scc0 DT_15
    s_sub_u32 s32, s30, 944
    s_mov_b32 s30, 58
    s_branch W_A
DT_15:
    s_cmp_lt_u32 s30, 976
    s_cbranch_scc0 DT_16
    s_sub_u32 s32, s30, 960
    s_mov_b32 s30, 57
    s_branch W_GB
DT_16:
    s_cmp_lt_u32 s30, 992
    s_cbranch_scc0 DT_17
    s_sub_u32 s32, s30, 976
    s_mov_b32 s30, 59
    s_branch W_A
DT_17:
    s_cmp_lt_u32 s30, 1008
    s_cbranch_scc0 DT_18
    s_sub_u32 s32, s30, 992
    s_mov_b32 s30, 58
    s_branch W_GB
DT_18:
    s_cmp_lt_u32 s30, 1024
    s_cbranch_scc0 DT_19
    s_sub_u32 s32, s30, 1008
    s_mov_b32 s30, 60
    s_branch W_A
DT_19:
    s_cmp_lt_u32 s30, 1040
    s_cbranch_scc0 DT_20
    s_sub_u32 s32, s30, 1024
    s_mov_b32 s30, 59
    s_branch W_GB
DT_20:
    s_cmp_lt_u32 s30, 1056
    s_cbranch_scc0 DT_21
    s_sub_u32 s32, s30, 1040
    s_mov_b32 s30, 61
    s_branch W_A
DT_21:
    s_cmp_lt_u32 s30, 1088
    s_cbranch_scc0 DT_22
    s_sub_u32 s32, s30, 1056
    s_mov_b32 s30, 60
    s_branch W_GH
DT_22:
    s_cmp_lt_u32 s30, 1104
    s_cbranch_scc0 DT_23
    s_sub_u32 s32, s30, 1088
    s_mov_b32 s30, 62
    s_branch W_A
DT_23:
    s_cmp_lt_u32 s30, 1136
    s_cbranch_scc0 DT_24
    s_sub_u32 s32, s30, 1104
    s_mov_b32 s30, 61
    s_branch W_GH
DT_24:
    s_cmp_lt_u32 s30, 1152
    s_cbranch_scc0 DT_25
    s_sub_u32 s32, s30, 1136
    s_mov_b32 s30, 63
    s_branch W_A
DT_25:
    s_cmp_lt_u32 s30, 1184
    s_cbranch_scc0 DT_26
    s_sub_u32 s32, s30, 1152
    s_mov_b32 s30, 62
    s_branch W_GH
DT_26:
    s_cmp_lt_u32 s30, 1216
    s_cbranch_scc0 DT_27
    s_sub_u32 s32, s30, 1184
    s_mov_b32 s30, 63
    s_branch W_GH
DT_27:
    s_branch W_EXIT
W_P:
    s_and_b32 s28, s30, 31
    s_lshr_b32 s30, s30, 5
    s_load_dwordx4 s[40:43], s[0:1], 16
    s_load_dwordx2 s[44:45], s[0:1], 32
    v_lshlrev_b32 v3, 4, v1
    v_and_b32 v4, 15, v1
    v_lshrrev_b32 v5, 4, v1
    v_lshrrev_b32 v6, 2, v4
    v_and_b32 v7, 3, v4
    v_lshl_add_u32 v6, v6, 3, v7
    v_lshlrev_b32 v8, 10, v6
    v_lshl_add_u32 v8, v5, 4, v8
    v_lshrrev_b32 v10, 4, v1
    v_and_b32 v15, 15, v1
    v_lshlrev_b32 v9, 4, v15
    v_lshl_add_u32 v9, v10, 13, v9
    v_lshlrev_b32 v12, 2, v10
    v_xor_b32 v12, v12, v15
    v_lshlrev_b32 v12, 4, v12
    v_lshl_add_u32 v12, v10, 8, v12
    v_lshl_add_u32 v12, v2, 15, v12
    v_add_u32 v12, 2048, v12
    v_bfe_u32 v15, v1, 2, 2
    v_lshl_add_u32 v13, v10, 3, v15
    v_lshlrev_b32 v13, 8, v13
    v_xor_b32 v15, v15, v2
    v_lshl_add_u32 v13, v15, 6, v13
    v_and_b32 v15, 3, v1
    v_lshl_add_u32 v13, v15, 4, v13
    v_add_u32 v13, 2048, v13
    v_add_u32 v14, 0x10000, v13
    s_lshl_b32 s32, s28, 8
    s_lshl_b32 s33, s29, 20
    s_add_u32 s32, s32, s33
    s_waitcnt lgkmcnt(0)
    s_mov_b32 s48, s40
    s_and_b32 s49, s41, 0xffff
    s_mov_b32 s50, 0x400000
    s_mov_b32 s51, 0x00020000
    s_mov_b32 s52, s42
    s_and_b32 s53, s43, 0xffff
    s_mov_b32 s54, 0x400000
    s_mov_b32 s55, 0x00020000
    s_mov_b32 s56, s44
    s_and_b32 s57, s45, 0xffff
    s_mov_b32 s58, 0x400000
    s_mov_b32 s59, 0x00020000
    s_mov_b32 s33, s32
    buffer_load_dwordx4 a[0:3], v9, s[48:51], s33 offen
    s_add_u32 s33, s33, 0x8000
    buffer_load_dwordx4 a[4:7], v9, s[48:51], s33 offen
    s_add_u32 s33, s33, 0x8000
    buffer_load_dwordx4 a[8:11], v9, s[48:51], s33 offen
    s_add_u32 s33, s33, 0x8000
    buffer_load_dwordx4 a[12:15], v9, s[48:51], s33 offen
    s_add_u32 s33, s33, 0x8000
    buffer_load_dwordx4 a[16:19], v9, s[48:51], s33 offen
    s_add_u32 s33, s33, 0x8000
    buffer_load_dwordx4 a[20:23], v9, s[48:51], s33 offen
    s_add_u32 s33, s33, 0x8000
    buffer_load_dwordx4 a[24:27], v9, s[48:51], s33 offen
    s_add_u32 s33, s33, 0x8000
    buffer_load_dwordx4 a[28:31], v9, s[48:51], s33 offen
    s_add_u32 s33, s33, 0x8000
    buffer_load_dwordx4 a[32:35], v9, s[48:51], s33 offen
    s_add_u32 s33, s33, 0x8000
    buffer_load_dwordx4 a[36:39], v9, s[48:51], s33 offen
    s_add_u32 s33, s33, 0x8000
    buffer_load_dwordx4 a[40:43], v9, s[48:51], s33 offen
    s_add_u32 s33, s33, 0x8000
    buffer_load_dwordx4 a[44:47], v9, s[48:51], s33 offen
    s_add_u32 s33, s33, 0x8000
    buffer_load_dwordx4 a[48:51], v9, s[48:51], s33 offen
    s_add_u32 s33, s33, 0x8000
    buffer_load_dwordx4 a[52:55], v9, s[48:51], s33 offen
    s_add_u32 s33, s33, 0x8000
    buffer_load_dwordx4 a[56:59], v9, s[48:51], s33 offen
    s_add_u32 s33, s33, 0x8000
    buffer_load_dwordx4 a[60:63], v9, s[48:51], s33 offen
    s_add_u32 s33, s33, 0x8000
    buffer_load_dwordx4 a[64:67], v9, s[48:51], s33 offen
    s_add_u32 s33, s33, 0x8000
    buffer_load_dwordx4 a[68:71], v9, s[48:51], s33 offen
    s_add_u32 s33, s33, 0x8000
    buffer_load_dwordx4 a[72:75], v9, s[48:51], s33 offen
    s_add_u32 s33, s33, 0x8000
    buffer_load_dwordx4 a[76:79], v9, s[48:51], s33 offen
    s_add_u32 s33, s33, 0x8000
    buffer_load_dwordx4 a[80:83], v9, s[48:51], s33 offen
    s_add_u32 s33, s33, 0x8000
    buffer_load_dwordx4 a[84:87], v9, s[48:51], s33 offen
    s_add_u32 s33, s33, 0x8000
    buffer_load_dwordx4 a[88:91], v9, s[48:51], s33 offen
    s_add_u32 s33, s33, 0x8000
    buffer_load_dwordx4 a[92:95], v9, s[48:51], s33 offen
    s_add_u32 s33, s33, 0x8000
    buffer_load_dwordx4 a[96:99], v9, s[48:51], s33 offen
    s_add_u32 s33, s33, 0x8000
    buffer_load_dwordx4 a[100:103], v9, s[48:51], s33 offen
    s_add_u32 s33, s33, 0x8000
    buffer_load_dwordx4 a[104:107], v9, s[48:51], s33 offen
    s_add_u32 s33, s33, 0x8000
    buffer_load_dwordx4 a[108:111], v9, s[48:51], s33 offen
    s_add_u32 s33, s33, 0x8000
    buffer_load_dwordx4 a[112:115], v9, s[48:51], s33 offen
    s_add_u32 s33, s33, 0x8000
    buffer_load_dwordx4 a[116:119], v9, s[48:51], s33 offen
    s_add_u32 s33, s33, 0x8000
    buffer_load_dwordx4 a[120:123], v9, s[48:51], s33 offen
    s_add_u32 s33, s33, 0x8000
    buffer_load_dwordx4 a[124:127], v9, s[48:51], s33 offen
    s_add_u32 s33, s33, 0x8000
    s_mov_b32 s33, s32
    buffer_load_dwordx4 a[128:131], v9, s[52:55], s33 offen
    s_add_u32 s33, s33, 0x8000
    buffer_load_dwordx4 a[132:135], v9, s[52:55], s33 offen
    s_add_u32 s33, s33, 0x8000
    buffer_load_dwordx4 a[136:139], v9, s[52:55], s33 offen
    s_add_u32 s33, s33, 0x8000
    buffer_load_dwordx4 a[140:143], v9, s[52:55], s33 offen
    s_add_u32 s33, s33, 0x8000
    buffer_load_dwordx4 a[144:147], v9, s[52:55], s33 offen
    s_add_u32 s33, s33, 0x8000
    buffer_load_dwordx4 a[148:151], v9, s[52:55], s33 offen
    s_add_u32 s33, s33, 0x8000
    buffer_load_dwordx4 a[152:155], v9, s[52:55], s33 offen
    s_add_u32 s33, s33, 0x8000
    buffer_load_dwordx4 a[156:159], v9, s[52:55], s33 offen
    s_add_u32 s33, s33, 0x8000
    buffer_load_dwordx4 a[160:163], v9, s[52:55], s33 offen
    s_add_u32 s33, s33, 0x8000
    buffer_load_dwordx4 a[164:167], v9, s[52:55], s33 offen
    s_add_u32 s33, s33, 0x8000
    buffer_load_dwordx4 a[168:171], v9, s[52:55], s33 offen
    s_add_u32 s33, s33, 0x8000
    buffer_load_dwordx4 a[172:175], v9, s[52:55], s33 offen
    s_add_u32 s33, s33, 0x8000
    buffer_load_dwordx4 a[176:179], v9, s[52:55], s33 offen
    s_add_u32 s33, s33, 0x8000
    buffer_load_dwordx4 a[180:183], v9, s[52:55], s33 offen
    s_add_u32 s33, s33, 0x8000
    buffer_load_dwordx4 a[184:187], v9, s[52:55], s33 offen
    s_add_u32 s33, s33, 0x8000
    buffer_load_dwordx4 a[188:191], v9, s[52:55], s33 offen
    s_add_u32 s33, s33, 0x8000
    buffer_load_dwordx4 a[192:195], v9, s[52:55], s33 offen
    s_add_u32 s33, s33, 0x8000
    buffer_load_dwordx4 a[196:199], v9, s[52:55], s33 offen
    s_add_u32 s33, s33, 0x8000
    buffer_load_dwordx4 a[200:203], v9, s[52:55], s33 offen
    s_add_u32 s33, s33, 0x8000
    buffer_load_dwordx4 a[204:207], v9, s[52:55], s33 offen
    s_add_u32 s33, s33, 0x8000
    buffer_load_dwordx4 a[208:211], v9, s[52:55], s33 offen
    s_add_u32 s33, s33, 0x8000
    buffer_load_dwordx4 a[212:215], v9, s[52:55], s33 offen
    s_add_u32 s33, s33, 0x8000
    buffer_load_dwordx4 a[216:219], v9, s[52:55], s33 offen
    s_add_u32 s33, s33, 0x8000
    buffer_load_dwordx4 a[220:223], v9, s[52:55], s33 offen
    s_add_u32 s33, s33, 0x8000
    buffer_load_dwordx4 a[224:227], v9, s[52:55], s33 offen
    s_add_u32 s33, s33, 0x8000
    buffer_load_dwordx4 a[228:231], v9, s[52:55], s33 offen
    s_add_u32 s33, s33, 0x8000
    buffer_load_dwordx4 a[232:235], v9, s[52:55], s33 offen
    s_add_u32 s33, s33, 0x8000
    buffer_load_dwordx4 a[236:239], v9, s[52:55], s33 offen
    s_add_u32 s33, s33, 0x8000
    buffer_load_dwordx4 a[240:243], v9, s[52:55], s33 offen
    s_add_u32 s33, s33, 0x8000
    buffer_load_dwordx4 a[244:247], v9, s[52:55], s33 offen
    s_add_u32 s33, s33, 0x8000
    buffer_load_dwordx4 a[248:251], v9, s[52:55], s33 offen
    s_add_u32 s33, s33, 0x8000
    buffer_load_dwordx4 a[252:255], v9, s[52:55], s33 offen
    s_add_u32 s33, s33, 0x8000
    s_mov_b32 s33, s32
    buffer_load_dwordx4 v[128:131], v9, s[56:59], s33 offen
    s_add_u32 s33, s33, 0x8000
    buffer_load_dwordx4 v[132:135], v9, s[56:59], s33 offen
    s_add_u32 s33, s33, 0x8000
    buffer_load_dwordx4 v[136:139], v9, s[56:59], s33 offen
    s_add_u32 s33, s33, 0x8000
    buffer_load_dwordx4 v[140:143], v9, s[56:59], s33 offen
    s_add_u32 s33, s33, 0x8000
    buffer_load_dwordx4 v[144:147], v9, s[56:59], s33 offen
    s_add_u32 s33, s33, 0x8000
    buffer_load_dwordx4 v[148:151], v9, s[56:59], s33 offen
    s_add_u32 s33, s33, 0x8000
    buffer_load_dwordx4 v[152:155], v9, s[56:59], s33 offen
    s_add_u32 s33, s33, 0x8000
    buffer_load_dwordx4 v[156:159], v9, s[56:59], s33 offen
    s_add_u32 s33, s33, 0x8000
    buffer_load_dwordx4 v[160:163], v9, s[56:59], s33 offen
    s_add_u32 s33, s33, 0x8000
    buffer_load_dwordx4 v[164:167], v9, s[56:59], s33 offen
    s_add_u32 s33, s33, 0x8000
    buffer_load_dwordx4 v[168:171], v9, s[56:59], s33 offen
    s_add_u32 s33, s33, 0x8000
    buffer_load_dwordx4 v[172:175], v9, s[56:59], s33 offen
    s_add_u32 s33, s33, 0x8000
    buffer_load_dwordx4 v[176:179], v9, s[56:59], s33 offen
    s_add_u32 s33, s33, 0x8000
    buffer_load_dwordx4 v[180:183], v9, s[56:59], s33 offen
    s_add_u32 s33, s33, 0x8000
    buffer_load_dwordx4 v[184:187], v9, s[56:59], s33 offen
    s_add_u32 s33, s33, 0x8000
    buffer_load_dwordx4 v[188:191], v9, s[56:59], s33 offen
    s_add_u32 s33, s33, 0x8000
    buffer_load_dwordx4 v[192:195], v9, s[56:59], s33 offen
    s_add_u32 s33, s33, 0x8000
    buffer_load_dwordx4 v[196:199], v9, s[56:59], s33 offen
    s_add_u32 s33, s33, 0x8000
    buffer_load_dwordx4 v[200:203], v9, s[56:59], s33 offen
    s_add_u32 s33, s33, 0x8000
    buffer_load_dwordx4 v[204:207], v9, s[56:59], s33 offen
    s_add_u32 s33, s33, 0x8000
    buffer_load_dwordx4 v[208:211], v9, s[56:59], s33 offen
    s_add_u32 s33, s33, 0x8000
    buffer_load_dwordx4 v[212:215], v9, s[56:59], s33 offen
    s_add_u32 s33, s33, 0x8000
    buffer_load_dwordx4 v[216:219], v9, s[56:59], s33 offen
    s_add_u32 s33, s33, 0x8000
    buffer_load_dwordx4 v[220:223], v9, s[56:59], s33 offen
    s_add_u32 s33, s33, 0x8000
    buffer_load_dwordx4 v[224:227], v9, s[56:59], s33 offen
    s_add_u32 s33, s33, 0x8000
    buffer_load_dwordx4 v[228:231], v9, s[56:59], s33 offen
    s_add_u32 s33, s33, 0x8000
    buffer_load_dwordx4 v[232:235], v9, s[56:59], s33 offen
    s_add_u32 s33, s33, 0x8000
    buffer_load_dwordx4 v[236:239], v9, s[56:59], s33 offen
    s_add_u32 s33, s33, 0x8000
    buffer_load_dwordx4 v[240:243], v9, s[56:59], s33 offen
    s_add_u32 s33, s33, 0x8000
    buffer_load_dwordx4 v[244:247], v9, s[56:59], s33 offen
    s_add_u32 s33, s33, 0x8000
    buffer_load_dwordx4 v[248:251], v9, s[56:59], s33 offen
    s_add_u32 s33, s33, 0x8000
    buffer_load_dwordx4 v[252:255], v9, s[56:59], s33 offen
    s_add_u32 s33, s33, 0x8000
    v_lshl_add_u32 v11, v2, 15, v3
    v_add_u32 v11, 2048, v11
    s_waitcnt vmcnt(63)
    ds_write_b128 v12, a[0:3] offset:0
    ds_write_b128 v12, a[4:7] offset:1024
    ds_write_b128 v12, a[8:11] offset:2048
    ds_write_b128 v12, a[12:15] offset:3072
    ds_write_b128 v12, a[16:19] offset:4096
    ds_write_b128 v12, a[20:23] offset:5120
    ds_write_b128 v12, a[24:27] offset:6144
    ds_write_b128 v12, a[28:31] offset:7168
    ds_write_b128 v12, a[32:35] offset:8192
    ds_write_b128 v12, a[36:39] offset:9216
    ds_write_b128 v12, a[40:43] offset:10240
    ds_write_b128 v12, a[44:47] offset:11264
    ds_write_b128 v12, a[48:51] offset:12288
    ds_write_b128 v12, a[52:55] offset:13312
    ds_write_b128 v12, a[56:59] offset:14336
    ds_write_b128 v12, a[60:63] offset:15360
    ds_write_b128 v12, a[64:67] offset:16384
    ds_write_b128 v12, a[68:71] offset:17408
    ds_write_b128 v12, a[72:75] offset:18432
    ds_write_b128 v12, a[76:79] offset:19456
    ds_write_b128 v12, a[80:83] offset:20480
    ds_write_b128 v12, a[84:87] offset:21504
    ds_write_b128 v12, a[88:91] offset:22528
    ds_write_b128 v12, a[92:95] offset:23552
    ds_write_b128 v12, a[96:99] offset:24576
    ds_write_b128 v12, a[100:103] offset:25600
    ds_write_b128 v12, a[104:107] offset:26624
    ds_write_b128 v12, a[108:111] offset:27648
    ds_write_b128 v12, a[112:115] offset:28672
    ds_write_b128 v12, a[116:119] offset:29696
    ds_write_b128 v12, a[120:123] offset:30720
    ds_write_b128 v12, a[124:127] offset:31744
    s_waitcnt lgkmcnt(0)
    s_barrier
    ds_read_b64_tr_b16 a[0:1], v13 offset:0
    ds_read_b64_tr_b16 a[2:3], v13 offset:1024
    ds_read_b64_tr_b16 a[4:5], v13 offset:8192
    ds_read_b64_tr_b16 a[6:7], v13 offset:9216
    ds_read_b64_tr_b16 a[8:9], v13 offset:16384
    ds_read_b64_tr_b16 a[10:11], v13 offset:17408
    ds_read_b64_tr_b16 a[12:13], v13 offset:24576
    ds_read_b64_tr_b16 a[14:15], v13 offset:25600
    ds_read_b64_tr_b16 a[16:17], v13 offset:32768
    ds_read_b64_tr_b16 a[18:19], v13 offset:33792
    ds_read_b64_tr_b16 a[20:21], v13 offset:40960
    ds_read_b64_tr_b16 a[22:23], v13 offset:41984
    ds_read_b64_tr_b16 a[24:25], v13 offset:49152
    ds_read_b64_tr_b16 a[26:27], v13 offset:50176
    ds_read_b64_tr_b16 a[28:29], v13 offset:57344
    ds_read_b64_tr_b16 a[30:31], v13 offset:58368
    ds_read_b64_tr_b16 a[32:33], v14 offset:0
    ds_read_b64_tr_b16 a[34:35], v14 offset:1024
    ds_read_b64_tr_b16 a[36:37], v14 offset:8192
    ds_read_b64_tr_b16 a[38:39], v14 offset:9216
    ds_read_b64_tr_b16 a[40:41], v14 offset:16384
    ds_read_b64_tr_b16 a[42:43], v14 offset:17408
    ds_read_b64_tr_b16 a[44:45], v14 offset:24576
    ds_read_b64_tr_b16 a[46:47], v14 offset:25600
    ds_read_b64_tr_b16 a[48:49], v14 offset:32768
    ds_read_b64_tr_b16 a[50:51], v14 offset:33792
    ds_read_b64_tr_b16 a[52:53], v14 offset:40960
    ds_read_b64_tr_b16 a[54:55], v14 offset:41984
    ds_read_b64_tr_b16 a[56:57], v14 offset:49152
    ds_read_b64_tr_b16 a[58:59], v14 offset:50176
    ds_read_b64_tr_b16 a[60:61], v14 offset:57344
    ds_read_b64_tr_b16 a[62:63], v14 offset:58368
    ds_read_b64_tr_b16 a[64:65], v13 offset:8
    ds_read_b64_tr_b16 a[66:67], v13 offset:1032
    ds_read_b64_tr_b16 a[68:69], v13 offset:8200
    ds_read_b64_tr_b16 a[70:71], v13 offset:9224
    ds_read_b64_tr_b16 a[72:73], v13 offset:16392
    ds_read_b64_tr_b16 a[74:75], v13 offset:17416
    ds_read_b64_tr_b16 a[76:77], v13 offset:24584
    ds_read_b64_tr_b16 a[78:79], v13 offset:25608
    ds_read_b64_tr_b16 a[80:81], v13 offset:32776
    ds_read_b64_tr_b16 a[82:83], v13 offset:33800
    ds_read_b64_tr_b16 a[84:85], v13 offset:40968
    ds_read_b64_tr_b16 a[86:87], v13 offset:41992
    ds_read_b64_tr_b16 a[88:89], v13 offset:49160
    ds_read_b64_tr_b16 a[90:91], v13 offset:50184
    ds_read_b64_tr_b16 a[92:93], v13 offset:57352
    ds_read_b64_tr_b16 a[94:95], v13 offset:58376
    ds_read_b64_tr_b16 a[96:97], v14 offset:8
    ds_read_b64_tr_b16 a[98:99], v14 offset:1032
    ds_read_b64_tr_b16 a[100:101], v14 offset:8200
    ds_read_b64_tr_b16 a[102:103], v14 offset:9224
    ds_read_b64_tr_b16 a[104:105], v14 offset:16392
    ds_read_b64_tr_b16 a[106:107], v14 offset:17416
    ds_read_b64_tr_b16 a[108:109], v14 offset:24584
    ds_read_b64_tr_b16 a[110:111], v14 offset:25608
    ds_read_b64_tr_b16 a[112:113], v14 offset:32776
    ds_read_b64_tr_b16 a[114:115], v14 offset:33800
    ds_read_b64_tr_b16 a[116:117], v14 offset:40968
    ds_read_b64_tr_b16 a[118:119], v14 offset:41992
    ds_read_b64_tr_b16 a[120:121], v14 offset:49160
    ds_read_b64_tr_b16 a[122:123], v14 offset:50184
    ds_read_b64_tr_b16 a[124:125], v14 offset:57352
    ds_read_b64_tr_b16 a[126:127], v14 offset:58376
    s_waitcnt lgkmcnt(0)
    s_barrier
    s_waitcnt vmcnt(32)
    ds_write_b128 v12, a[128:131] offset:0
    ds_write_b128 v12, a[132:135] offset:1024
    ds_write_b128 v12, a[136:139] offset:2048
    ds_write_b128 v12, a[140:143] offset:3072
    ds_write_b128 v12, a[144:147] offset:4096
    ds_write_b128 v12, a[148:151] offset:5120
    ds_write_b128 v12, a[152:155] offset:6144
    ds_write_b128 v12, a[156:159] offset:7168
    ds_write_b128 v12, a[160:163] offset:8192
    ds_write_b128 v12, a[164:167] offset:9216
    ds_write_b128 v12, a[168:171] offset:10240
    ds_write_b128 v12, a[172:175] offset:11264
    ds_write_b128 v12, a[176:179] offset:12288
    ds_write_b128 v12, a[180:183] offset:13312
    ds_write_b128 v12, a[184:187] offset:14336
    ds_write_b128 v12, a[188:191] offset:15360
    ds_write_b128 v12, a[192:195] offset:16384
    ds_write_b128 v12, a[196:199] offset:17408
    ds_write_b128 v12, a[200:203] offset:18432
    ds_write_b128 v12, a[204:207] offset:19456
    ds_write_b128 v12, a[208:211] offset:20480
    ds_write_b128 v12, a[212:215] offset:21504
    ds_write_b128 v12, a[216:219] offset:22528
    ds_write_b128 v12, a[220:223] offset:23552
    ds_write_b128 v12, a[224:227] offset:24576
    ds_write_b128 v12, a[228:231] offset:25600
    ds_write_b128 v12, a[232:235] offset:26624
    ds_write_b128 v12, a[236:239] offset:27648
    ds_write_b128 v12, a[240:243] offset:28672
    ds_write_b128 v12, a[244:247] offset:29696
    ds_write_b128 v12, a[248:251] offset:30720
    ds_write_b128 v12, a[252:255] offset:31744
    s_waitcnt lgkmcnt(0)
    s_barrier
    ds_read_b64_tr_b16 a[128:129], v13 offset:0
    ds_read_b64_tr_b16 a[130:131], v13 offset:1024
    ds_read_b64_tr_b16 a[132:133], v13 offset:8192
    ds_read_b64_tr_b16 a[134:135], v13 offset:9216
    ds_read_b64_tr_b16 a[136:137], v13 offset:16384
    ds_read_b64_tr_b16 a[138:139], v13 offset:17408
    ds_read_b64_tr_b16 a[140:141], v13 offset:24576
    ds_read_b64_tr_b16 a[142:143], v13 offset:25600
    ds_read_b64_tr_b16 a[144:145], v13 offset:32768
    ds_read_b64_tr_b16 a[146:147], v13 offset:33792
    ds_read_b64_tr_b16 a[148:149], v13 offset:40960
    ds_read_b64_tr_b16 a[150:151], v13 offset:41984
    ds_read_b64_tr_b16 a[152:153], v13 offset:49152
    ds_read_b64_tr_b16 a[154:155], v13 offset:50176
    ds_read_b64_tr_b16 a[156:157], v13 offset:57344
    ds_read_b64_tr_b16 a[158:159], v13 offset:58368
    ds_read_b64_tr_b16 a[160:161], v14 offset:0
    ds_read_b64_tr_b16 a[162:163], v14 offset:1024
    ds_read_b64_tr_b16 a[164:165], v14 offset:8192
    ds_read_b64_tr_b16 a[166:167], v14 offset:9216
    ds_read_b64_tr_b16 a[168:169], v14 offset:16384
    ds_read_b64_tr_b16 a[170:171], v14 offset:17408
    ds_read_b64_tr_b16 a[172:173], v14 offset:24576
    ds_read_b64_tr_b16 a[174:175], v14 offset:25600
    ds_read_b64_tr_b16 a[176:177], v14 offset:32768
    ds_read_b64_tr_b16 a[178:179], v14 offset:33792
    ds_read_b64_tr_b16 a[180:181], v14 offset:40960
    ds_read_b64_tr_b16 a[182:183], v14 offset:41984
    ds_read_b64_tr_b16 a[184:185], v14 offset:49152
    ds_read_b64_tr_b16 a[186:187], v14 offset:50176
    ds_read_b64_tr_b16 a[188:189], v14 offset:57344
    ds_read_b64_tr_b16 a[190:191], v14 offset:58368
    ds_read_b64_tr_b16 a[192:193], v13 offset:8
    ds_read_b64_tr_b16 a[194:195], v13 offset:1032
    ds_read_b64_tr_b16 a[196:197], v13 offset:8200
    ds_read_b64_tr_b16 a[198:199], v13 offset:9224
    ds_read_b64_tr_b16 a[200:201], v13 offset:16392
    ds_read_b64_tr_b16 a[202:203], v13 offset:17416
    ds_read_b64_tr_b16 a[204:205], v13 offset:24584
    ds_read_b64_tr_b16 a[206:207], v13 offset:25608
    ds_read_b64_tr_b16 a[208:209], v13 offset:32776
    ds_read_b64_tr_b16 a[210:211], v13 offset:33800
    ds_read_b64_tr_b16 a[212:213], v13 offset:40968
    ds_read_b64_tr_b16 a[214:215], v13 offset:41992
    ds_read_b64_tr_b16 a[216:217], v13 offset:49160
    ds_read_b64_tr_b16 a[218:219], v13 offset:50184
    ds_read_b64_tr_b16 a[220:221], v13 offset:57352
    ds_read_b64_tr_b16 a[222:223], v13 offset:58376
    ds_read_b64_tr_b16 a[224:225], v14 offset:8
    ds_read_b64_tr_b16 a[226:227], v14 offset:1032
    ds_read_b64_tr_b16 a[228:229], v14 offset:8200
    ds_read_b64_tr_b16 a[230:231], v14 offset:9224
    ds_read_b64_tr_b16 a[232:233], v14 offset:16392
    ds_read_b64_tr_b16 a[234:235], v14 offset:17416
    ds_read_b64_tr_b16 a[236:237], v14 offset:24584
    ds_read_b64_tr_b16 a[238:239], v14 offset:25608
    ds_read_b64_tr_b16 a[240:241], v14 offset:32776
    ds_read_b64_tr_b16 a[242:243], v14 offset:33800
    ds_read_b64_tr_b16 a[244:245], v14 offset:40968
    ds_read_b64_tr_b16 a[246:247], v14 offset:41992
    ds_read_b64_tr_b16 a[248:249], v14 offset:49160
    ds_read_b64_tr_b16 a[250:251], v14 offset:50184
    ds_read_b64_tr_b16 a[252:253], v14 offset:57352
    ds_read_b64_tr_b16 a[254:255], v14 offset:58376
    s_waitcnt lgkmcnt(0)
    s_barrier
    s_lshr_b32 s34, s30, 2
    s_lshl_b32 s34, s34, 2
    s_cmp_lg_u32 s29, 0
    s_cbranch_scc1 W0_28
    s_mov_b32 s31, 0
W_PLN:
    buffer_load_dword v24, off, s[12:15], s34 offset:68 sc1
    buffer_load_dword v25, off, s[12:15], 0 offset:240 sc1
    s_add_u32 s31, s31, 1
    s_cmp_gt_u32 s31, 0x200000
    s_cbranch_scc1 W_EXIT
    s_waitcnt vmcnt(0)
    v_readfirstlane_b32 s70, v24
    v_readfirstlane_b32 s71, v25
    s_and_b32 s35, s30, 3
    s_lshl_b32 s35, s35, 3
    s_lshr_b32 s70, s70, s35
    s_and_b32 s70, s70, 0xff
    s_cmp_lg_u32 s70, 4
    s_cbranch_scc1 W_PLN
    s_cmp_lg_u32 s71, 21
    s_cbranch_scc1 W_PLN
W0_28:
    s_barrier
    s_lshl_b32 s34, s30, 17
    s_lshl_b32 s35, s29, 15
    s_add_u32 s34, s34, s35
    s_add_u32 s35, s34, 4096
    buffer_load_dwordx4 v[64:67], v8, s[24:27], s34 offen offset:0 sc1
    buffer_load_dwordx4 v[68:71], v8, s[24:27], s34 offen offset:64 sc1
    buffer_load_dwordx4 v[72:75], v8, s[24:27], s34 offen offset:128 sc1
    buffer_load_dwordx4 v[76:79], v8, s[24:27], s34 offen offset:192 sc1
    buffer_load_dwordx4 v[80:83], v8, s[24:27], s34 offen offset:256 sc1
    buffer_load_dwordx4 v[84:87], v8, s[24:27], s34 offen offset:320 sc1
    buffer_load_dwordx4 v[88:91], v8, s[24:27], s34 offen offset:384 sc1
    buffer_load_dwordx4 v[92:95], v8, s[24:27], s34 offen offset:448 sc1
    buffer_load_dwordx4 v[96:99], v8, s[24:27], s34 offen offset:512 sc1
    buffer_load_dwordx4 v[100:103], v8, s[24:27], s34 offen offset:576 sc1
    buffer_load_dwordx4 v[104:107], v8, s[24:27], s34 offen offset:640 sc1
    buffer_load_dwordx4 v[108:111], v8, s[24:27], s34 offen offset:704 sc1
    buffer_load_dwordx4 v[112:115], v8, s[24:27], s34 offen offset:768 sc1
    buffer_load_dwordx4 v[116:119], v8, s[24:27], s34 offen offset:832 sc1
    buffer_load_dwordx4 v[120:123], v8, s[24:27], s34 offen offset:896 sc1
    buffer_load_dwordx4 v[124:127], v8, s[24:27], s34 offen offset:960 sc1
    s_waitcnt vmcnt(16)
    ds_write_b128 v12, v[128:131] offset:0
    ds_write_b128 v12, v[132:135] offset:1024
    ds_write_b128 v12, v[136:139] offset:2048
    ds_write_b128 v12, v[140:143] offset:3072
    ds_write_b128 v12, v[144:147] offset:4096
    ds_write_b128 v12, v[148:151] offset:5120
    ds_write_b128 v12, v[152:155] offset:6144
    ds_write_b128 v12, v[156:159] offset:7168
    ds_write_b128 v12, v[160:163] offset:8192
    ds_write_b128 v12, v[164:167] offset:9216
    ds_write_b128 v12, v[168:171] offset:10240
    ds_write_b128 v12, v[172:175] offset:11264
    ds_write_b128 v12, v[176:179] offset:12288
    ds_write_b128 v12, v[180:183] offset:13312
    ds_write_b128 v12, v[184:187] offset:14336
    ds_write_b128 v12, v[188:191] offset:15360
    ds_write_b128 v12, v[192:195] offset:16384
    ds_write_b128 v12, v[196:199] offset:17408
    ds_write_b128 v12, v[200:203] offset:18432
    ds_write_b128 v12, v[204:207] offset:19456
    ds_write_b128 v12, v[208:211] offset:20480
    ds_write_b128 v12, v[212:215] offset:21504
    ds_write_b128 v12, v[216:219] offset:22528
    ds_write_b128 v12, v[220:223] offset:23552
    ds_write_b128 v12, v[224:227] offset:24576
    ds_write_b128 v12, v[228:231] offset:25600
    ds_write_b128 v12, v[232:235] offset:26624
    ds_write_b128 v12, v[236:239] offset:27648
    ds_write_b128 v12, v[240:243] offset:28672
    ds_write_b128 v12, v[244:247] offset:29696
    ds_write_b128 v12, v[248:251] offset:30720
    ds_write_b128 v12, v[252:255] offset:31744
    s_waitcnt lgkmcnt(0)
    s_barrier
    ds_read_b64_tr_b16 v[128:129], v13 offset:0
    ds_read_b64_tr_b16 v[130:131], v13 offset:1024
    ds_read_b64_tr_b16 v[132:133], v13 offset:8192
    ds_read_b64_tr_b16 v[134:135], v13 offset:9216
    ds_read_b64_tr_b16 v[136:137], v13 offset:16384
    ds_read_b64_tr_b16 v[138:139], v13 offset:17408
    ds_read_b64_tr_b16 v[140:141], v13 offset:24576
    ds_read_b64_tr_b16 v[142:143], v13 offset:25600
    ds_read_b64_tr_b16 v[144:145], v13 offset:32768
    ds_read_b64_tr_b16 v[146:147], v13 offset:33792
    ds_read_b64_tr_b16 v[148:149], v13 offset:40960
    ds_read_b64_tr_b16 v[150:151], v13 offset:41984
    ds_read_b64_tr_b16 v[152:153], v13 offset:49152
    ds_read_b64_tr_b16 v[154:155], v13 offset:50176
    ds_read_b64_tr_b16 v[156:157], v13 offset:57344
    ds_read_b64_tr_b16 v[158:159], v13 offset:58368
    ds_read_b64_tr_b16 v[160:161], v14 offset:0
    ds_read_b64_tr_b16 v[162:163], v14 offset:1024
    ds_read_b64_tr_b16 v[164:165], v14 offset:8192
    ds_read_b64_tr_b16 v[166:167], v14 offset:9216
    ds_read_b64_tr_b16 v[168:169], v14 offset:16384
    ds_read_b64_tr_b16 v[170:171], v14 offset:17408
    ds_read_b64_tr_b16 v[172:173], v14 offset:24576
    ds_read_b64_tr_b16 v[174:175], v14 offset:25600
    ds_read_b64_tr_b16 v[176:177], v14 offset:32768
    ds_read_b64_tr_b16 v[178:179], v14 offset:33792
    ds_read_b64_tr_b16 v[180:181], v14 offset:40960
    ds_read_b64_tr_b16 v[182:183], v14 offset:41984
    ds_read_b64_tr_b16 v[184:185], v14 offset:49152
    ds_read_b64_tr_b16 v[186:187], v14 offset:50176
    ds_read_b64_tr_b16 v[188:189], v14 offset:57344
    ds_read_b64_tr_b16 v[190:191], v14 offset:58368
    ds_read_b64_tr_b16 v[192:193], v13 offset:8
    ds_read_b64_tr_b16 v[194:195], v13 offset:1032
    ds_read_b64_tr_b16 v[196:197], v13 offset:8200
    ds_read_b64_tr_b16 v[198:199], v13 offset:9224
    ds_read_b64_tr_b16 v[200:201], v13 offset:16392
    ds_read_b64_tr_b16 v[202:203], v13 offset:17416
    ds_read_b64_tr_b16 v[204:205], v13 offset:24584
    ds_read_b64_tr_b16 v[206:207], v13 offset:25608
    ds_read_b64_tr_b16 v[208:209], v13 offset:32776
    ds_read_b64_tr_b16 v[210:211], v13 offset:33800
    ds_read_b64_tr_b16 v[212:213], v13 offset:40968
    ds_read_b64_tr_b16 v[214:215], v13 offset:41992
    ds_read_b64_tr_b16 v[216:217], v13 offset:49160
    ds_read_b64_tr_b16 v[218:219], v13 offset:50184
    ds_read_b64_tr_b16 v[220:221], v13 offset:57352
    ds_read_b64_tr_b16 v[222:223], v13 offset:58376
    ds_read_b64_tr_b16 v[224:225], v14 offset:8
    ds_read_b64_tr_b16 v[226:227], v14 offset:1032
    ds_read_b64_tr_b16 v[228:229], v14 offset:8200
    ds_read_b64_tr_b16 v[230:231], v14 offset:9224
    ds_read_b64_tr_b16 v[232:233], v14 offset:16392
    ds_read_b64_tr_b16 v[234:235], v14 offset:17416
    ds_read_b64_tr_b16 v[236:237], v14 offset:24584
    ds_read_b64_tr_b16 v[238:239], v14 offset:25608
    ds_read_b64_tr_b16 v[240:241], v14 offset:32776
    ds_read_b64_tr_b16 v[242:243], v14 offset:33800
    ds_read_b64_tr_b16 v[244:245], v14 offset:40968
    ds_read_b64_tr_b16 v[246:247], v14 offset:41992
    ds_read_b64_tr_b16 v[248:249], v14 offset:49160
    ds_read_b64_tr_b16 v[250:251], v14 offset:50184
    ds_read_b64_tr_b16 v[252:253], v14 offset:57352
    ds_read_b64_tr_b16 v[254:255], v14 offset:58376
    s_waitcnt lgkmcnt(0)
    s_barrier
    s_waitcnt vmcnt(0)
    ds_write_b128 v11, v[64:67] offset:0
    ds_write_b128 v11, v[68:71] offset:1024
    ds_write_b128 v11, v[72:75] offset:2048
    ds_write_b128 v11, v[76:79] offset:3072
    ds_write_b128 v11, v[80:83] offset:4096
    ds_write_b128 v11, v[84:87] offset:5120
    ds_write_b128 v11, v[88:91] offset:6144
    ds_write_b128 v11, v[92:95] offset:7168
    ds_write_b128 v11, v[96:99] offset:8192
    ds_write_b128 v11, v[100:103] offset:9216
    ds_write_b128 v11, v[104:107] offset:10240
    ds_write_b128 v11, v[108:111] offset:11264
    ds_write_b128 v11, v[112:115] offset:12288
    ds_write_b128 v11, v[116:119] offset:13312
    ds_write_b128 v11, v[120:123] offset:14336
    ds_write_b128 v11, v[124:127] offset:15360
    s_waitcnt lgkmcnt(0)
    buffer_load_dwordx4 v[64:67], v8, s[24:27], s35 offen offset:0 sc1
    buffer_load_dwordx4 v[68:71], v8, s[24:27], s35 offen offset:64 sc1
    buffer_load_dwordx4 v[72:75], v8, s[24:27], s35 offen offset:128 sc1
    buffer_load_dwordx4 v[76:79], v8, s[24:27], s35 offen offset:192 sc1
    buffer_load_dwordx4 v[80:83], v8, s[24:27], s35 offen offset:256 sc1
    buffer_load_dwordx4 v[84:87], v8, s[24:27], s35 offen offset:320 sc1
    buffer_load_dwordx4 v[88:91], v8, s[24:27], s35 offen offset:384 sc1
    buffer_load_dwordx4 v[92:95], v8, s[24:27], s35 offen offset:448 sc1
    buffer_load_dwordx4 v[96:99], v8, s[24:27], s35 offen offset:512 sc1
    buffer_load_dwordx4 v[100:103], v8, s[24:27], s35 offen offset:576 sc1
    buffer_load_dwordx4 v[104:107], v8, s[24:27], s35 offen offset:640 sc1
    buffer_load_dwordx4 v[108:111], v8, s[24:27], s35 offen offset:704 sc1
    buffer_load_dwordx4 v[112:115], v8, s[24:27], s35 offen offset:768 sc1
    buffer_load_dwordx4 v[116:119], v8, s[24:27], s35 offen offset:832 sc1
    buffer_load_dwordx4 v[120:123], v8, s[24:27], s35 offen offset:896 sc1
    buffer_load_dwordx4 v[124:127], v8, s[24:27], s35 offen offset:960 sc1
    v_lshlrev_b32 v9, 8, v6
    v_lshl_add_u32 v9, v5, 4, v9
    v_lshl_add_u32 v9, v2, 6, v9
    v_lshl_add_u32 v10, v2, 5, v6
    v_lshlrev_b32 v10, 6, v10
    v_lshl_add_u32 v10, v5, 4, v10
    v_mov_b32 v28, 1
    v_add_u32 v29, 2048, v3
    v_add_u32 v31, 67584, v3
    s_lshl_b32 s35, s30, 7
    s_add_u32 s35, s35, s28
    s_lshl_b32 s35, s35, 13
    s_add_u32 s36, s35, 0x4000000
    s_add_u32 s37, s35, 0x3000000
    s_add_u32 s35, s35, 0x2000000
    s_lshl_b32 s38, s28, 6
    s_lshl_b32 s39, s30, 2
    s_add_u32 s38, s38, s39
    s_lshl_b32 s38, s38, 2
    s_add_u32 s38, s38, s29
    s_mov_b32 s39, 0x228000
    s_cmp_eq_u32 s30, 0
    s_cselect_b32 s39, 0x22c000, s39
    s_add_u32 s38, s38, s39
    s_waitcnt vmcnt(0)
    ds_write_b128 v11, v[64:67] offset:16384
    ds_write_b128 v11, v[68:71] offset:17408
    ds_write_b128 v11, v[72:75] offset:18432
    ds_write_b128 v11, v[76:79] offset:19456
    ds_write_b128 v11, v[80:83] offset:20480
    ds_write_b128 v11, v[84:87] offset:21504
    ds_write_b128 v11, v[88:91] offset:22528
    ds_write_b128 v11, v[92:95] offset:23552
    ds_write_b128 v11, v[96:99] offset:24576
    ds_write_b128 v11, v[100:103] offset:25600
    ds_write_b128 v11, v[104:107] offset:26624
    ds_write_b128 v11, v[108:111] offset:27648
    ds_write_b128 v11, v[112:115] offset:28672
    ds_write_b128 v11, v[116:119] offset:29696
    ds_write_b128 v11, v[120:123] offset:30720
    ds_write_b128 v11, v[124:127] offset:31744
    s_waitcnt lgkmcnt(0)
    s_barrier
    ds_read_b128 v[64:67], v29 offset:0
    ds_read_b128 v[68:71], v29 offset:1024
    ds_read_b128 v[72:75], v29 offset:2048
    ds_read_b128 v[76:79], v29 offset:3072
    ds_read_b128 v[80:83], v29 offset:4096
    ds_read_b128 v[84:87], v29 offset:5120
    ds_read_b128 v[88:91], v29 offset:6144
    ds_read_b128 v[92:95], v29 offset:7168
    ds_read_b128 v[96:99], v29 offset:8192
    ds_read_b128 v[100:103], v29 offset:9216
    ds_read_b128 v[104:107], v29 offset:10240
    ds_read_b128 v[108:111], v29 offset:11264
    ds_read_b128 v[112:115], v29 offset:12288
    ds_read_b128 v[116:119], v29 offset:13312
    ds_read_b128 v[120:123], v29 offset:14336
    ds_read_b128 v[124:127], v29 offset:15360
    s_waitcnt lgkmcnt(15)
    v_mfma_f32_16x16x32_bf16 v[40:43], a[0:3], v[64:67], 0
    v_mfma_f32_16x16x32_bf16 v[44:47], a[64:67], v[64:67], 0
    v_mfma_f32_16x16x32_bf16 v[48:51], a[128:131], v[64:67], 0
    v_mfma_f32_16x16x32_bf16 v[52:55], a[192:195], v[64:67], 0
    v_mfma_f32_16x16x32_bf16 v[56:59], v[64:67], v[128:131], 0
    v_mfma_f32_16x16x32_bf16 v[60:63], v[64:67], v[192:195], 0
    ds_read_b128 v[64:67], v29 offset:16384
    s_waitcnt lgkmcnt(15)
    v_mfma_f32_16x16x32_bf16 v[40:43], a[4:7], v[68:71], v[40:43]
    v_mfma_f32_16x16x32_bf16 v[44:47], a[68:71], v[68:71], v[44:47]
    v_mfma_f32_16x16x32_bf16 v[48:51], a[132:135], v[68:71], v[48:51]
    v_mfma_f32_16x16x32_bf16 v[52:55], a[196:199], v[68:71], v[52:55]
    v_mfma_f32_16x16x32_bf16 v[56:59], v[68:71], v[132:135], v[56:59]
    v_mfma_f32_16x16x32_bf16 v[60:63], v[68:71], v[196:199], v[60:63]
    ds_read_b128 v[68:71], v29 offset:17408
    s_waitcnt lgkmcnt(15)
    v_mfma_f32_16x16x32_bf16 v[40:43], a[8:11], v[72:75], v[40:43]
    v_mfma_f32_16x16x32_bf16 v[44:47], a[72:75], v[72:75], v[44:47]
    v_mfma_f32_16x16x32_bf16 v[48:51], a[136:139], v[72:75], v[48:51]
    v_mfma_f32_16x16x32_bf16 v[52:55], a[200:203], v[72:75], v[52:55]
    v_mfma_f32_16x16x32_bf16 v[56:59], v[72:75], v[136:139], v[56:59]
    v_mfma_f32_16x16x32_bf16 v[60:63], v[72:75], v[200:203], v[60:63]
    ds_read_b128 v[72:75], v29 offset:18432
    s_waitcnt lgkmcnt(15)
    v_mfma_f32_16x16x32_bf16 v[40:43], a[12:15], v[76:79], v[40:43]
    v_mfma_f32_16x16x32_bf16 v[44:47], a[76:79], v[76:79], v[44:47]
    v_mfma_f32_16x16x32_bf16 v[48:51], a[140:143], v[76:79], v[48:51]
    v_mfma_f32_16x16x32_bf16 v[52:55], a[204:207], v[76:79], v[52:55]
    v_mfma_f32_16x16x32_bf16 v[56:59], v[76:79], v[140:143], v[56:59]
    v_mfma_f32_16x16x32_bf16 v[60:63], v[76:79], v[204:207], v[60:63]
    ds_read_b128 v[76:79], v29 offset:19456
    s_waitcnt lgkmcnt(15)
    v_mfma_f32_16x16x32_bf16 v[40:43], a[16:19], v[80:83], v[40:43]
    v_mfma_f32_16x16x32_bf16 v[44:47], a[80:83], v[80:83], v[44:47]
    v_mfma_f32_16x16x32_bf16 v[48:51], a[144:147], v[80:83], v[48:51]
    v_mfma_f32_16x16x32_bf16 v[52:55], a[208:211], v[80:83], v[52:55]
    v_mfma_f32_16x16x32_bf16 v[56:59], v[80:83], v[144:147], v[56:59]
    v_mfma_f32_16x16x32_bf16 v[60:63], v[80:83], v[208:211], v[60:63]
    ds_read_b128 v[80:83], v29 offset:20480
    s_waitcnt lgkmcnt(15)
    v_mfma_f32_16x16x32_bf16 v[40:43], a[20:23], v[84:87], v[40:43]
    v_mfma_f32_16x16x32_bf16 v[44:47], a[84:87], v[84:87], v[44:47]
    v_mfma_f32_16x16x32_bf16 v[48:51], a[148:151], v[84:87], v[48:51]
    v_mfma_f32_16x16x32_bf16 v[52:55], a[212:215], v[84:87], v[52:55]
    v_mfma_f32_16x16x32_bf16 v[56:59], v[84:87], v[148:151], v[56:59]
    v_mfma_f32_16x16x32_bf16 v[60:63], v[84:87], v[212:215], v[60:63]
    ds_read_b128 v[84:87], v29 offset:21504
    s_waitcnt lgkmcnt(15)
    v_mfma_f32_16x16x32_bf16 v[40:43], a[24:27], v[88:91], v[40:43]
    v_mfma_f32_16x16x32_bf16 v[44:47], a[88:91], v[88:91], v[44:47]
    v_mfma_f32_16x16x32_bf16 v[48:51], a[152:155], v[88:91], v[48:51]
    v_mfma_f32_16x16x32_bf16 v[52:55], a[216:219], v[88:91], v[52:55]
    v_mfma_f32_16x16x32_bf16 v[56:59], v[88:91], v[152:155], v[56:59]
    v_mfma_f32_16x16x32_bf16 v[60:63], v[88:91], v[216:219], v[60:63]
    ds_read_b128 v[88:91], v29 offset:22528
    s_waitcnt lgkmcnt(15)
    v_mfma_f32_16x16x32_bf16 v[40:43], a[28:31], v[92:95], v[40:43]
    v_mfma_f32_16x16x32_bf16 v[44:47], a[92:95], v[92:95], v[44:47]
    v_mfma_f32_16x16x32_bf16 v[48:51], a[156:159], v[92:95], v[48:51]
    v_mfma_f32_16x16x32_bf16 v[52:55], a[220:223], v[92:95], v[52:55]
    v_mfma_f32_16x16x32_bf16 v[56:59], v[92:95], v[156:159], v[56:59]
    v_mfma_f32_16x16x32_bf16 v[60:63], v[92:95], v[220:223], v[60:63]
    ds_read_b128 v[92:95], v29 offset:23552
    s_waitcnt lgkmcnt(15)
    v_mfma_f32_16x16x32_bf16 v[40:43], a[32:35], v[96:99], v[40:43]
    v_mfma_f32_16x16x32_bf16 v[44:47], a[96:99], v[96:99], v[44:47]
    v_mfma_f32_16x16x32_bf16 v[48:51], a[160:163], v[96:99], v[48:51]
    v_mfma_f32_16x16x32_bf16 v[52:55], a[224:227], v[96:99], v[52:55]
    v_mfma_f32_16x16x32_bf16 v[56:59], v[96:99], v[160:163], v[56:59]
    v_mfma_f32_16x16x32_bf16 v[60:63], v[96:99], v[224:227], v[60:63]
    ds_read_b128 v[96:99], v29 offset:24576
    s_waitcnt lgkmcnt(15)
    v_mfma_f32_16x16x32_bf16 v[40:43], a[36:39], v[100:103], v[40:43]
    v_mfma_f32_16x16x32_bf16 v[44:47], a[100:103], v[100:103], v[44:47]
    v_mfma_f32_16x16x32_bf16 v[48:51], a[164:167], v[100:103], v[48:51]
    v_mfma_f32_16x16x32_bf16 v[52:55], a[228:231], v[100:103], v[52:55]
    v_mfma_f32_16x16x32_bf16 v[56:59], v[100:103], v[164:167], v[56:59]
    v_mfma_f32_16x16x32_bf16 v[60:63], v[100:103], v[228:231], v[60:63]
    ds_read_b128 v[100:103], v29 offset:25600
    s_waitcnt lgkmcnt(15)
    v_mfma_f32_16x16x32_bf16 v[40:43], a[40:43], v[104:107], v[40:43]
    v_mfma_f32_16x16x32_bf16 v[44:47], a[104:107], v[104:107], v[44:47]
    v_mfma_f32_16x16x32_bf16 v[48:51], a[168:171], v[104:107], v[48:51]
    v_mfma_f32_16x16x32_bf16 v[52:55], a[232:235], v[104:107], v[52:55]
    v_mfma_f32_16x16x32_bf16 v[56:59], v[104:107], v[168:171], v[56:59]
    v_mfma_f32_16x16x32_bf16 v[60:63], v[104:107], v[232:235], v[60:63]
    ds_read_b128 v[104:107], v29 offset:26624
    s_waitcnt lgkmcnt(15)
    v_mfma_f32_16x16x32_bf16 v[40:43], a[44:47], v[108:111], v[40:43]
    v_mfma_f32_16x16x32_bf16 v[44:47], a[108:111], v[108:111], v[44:47]
    v_mfma_f32_16x16x32_bf16 v[48:51], a[172:175], v[108:111], v[48:51]
    v_mfma_f32_16x16x32_bf16 v[52:55], a[236:239], v[108:111], v[52:55]
    v_mfma_f32_16x16x32_bf16 v[56:59], v[108:111], v[172:175], v[56:59]
    v_mfma_f32_16x16x32_bf16 v[60:63], v[108:111], v[236:239], v[60:63]
    ds_read_b128 v[108:111], v29 offset:27648
    s_waitcnt lgkmcnt(15)
    v_mfma_f32_16x16x32_bf16 v[40:43], a[48:51], v[112:115], v[40:43]
    v_mfma_f32_16x16x32_bf16 v[44:47], a[112:115], v[112:115], v[44:47]
    v_mfma_f32_16x16x32_bf16 v[48:51], a[176:179], v[112:115], v[48:51]
    v_mfma_f32_16x16x32_bf16 v[52:55], a[240:243], v[112:115], v[52:55]
    v_mfma_f32_16x16x32_bf16 v[56:59], v[112:115], v[176:179], v[56:59]
    v_mfma_f32_16x16x32_bf16 v[60:63], v[112:115], v[240:243], v[60:63]
    ds_read_b128 v[112:115], v29 offset:28672
    s_waitcnt lgkmcnt(15)
    v_mfma_f32_16x16x32_bf16 v[40:43], a[52:55], v[116:119], v[40:43]
    v_mfma_f32_16x16x32_bf16 v[44:47], a[116:119], v[116:119], v[44:47]
    v_mfma_f32_16x16x32_bf16 v[48:51], a[180:183], v[116:119], v[48:51]
    v_mfma_f32_16x16x32_bf16 v[52:55], a[244:247], v[116:119], v[52:55]
    v_mfma_f32_16x16x32_bf16 v[56:59], v[116:119], v[180:183], v[56:59]
    v_mfma_f32_16x16x32_bf16 v[60:63], v[116:119], v[244:247], v[60:63]
    ds_read_b128 v[116:119], v29 offset:29696
    s_waitcnt lgkmcnt(15)
    v_mfma_f32_16x16x32_bf16 v[40:43], a[56:59], v[120:123], v[40:43]
    v_mfma_f32_16x16x32_bf16 v[44:47], a[120:123], v[120:123], v[44:47]
    v_mfma_f32_16x16x32_bf16 v[48:51], a[184:187], v[120:123], v[48:51]
    v_mfma_f32_16x16x32_bf16 v[52:55], a[248:251], v[120:123], v[52:55]
    v_mfma_f32_16x16x32_bf16 v[56:59], v[120:123], v[184:187], v[56:59]
    v_mfma_f32_16x16x32_bf16 v[60:63], v[120:123], v[248:251], v[60:63]
    ds_read_b128 v[120:123], v29 offset:30720
    s_waitcnt lgkmcnt(15)
    v_mfma_f32_16x16x32_bf16 v[40:43], a[60:63], v[124:127], v[40:43]
    v_mfma_f32_16x16x32_bf16 v[44:47], a[124:127], v[124:127], v[44:47]
    v_mfma_f32_16x16x32_bf16 v[48:51], a[188:191], v[124:127], v[48:51]
    v_mfma_f32_16x16x32_bf16 v[52:55], a[252:255], v[124:127], v[52:55]
    v_mfma_f32_16x16x32_bf16 v[56:59], v[124:127], v[188:191], v[56:59]
    v_mfma_f32_16x16x32_bf16 v[60:63], v[124:127], v[252:255], v[60:63]
    ds_read_b128 v[124:127], v29 offset:31744
    s_nop 7
    v_cvt_pk_bf16_f32 v12, v40, v41
    v_cvt_pk_bf16_f32 v13, v42, v43
    v_cvt_pk_bf16_f32 v14, v44, v45
    v_cvt_pk_bf16_f32 v15, v46, v47
    buffer_store_dwordx4 v[12:15], v9, s[24:27], s35 offen offset:0 sc1
    v_cvt_pk_bf16_f32 v16, v48, v49
    v_cvt_pk_bf16_f32 v17, v50, v51
    v_cvt_pk_bf16_f32 v18, v52, v53
    v_cvt_pk_bf16_f32 v19, v54, v55
    buffer_store_dwordx4 v[16:19], v9, s[24:27], s37 offen offset:0 sc1
    v_cvt_pk_bf16_f32 v20, v56, v57
    v_cvt_pk_bf16_f32 v21, v58, v59
    v_cvt_pk_bf16_f32 v24, v60, v61
    v_cvt_pk_bf16_f32 v25, v62, v63
    s_nop 1
    s_waitcnt lgkmcnt(15)
    v_mfma_f32_16x16x32_bf16 v[40:43], a[0:3], v[64:67], 0
    v_mfma_f32_16x16x32_bf16 v[44:47], a[64:67], v[64:67], 0
    v_mfma_f32_16x16x32_bf16 v[48:51], a[128:131], v[64:67], 0
    v_mfma_f32_16x16x32_bf16 v[52:55], a[192:195], v[64:67], 0
    v_mfma_f32_16x16x32_bf16 v[56:59], v[64:67], v[128:131], 0
    v_mfma_f32_16x16x32_bf16 v[60:63], v[64:67], v[192:195], 0
    ds_read_b128 v[64:67], v29 offset:32768
    s_waitcnt lgkmcnt(15)
    v_mfma_f32_16x16x32_bf16 v[40:43], a[4:7], v[68:71], v[40:43]
    v_mfma_f32_16x16x32_bf16 v[44:47], a[68:71], v[68:71], v[44:47]
    v_mfma_f32_16x16x32_bf16 v[48:51], a[132:135], v[68:71], v[48:51]
    v_mfma_f32_16x16x32_bf16 v[52:55], a[196:199], v[68:71], v[52:55]
    v_mfma_f32_16x16x32_bf16 v[56:59], v[68:71], v[132:135], v[56:59]
    v_mfma_f32_16x16x32_bf16 v[60:63], v[68:71], v[196:199], v[60:63]
    ds_read_b128 v[68:71], v29 offset:33792
    s_waitcnt lgkmcnt(15)
    v_mfma_f32_16x16x32_bf16 v[40:43], a[8:11], v[72:75], v[40:43]
    v_mfma_f32_16x16x32_bf16 v[44:47], a[72:75], v[72:75], v[44:47]
    v_mfma_f32_16x16x32_bf16 v[48:51], a[136:139], v[72:75], v[48:51]
    v_mfma_f32_16x16x32_bf16 v[52:55], a[200:203], v[72:75], v[52:55]
    v_mfma_f32_16x16x32_bf16 v[56:59], v[72:75], v[136:139], v[56:59]
    v_mfma_f32_16x16x32_bf16 v[60:63], v[72:75], v[200:203], v[60:63]
    ds_read_b128 v[72:75], v29 offset:34816
    s_waitcnt lgkmcnt(15)
    v_mfma_f32_16x16x32_bf16 v[40:43], a[12:15], v[76:79], v[40:43]
    v_mfma_f32_16x16x32_bf16 v[44:47], a[76:79], v[76:79], v[44:47]
    v_mfma_f32_16x16x32_bf16 v[48:51], a[140:143], v[76:79], v[48:51]
    v_mfma_f32_16x16x32_bf16 v[52:55], a[204:207], v[76:79], v[52:55]
    v_mfma_f32_16x16x32_bf16 v[56:59], v[76:79], v[140:143], v[56:59]
    v_mfma_f32_16x16x32_bf16 v[60:63], v[76:79], v[204:207], v[60:63]
    ds_read_b128 v[76:79], v29 offset:35840
    s_waitcnt lgkmcnt(15)
    v_mfma_f32_16x16x32_bf16 v[40:43], a[16:19], v[80:83], v[40:43]
    v_mfma_f32_16x16x32_bf16 v[44:47], a[80:83], v[80:83], v[44:47]
    v_mfma_f32_16x16x32_bf16 v[48:51], a[144:147], v[80:83], v[48:51]
    v_mfma_f32_16x16x32_bf16 v[52:55], a[208:211], v[80:83], v[52:55]
    v_mfma_f32_16x16x32_bf16 v[56:59], v[80:83], v[144:147], v[56:59]
    v_mfma_f32_16x16x32_bf16 v[60:63], v[80:83], v[208:211], v[60:63]
    ds_read_b128 v[80:83], v29 offset:36864
    s_waitcnt lgkmcnt(15)
    v_mfma_f32_16x16x32_bf16 v[40:43], a[20:23], v[84:87], v[40:43]
    v_mfma_f32_16x16x32_bf16 v[44:47], a[84:87], v[84:87], v[44:47]
    v_mfma_f32_16x16x32_bf16 v[48:51], a[148:151], v[84:87], v[48:51]
    v_mfma_f32_16x16x32_bf16 v[52:55], a[212:215], v[84:87], v[52:55]
    v_mfma_f32_16x16x32_bf16 v[56:59], v[84:87], v[148:151], v[56:59]
    v_mfma_f32_16x16x32_bf16 v[60:63], v[84:87], v[212:215], v[60:63]
    ds_read_b128 v[84:87], v29 offset:37888
    s_waitcnt lgkmcnt(15)
    v_mfma_f32_16x16x32_bf16 v[40:43], a[24:27], v[88:91], v[40:43]
    v_mfma_f32_16x16x32_bf16 v[44:47], a[88:91], v[88:91], v[44:47]
    v_mfma_f32_16x16x32_bf16 v[48:51], a[152:155], v[88:91], v[48:51]
    v_mfma_f32_16x16x32_bf16 v[52:55], a[216:219], v[88:91], v[52:55]
    v_mfma_f32_16x16x32_bf16 v[56:59], v[88:91], v[152:155], v[56:59]
    v_mfma_f32_16x16x32_bf16 v[60:63], v[88:91], v[216:219], v[60:63]
    ds_read_b128 v[88:91], v29 offset:38912
    s_waitcnt lgkmcnt(15)
    v_mfma_f32_16x16x32_bf16 v[40:43], a[28:31], v[92:95], v[40:43]
    v_mfma_f32_16x16x32_bf16 v[44:47], a[92:95], v[92:95], v[44:47]
    v_mfma_f32_16x16x32_bf16 v[48:51], a[156:159], v[92:95], v[48:51]
    v_mfma_f32_16x16x32_bf16 v[52:55], a[220:223], v[92:95], v[52:55]
    v_mfma_f32_16x16x32_bf16 v[56:59], v[92:95], v[156:159], v[56:59]
    v_mfma_f32_16x16x32_bf16 v[60:63], v[92:95], v[220:223], v[60:63]
    ds_read_b128 v[92:95], v29 offset:39936
    s_waitcnt lgkmcnt(15)
    v_mfma_f32_16x16x32_bf16 v[40:43], a[32:35], v[96:99], v[40:43]
    v_mfma_f32_16x16x32_bf16 v[44:47], a[96:99], v[96:99], v[44:47]
    v_mfma_f32_16x16x32_bf16 v[48:51], a[160:163], v[96:99], v[48:51]
    v_mfma_f32_16x16x32_bf16 v[52:55], a[224:227], v[96:99], v[52:55]
    v_mfma_f32_16x16x32_bf16 v[56:59], v[96:99], v[160:163], v[56:59]
    v_mfma_f32_16x16x32_bf16 v[60:63], v[96:99], v[224:227], v[60:63]
    ds_read_b128 v[96:99], v29 offset:40960
    s_waitcnt lgkmcnt(15)
    v_mfma_f32_16x16x32_bf16 v[40:43], a[36:39], v[100:103], v[40:43]
    v_mfma_f32_16x16x32_bf16 v[44:47], a[100:103], v[100:103], v[44:47]
    v_mfma_f32_16x16x32_bf16 v[48:51], a[164:167], v[100:103], v[48:51]
    v_mfma_f32_16x16x32_bf16 v[52:55], a[228:231], v[100:103], v[52:55]
    v_mfma_f32_16x16x32_bf16 v[56:59], v[100:103], v[164:167], v[56:59]
    v_mfma_f32_16x16x32_bf16 v[60:63], v[100:103], v[228:231], v[60:63]
    ds_read_b128 v[100:103], v29 offset:41984
    s_waitcnt lgkmcnt(15)
    v_mfma_f32_16x16x32_bf16 v[40:43], a[40:43], v[104:107], v[40:43]
    v_mfma_f32_16x16x32_bf16 v[44:47], a[104:107], v[104:107], v[44:47]
    v_mfma_f32_16x16x32_bf16 v[48:51], a[168:171], v[104:107], v[48:51]
    v_mfma_f32_16x16x32_bf16 v[52:55], a[232:235], v[104:107], v[52:55]
    v_mfma_f32_16x16x32_bf16 v[56:59], v[104:107], v[168:171], v[56:59]
    v_mfma_f32_16x16x32_bf16 v[60:63], v[104:107], v[232:235], v[60:63]
    ds_read_b128 v[104:107], v29 offset:43008
    s_waitcnt lgkmcnt(15)
    v_mfma_f32_16x16x32_bf16 v[40:43], a[44:47], v[108:111], v[40:43]
    v_mfma_f32_16x16x32_bf16 v[44:47], a[108:111], v[108:111], v[44:47]
    v_mfma_f32_16x16x32_bf16 v[48:51], a[172:175], v[108:111], v[48:51]
    v_mfma_f32_16x16x32_bf16 v[52:55], a[236:239], v[108:111], v[52:55]
    v_mfma_f32_16x16x32_bf16 v[56:59], v[108:111], v[172:175], v[56:59]
    v_mfma_f32_16x16x32_bf16 v[60:63], v[108:111], v[236:239], v[60:63]
    ds_read_b128 v[108:111], v29 offset:44032
    s_waitcnt lgkmcnt(15)
    v_mfma_f32_16x16x32_bf16 v[40:43], a[48:51], v[112:115], v[40:43]
    v_mfma_f32_16x16x32_bf16 v[44:47], a[112:115], v[112:115], v[44:47]
    v_mfma_f32_16x16x32_bf16 v[48:51], a[176:179], v[112:115], v[48:51]
    v_mfma_f32_16x16x32_bf16 v[52:55], a[240:243], v[112:115], v[52:55]
    v_mfma_f32_16x16x32_bf16 v[56:59], v[112:115], v[176:179], v[56:59]
    v_mfma_f32_16x16x32_bf16 v[60:63], v[112:115], v[240:243], v[60:63]
    ds_read_b128 v[112:115], v29 offset:45056
    s_waitcnt lgkmcnt(15)
    v_mfma_f32_16x16x32_bf16 v[40:43], a[52:55], v[116:119], v[40:43]
    v_mfma_f32_16x16x32_bf16 v[44:47], a[116:119], v[116:119], v[44:47]
    v_mfma_f32_16x16x32_bf16 v[48:51], a[180:183], v[116:119], v[48:51]
    v_mfma_f32_16x16x32_bf16 v[52:55], a[244:247], v[116:119], v[52:55]
    v_mfma_f32_16x16x32_bf16 v[56:59], v[116:119], v[180:183], v[56:59]
    v_mfma_f32_16x16x32_bf16 v[60:63], v[116:119], v[244:247], v[60:63]
    ds_read_b128 v[116:119], v29 offset:46080
    s_waitcnt lgkmcnt(15)
    v_mfma_f32_16x16x32_bf16 v[40:43], a[56:59], v[120:123], v[40:43]
    v_mfma_f32_16x16x32_bf16 v[44:47], a[120:123], v[120:123], v[44:47]
    v_mfma_f32_16x16x32_bf16 v[48:51], a[184:187], v[120:123], v[48:51]
    v_mfma_f32_16x16x32_bf16 v[52:55], a[248:251], v[120:123], v[52:55]
    v_mfma_f32_16x16x32_bf16 v[56:59], v[120:123], v[184:187], v[56:59]
    v_mfma_f32_16x16x32_bf16 v[60:63], v[120:123], v[248:251], v[60:63]
    ds_read_b128 v[120:123], v29 offset:47104
    s_waitcnt lgkmcnt(15)
    v_mfma_f32_16x16x32_bf16 v[40:43], a[60:63], v[124:127], v[40:43]
    v_mfma_f32_16x16x32_bf16 v[44:47], a[124:127], v[124:127], v[44:47]
    v_mfma_f32_16x16x32_bf16 v[48:51], a[188:191], v[124:127], v[48:51]
    v_mfma_f32_16x16x32_bf16 v[52:55], a[252:255], v[124:127], v[52:55]
    v_mfma_f32_16x16x32_bf16 v[56:59], v[124:127], v[188:191], v[56:59]
    v_mfma_f32_16x16x32_bf16 v[60:63], v[124:127], v[252:255], v[60:63]
    ds_read_b128 v[124:127], v29 offset:48128
    s_nop 7
    v_cvt_pk_bf16_f32 v12, v40, v41
    v_cvt_pk_bf16_f32 v13, v42, v43
    v_cvt_pk_bf16_f32 v14, v44, v45
    v_cvt_pk_bf16_f32 v15, v46, v47
    buffer_store_dwordx4 v[12:15], v9, s[24:27], s35 offen offset:1024 sc1
    v_cvt_pk_bf16_f32 v16, v48, v49
    v_cvt_pk_bf16_f32 v17, v50, v51
    v_cvt_pk_bf16_f32 v18, v52, v53
    v_cvt_pk_bf16_f32 v19, v54, v55
    buffer_store_dwordx4 v[16:19], v9, s[24:27], s37 offen offset:1024 sc1
    v_cvt_pk_bf16_f32 v22, v56, v57
    v_cvt_pk_bf16_f32 v23, v58, v59
    v_cvt_pk_bf16_f32 v26, v60, v61
    v_cvt_pk_bf16_f32 v27, v62, v63
    buffer_store_dwordx4 v[20:23], v10, s[24:27], s36 offen sc1
    buffer_store_dwordx4 v[24:27], v10, s[24:27], s36 offen offset:256 sc1
    s_add_u32 s35, s35, 0x40000
    s_add_u32 s36, s36, 0x40000
    s_add_u32 s37, s37, 0x40000
    s_nop 1
    s_waitcnt lgkmcnt(15)
    v_mfma_f32_16x16x32_bf16 v[40:43], a[0:3], v[64:67], 0
    v_mfma_f32_16x16x32_bf16 v[44:47], a[64:67], v[64:67], 0
    v_mfma_f32_16x16x32_bf16 v[48:51], a[128:131], v[64:67], 0
    v_mfma_f32_16x16x32_bf16 v[52:55], a[192:195], v[64:67], 0
    v_mfma_f32_16x16x32_bf16 v[56:59], v[64:67], v[128:131], 0
    v_mfma_f32_16x16x32_bf16 v[60:63], v[64:67], v[192:195], 0
    ds_read_b128 v[64:67], v29 offset:49152
    s_waitcnt lgkmcnt(15)
    v_mfma_f32_16x16x32_bf16 v[40:43], a[4:7], v[68:71], v[40:43]
    v_mfma_f32_16x16x32_bf16 v[44:47], a[68:71], v[68:71], v[44:47]
    v_mfma_f32_16x16x32_bf16 v[48:51], a[132:135], v[68:71], v[48:51]
    v_mfma_f32_16x16x32_bf16 v[52:55], a[196:199], v[68:71], v[52:55]
    v_mfma_f32_16x16x32_bf16 v[56:59], v[68:71], v[132:135], v[56:59]
    v_mfma_f32_16x16x32_bf16 v[60:63], v[68:71], v[196:199], v[60:63]
    ds_read_b128 v[68:71], v29 offset:50176
    s_waitcnt lgkmcnt(15)
    v_mfma_f32_16x16x32_bf16 v[40:43], a[8:11], v[72:75], v[40:43]
    v_mfma_f32_16x16x32_bf16 v[44:47], a[72:75], v[72:75], v[44:47]
    v_mfma_f32_16x16x32_bf16 v[48:51], a[136:139], v[72:75], v[48:51]
    v_mfma_f32_16x16x32_bf16 v[52:55], a[200:203], v[72:75], v[52:55]
    v_mfma_f32_16x16x32_bf16 v[56:59], v[72:75], v[136:139], v[56:59]
    v_mfma_f32_16x16x32_bf16 v[60:63], v[72:75], v[200:203], v[60:63]
    ds_read_b128 v[72:75], v29 offset:51200
    s_waitcnt lgkmcnt(15)
    v_mfma_f32_16x16x32_bf16 v[40:43], a[12:15], v[76:79], v[40:43]
    v_mfma_f32_16x16x32_bf16 v[44:47], a[76:79], v[76:79], v[44:47]
    v_mfma_f32_16x16x32_bf16 v[48:51], a[140:143], v[76:79], v[48:51]
    v_mfma_f32_16x16x32_bf16 v[52:55], a[204:207], v[76:79], v[52:55]
    v_mfma_f32_16x16x32_bf16 v[56:59], v[76:79], v[140:143], v[56:59]
    v_mfma_f32_16x16x32_bf16 v[60:63], v[76:79], v[204:207], v[60:63]
    ds_read_b128 v[76:79], v29 offset:52224
    s_waitcnt lgkmcnt(15)
    v_mfma_f32_16x16x32_bf16 v[40:43], a[16:19], v[80:83], v[40:43]
    v_mfma_f32_16x16x32_bf16 v[44:47], a[80:83], v[80:83], v[44:47]
    v_mfma_f32_16x16x32_bf16 v[48:51], a[144:147], v[80:83], v[48:51]
    v_mfma_f32_16x16x32_bf16 v[52:55], a[208:211], v[80:83], v[52:55]
    v_mfma_f32_16x16x32_bf16 v[56:59], v[80:83], v[144:147], v[56:59]
    v_mfma_f32_16x16x32_bf16 v[60:63], v[80:83], v[208:211], v[60:63]
    ds_read_b128 v[80:83], v29 offset:53248
    s_waitcnt lgkmcnt(15)
    v_mfma_f32_16x16x32_bf16 v[40:43], a[20:23], v[84:87], v[40:43]
    v_mfma_f32_16x16x32_bf16 v[44:47], a[84:87], v[84:87], v[44:47]
    v_mfma_f32_16x16x32_bf16 v[48:51], a[148:151], v[84:87], v[48:51]
    v_mfma_f32_16x16x32_bf16 v[52:55], a[212:215], v[84:87], v[52:55]
    v_mfma_f32_16x16x32_bf16 v[56:59], v[84:87], v[148:151], v[56:59]
    v_mfma_f32_16x16x32_bf16 v[60:63], v[84:87], v[212:215], v[60:63]
    ds_read_b128 v[84:87], v29 offset:54272
    s_waitcnt lgkmcnt(15)
    v_mfma_f32_16x16x32_bf16 v[40:43], a[24:27], v[88:91], v[40:43]
    v_mfma_f32_16x16x32_bf16 v[44:47], a[88:91], v[88:91], v[44:47]
    v_mfma_f32_16x16x32_bf16 v[48:51], a[152:155], v[88:91], v[48:51]
    v_mfma_f32_16x16x32_bf16 v[52:55], a[216:219], v[88:91], v[52:55]
    v_mfma_f32_16x16x32_bf16 v[56:59], v[88:91], v[152:155], v[56:59]
    v_mfma_f32_16x16x32_bf16 v[60:63], v[88:91], v[216:219], v[60:63]
    ds_read_b128 v[88:91], v29 offset:55296
    s_waitcnt lgkmcnt(15)
    v_mfma_f32_16x16x32_bf16 v[40:43], a[28:31], v[92:95], v[40:43]
    v_mfma_f32_16x16x32_bf16 v[44:47], a[92:95], v[92:95], v[44:47]
    v_mfma_f32_16x16x32_bf16 v[48:51], a[156:159], v[92:95], v[48:51]
    v_mfma_f32_16x16x32_bf16 v[52:55], a[220:223], v[92:95], v[52:55]
    v_mfma_f32_16x16x32_bf16 v[56:59], v[92:95], v[156:159], v[56:59]
    v_mfma_f32_16x16x32_bf16 v[60:63], v[92:95], v[220:223], v[60:63]
    ds_read_b128 v[92:95], v29 offset:56320
    s_waitcnt lgkmcnt(15)
    v_mfma_f32_16x16x32_bf16 v[40:43], a[32:35], v[96:99], v[40:43]
    v_mfma_f32_16x16x32_bf16 v[44:47], a[96:99], v[96:99], v[44:47]
    v_mfma_f32_16x16x32_bf16 v[48:51], a[160:163], v[96:99], v[48:51]
    v_mfma_f32_16x16x32_bf16 v[52:55], a[224:227], v[96:99], v[52:55]
    v_mfma_f32_16x16x32_bf16 v[56:59], v[96:99], v[160:163], v[56:59]
    v_mfma_f32_16x16x32_bf16 v[60:63], v[96:99], v[224:227], v[60:63]
    ds_read_b128 v[96:99], v29 offset:57344
    s_waitcnt lgkmcnt(15)
    v_mfma_f32_16x16x32_bf16 v[40:43], a[36:39], v[100:103], v[40:43]
    v_mfma_f32_16x16x32_bf16 v[44:47], a[100:103], v[100:103], v[44:47]
    v_mfma_f32_16x16x32_bf16 v[48:51], a[164:167], v[100:103], v[48:51]
    v_mfma_f32_16x16x32_bf16 v[52:55], a[228:231], v[100:103], v[52:55]
    v_mfma_f32_16x16x32_bf16 v[56:59], v[100:103], v[164:167], v[56:59]
    v_mfma_f32_16x16x32_bf16 v[60:63], v[100:103], v[228:231], v[60:63]
    ds_read_b128 v[100:103], v29 offset:58368
    s_waitcnt lgkmcnt(15)
    v_mfma_f32_16x16x32_bf16 v[40:43], a[40:43], v[104:107], v[40:43]
    v_mfma_f32_16x16x32_bf16 v[44:47], a[104:107], v[104:107], v[44:47]
    v_mfma_f32_16x16x32_bf16 v[48:51], a[168:171], v[104:107], v[48:51]
    v_mfma_f32_16x16x32_bf16 v[52:55], a[232:235], v[104:107], v[52:55]
    v_mfma_f32_16x16x32_bf16 v[56:59], v[104:107], v[168:171], v[56:59]
    v_mfma_f32_16x16x32_bf16 v[60:63], v[104:107], v[232:235], v[60:63]
    ds_read_b128 v[104:107], v29 offset:59392
    s_waitcnt lgkmcnt(15)
    v_mfma_f32_16x16x32_bf16 v[40:43], a[44:47], v[108:111], v[40:43]
    v_mfma_f32_16x16x32_bf16 v[44:47], a[108:111], v[108:111], v[44:47]
    v_mfma_f32_16x16x32_bf16 v[48:51], a[172:175], v[108:111], v[48:51]
    v_mfma_f32_16x16x32_bf16 v[52:55], a[236:239], v[108:111], v[52:55]
    v_mfma_f32_16x16x32_bf16 v[56:59], v[108:111], v[172:175], v[56:59]
    v_mfma_f32_16x16x32_bf16 v[60:63], v[108:111], v[236:239], v[60:63]
    ds_read_b128 v[108:111], v29 offset:60416
    s_waitcnt lgkmcnt(15)
    v_mfma_f32_16x16x32_bf16 v[40:43], a[48:51], v[112:115], v[40:43]
    v_mfma_f32_16x16x32_bf16 v[44:47], a[112:115], v[112:115], v[44:47]
    v_mfma_f32_16x16x32_bf16 v[48:51], a[176:179], v[112:115], v[48:51]
    v_mfma_f32_16x16x32_bf16 v[52:55], a[240:243], v[112:115], v[52:55]
    v_mfma_f32_16x16x32_bf16 v[56:59], v[112:115], v[176:179], v[56:59]
    v_mfma_f32_16x16x32_bf16 v[60:63], v[112:115], v[240:243], v[60:63]
    ds_read_b128 v[112:115], v29 offset:61440
    s_waitcnt lgkmcnt(15)
    v_mfma_f32_16x16x32_bf16 v[40:43], a[52:55], v[116:119], v[40:43]
    v_mfma_f32_16x16x32_bf16 v[44:47], a[116:119], v[116:119], v[44:47]
    v_mfma_f32_16x16x32_bf16 v[48:51], a[180:183], v[116:119], v[48:51]
    v_mfma_f32_16x16x32_bf16 v[52:55], a[244:247], v[116:119], v[52:55]
    v_mfma_f32_16x16x32_bf16 v[56:59], v[116:119], v[180:183], v[56:59]
    v_mfma_f32_16x16x32_bf16 v[60:63], v[116:119], v[244:247], v[60:63]
    ds_read_b128 v[116:119], v29 offset:62464
    s_waitcnt lgkmcnt(15)
    v_mfma_f32_16x16x32_bf16 v[40:43], a[56:59], v[120:123], v[40:43]
    v_mfma_f32_16x16x32_bf16 v[44:47], a[120:123], v[120:123], v[44:47]
    v_mfma_f32_16x16x32_bf16 v[48:51], a[184:187], v[120:123], v[48:51]
    v_mfma_f32_16x16x32_bf16 v[52:55], a[248:251], v[120:123], v[52:55]
    v_mfma_f32_16x16x32_bf16 v[56:59], v[120:123], v[184:187], v[56:59]
    v_mfma_f32_16x16x32_bf16 v[60:63], v[120:123], v[248:251], v[60:63]
    ds_read_b128 v[120:123], v29 offset:63488
    s_waitcnt lgkmcnt(15)
    v_mfma_f32_16x16x32_bf16 v[40:43], a[60:63], v[124:127], v[40:43]
    v_mfma_f32_16x16x32_bf16 v[44:47], a[124:127], v[124:127], v[44:47]
    v_mfma_f32_16x16x32_bf16 v[48:51], a[188:191], v[124:127], v[48:51]
    v_mfma_f32_16x16x32_bf16 v[52:55], a[252:255], v[124:127], v[52:55]
    v_mfma_f32_16x16x32_bf16 v[56:59], v[124:127], v[188:191], v[56:59]
    v_mfma_f32_16x16x32_bf16 v[60:63], v[124:127], v[252:255], v[60:63]
    ds_read_b128 v[124:127], v29 offset:64512
    s_waitcnt vmcnt(0)
    s_mov_b64 exec, 1
    buffer_store_byte v28, off, s[24:27], s38 sc1
    s_mov_b64 exec, -1
    s_add_u32 s38, s38, 4
    s_nop 7
    v_cvt_pk_bf16_f32 v12, v40, v41
    v_cvt_pk_bf16_f32 v13, v42, v43
    v_cvt_pk_bf16_f32 v14, v44, v45
    v_cvt_pk_bf16_f32 v15, v46, v47
    buffer_store_dwordx4 v[12:15], v9, s[24:27], s35 offen offset:0 sc1
    v_cvt_pk_bf16_f32 v16, v48, v49
    v_cvt_pk_bf16_f32 v17, v50, v51
    v_cvt_pk_bf16_f32 v18, v52, v53
    v_cvt_pk_bf16_f32 v19, v54, v55
    buffer_store_dwordx4 v[16:19], v9, s[24:27], s37 offen offset:0 sc1
    v_cvt_pk_bf16_f32 v20, v56, v57
    v_cvt_pk_bf16_f32 v21, v58, v59
    v_cvt_pk_bf16_f32 v24, v60, v61
    v_cvt_pk_bf16_f32 v25, v62, v63
    s_nop 1
    s_waitcnt lgkmcnt(15)
    v_mfma_f32_16x16x32_bf16 v[40:43], a[0:3], v[64:67], 0
    v_mfma_f32_16x16x32_bf16 v[44:47], a[64:67], v[64:67], 0
    v_mfma_f32_16x16x32_bf16 v[48:51], a[128:131], v[64:67], 0
    v_mfma_f32_16x16x32_bf16 v[52:55], a[192:195], v[64:67], 0
    v_mfma_f32_16x16x32_bf16 v[56:59], v[64:67], v[128:131], 0
    v_mfma_f32_16x16x32_bf16 v[60:63], v[64:67], v[192:195], 0
    ds_read_b128 v[64:67], v31 offset:0
    s_waitcnt lgkmcnt(15)
    v_mfma_f32_16x16x32_bf16 v[40:43], a[4:7], v[68:71], v[40:43]
    v_mfma_f32_16x16x32_bf16 v[44:47], a[68:71], v[68:71], v[44:47]
    v_mfma_f32_16x16x32_bf16 v[48:51], a[132:135], v[68:71], v[48:51]
    v_mfma_f32_16x16x32_bf16 v[52:55], a[196:199], v[68:71], v[52:55]
    v_mfma_f32_16x16x32_bf16 v[56:59], v[68:71], v[132:135], v[56:59]
    v_mfma_f32_16x16x32_bf16 v[60:63], v[68:71], v[196:199], v[60:63]
    ds_read_b128 v[68:71], v31 offset:1024
    s_waitcnt lgkmcnt(15)
    v_mfma_f32_16x16x32_bf16 v[40:43], a[8:11], v[72:75], v[40:43]
    v_mfma_f32_16x16x32_bf16 v[44:47], a[72:75], v[72:75], v[44:47]
    v_mfma_f32_16x16x32_bf16 v[48:51], a[136:139], v[72:75], v[48:51]
    v_mfma_f32_16x16x32_bf16 v[52:55], a[200:203], v[72:75], v[52:55]
    v_mfma_f32_16x16x32_bf16 v[56:59], v[72:75], v[136:139], v[56:59]
    v_mfma_f32_16x16x32_bf16 v[60:63], v[72:75], v[200:203], v[60:63]
    ds_read_b128 v[72:75], v31 offset:2048
    s_waitcnt lgkmcnt(15)
    v_mfma_f32_16x16x32_bf16 v[40:43], a[12:15], v[76:79], v[40:43]
    v_mfma_f32_16x16x32_bf16 v[44:47], a[76:79], v[76:79], v[44:47]
    v_mfma_f32_16x16x32_bf16 v[48:51], a[140:143], v[76:79], v[48:51]
    v_mfma_f32_16x16x32_bf16 v[52:55], a[204:207], v[76:79], v[52:55]
    v_mfma_f32_16x16x32_bf16 v[56:59], v[76:79], v[140:143], v[56:59]
    v_mfma_f32_16x16x32_bf16 v[60:63], v[76:79], v[204:207], v[60:63]
    ds_read_b128 v[76:79], v31 offset:3072
    s_waitcnt lgkmcnt(15)
    v_mfma_f32_16x16x32_bf16 v[40:43], a[16:19], v[80:83], v[40:43]
    v_mfma_f32_16x16x32_bf16 v[44:47], a[80:83], v[80:83], v[44:47]
    v_mfma_f32_16x16x32_bf16 v[48:51], a[144:147], v[80:83], v[48:51]
    v_mfma_f32_16x16x32_bf16 v[52:55], a[208:211], v[80:83], v[52:55]
    v_mfma_f32_16x16x32_bf16 v[56:59], v[80:83], v[144:147], v[56:59]
    v_mfma_f32_16x16x32_bf16 v[60:63], v[80:83], v[208:211], v[60:63]
    ds_read_b128 v[80:83], v31 offset:4096
    s_waitcnt lgkmcnt(15)
    v_mfma_f32_16x16x32_bf16 v[40:43], a[20:23], v[84:87], v[40:43]
    v_mfma_f32_16x16x32_bf16 v[44:47], a[84:87], v[84:87], v[44:47]
    v_mfma_f32_16x16x32_bf16 v[48:51], a[148:151], v[84:87], v[48:51]
    v_mfma_f32_16x16x32_bf16 v[52:55], a[212:215], v[84:87], v[52:55]
    v_mfma_f32_16x16x32_bf16 v[56:59], v[84:87], v[148:151], v[56:59]
    v_mfma_f32_16x16x32_bf16 v[60:63], v[84:87], v[212:215], v[60:63]
    ds_read_b128 v[84:87], v31 offset:5120
    s_waitcnt lgkmcnt(15)
    v_mfma_f32_16x16x32_bf16 v[40:43], a[24:27], v[88:91], v[40:43]
    v_mfma_f32_16x16x32_bf16 v[44:47], a[88:91], v[88:91], v[44:47]
    v_mfma_f32_16x16x32_bf16 v[48:51], a[152:155], v[88:91], v[48:51]
    v_mfma_f32_16x16x32_bf16 v[52:55], a[216:219], v[88:91], v[52:55]
    v_mfma_f32_16x16x32_bf16 v[56:59], v[88:91], v[152:155], v[56:59]
    v_mfma_f32_16x16x32_bf16 v[60:63], v[88:91], v[216:219], v[60:63]
    ds_read_b128 v[88:91], v31 offset:6144
    s_waitcnt lgkmcnt(15)
    v_mfma_f32_16x16x32_bf16 v[40:43], a[28:31], v[92:95], v[40:43]
    v_mfma_f32_16x16x32_bf16 v[44:47], a[92:95], v[92:95], v[44:47]
    v_mfma_f32_16x16x32_bf16 v[48:51], a[156:159], v[92:95], v[48:51]
    v_mfma_f32_16x16x32_bf16 v[52:55], a[220:223], v[92:95], v[52:55]
    v_mfma_f32_16x16x32_bf16 v[56:59], v[92:95], v[156:159], v[56:59]
    v_mfma_f32_16x16x32_bf16 v[60:63], v[92:95], v[220:223], v[60:63]
    ds_read_b128 v[92:95], v31 offset:7168
    s_waitcnt lgkmcnt(15)
    v_mfma_f32_16x16x32_bf16 v[40:43], a[32:35], v[96:99], v[40:43]
    v_mfma_f32_16x16x32_bf16 v[44:47], a[96:99], v[96:99], v[44:47]
    v_mfma_f32_16x16x32_bf16 v[48:51], a[160:163], v[96:99], v[48:51]
    v_mfma_f32_16x16x32_bf16 v[52:55], a[224:227], v[96:99], v[52:55]
    v_mfma_f32_16x16x32_bf16 v[56:59], v[96:99], v[160:163], v[56:59]
    v_mfma_f32_16x16x32_bf16 v[60:63], v[96:99], v[224:227], v[60:63]
    ds_read_b128 v[96:99], v31 offset:8192
    s_waitcnt lgkmcnt(15)
    v_mfma_f32_16x16x32_bf16 v[40:43], a[36:39], v[100:103], v[40:43]
    v_mfma_f32_16x16x32_bf16 v[44:47], a[100:103], v[100:103], v[44:47]
    v_mfma_f32_16x16x32_bf16 v[48:51], a[164:167], v[100:103], v[48:51]
    v_mfma_f32_16x16x32_bf16 v[52:55], a[228:231], v[100:103], v[52:55]
    v_mfma_f32_16x16x32_bf16 v[56:59], v[100:103], v[164:167], v[56:59]
    v_mfma_f32_16x16x32_bf16 v[60:63], v[100:103], v[228:231], v[60:63]
    ds_read_b128 v[100:103], v31 offset:9216
    s_waitcnt lgkmcnt(15)
    v_mfma_f32_16x16x32_bf16 v[40:43], a[40:43], v[104:107], v[40:43]
    v_mfma_f32_16x16x32_bf16 v[44:47], a[104:107], v[104:107], v[44:47]
    v_mfma_f32_16x16x32_bf16 v[48:51], a[168:171], v[104:107], v[48:51]
    v_mfma_f32_16x16x32_bf16 v[52:55], a[232:235], v[104:107], v[52:55]
    v_mfma_f32_16x16x32_bf16 v[56:59], v[104:107], v[168:171], v[56:59]
    v_mfma_f32_16x16x32_bf16 v[60:63], v[104:107], v[232:235], v[60:63]
    ds_read_b128 v[104:107], v31 offset:10240
    s_waitcnt lgkmcnt(15)
    v_mfma_f32_16x16x32_bf16 v[40:43], a[44:47], v[108:111], v[40:43]
    v_mfma_f32_16x16x32_bf16 v[44:47], a[108:111], v[108:111], v[44:47]
    v_mfma_f32_16x16x32_bf16 v[48:51], a[172:175], v[108:111], v[48:51]
    v_mfma_f32_16x16x32_bf16 v[52:55], a[236:239], v[108:111], v[52:55]
    v_mfma_f32_16x16x32_bf16 v[56:59], v[108:111], v[172:175], v[56:59]
    v_mfma_f32_16x16x32_bf16 v[60:63], v[108:111], v[236:239], v[60:63]
    ds_read_b128 v[108:111], v31 offset:11264
    s_waitcnt lgkmcnt(15)
    v_mfma_f32_16x16x32_bf16 v[40:43], a[48:51], v[112:115], v[40:43]
    v_mfma_f32_16x16x32_bf16 v[44:47], a[112:115], v[112:115], v[44:47]
    v_mfma_f32_16x16x32_bf16 v[48:51], a[176:179], v[112:115], v[48:51]
    v_mfma_f32_16x16x32_bf16 v[52:55], a[240:243], v[112:115], v[52:55]
    v_mfma_f32_16x16x32_bf16 v[56:59], v[112:115], v[176:179], v[56:59]
    v_mfma_f32_16x16x32_bf16 v[60:63], v[112:115], v[240:243], v[60:63]
    ds_read_b128 v[112:115], v31 offset:12288
    s_waitcnt lgkmcnt(15)
    v_mfma_f32_16x16x32_bf16 v[40:43], a[52:55], v[116:119], v[40:43]
    v_mfma_f32_16x16x32_bf16 v[44:47], a[116:119], v[116:119], v[44:47]
    v_mfma_f32_16x16x32_bf16 v[48:51], a[180:183], v[116:119], v[48:51]
    v_mfma_f32_16x16x32_bf16 v[52:55], a[244:247], v[116:119], v[52:55]
    v_mfma_f32_16x16x32_bf16 v[56:59], v[116:119], v[180:183], v[56:59]
    v_mfma_f32_16x16x32_bf16 v[60:63], v[116:119], v[244:247], v[60:63]
    ds_read_b128 v[116:119], v31 offset:13312
    s_waitcnt lgkmcnt(15)
    v_mfma_f32_16x16x32_bf16 v[40:43], a[56:59], v[120:123], v[40:43]
    v_mfma_f32_16x16x32_bf16 v[44:47], a[120:123], v[120:123], v[44:47]
    v_mfma_f32_16x16x32_bf16 v[48:51], a[184:187], v[120:123], v[48:51]
    v_mfma_f32_16x16x32_bf16 v[52:55], a[248:251], v[120:123], v[52:55]
    v_mfma_f32_16x16x32_bf16 v[56:59], v[120:123], v[184:187], v[56:59]
    v_mfma_f32_16x16x32_bf16 v[60:63], v[120:123], v[248:251], v[60:63]
    ds_read_b128 v[120:123], v31 offset:14336
    s_waitcnt lgkmcnt(15)
    v_mfma_f32_16x16x32_bf16 v[40:43], a[60:63], v[124:127], v[40:43]
    v_mfma_f32_16x16x32_bf16 v[44:47], a[124:127], v[124:127], v[44:47]
    v_mfma_f32_16x16x32_bf16 v[48:51], a[188:191], v[124:127], v[48:51]
    v_mfma_f32_16x16x32_bf16 v[52:55], a[252:255], v[124:127], v[52:55]
    v_mfma_f32_16x16x32_bf16 v[56:59], v[124:127], v[188:191], v[56:59]
    v_mfma_f32_16x16x32_bf16 v[60:63], v[124:127], v[252:255], v[60:63]
    ds_read_b128 v[124:127], v31 offset:15360
    s_nop 7
    v_cvt_pk_bf16_f32 v12, v40, v41
    v_cvt_pk_bf16_f32 v13, v42, v43
    v_cvt_pk_bf16_f32 v14, v44, v45
    v_cvt_pk_bf16_f32 v15, v46, v47
    buffer_store_dwordx4 v[12:15], v9, s[24:27], s35 offen offset:1024 sc1
    v_cvt_pk_bf16_f32 v16, v48, v49
    v_cvt_pk_bf16_f32 v17, v50, v51
    v_cvt_pk_bf16_f32 v18, v52, v53
    v_cvt_pk_bf16_f32 v19, v54, v55
    buffer_store_dwordx4 v[16:19], v9, s[24:27], s37 offen offset:1024 sc1
    v_cvt_pk_bf16_f32 v22, v56, v57
    v_cvt_pk_bf16_f32 v23, v58, v59
    v_cvt_pk_bf16_f32 v26, v60, v61
    v_cvt_pk_bf16_f32 v27, v62, v63
    buffer_store_dwordx4 v[20:23], v10, s[24:27], s36 offen sc1
    buffer_store_dwordx4 v[24:27], v10, s[24:27], s36 offen offset:256 sc1
    s_add_u32 s35, s35, 0x40000
    s_add_u32 s36, s36, 0x40000
    s_add_u32 s37, s37, 0x40000
    s_nop 1
    s_waitcnt lgkmcnt(15)
    v_mfma_f32_16x16x32_bf16 v[40:43], a[0:3], v[64:67], 0
    v_mfma_f32_16x16x32_bf16 v[44:47], a[64:67], v[64:67], 0
    v_mfma_f32_16x16x32_bf16 v[48:51], a[128:131], v[64:67], 0
    v_mfma_f32_16x16x32_bf16 v[52:55], a[192:195], v[64:67], 0
    v_mfma_f32_16x16x32_bf16 v[56:59], v[64:67], v[128:131], 0
    v_mfma_f32_16x16x32_bf16 v[60:63], v[64:67], v[192:195], 0
    ds_read_b128 v[64:67], v31 offset:16384
    s_waitcnt lgkmcnt(15)
    v_mfma_f32_16x16x32_bf16 v[40:43], a[4:7], v[68:71], v[40:43]
    v_mfma_f32_16x16x32_bf16 v[44:47], a[68:71], v[68:71], v[44:47]
    v_mfma_f32_16x16x32_bf16 v[48:51], a[132:135], v[68:71], v[48:51]
    v_mfma_f32_16x16x32_bf16 v[52:55], a[196:199], v[68:71], v[52:55]
    v_mfma_f32_16x16x32_bf16 v[56:59], v[68:71], v[132:135], v[56:59]
    v_mfma_f32_16x16x32_bf16 v[60:63], v[68:71], v[196:199], v[60:63]
    ds_read_b128 v[68:71], v31 offset:17408
    s_waitcnt lgkmcnt(15)
    v_mfma_f32_16x16x32_bf16 v[40:43], a[8:11], v[72:75], v[40:43]
    v_mfma_f32_16x16x32_bf16 v[44:47], a[72:75], v[72:75], v[44:47]
    v_mfma_f32_16x16x32_bf16 v[48:51], a[136:139], v[72:75], v[48:51]
    v_mfma_f32_16x16x32_bf16 v[52:55], a[200:203], v[72:75], v[52:55]
    v_mfma_f32_16x16x32_bf16 v[56:59], v[72:75], v[136:139], v[56:59]
    v_mfma_f32_16x16x32_bf16 v[60:63], v[72:75], v[200:203], v[60:63]
    ds_read_b128 v[72:75], v31 offset:18432
    s_waitcnt lgkmcnt(15)
    v_mfma_f32_16x16x32_bf16 v[40:43], a[12:15], v[76:79], v[40:43]
    v_mfma_f32_16x16x32_bf16 v[44:47], a[76:79], v[76:79], v[44:47]
    v_mfma_f32_16x16x32_bf16 v[48:51], a[140:143], v[76:79], v[48:51]
    v_mfma_f32_16x16x32_bf16 v[52:55], a[204:207], v[76:79], v[52:55]
    v_mfma_f32_16x16x32_bf16 v[56:59], v[76:79], v[140:143], v[56:59]
    v_mfma_f32_16x16x32_bf16 v[60:63], v[76:79], v[204:207], v[60:63]
    ds_read_b128 v[76:79], v31 offset:19456
    s_waitcnt lgkmcnt(15)
    v_mfma_f32_16x16x32_bf16 v[40:43], a[16:19], v[80:83], v[40:43]
    v_mfma_f32_16x16x32_bf16 v[44:47], a[80:83], v[80:83], v[44:47]
    v_mfma_f32_16x16x32_bf16 v[48:51], a[144:147], v[80:83], v[48:51]
    v_mfma_f32_16x16x32_bf16 v[52:55], a[208:211], v[80:83], v[52:55]
    v_mfma_f32_16x16x32_bf16 v[56:59], v[80:83], v[144:147], v[56:59]
    v_mfma_f32_16x16x32_bf16 v[60:63], v[80:83], v[208:211], v[60:63]
    ds_read_b128 v[80:83], v31 offset:20480
    s_waitcnt lgkmcnt(15)
    v_mfma_f32_16x16x32_bf16 v[40:43], a[20:23], v[84:87], v[40:43]
    v_mfma_f32_16x16x32_bf16 v[44:47], a[84:87], v[84:87], v[44:47]
    v_mfma_f32_16x16x32_bf16 v[48:51], a[148:151], v[84:87], v[48:51]
    v_mfma_f32_16x16x32_bf16 v[52:55], a[212:215], v[84:87], v[52:55]
    v_mfma_f32_16x16x32_bf16 v[56:59], v[84:87], v[148:151], v[56:59]
    v_mfma_f32_16x16x32_bf16 v[60:63], v[84:87], v[212:215], v[60:63]
    ds_read_b128 v[84:87], v31 offset:21504
    s_waitcnt lgkmcnt(15)
    v_mfma_f32_16x16x32_bf16 v[40:43], a[24:27], v[88:91], v[40:43]
    v_mfma_f32_16x16x32_bf16 v[44:47], a[88:91], v[88:91], v[44:47]
    v_mfma_f32_16x16x32_bf16 v[48:51], a[152:155], v[88:91], v[48:51]
    v_mfma_f32_16x16x32_bf16 v[52:55], a[216:219], v[88:91], v[52:55]
    v_mfma_f32_16x16x32_bf16 v[56:59], v[88:91], v[152:155], v[56:59]
    v_mfma_f32_16x16x32_bf16 v[60:63], v[88:91], v[216:219], v[60:63]
    ds_read_b128 v[88:91], v31 offset:22528
    s_waitcnt lgkmcnt(15)
    v_mfma_f32_16x16x32_bf16 v[40:43], a[28:31], v[92:95], v[40:43]
    v_mfma_f32_16x16x32_bf16 v[44:47], a[92:95], v[92:95], v[44:47]
    v_mfma_f32_16x16x32_bf16 v[48:51], a[156:159], v[92:95], v[48:51]
    v_mfma_f32_16x16x32_bf16 v[52:55], a[220:223], v[92:95], v[52:55]
    v_mfma_f32_16x16x32_bf16 v[56:59], v[92:95], v[156:159], v[56:59]
    v_mfma_f32_16x16x32_bf16 v[60:63], v[92:95], v[220:223], v[60:63]
    ds_read_b128 v[92:95], v31 offset:23552
    s_waitcnt lgkmcnt(15)
    v_mfma_f32_16x16x32_bf16 v[40:43], a[32:35], v[96:99], v[40:43]
    v_mfma_f32_16x16x32_bf16 v[44:47], a[96:99], v[96:99], v[44:47]
    v_mfma_f32_16x16x32_bf16 v[48:51], a[160:163], v[96:99], v[48:51]
    v_mfma_f32_16x16x32_bf16 v[52:55], a[224:227], v[96:99], v[52:55]
    v_mfma_f32_16x16x32_bf16 v[56:59], v[96:99], v[160:163], v[56:59]
    v_mfma_f32_16x16x32_bf16 v[60:63], v[96:99], v[224:227], v[60:63]
    ds_read_b128 v[96:99], v31 offset:24576
    s_waitcnt lgkmcnt(15)
    v_mfma_f32_16x16x32_bf16 v[40:43], a[36:39], v[100:103], v[40:43]
    v_mfma_f32_16x16x32_bf16 v[44:47], a[100:103], v[100:103], v[44:47]
    v_mfma_f32_16x16x32_bf16 v[48:51], a[164:167], v[100:103], v[48:51]
    v_mfma_f32_16x16x32_bf16 v[52:55], a[228:231], v[100:103], v[52:55]
    v_mfma_f32_16x16x32_bf16 v[56:59], v[100:103], v[164:167], v[56:59]
    v_mfma_f32_16x16x32_bf16 v[60:63], v[100:103], v[228:231], v[60:63]
    ds_read_b128 v[100:103], v31 offset:25600
    s_waitcnt lgkmcnt(15)
    v_mfma_f32_16x16x32_bf16 v[40:43], a[40:43], v[104:107], v[40:43]
    v_mfma_f32_16x16x32_bf16 v[44:47], a[104:107], v[104:107], v[44:47]
    v_mfma_f32_16x16x32_bf16 v[48:51], a[168:171], v[104:107], v[48:51]
    v_mfma_f32_16x16x32_bf16 v[52:55], a[232:235], v[104:107], v[52:55]
    v_mfma_f32_16x16x32_bf16 v[56:59], v[104:107], v[168:171], v[56:59]
    v_mfma_f32_16x16x32_bf16 v[60:63], v[104:107], v[232:235], v[60:63]
    ds_read_b128 v[104:107], v31 offset:26624
    s_waitcnt lgkmcnt(15)
    v_mfma_f32_16x16x32_bf16 v[40:43], a[44:47], v[108:111], v[40:43]
    v_mfma_f32_16x16x32_bf16 v[44:47], a[108:111], v[108:111], v[44:47]
    v_mfma_f32_16x16x32_bf16 v[48:51], a[172:175], v[108:111], v[48:51]
    v_mfma_f32_16x16x32_bf16 v[52:55], a[236:239], v[108:111], v[52:55]
    v_mfma_f32_16x16x32_bf16 v[56:59], v[108:111], v[172:175], v[56:59]
    v_mfma_f32_16x16x32_bf16 v[60:63], v[108:111], v[236:239], v[60:63]
    ds_read_b128 v[108:111], v31 offset:27648
    s_waitcnt lgkmcnt(15)
    v_mfma_f32_16x16x32_bf16 v[40:43], a[48:51], v[112:115], v[40:43]
    v_mfma_f32_16x16x32_bf16 v[44:47], a[112:115], v[112:115], v[44:47]
    v_mfma_f32_16x16x32_bf16 v[48:51], a[176:179], v[112:115], v[48:51]
    v_mfma_f32_16x16x32_bf16 v[52:55], a[240:243], v[112:115], v[52:55]
    v_mfma_f32_16x16x32_bf16 v[56:59], v[112:115], v[176:179], v[56:59]
    v_mfma_f32_16x16x32_bf16 v[60:63], v[112:115], v[240:243], v[60:63]
    ds_read_b128 v[112:115], v31 offset:28672
    s_waitcnt lgkmcnt(15)
    v_mfma_f32_16x16x32_bf16 v[40:43], a[52:55], v[116:119], v[40:43]
    v_mfma_f32_16x16x32_bf16 v[44:47], a[116:119], v[116:119], v[44:47]
    v_mfma_f32_16x16x32_bf16 v[48:51], a[180:183], v[116:119], v[48:51]
    v_mfma_f32_16x16x32_bf16 v[52:55], a[244:247], v[116:119], v[52:55]
    v_mfma_f32_16x16x32_bf16 v[56:59], v[116:119], v[180:183], v[56:59]
    v_mfma_f32_16x16x32_bf16 v[60:63], v[116:119], v[244:247], v[60:63]
    ds_read_b128 v[116:119], v31 offset:29696
    s_waitcnt lgkmcnt(15)
    v_mfma_f32_16x16x32_bf16 v[40:43], a[56:59], v[120:123], v[40:43]
    v_mfma_f32_16x16x32_bf16 v[44:47], a[120:123], v[120:123], v[44:47]
    v_mfma_f32_16x16x32_bf16 v[48:51], a[184:187], v[120:123], v[48:51]
    v_mfma_f32_16x16x32_bf16 v[52:55], a[248:251], v[120:123], v[52:55]
    v_mfma_f32_16x16x32_bf16 v[56:59], v[120:123], v[184:187], v[56:59]
    v_mfma_f32_16x16x32_bf16 v[60:63], v[120:123], v[248:251], v[60:63]
    ds_read_b128 v[120:123], v31 offset:30720
    s_waitcnt lgkmcnt(15)
    v_mfma_f32_16x16x32_bf16 v[40:43], a[60:63], v[124:127], v[40:43]
    v_mfma_f32_16x16x32_bf16 v[44:47], a[124:127], v[124:127], v[44:47]
    v_mfma_f32_16x16x32_bf16 v[48:51], a[188:191], v[124:127], v[48:51]
    v_mfma_f32_16x16x32_bf16 v[52:55], a[252:255], v[124:127], v[52:55]
    v_mfma_f32_16x16x32_bf16 v[56:59], v[124:127], v[188:191], v[56:59]
    v_mfma_f32_16x16x32_bf16 v[60:63], v[124:127], v[252:255], v[60:63]
    ds_read_b128 v[124:127], v31 offset:31744
    s_waitcnt vmcnt(0)
    s_mov_b64 exec, 1
    buffer_store_byte v28, off, s[24:27], s38 sc1
    s_mov_b64 exec, -1
    s_add_u32 s38, s38, 4
    s_nop 7
    v_cvt_pk_bf16_f32 v12, v40, v41
    v_cvt_pk_bf16_f32 v13, v42, v43
    v_cvt_pk_bf16_f32 v14, v44, v45
    v_cvt_pk_bf16_f32 v15, v46, v47
    buffer_store_dwordx4 v[12:15], v9, s[24:27], s35 offen offset:0 sc1
    v_cvt_pk_bf16_f32 v16, v48, v49
    v_cvt_pk_bf16_f32 v17, v50, v51
    v_cvt_pk_bf16_f32 v18, v52, v53
    v_cvt_pk_bf16_f32 v19, v54, v55
    buffer_store_dwordx4 v[16:19], v9, s[24:27], s37 offen offset:0 sc1
    v_cvt_pk_bf16_f32 v20, v56, v57
    v_cvt_pk_bf16_f32 v21, v58, v59
    v_cvt_pk_bf16_f32 v24, v60, v61
    v_cvt_pk_bf16_f32 v25, v62, v63
    s_nop 1
    s_waitcnt lgkmcnt(15)
    v_mfma_f32_16x16x32_bf16 v[40:43], a[0:3], v[64:67], 0
    v_mfma_f32_16x16x32_bf16 v[44:47], a[64:67], v[64:67], 0
    v_mfma_f32_16x16x32_bf16 v[48:51], a[128:131], v[64:67], 0
    v_mfma_f32_16x16x32_bf16 v[52:55], a[192:195], v[64:67], 0
    v_mfma_f32_16x16x32_bf16 v[56:59], v[64:67], v[128:131], 0
    v_mfma_f32_16x16x32_bf16 v[60:63], v[64:67], v[192:195], 0
    ds_read_b128 v[64:67], v31 offset:32768
    s_waitcnt lgkmcnt(15)
    v_mfma_f32_16x16x32_bf16 v[40:43], a[4:7], v[68:71], v[40:43]
    v_mfma_f32_16x16x32_bf16 v[44:47], a[68:71], v[68:71], v[44:47]
    v_mfma_f32_16x16x32_bf16 v[48:51], a[132:135], v[68:71], v[48:51]
    v_mfma_f32_16x16x32_bf16 v[52:55], a[196:199], v[68:71], v[52:55]
    v_mfma_f32_16x16x32_bf16 v[56:59], v[68:71], v[132:135], v[56:59]
    v_mfma_f32_16x16x32_bf16 v[60:63], v[68:71], v[196:199], v[60:63]
    ds_read_b128 v[68:71], v31 offset:33792
    s_waitcnt lgkmcnt(15)
    v_mfma_f32_16x16x32_bf16 v[40:43], a[8:11], v[72:75], v[40:43]
    v_mfma_f32_16x16x32_bf16 v[44:47], a[72:75], v[72:75], v[44:47]
    v_mfma_f32_16x16x32_bf16 v[48:51], a[136:139], v[72:75], v[48:51]
    v_mfma_f32_16x16x32_bf16 v[52:55], a[200:203], v[72:75], v[52:55]
    v_mfma_f32_16x16x32_bf16 v[56:59], v[72:75], v[136:139], v[56:59]
    v_mfma_f32_16x16x32_bf16 v[60:63], v[72:75], v[200:203], v[60:63]
    ds_read_b128 v[72:75], v31 offset:34816
    s_waitcnt lgkmcnt(15)
    v_mfma_f32_16x16x32_bf16 v[40:43], a[12:15], v[76:79], v[40:43]
    v_mfma_f32_16x16x32_bf16 v[44:47], a[76:79], v[76:79], v[44:47]
    v_mfma_f32_16x16x32_bf16 v[48:51], a[140:143], v[76:79], v[48:51]
    v_mfma_f32_16x16x32_bf16 v[52:55], a[204:207], v[76:79], v[52:55]
    v_mfma_f32_16x16x32_bf16 v[56:59], v[76:79], v[140:143], v[56:59]
    v_mfma_f32_16x16x32_bf16 v[60:63], v[76:79], v[204:207], v[60:63]
    ds_read_b128 v[76:79], v31 offset:35840
    s_waitcnt lgkmcnt(15)
    v_mfma_f32_16x16x32_bf16 v[40:43], a[16:19], v[80:83], v[40:43]
    v_mfma_f32_16x16x32_bf16 v[44:47], a[80:83], v[80:83], v[44:47]
    v_mfma_f32_16x16x32_bf16 v[48:51], a[144:147], v[80:83], v[48:51]
    v_mfma_f32_16x16x32_bf16 v[52:55], a[208:211], v[80:83], v[52:55]
    v_mfma_f32_16x16x32_bf16 v[56:59], v[80:83], v[144:147], v[56:59]
    v_mfma_f32_16x16x32_bf16 v[60:63], v[80:83], v[208:211], v[60:63]
    ds_read_b128 v[80:83], v31 offset:36864
    s_waitcnt lgkmcnt(15)
    v_mfma_f32_16x16x32_bf16 v[40:43], a[20:23], v[84:87], v[40:43]
    v_mfma_f32_16x16x32_bf16 v[44:47], a[84:87], v[84:87], v[44:47]
    v_mfma_f32_16x16x32_bf16 v[48:51], a[148:151], v[84:87], v[48:51]
    v_mfma_f32_16x16x32_bf16 v[52:55], a[212:215], v[84:87], v[52:55]
    v_mfma_f32_16x16x32_bf16 v[56:59], v[84:87], v[148:151], v[56:59]
    v_mfma_f32_16x16x32_bf16 v[60:63], v[84:87], v[212:215], v[60:63]
    ds_read_b128 v[84:87], v31 offset:37888
    s_waitcnt lgkmcnt(15)
    v_mfma_f32_16x16x32_bf16 v[40:43], a[24:27], v[88:91], v[40:43]
    v_mfma_f32_16x16x32_bf16 v[44:47], a[88:91], v[88:91], v[44:47]
    v_mfma_f32_16x16x32_bf16 v[48:51], a[152:155], v[88:91], v[48:51]
    v_mfma_f32_16x16x32_bf16 v[52:55], a[216:219], v[88:91], v[52:55]
    v_mfma_f32_16x16x32_bf16 v[56:59], v[88:91], v[152:155], v[56:59]
    v_mfma_f32_16x16x32_bf16 v[60:63], v[88:91], v[216:219], v[60:63]
    ds_read_b128 v[88:91], v31 offset:38912
    s_waitcnt lgkmcnt(15)
    v_mfma_f32_16x16x32_bf16 v[40:43], a[28:31], v[92:95], v[40:43]
    v_mfma_f32_16x16x32_bf16 v[44:47], a[92:95], v[92:95], v[44:47]
    v_mfma_f32_16x16x32_bf16 v[48:51], a[156:159], v[92:95], v[48:51]
    v_mfma_f32_16x16x32_bf16 v[52:55], a[220:223], v[92:95], v[52:55]
    v_mfma_f32_16x16x32_bf16 v[56:59], v[92:95], v[156:159], v[56:59]
    v_mfma_f32_16x16x32_bf16 v[60:63], v[92:95], v[220:223], v[60:63]
    ds_read_b128 v[92:95], v31 offset:39936
    s_waitcnt lgkmcnt(15)
    v_mfma_f32_16x16x32_bf16 v[40:43], a[32:35], v[96:99], v[40:43]
    v_mfma_f32_16x16x32_bf16 v[44:47], a[96:99], v[96:99], v[44:47]
    v_mfma_f32_16x16x32_bf16 v[48:51], a[160:163], v[96:99], v[48:51]
    v_mfma_f32_16x16x32_bf16 v[52:55], a[224:227], v[96:99], v[52:55]
    v_mfma_f32_16x16x32_bf16 v[56:59], v[96:99], v[160:163], v[56:59]
    v_mfma_f32_16x16x32_bf16 v[60:63], v[96:99], v[224:227], v[60:63]
    ds_read_b128 v[96:99], v31 offset:40960
    s_waitcnt lgkmcnt(15)
    v_mfma_f32_16x16x32_bf16 v[40:43], a[36:39], v[100:103], v[40:43]
    v_mfma_f32_16x16x32_bf16 v[44:47], a[100:103], v[100:103], v[44:47]
    v_mfma_f32_16x16x32_bf16 v[48:51], a[164:167], v[100:103], v[48:51]
    v_mfma_f32_16x16x32_bf16 v[52:55], a[228:231], v[100:103], v[52:55]
    v_mfma_f32_16x16x32_bf16 v[56:59], v[100:103], v[164:167], v[56:59]
    v_mfma_f32_16x16x32_bf16 v[60:63], v[100:103], v[228:231], v[60:63]
    ds_read_b128 v[100:103], v31 offset:41984
    s_waitcnt lgkmcnt(15)
    v_mfma_f32_16x16x32_bf16 v[40:43], a[40:43], v[104:107], v[40:43]
    v_mfma_f32_16x16x32_bf16 v[44:47], a[104:107], v[104:107], v[44:47]
    v_mfma_f32_16x16x32_bf16 v[48:51], a[168:171], v[104:107], v[48:51]
    v_mfma_f32_16x16x32_bf16 v[52:55], a[232:235], v[104:107], v[52:55]
    v_mfma_f32_16x16x32_bf16 v[56:59], v[104:107], v[168:171], v[56:59]
    v_mfma_f32_16x16x32_bf16 v[60:63], v[104:107], v[232:235], v[60:63]
    ds_read_b128 v[104:107], v31 offset:43008
    s_waitcnt lgkmcnt(15)
    v_mfma_f32_16x16x32_bf16 v[40:43], a[44:47], v[108:111], v[40:43]
    v_mfma_f32_16x16x32_bf16 v[44:47], a[108:111], v[108:111], v[44:47]
    v_mfma_f32_16x16x32_bf16 v[48:51], a[172:175], v[108:111], v[48:51]
    v_mfma_f32_16x16x32_bf16 v[52:55], a[236:239], v[108:111], v[52:55]
    v_mfma_f32_16x16x32_bf16 v[56:59], v[108:111], v[172:175], v[56:59]
    v_mfma_f32_16x16x32_bf16 v[60:63], v[108:111], v[236:239], v[60:63]
    ds_read_b128 v[108:111], v31 offset:44032
    s_waitcnt lgkmcnt(15)
    v_mfma_f32_16x16x32_bf16 v[40:43], a[48:51], v[112:115], v[40:43]
    v_mfma_f32_16x16x32_bf16 v[44:47], a[112:115], v[112:115], v[44:47]
    v_mfma_f32_16x16x32_bf16 v[48:51], a[176:179], v[112:115], v[48:51]
    v_mfma_f32_16x16x32_bf16 v[52:55], a[240:243], v[112:115], v[52:55]
    v_mfma_f32_16x16x32_bf16 v[56:59], v[112:115], v[176:179], v[56:59]
    v_mfma_f32_16x16x32_bf16 v[60:63], v[112:115], v[240:243], v[60:63]
    ds_read_b128 v[112:115], v31 offset:45056
    s_waitcnt lgkmcnt(15)
    v_mfma_f32_16x16x32_bf16 v[40:43], a[52:55], v[116:119], v[40:43]
    v_mfma_f32_16x16x32_bf16 v[44:47], a[116:119], v[116:119], v[44:47]
    v_mfma_f32_16x16x32_bf16 v[48:51], a[180:183], v[116:119], v[48:51]
    v_mfma_f32_16x16x32_bf16 v[52:55], a[244:247], v[116:119], v[52:55]
    v_mfma_f32_16x16x32_bf16 v[56:59], v[116:119], v[180:183], v[56:59]
    v_mfma_f32_16x16x32_bf16 v[60:63], v[116:119], v[244:247], v[60:63]
    ds_read_b128 v[116:119], v31 offset:46080
    s_waitcnt lgkmcnt(15)
    v_mfma_f32_16x16x32_bf16 v[40:43], a[56:59], v[120:123], v[40:43]
    v_mfma_f32_16x16x32_bf16 v[44:47], a[120:123], v[120:123], v[44:47]
    v_mfma_f32_16x16x32_bf16 v[48:51], a[184:187], v[120:123], v[48:51]
    v_mfma_f32_16x16x32_bf16 v[52:55], a[248:251], v[120:123], v[52:55]
    v_mfma_f32_16x16x32_bf16 v[56:59], v[120:123], v[184:187], v[56:59]
    v_mfma_f32_16x16x32_bf16 v[60:63], v[120:123], v[248:251], v[60:63]
    ds_read_b128 v[120:123], v31 offset:47104
    s_waitcnt lgkmcnt(15)
    v_mfma_f32_16x16x32_bf16 v[40:43], a[60:63], v[124:127], v[40:43]
    v_mfma_f32_16x16x32_bf16 v[44:47], a[124:127], v[124:127], v[44:47]
    v_mfma_f32_16x16x32_bf16 v[48:51], a[188:191], v[124:127], v[48:51]
    v_mfma_f32_16x16x32_bf16 v[52:55], a[252:255], v[124:127], v[52:55]
    v_mfma_f32_16x16x32_bf16 v[56:59], v[124:127], v[188:191], v[56:59]
    v_mfma_f32_16x16x32_bf16 v[60:63], v[124:127], v[252:255], v[60:63]
    ds_read_b128 v[124:127], v31 offset:48128
    s_nop 7
    v_cvt_pk_bf16_f32 v12, v40, v41
    v_cvt_pk_bf16_f32 v13, v42, v43
    v_cvt_pk_bf16_f32 v14, v44, v45
    v_cvt_pk_bf16_f32 v15, v46, v47
    buffer_store_dwordx4 v[12:15], v9, s[24:27], s35 offen offset:1024 sc1
    v_cvt_pk_bf16_f32 v16, v48, v49
    v_cvt_pk_bf16_f32 v17, v50, v51
    v_cvt_pk_bf16_f32 v18, v52, v53
    v_cvt_pk_bf16_f32 v19, v54, v55
    buffer_store_dwordx4 v[16:19], v9, s[24:27], s37 offen offset:1024 sc1
    v_cvt_pk_bf16_f32 v22, v56, v57
    v_cvt_pk_bf16_f32 v23, v58, v59
    v_cvt_pk_bf16_f32 v26, v60, v61
    v_cvt_pk_bf16_f32 v27, v62, v63
    buffer_store_dwordx4 v[20:23], v10, s[24:27], s36 offen sc1
    buffer_store_dwordx4 v[24:27], v10, s[24:27], s36 offen offset:256 sc1
    s_add_u32 s35, s35, 0x40000
    s_add_u32 s36, s36, 0x40000
    s_add_u32 s37, s37, 0x40000
    s_nop 1
    s_waitcnt lgkmcnt(15)
    v_mfma_f32_16x16x32_bf16 v[40:43], a[0:3], v[64:67], 0
    v_mfma_f32_16x16x32_bf16 v[44:47], a[64:67], v[64:67], 0
    v_mfma_f32_16x16x32_bf16 v[48:51], a[128:131], v[64:67], 0
    v_mfma_f32_16x16x32_bf16 v[52:55], a[192:195], v[64:67], 0
    v_mfma_f32_16x16x32_bf16 v[56:59], v[64:67], v[128:131], 0
    v_mfma_f32_16x16x32_bf16 v[60:63], v[64:67], v[192:195], 0
    ds_read_b128 v[64:67], v31 offset:49152
    s_waitcnt lgkmcnt(15)
    v_mfma_f32_16x16x32_bf16 v[40:43], a[4:7], v[68:71], v[40:43]
    v_mfma_f32_16x16x32_bf16 v[44:47], a[68:71], v[68:71], v[44:47]
    v_mfma_f32_16x16x32_bf16 v[48:51], a[132:135], v[68:71], v[48:51]
    v_mfma_f32_16x16x32_bf16 v[52:55], a[196:199], v[68:71], v[52:55]
    v_mfma_f32_16x16x32_bf16 v[56:59], v[68:71], v[132:135], v[56:59]
    v_mfma_f32_16x16x32_bf16 v[60:63], v[68:71], v[196:199], v[60:63]
    ds_read_b128 v[68:71], v31 offset:50176
    s_waitcnt lgkmcnt(15)
    v_mfma_f32_16x16x32_bf16 v[40:43], a[8:11], v[72:75], v[40:43]
    v_mfma_f32_16x16x32_bf16 v[44:47], a[72:75], v[72:75], v[44:47]
    v_mfma_f32_16x16x32_bf16 v[48:51], a[136:139], v[72:75], v[48:51]
    v_mfma_f32_16x16x32_bf16 v[52:55], a[200:203], v[72:75], v[52:55]
    v_mfma_f32_16x16x32_bf16 v[56:59], v[72:75], v[136:139], v[56:59]
    v_mfma_f32_16x16x32_bf16 v[60:63], v[72:75], v[200:203], v[60:63]
    ds_read_b128 v[72:75], v31 offset:51200
    s_waitcnt lgkmcnt(15)
    v_mfma_f32_16x16x32_bf16 v[40:43], a[12:15], v[76:79], v[40:43]
    v_mfma_f32_16x16x32_bf16 v[44:47], a[76:79], v[76:79], v[44:47]
    v_mfma_f32_16x16x32_bf16 v[48:51], a[140:143], v[76:79], v[48:51]
    v_mfma_f32_16x16x32_bf16 v[52:55], a[204:207], v[76:79], v[52:55]
    v_mfma_f32_16x16x32_bf16 v[56:59], v[76:79], v[140:143], v[56:59]
    v_mfma_f32_16x16x32_bf16 v[60:63], v[76:79], v[204:207], v[60:63]
    ds_read_b128 v[76:79], v31 offset:52224
    s_waitcnt lgkmcnt(15)
    v_mfma_f32_16x16x32_bf16 v[40:43], a[16:19], v[80:83], v[40:43]
    v_mfma_f32_16x16x32_bf16 v[44:47], a[80:83], v[80:83], v[44:47]
    v_mfma_f32_16x16x32_bf16 v[48:51], a[144:147], v[80:83], v[48:51]
    v_mfma_f32_16x16x32_bf16 v[52:55], a[208:211], v[80:83], v[52:55]
    v_mfma_f32_16x16x32_bf16 v[56:59], v[80:83], v[144:147], v[56:59]
    v_mfma_f32_16x16x32_bf16 v[60:63], v[80:83], v[208:211], v[60:63]
    ds_read_b128 v[80:83], v31 offset:53248
    s_waitcnt lgkmcnt(15)
    v_mfma_f32_16x16x32_bf16 v[40:43], a[20:23], v[84:87], v[40:43]
    v_mfma_f32_16x16x32_bf16 v[44:47], a[84:87], v[84:87], v[44:47]
    v_mfma_f32_16x16x32_bf16 v[48:51], a[148:151], v[84:87], v[48:51]
    v_mfma_f32_16x16x32_bf16 v[52:55], a[212:215], v[84:87], v[52:55]
    v_mfma_f32_16x16x32_bf16 v[56:59], v[84:87], v[148:151], v[56:59]
    v_mfma_f32_16x16x32_bf16 v[60:63], v[84:87], v[212:215], v[60:63]
    ds_read_b128 v[84:87], v31 offset:54272
    s_waitcnt lgkmcnt(15)
    v_mfma_f32_16x16x32_bf16 v[40:43], a[24:27], v[88:91], v[40:43]
    v_mfma_f32_16x16x32_bf16 v[44:47], a[88:91], v[88:91], v[44:47]
    v_mfma_f32_16x16x32_bf16 v[48:51], a[152:155], v[88:91], v[48:51]
    v_mfma_f32_16x16x32_bf16 v[52:55], a[216:219], v[88:91], v[52:55]
    v_mfma_f32_16x16x32_bf16 v[56:59], v[88:91], v[152:155], v[56:59]
    v_mfma_f32_16x16x32_bf16 v[60:63], v[88:91], v[216:219], v[60:63]
    ds_read_b128 v[88:91], v31 offset:55296
    s_waitcnt lgkmcnt(15)
    v_mfma_f32_16x16x32_bf16 v[40:43], a[28:31], v[92:95], v[40:43]
    v_mfma_f32_16x16x32_bf16 v[44:47], a[92:95], v[92:95], v[44:47]
    v_mfma_f32_16x16x32_bf16 v[48:51], a[156:159], v[92:95], v[48:51]
    v_mfma_f32_16x16x32_bf16 v[52:55], a[220:223], v[92:95], v[52:55]
    v_mfma_f32_16x16x32_bf16 v[56:59], v[92:95], v[156:159], v[56:59]
    v_mfma_f32_16x16x32_bf16 v[60:63], v[92:95], v[220:223], v[60:63]
    ds_read_b128 v[92:95], v31 offset:56320
    s_waitcnt lgkmcnt(15)
    v_mfma_f32_16x16x32_bf16 v[40:43], a[32:35], v[96:99], v[40:43]
    v_mfma_f32_16x16x32_bf16 v[44:47], a[96:99], v[96:99], v[44:47]
    v_mfma_f32_16x16x32_bf16 v[48:51], a[160:163], v[96:99], v[48:51]
    v_mfma_f32_16x16x32_bf16 v[52:55], a[224:227], v[96:99], v[52:55]
    v_mfma_f32_16x16x32_bf16 v[56:59], v[96:99], v[160:163], v[56:59]
    v_mfma_f32_16x16x32_bf16 v[60:63], v[96:99], v[224:227], v[60:63]
    ds_read_b128 v[96:99], v31 offset:57344
    s_waitcnt lgkmcnt(15)
    v_mfma_f32_16x16x32_bf16 v[40:43], a[36:39], v[100:103], v[40:43]
    v_mfma_f32_16x16x32_bf16 v[44:47], a[100:103], v[100:103], v[44:47]
    v_mfma_f32_16x16x32_bf16 v[48:51], a[164:167], v[100:103], v[48:51]
    v_mfma_f32_16x16x32_bf16 v[52:55], a[228:231], v[100:103], v[52:55]
    v_mfma_f32_16x16x32_bf16 v[56:59], v[100:103], v[164:167], v[56:59]
    v_mfma_f32_16x16x32_bf16 v[60:63], v[100:103], v[228:231], v[60:63]
    ds_read_b128 v[100:103], v31 offset:58368
    s_waitcnt lgkmcnt(15)
    v_mfma_f32_16x16x32_bf16 v[40:43], a[40:43], v[104:107], v[40:43]
    v_mfma_f32_16x16x32_bf16 v[44:47], a[104:107], v[104:107], v[44:47]
    v_mfma_f32_16x16x32_bf16 v[48:51], a[168:171], v[104:107], v[48:51]
    v_mfma_f32_16x16x32_bf16 v[52:55], a[232:235], v[104:107], v[52:55]
    v_mfma_f32_16x16x32_bf16 v[56:59], v[104:107], v[168:171], v[56:59]
    v_mfma_f32_16x16x32_bf16 v[60:63], v[104:107], v[232:235], v[60:63]
    ds_read_b128 v[104:107], v31 offset:59392
    s_waitcnt lgkmcnt(15)
    v_mfma_f32_16x16x32_bf16 v[40:43], a[44:47], v[108:111], v[40:43]
    v_mfma_f32_16x16x32_bf16 v[44:47], a[108:111], v[108:111], v[44:47]
    v_mfma_f32_16x16x32_bf16 v[48:51], a[172:175], v[108:111], v[48:51]
    v_mfma_f32_16x16x32_bf16 v[52:55], a[236:239], v[108:111], v[52:55]
    v_mfma_f32_16x16x32_bf16 v[56:59], v[108:111], v[172:175], v[56:59]
    v_mfma_f32_16x16x32_bf16 v[60:63], v[108:111], v[236:239], v[60:63]
    ds_read_b128 v[108:111], v31 offset:60416
    s_waitcnt lgkmcnt(15)
    v_mfma_f32_16x16x32_bf16 v[40:43], a[48:51], v[112:115], v[40:43]
    v_mfma_f32_16x16x32_bf16 v[44:47], a[112:115], v[112:115], v[44:47]
    v_mfma_f32_16x16x32_bf16 v[48:51], a[176:179], v[112:115], v[48:51]
    v_mfma_f32_16x16x32_bf16 v[52:55], a[240:243], v[112:115], v[52:55]
    v_mfma_f32_16x16x32_bf16 v[56:59], v[112:115], v[176:179], v[56:59]
    v_mfma_f32_16x16x32_bf16 v[60:63], v[112:115], v[240:243], v[60:63]
    ds_read_b128 v[112:115], v31 offset:61440
    s_waitcnt lgkmcnt(15)
    v_mfma_f32_16x16x32_bf16 v[40:43], a[52:55], v[116:119], v[40:43]
    v_mfma_f32_16x16x32_bf16 v[44:47], a[116:119], v[116:119], v[44:47]
    v_mfma_f32_16x16x32_bf16 v[48:51], a[180:183], v[116:119], v[48:51]
    v_mfma_f32_16x16x32_bf16 v[52:55], a[244:247], v[116:119], v[52:55]
    v_mfma_f32_16x16x32_bf16 v[56:59], v[116:119], v[180:183], v[56:59]
    v_mfma_f32_16x16x32_bf16 v[60:63], v[116:119], v[244:247], v[60:63]
    ds_read_b128 v[116:119], v31 offset:62464
    s_waitcnt lgkmcnt(15)
    v_mfma_f32_16x16x32_bf16 v[40:43], a[56:59], v[120:123], v[40:43]
    v_mfma_f32_16x16x32_bf16 v[44:47], a[120:123], v[120:123], v[44:47]
    v_mfma_f32_16x16x32_bf16 v[48:51], a[184:187], v[120:123], v[48:51]
    v_mfma_f32_16x16x32_bf16 v[52:55], a[248:251], v[120:123], v[52:55]
    v_mfma_f32_16x16x32_bf16 v[56:59], v[120:123], v[184:187], v[56:59]
    v_mfma_f32_16x16x32_bf16 v[60:63], v[120:123], v[248:251], v[60:63]
    ds_read_b128 v[120:123], v31 offset:63488
    s_waitcnt lgkmcnt(15)
    v_mfma_f32_16x16x32_bf16 v[40:43], a[60:63], v[124:127], v[40:43]
    v_mfma_f32_16x16x32_bf16 v[44:47], a[124:127], v[124:127], v[44:47]
    v_mfma_f32_16x16x32_bf16 v[48:51], a[188:191], v[124:127], v[48:51]
    v_mfma_f32_16x16x32_bf16 v[52:55], a[252:255], v[124:127], v[52:55]
    v_mfma_f32_16x16x32_bf16 v[56:59], v[124:127], v[188:191], v[56:59]
    v_mfma_f32_16x16x32_bf16 v[60:63], v[124:127], v[252:255], v[60:63]
    ds_read_b128 v[124:127], v31 offset:64512
    s_waitcnt vmcnt(0)
    s_mov_b64 exec, 1
    buffer_store_byte v28, off, s[24:27], s38 sc1
    s_mov_b64 exec, -1
    s_add_u32 s38, s38, 4
    s_nop 7
    v_cvt_pk_bf16_f32 v12, v40, v41
    v_cvt_pk_bf16_f32 v13, v42, v43
    v_cvt_pk_bf16_f32 v14, v44, v45
    v_cvt_pk_bf16_f32 v15, v46, v47
    buffer_store_dwordx4 v[12:15], v9, s[24:27], s35 offen offset:0 sc1
    v_cvt_pk_bf16_f32 v16, v48, v49
    v_cvt_pk_bf16_f32 v17, v50, v51
    v_cvt_pk_bf16_f32 v18, v52, v53
    v_cvt_pk_bf16_f32 v19, v54, v55
    buffer_store_dwordx4 v[16:19], v9, s[24:27], s37 offen offset:0 sc1
    v_cvt_pk_bf16_f32 v20, v56, v57
    v_cvt_pk_bf16_f32 v21, v58, v59
    v_cvt_pk_bf16_f32 v24, v60, v61
    v_cvt_pk_bf16_f32 v25, v62, v63
    s_nop 1
    s_waitcnt lgkmcnt(15)
    v_mfma_f32_16x16x32_bf16 v[40:43], a[0:3], v[64:67], 0
    v_mfma_f32_16x16x32_bf16 v[44:47], a[64:67], v[64:67], 0
    v_mfma_f32_16x16x32_bf16 v[48:51], a[128:131], v[64:67], 0
    v_mfma_f32_16x16x32_bf16 v[52:55], a[192:195], v[64:67], 0
    v_mfma_f32_16x16x32_bf16 v[56:59], v[64:67], v[128:131], 0
    v_mfma_f32_16x16x32_bf16 v[60:63], v[64:67], v[192:195], 0
    s_waitcnt lgkmcnt(14)
    v_mfma_f32_16x16x32_bf16 v[40:43], a[4:7], v[68:71], v[40:43]
    v_mfma_f32_16x16x32_bf16 v[44:47], a[68:71], v[68:71], v[44:47]
    v_mfma_f32_16x16x32_bf16 v[48:51], a[132:135], v[68:71], v[48:51]
    v_mfma_f32_16x16x32_bf16 v[52:55], a[196:199], v[68:71], v[52:55]
    v_mfma_f32_16x16x32_bf16 v[56:59], v[68:71], v[132:135], v[56:59]
    v_mfma_f32_16x16x32_bf16 v[60:63], v[68:71], v[196:199], v[60:63]
    s_waitcnt lgkmcnt(13)
    v_mfma_f32_16x16x32_bf16 v[40:43], a[8:11], v[72:75], v[40:43]
    v_mfma_f32_16x16x32_bf16 v[44:47], a[72:75], v[72:75], v[44:47]
    v_mfma_f32_16x16x32_bf16 v[48:51], a[136:139], v[72:75], v[48:51]
    v_mfma_f32_16x16x32_bf16 v[52:55], a[200:203], v[72:75], v[52:55]
    v_mfma_f32_16x16x32_bf16 v[56:59], v[72:75], v[136:139], v[56:59]
    v_mfma_f32_16x16x32_bf16 v[60:63], v[72:75], v[200:203], v[60:63]
    s_waitcnt lgkmcnt(12)
    v_mfma_f32_16x16x32_bf16 v[40:43], a[12:15], v[76:79], v[40:43]
    v_mfma_f32_16x16x32_bf16 v[44:47], a[76:79], v[76:79], v[44:47]
    v_mfma_f32_16x16x32_bf16 v[48:51], a[140:143], v[76:79], v[48:51]
    v_mfma_f32_16x16x32_bf16 v[52:55], a[204:207], v[76:79], v[52:55]
    v_mfma_f32_16x16x32_bf16 v[56:59], v[76:79], v[140:143], v[56:59]
    v_mfma_f32_16x16x32_bf16 v[60:63], v[76:79], v[204:207], v[60:63]
    s_waitcnt lgkmcnt(11)
    v_mfma_f32_16x16x32_bf16 v[40:43], a[16:19], v[80:83], v[40:43]
    v_mfma_f32_16x16x32_bf16 v[44:47], a[80:83], v[80:83], v[44:47]
    v_mfma_f32_16x16x32_bf16 v[48:51], a[144:147], v[80:83], v[48:51]
    v_mfma_f32_16x16x32_bf16 v[52:55], a[208:211], v[80:83], v[52:55]
    v_mfma_f32_16x16x32_bf16 v[56:59], v[80:83], v[144:147], v[56:59]
    v_mfma_f32_16x16x32_bf16 v[60:63], v[80:83], v[208:211], v[60:63]
    s_waitcnt lgkmcnt(10)
    v_mfma_f32_16x16x32_bf16 v[40:43], a[20:23], v[84:87], v[40:43]
    v_mfma_f32_16x16x32_bf16 v[44:47], a[84:87], v[84:87], v[44:47]
    v_mfma_f32_16x16x32_bf16 v[48:51], a[148:151], v[84:87], v[48:51]
    v_mfma_f32_16x16x32_bf16 v[52:55], a[212:215], v[84:87], v[52:55]
    v_mfma_f32_16x16x32_bf16 v[56:59], v[84:87], v[148:151], v[56:59]
    v_mfma_f32_16x16x32_bf16 v[60:63], v[84:87], v[212:215], v[60:63]
    s_waitcnt lgkmcnt(9)
    v_mfma_f32_16x16x32_bf16 v[40:43], a[24:27], v[88:91], v[40:43]
    v_mfma_f32_16x16x32_bf16 v[44:47], a[88:91], v[88:91], v[44:47]
    v_mfma_f32_16x16x32_bf16 v[48:51], a[152:155], v[88:91], v[48:51]
    v_mfma_f32_16x16x32_bf16 v[52:55], a[216:219], v[88:91], v[52:55]
    v_mfma_f32_16x16x32_bf16 v[56:59], v[88:91], v[152:155], v[56:59]
    v_mfma_f32_16x16x32_bf16 v[60:63], v[88:91], v[216:219], v[60:63]
    s_waitcnt lgkmcnt(8)
    v_mfma_f32_16x16x32_bf16 v[40:43], a[28:31], v[92:95], v[40:43]
    v_mfma_f32_16x16x32_bf16 v[44:47], a[92:95], v[92:95], v[44:47]
    v_mfma_f32_16x16x32_bf16 v[48:51], a[156:159], v[92:95], v[48:51]
    v_mfma_f32_16x16x32_bf16 v[52:55], a[220:223], v[92:95], v[52:55]
    v_mfma_f32_16x16x32_bf16 v[56:59], v[92:95], v[156:159], v[56:59]
    v_mfma_f32_16x16x32_bf16 v[60:63], v[92:95], v[220:223], v[60:63]
    s_waitcnt lgkmcnt(7)
    v_mfma_f32_16x16x32_bf16 v[40:43], a[32:35], v[96:99], v[40:43]
    v_mfma_f32_16x16x32_bf16 v[44:47], a[96:99], v[96:99], v[44:47]
    v_mfma_f32_16x16x32_bf16 v[48:51], a[160:163], v[96:99], v[48:51]
    v_mfma_f32_16x16x32_bf16 v[52:55], a[224:227], v[96:99], v[52:55]
    v_mfma_f32_16x16x32_bf16 v[56:59], v[96:99], v[160:163], v[56:59]
    v_mfma_f32_16x16x32_bf16 v[60:63], v[96:99], v[224:227], v[60:63]
    s_waitcnt lgkmcnt(6)
    v_mfma_f32_16x16x32_bf16 v[40:43], a[36:39], v[100:103], v[40:43]
    v_mfma_f32_16x16x32_bf16 v[44:47], a[100:103], v[100:103], v[44:47]
    v_mfma_f32_16x16x32_bf16 v[48:51], a[164:167], v[100:103], v[48:51]
    v_mfma_f32_16x16x32_bf16 v[52:55], a[228:231], v[100:103], v[52:55]
    v_mfma_f32_16x16x32_bf16 v[56:59], v[100:103], v[164:167], v[56:59]
    v_mfma_f32_16x16x32_bf16 v[60:63], v[100:103], v[228:231], v[60:63]
    s_waitcnt lgkmcnt(5)
    v_mfma_f32_16x16x32_bf16 v[40:43], a[40:43], v[104:107], v[40:43]
    v_mfma_f32_16x16x32_bf16 v[44:47], a[104:107], v[104:107], v[44:47]
    v_mfma_f32_16x16x32_bf16 v[48:51], a[168:171], v[104:107], v[48:51]
    v_mfma_f32_16x16x32_bf16 v[52:55], a[232:235], v[104:107], v[52:55]
    v_mfma_f32_16x16x32_bf16 v[56:59], v[104:107], v[168:171], v[56:59]
    v_mfma_f32_16x16x32_bf16 v[60:63], v[104:107], v[232:235], v[60:63]
    s_waitcnt lgkmcnt(4)
    v_mfma_f32_16x16x32_bf16 v[40:43], a[44:47], v[108:111], v[40:43]
    v_mfma_f32_16x16x32_bf16 v[44:47], a[108:111], v[108:111], v[44:47]
    v_mfma_f32_16x16x32_bf16 v[48:51], a[172:175], v[108:111], v[48:51]
    v_mfma_f32_16x16x32_bf16 v[52:55], a[236:239], v[108:111], v[52:55]
    v_mfma_f32_16x16x32_bf16 v[56:59], v[108:111], v[172:175], v[56:59]
    v_mfma_f32_16x16x32_bf16 v[60:63], v[108:111], v[236:239], v[60:63]
    s_waitcnt lgkmcnt(3)
    v_mfma_f32_16x16x32_bf16 v[40:43], a[48:51], v[112:115], v[40:43]
    v_mfma_f32_16x16x32_bf16 v[44:47], a[112:115], v[112:115], v[44:47]
    v_mfma_f32_16x16x32_bf16 v[48:51], a[176:179], v[112:115], v[48:51]
    v_mfma_f32_16x16x32_bf16 v[52:55], a[240:243], v[112:115], v[52:55]
    v_mfma_f32_16x16x32_bf16 v[56:59], v[112:115], v[176:179], v[56:59]
    v_mfma_f32_16x16x32_bf16 v[60:63], v[112:115], v[240:243], v[60:63]
    s_waitcnt lgkmcnt(2)
    v_mfma_f32_16x16x32_bf16 v[40:43], a[52:55], v[116:119], v[40:43]
    v_mfma_f32_16x16x32_bf16 v[44:47], a[116:119], v[116:119], v[44:47]
    v_mfma_f32_16x16x32_bf16 v[48:51], a[180:183], v[116:119], v[48:51]
    v_mfma_f32_16x16x32_bf16 v[52:55], a[244:247], v[116:119], v[52:55]
    v_mfma_f32_16x16x32_bf16 v[56:59], v[116:119], v[180:183], v[56:59]
    v_mfma_f32_16x16x32_bf16 v[60:63], v[116:119], v[244:247], v[60:63]
    s_waitcnt lgkmcnt(1)
    v_mfma_f32_16x16x32_bf16 v[40:43], a[56:59], v[120:123], v[40:43]
    v_mfma_f32_16x16x32_bf16 v[44:47], a[120:123], v[120:123], v[44:47]
    v_mfma_f32_16x16x32_bf16 v[48:51], a[184:187], v[120:123], v[48:51]
    v_mfma_f32_16x16x32_bf16 v[52:55], a[248:251], v[120:123], v[52:55]
    v_mfma_f32_16x16x32_bf16 v[56:59], v[120:123], v[184:187], v[56:59]
    v_mfma_f32_16x16x32_bf16 v[60:63], v[120:123], v[248:251], v[60:63]
    s_waitcnt lgkmcnt(0)
    v_mfma_f32_16x16x32_bf16 v[40:43], a[60:63], v[124:127], v[40:43]
    v_mfma_f32_16x16x32_bf16 v[44:47], a[124:127], v[124:127], v[44:47]
    v_mfma_f32_16x16x32_bf16 v[48:51], a[188:191], v[124:127], v[48:51]
    v_mfma_f32_16x16x32_bf16 v[52:55], a[252:255], v[124:127], v[52:55]
    v_mfma_f32_16x16x32_bf16 v[56:59], v[124:127], v[188:191], v[56:59]
    v_mfma_f32_16x16x32_bf16 v[60:63], v[124:127], v[252:255], v[60:63]
    s_nop 7
    v_cvt_pk_bf16_f32 v12, v40, v41
    v_cvt_pk_bf16_f32 v13, v42, v43
    v_cvt_pk_bf16_f32 v14, v44, v45
    v_cvt_pk_bf16_f32 v15, v46, v47
    buffer_store_dwordx4 v[12:15], v9, s[24:27], s35 offen offset:1024 sc1
    v_cvt_pk_bf16_f32 v16, v48, v49
    v_cvt_pk_bf16_f32 v17, v50, v51
    v_cvt_pk_bf16_f32 v18, v52, v53
    v_cvt_pk_bf16_f32 v19, v54, v55
    buffer_store_dwordx4 v[16:19], v9, s[24:27], s37 offen offset:1024 sc1
    v_cvt_pk_bf16_f32 v22, v56, v57
    v_cvt_pk_bf16_f32 v23, v58, v59
    v_cvt_pk_bf16_f32 v26, v60, v61
    v_cvt_pk_bf16_f32 v27, v62, v63
    buffer_store_dwordx4 v[20:23], v10, s[24:27], s36 offen sc1
    buffer_store_dwordx4 v[24:27], v10, s[24:27], s36 offen offset:256 sc1
    s_add_u32 s35, s35, 0x40000
    s_add_u32 s36, s36, 0x40000
    s_add_u32 s37, s37, 0x40000
    s_nop 1
    s_waitcnt vmcnt(0)
    s_mov_b64 exec, 1
    buffer_store_byte v28, off, s[24:27], s38 sc1
    s_mov_b64 exec, -1
    s_branch W_LOOP
W_P0:
    s_and_b32 s28, s30, 31
    s_lshr_b32 s30, s30, 5
    s_load_dwordx4 s[40:43], s[0:1], 16
    s_load_dwordx2 s[44:45], s[0:1], 32
    v_lshlrev_b32 v3, 4, v1
    v_and_b32 v4, 15, v1
    v_lshrrev_b32 v5, 4, v1
    v_lshrrev_b32 v6, 2, v4
    v_and_b32 v7, 3, v4
    v_lshl_add_u32 v6, v6, 3, v7
    v_lshlrev_b32 v8, 10, v6
    v_lshl_add_u32 v8, v5, 4, v8
    v_lshrrev_b32 v10, 4, v1
    v_and_b32 v15, 15, v1
    v_lshlrev_b32 v9, 4, v15
    v_lshl_add_u32 v9, v10, 13, v9
    v_lshlrev_b32 v12, 2, v10
    v_xor_b32 v12, v12, v15
    v_lshlrev_b32 v12, 4, v12
    v_lshl_add_u32 v12, v10, 8, v12
    v_lshl_add_u32 v12, v2, 15, v12
    v_add_u32 v12, 2048, v12
    v_bfe_u32 v15, v1, 2, 2
    v_lshl_add_u32 v13, v10, 3, v15
    v_lshlrev_b32 v13, 8, v13
    v_xor_b32 v15, v15, v2
    v_lshl_add_u32 v13, v15, 6, v13
    v_and_b32 v15, 3, v1
    v_lshl_add_u32 v13, v15, 4, v13
    v_add_u32 v13, 2048, v13
    v_add_u32 v14, 0x10000, v13
    s_lshl_b32 s32, s28, 8
    s_lshl_b32 s33, s29, 20
    s_add_u32 s32, s32, s33
    s_waitcnt lgkmcnt(0)
    s_mov_b32 s48, s40
    s_and_b32 s49, s41, 0xffff
    s_mov_b32 s50, 0x400000
    s_mov_b32 s51, 0x00020000
    s_mov_b32 s52, s42
    s_and_b32 s53, s43, 0xffff
    s_mov_b32 s54, 0x400000
    s_mov_b32 s55, 0x00020000
    s_mov_b32 s56, s44
    s_and_b32 s57, s45, 0xffff
    s_mov_b32 s58, 0x400000
    s_mov_b32 s59, 0x00020000
    s_mov_b32 s33, s32
    buffer_load_dwordx4 a[128:131], v9, s[52:55], s33 offen
    s_add_u32 s33, s33, 0x8000
    buffer_load_dwordx4 a[132:135], v9, s[52:55], s33 offen
    s_add_u32 s33, s33, 0x8000
    buffer_load_dwordx4 a[136:139], v9, s[52:55], s33 offen
    s_add_u32 s33, s33, 0x8000
    buffer_load_dwordx4 a[140:143], v9, s[52:55], s33 offen
    s_add_u32 s33, s33, 0x8000
    buffer_load_dwordx4 a[144:147], v9, s[52:55], s33 offen
    s_add_u32 s33, s33, 0x8000
    buffer_load_dwordx4 a[148:151], v9, s[52:55], s33 offen
    s_add_u32 s33, s33, 0x8000
    buffer_load_dwordx4 a[152:155], v9, s[52:55], s33 offen
    s_add_u32 s33, s33, 0x8000
    buffer_load_dwordx4 a[156:159], v9, s[52:55], s33 offen
    s_add_u32 s33, s33, 0x8000
    buffer_load_dwordx4 a[160:163], v9, s[52:55], s33 offen
    s_add_u32 s33, s33, 0x8000
    buffer_load_dwordx4 a[164:167], v9, s[52:55], s33 offen
    s_add_u32 s33, s33, 0x8000
    buffer_load_dwordx4 a[168:171], v9, s[52:55], s33 offen
    s_add_u32 s33, s33, 0x8000
    buffer_load_dwordx4 a[172:175], v9, s[52:55], s33 offen
    s_add_u32 s33, s33, 0x8000
    buffer_load_dwordx4 a[176:179], v9, s[52:55], s33 offen
    s_add_u32 s33, s33, 0x8000
    buffer_load_dwordx4 a[180:183], v9, s[52:55], s33 offen
    s_add_u32 s33, s33, 0x8000
    buffer_load_dwordx4 a[184:187], v9, s[52:55], s33 offen
    s_add_u32 s33, s33, 0x8000
    buffer_load_dwordx4 a[188:191], v9, s[52:55], s33 offen
    s_add_u32 s33, s33, 0x8000
    buffer_load_dwordx4 a[192:195], v9, s[52:55], s33 offen
    s_add_u32 s33, s33, 0x8000
    buffer_load_dwordx4 a[196:199], v9, s[52:55], s33 offen
    s_add_u32 s33, s33, 0x8000
    buffer_load_dwordx4 a[200:203], v9, s[52:55], s33 offen
    s_add_u32 s33, s33, 0x8000
    buffer_load_dwordx4 a[204:207], v9, s[52:55], s33 offen
    s_add_u32 s33, s33, 0x8000
    buffer_load_dwordx4 a[208:211], v9, s[52:55], s33 offen
    s_add_u32 s33, s33, 0x8000
    buffer_load_dwordx4 a[212:215], v9, s[52:55], s33 offen
    s_add_u32 s33, s33, 0x8000
    buffer_load_dwordx4 a[216:219], v9, s[52:55], s33 offen
    s_add_u32 s33, s33, 0x8000
    buffer_load_dwordx4 a[220:223], v9, s[52:55], s33 offen
    s_add_u32 s33, s33, 0x8000
    buffer_load_dwordx4 a[224:227], v9, s[52:55], s33 offen
    s_add_u32 s33, s33, 0x8000
    buffer_load_dwordx4 a[228:231], v9, s[52:55], s33 offen
    s_add_u32 s33, s33, 0x8000
    buffer_load_dwordx4 a[232:235], v9, s[52:55], s33 offen
    s_add_u32 s33, s33, 0x8000
    buffer_load_dwordx4 a[236:239], v9, s[52:55], s33 offen
    s_add_u32 s33, s33, 0x8000
    buffer_load_dwordx4 a[240:243], v9, s[52:55], s33 offen
    s_add_u32 s33, s33, 0x8000
    buffer_load_dwordx4 a[244:247], v9, s[52:55], s33 offen
    s_add_u32 s33, s33, 0x8000
    buffer_load_dwordx4 a[248:251], v9, s[52:55], s33 offen
    s_add_u32 s33, s33, 0x8000
    buffer_load_dwordx4 a[252:255], v9, s[52:55], s33 offen
    s_add_u32 s33, s33, 0x8000
    s_mov_b32 s33, s32
    buffer_load_dwordx4 v[128:131], v9, s[56:59], s33 offen
    s_add_u32 s33, s33, 0x8000
    buffer_load_dwordx4 v[132:135], v9, s[56:59], s33 offen
    s_add_u32 s33, s33, 0x8000
    buffer_load_dwordx4 v[136:139], v9, s[56:59], s33 offen
    s_add_u32 s33, s33, 0x8000
    buffer_load_dwordx4 v[140:143], v9, s[56:59], s33 offen
    s_add_u32 s33, s33, 0x8000
    buffer_load_dwordx4 v[144:147], v9, s[56:59], s33 offen
    s_add_u32 s33, s33, 0x8000
    buffer_load_dwordx4 v[148:151], v9, s[56:59], s33 offen
    s_add_u32 s33, s33, 0x8000
    buffer_load_dwordx4 v[152:155], v9, s[56:59], s33 offen
    s_add_u32 s33, s33, 0x8000
    buffer_load_dwordx4 v[156:159], v9, s[56:59], s33 offen
    s_add_u32 s33, s33, 0x8000
    buffer_load_dwordx4 v[160:163], v9, s[56:59], s33 offen
    s_add_u32 s33, s33, 0x8000
    buffer_load_dwordx4 v[164:167], v9, s[56:59], s33 offen
    s_add_u32 s33, s33, 0x8000
    buffer_load_dwordx4 v[168:171], v9, s[56:59], s33 offen
    s_add_u32 s33, s33, 0x8000
    buffer_load_dwordx4 v[172:175], v9, s[56:59], s33 offen
    s_add_u32 s33, s33, 0x8000
    buffer_load_dwordx4 v[176:179], v9, s[56:59], s33 offen
    s_add_u32 s33, s33, 0x8000
    buffer_load_dwordx4 v[180:183], v9, s[56:59], s33 offen
    s_add_u32 s33, s33, 0x8000
    buffer_load_dwordx4 v[184:187], v9, s[56:59], s33 offen
    s_add_u32 s33, s33, 0x8000
    buffer_load_dwordx4 v[188:191], v9, s[56:59], s33 offen
    s_add_u32 s33, s33, 0x8000
    buffer_load_dwordx4 v[192:195], v9, s[56:59], s33 offen
    s_add_u32 s33, s33, 0x8000
    buffer_load_dwordx4 v[196:199], v9, s[56:59], s33 offen
    s_add_u32 s33, s33, 0x8000
    buffer_load_dwordx4 v[200:203], v9, s[56:59], s33 offen
    s_add_u32 s33, s33, 0x8000
    buffer_load_dwordx4 v[204:207], v9, s[56:59], s33 offen
    s_add_u32 s33, s33, 0x8000
    buffer_load_dwordx4 v[208:211], v9, s[56:59], s33 offen
    s_add_u32 s33, s33, 0x8000
    buffer_load_dwordx4 v[212:215], v9, s[56:59], s33 offen
    s_add_u32 s33, s33, 0x8000
    buffer_load_dwordx4 v[216:219], v9, s[56:59], s33 offen
    s_add_u32 s33, s33, 0x8000
    buffer_load_dwordx4 v[220:223], v9, s[56:59], s33 offen
    s_add_u32 s33, s33, 0x8000
    buffer_load_dwordx4 v[224:227], v9, s[56:59], s33 offen
    s_add_u32 s33, s33, 0x8000
    buffer_load_dwordx4 v[228:231], v9, s[56:59], s33 offen
    s_add_u32 s33, s33, 0x8000
    buffer_load_dwordx4 v[232:235], v9, s[56:59], s33 offen
    s_add_u32 s33, s33, 0x8000
    buffer_load_dwordx4 v[236:239], v9, s[56:59], s33 offen
    s_add_u32 s33, s33, 0x8000
    buffer_load_dwordx4 v[240:243], v9, s[56:59], s33 offen
    s_add_u32 s33, s33, 0x8000
    buffer_load_dwordx4 v[244:247], v9, s[56:59], s33 offen
    s_add_u32 s33, s33, 0x8000
    buffer_load_dwordx4 v[248:251], v9, s[56:59], s33 offen
    s_add_u32 s33, s33, 0x8000
    buffer_load_dwordx4 v[252:255], v9, s[56:59], s33 offen
    s_add_u32 s33, s33, 0x8000
    v_lshl_add_u32 v11, v2, 15, v3
    v_add_u32 v11, 2048, v11
    s_waitcnt vmcnt(32)
    ds_write_b128 v12, a[128:131] offset:0
    ds_write_b128 v12, a[132:135] offset:1024
    ds_write_b128 v12, a[136:139] offset:2048
    ds_write_b128 v12, a[140:143] offset:3072
    ds_write_b128 v12, a[144:147] offset:4096
    ds_write_b128 v12, a[148:151] offset:5120
    ds_write_b128 v12, a[152:155] offset:6144
    ds_write_b128 v12, a[156:159] offset:7168
    ds_write_b128 v12, a[160:163] offset:8192
    ds_write_b128 v12, a[164:167] offset:9216
    ds_write_b128 v12, a[168:171] offset:10240
    ds_write_b128 v12, a[172:175] offset:11264
    ds_write_b128 v12, a[176:179] offset:12288
    ds_write_b128 v12, a[180:183] offset:13312
    ds_write_b128 v12, a[184:187] offset:14336
    ds_write_b128 v12, a[188:191] offset:15360
    ds_write_b128 v12, a[192:195] offset:16384
    ds_write_b128 v12, a[196:199] offset:17408
    ds_write_b128 v12, a[200:203] offset:18432
    ds_write_b128 v12, a[204:207] offset:19456
    ds_write_b128 v12, a[208:211] offset:20480
    ds_write_b128 v12, a[212:215] offset:21504
    ds_write_b128 v12, a[216:219] offset:22528
    ds_write_b128 v12, a[220:223] offset:23552
    ds_write_b128 v12, a[224:227] offset:24576
    ds_write_b128 v12, a[228:231] offset:25600
    ds_write_b128 v12, a[232:235] offset:26624
    ds_write_b128 v12, a[236:239] offset:27648
    ds_write_b128 v12, a[240:243] offset:28672
    ds_write_b128 v12, a[244:247] offset:29696
    ds_write_b128 v12, a[248:251] offset:30720
    ds_write_b128 v12, a[252:255] offset:31744
    s_waitcnt lgkmcnt(0)
    s_barrier
    ds_read_b64_tr_b16 a[128:129], v13 offset:0
    ds_read_b64_tr_b16 a[130:131], v13 offset:1024
    ds_read_b64_tr_b16 a[132:133], v13 offset:8192
    ds_read_b64_tr_b16 a[134:135], v13 offset:9216
    ds_read_b64_tr_b16 a[136:137], v13 offset:16384
    ds_read_b64_tr_b16 a[138:139], v13 offset:17408
    ds_read_b64_tr_b16 a[140:141], v13 offset:24576
    ds_read_b64_tr_b16 a[142:143], v13 offset:25600
    ds_read_b64_tr_b16 a[144:145], v13 offset:32768
    ds_read_b64_tr_b16 a[146:147], v13 offset:33792
    ds_read_b64_tr_b16 a[148:149], v13 offset:40960
    ds_read_b64_tr_b16 a[150:151], v13 offset:41984
    ds_read_b64_tr_b16 a[152:153], v13 offset:49152
    ds_read_b64_tr_b16 a[154:155], v13 offset:50176
    ds_read_b64_tr_b16 a[156:157], v13 offset:57344
    ds_read_b64_tr_b16 a[158:159], v13 offset:58368
    ds_read_b64_tr_b16 a[160:161], v14 offset:0
    ds_read_b64_tr_b16 a[162:163], v14 offset:1024
    ds_read_b64_tr_b16 a[164:165], v14 offset:8192
    ds_read_b64_tr_b16 a[166:167], v14 offset:9216
    ds_read_b64_tr_b16 a[168:169], v14 offset:16384
    ds_read_b64_tr_b16 a[170:171], v14 offset:17408
    ds_read_b64_tr_b16 a[172:173], v14 offset:24576
    ds_read_b64_tr_b16 a[174:175], v14 offset:25600
    ds_read_b64_tr_b16 a[176:177], v14 offset:32768
    ds_read_b64_tr_b16 a[178:179], v14 offset:33792
    ds_read_b64_tr_b16 a[180:181], v14 offset:40960
    ds_read_b64_tr_b16 a[182:183], v14 offset:41984
    ds_read_b64_tr_b16 a[184:185], v14 offset:49152
    ds_read_b64_tr_b16 a[186:187], v14 offset:50176
    ds_read_b64_tr_b16 a[188:189], v14 offset:57344
    ds_read_b64_tr_b16 a[190:191], v14 offset:58368
    ds_read_b64_tr_b16 a[192:193], v13 offset:8
    ds_read_b64_tr_b16 a[194:195], v13 offset:1032
    ds_read_b64_tr_b16 a[196:197], v13 offset:8200
    ds_read_b64_tr_b16 a[198:199], v13 offset:9224
    ds_read_b64_tr_b16 a[200:201], v13 offset:16392
    ds_read_b64_tr_b16 a[202:203], v13 offset:17416
    ds_read_b64_tr_b16 a[204:205], v13 offset:24584
    ds_read_b64_tr_b16 a[206:207], v13 offset:25608
    ds_read_b64_tr_b16 a[208:209], v13 offset:32776
    ds_read_b64_tr_b16 a[210:211], v13 offset:33800
    ds_read_b64_tr_b16 a[212:213], v13 offset:40968
    ds_read_b64_tr_b16 a[214:215], v13 offset:41992
    ds_read_b64_tr_b16 a[216:217], v13 offset:49160
    ds_read_b64_tr_b16 a[218:219], v13 offset:50184
    ds_read_b64_tr_b16 a[220:221], v13 offset:57352
    ds_read_b64_tr_b16 a[222:223], v13 offset:58376
    ds_read_b64_tr_b16 a[224:225], v14 offset:8
    ds_read_b64_tr_b16 a[226:227], v14 offset:1032
    ds_read_b64_tr_b16 a[228:229], v14 offset:8200
    ds_read_b64_tr_b16 a[230:231], v14 offset:9224
    ds_read_b64_tr_b16 a[232:233], v14 offset:16392
    ds_read_b64_tr_b16 a[234:235], v14 offset:17416
    ds_read_b64_tr_b16 a[236:237], v14 offset:24584
    ds_read_b64_tr_b16 a[238:239], v14 offset:25608
    ds_read_b64_tr_b16 a[240:241], v14 offset:32776
    ds_read_b64_tr_b16 a[242:243], v14 offset:33800
    ds_read_b64_tr_b16 a[244:245], v14 offset:40968
    ds_read_b64_tr_b16 a[246:247], v14 offset:41992
    ds_read_b64_tr_b16 a[248:249], v14 offset:49160
    ds_read_b64_tr_b16 a[250:251], v14 offset:50184
    ds_read_b64_tr_b16 a[252:253], v14 offset:57352
    ds_read_b64_tr_b16 a[254:255], v14 offset:58376
    s_waitcnt lgkmcnt(0)
    s_barrier
    s_lshr_b32 s34, s30, 2
    s_lshl_b32 s34, s34, 2
    s_cmp_lg_u32 s29, 0
    s_cbranch_scc1 W0_29
    s_mov_b32 s31, 0
W_PLN0:
    buffer_load_dword v24, off, s[12:15], s34 offset:68 sc1
    buffer_load_dword v25, off, s[12:15], 0 offset:240 sc1
    s_add_u32 s31, s31, 1
    s_cmp_gt_u32 s31, 0x200000
    s_cbranch_scc1 W_EXIT
    s_waitcnt vmcnt(0)
    v_readfirstlane_b32 s70, v24
    v_readfirstlane_b32 s71, v25
    s_and_b32 s35, s30, 3
    s_lshl_b32 s35, s35, 3
    s_lshr_b32 s70, s70, s35
    s_and_b32 s70, s70, 0xff
    s_cmp_lg_u32 s70, 4
    s_cbranch_scc1 W_PLN0
    s_cmp_lg_u32 s71, 21
    s_cbranch_scc1 W_PLN0
W0_29:
    s_barrier
    s_lshl_b32 s34, s30, 17
    s_lshl_b32 s35, s29, 15
    s_add_u32 s34, s34, s35
    s_add_u32 s35, s34, 4096
    buffer_load_dwordx4 v[64:67], v8, s[24:27], s34 offen offset:0 sc1
    buffer_load_dwordx4 v[68:71], v8, s[24:27], s34 offen offset:64 sc1
    buffer_load_dwordx4 v[72:75], v8, s[24:27], s34 offen offset:128 sc1
    buffer_load_dwordx4 v[76:79], v8, s[24:27], s34 offen offset:192 sc1
    buffer_load_dwordx4 v[80:83], v8, s[24:27], s34 offen offset:256 sc1
    buffer_load_dwordx4 v[84:87], v8, s[24:27], s34 offen offset:320 sc1
    buffer_load_dwordx4 v[88:91], v8, s[24:27], s34 offen offset:384 sc1
    buffer_load_dwordx4 v[92:95], v8, s[24:27], s34 offen offset:448 sc1
    buffer_load_dwordx4 v[96:99], v8, s[24:27], s34 offen offset:512 sc1
    buffer_load_dwordx4 v[100:103], v8, s[24:27], s34 offen offset:576 sc1
    buffer_load_dwordx4 v[104:107], v8, s[24:27], s34 offen offset:640 sc1
    buffer_load_dwordx4 v[108:111], v8, s[24:27], s34 offen offset:704 sc1
    buffer_load_dwordx4 v[112:115], v8, s[24:27], s34 offen offset:768 sc1
    buffer_load_dwordx4 v[116:119], v8, s[24:27], s34 offen offset:832 sc1
    buffer_load_dwordx4 v[120:123], v8, s[24:27], s34 offen offset:896 sc1
    buffer_load_dwordx4 v[124:127], v8, s[24:27], s34 offen offset:960 sc1
    buffer_load_dwordx4 a[0:3], v8, s[24:27], s35 offen offset:0 sc1
    buffer_load_dwordx4 a[4:7], v8, s[24:27], s35 offen offset:64 sc1
    buffer_load_dwordx4 a[8:11], v8, s[24:27], s35 offen offset:128 sc1
    buffer_load_dwordx4 a[12:15], v8, s[24:27], s35 offen offset:192 sc1
    buffer_load_dwordx4 a[16:19], v8, s[24:27], s35 offen offset:256 sc1
    buffer_load_dwordx4 a[20:23], v8, s[24:27], s35 offen offset:320 sc1
    buffer_load_dwordx4 a[24:27], v8, s[24:27], s35 offen offset:384 sc1
    buffer_load_dwordx4 a[28:31], v8, s[24:27], s35 offen offset:448 sc1
    buffer_load_dwordx4 a[32:35], v8, s[24:27], s35 offen offset:512 sc1
    buffer_load_dwordx4 a[36:39], v8, s[24:27], s35 offen offset:576 sc1
    buffer_load_dwordx4 a[40:43], v8, s[24:27], s35 offen offset:640 sc1
    buffer_load_dwordx4 a[44:47], v8, s[24:27], s35 offen offset:704 sc1
    buffer_load_dwordx4 a[48:51], v8, s[24:27], s35 offen offset:768 sc1
    buffer_load_dwordx4 a[52:55], v8, s[24:27], s35 offen offset:832 sc1
    buffer_load_dwordx4 a[56:59], v8, s[24:27], s35 offen offset:896 sc1
    buffer_load_dwordx4 a[60:63], v8, s[24:27], s35 offen offset:960 sc1
    s_waitcnt vmcnt(32)
    ds_write_b128 v12, v[128:131] offset:0
    ds_write_b128 v12, v[132:135] offset:1024
    ds_write_b128 v12, v[136:139] offset:2048
    ds_write_b128 v12, v[140:143] offset:3072
    ds_write_b128 v12, v[144:147] offset:4096
    ds_write_b128 v12, v[148:151] offset:5120
    ds_write_b128 v12, v[152:155] offset:6144
    ds_write_b128 v12, v[156:159] offset:7168
    ds_write_b128 v12, v[160:163] offset:8192
    ds_write_b128 v12, v[164:167] offset:9216
    ds_write_b128 v12, v[168:171] offset:10240
    ds_write_b128 v12, v[172:175] offset:11264
    ds_write_b128 v12, v[176:179] offset:12288
    ds_write_b128 v12, v[180:183] offset:13312
    ds_write_b128 v12, v[184:187] offset:14336
    ds_write_b128 v12, v[188:191] offset:15360
    ds_write_b128 v12, v[192:195] offset:16384
    ds_write_b128 v12, v[196:199] offset:17408
    ds_write_b128 v12, v[200:203] offset:18432
    ds_write_b128 v12, v[204:207] offset:19456
    ds_write_b128 v12, v[208:211] offset:20480
    ds_write_b128 v12, v[212:215] offset:21504
    ds_write_b128 v12, v[216:219] offset:22528
    ds_write_b128 v12, v[220:223] offset:23552
    ds_write_b128 v12, v[224:227] offset:24576
    ds_write_b128 v12, v[228:231] offset:25600
    ds_write_b128 v12, v[232:235] offset:26624
    ds_write_b128 v12, v[236:239] offset:27648
    ds_write_b128 v12, v[240:243] offset:28672
    ds_write_b128 v12, v[244:247] offset:29696
    ds_write_b128 v12, v[248:251] offset:30720
    ds_write_b128 v12, v[252:255] offset:31744
    s_waitcnt lgkmcnt(0)
    s_barrier
    ds_read_b64_tr_b16 v[128:129], v13 offset:0
    ds_read_b64_tr_b16 v[130:131], v13 offset:1024
    ds_read_b64_tr_b16 v[132:133], v13 offset:8192
    ds_read_b64_tr_b16 v[134:135], v13 offset:9216
    ds_read_b64_tr_b16 v[136:137], v13 offset:16384
    ds_read_b64_tr_b16 v[138:139], v13 offset:17408
    ds_read_b64_tr_b16 v[140:141], v13 offset:24576
    ds_read_b64_tr_b16 v[142:143], v13 offset:25600
    ds_read_b64_tr_b16 v[144:145], v13 offset:32768
    ds_read_b64_tr_b16 v[146:147], v13 offset:33792
    ds_read_b64_tr_b16 v[148:149], v13 offset:40960
    ds_read_b64_tr_b16 v[150:151], v13 offset:41984
    ds_read_b64_tr_b16 v[152:153], v13 offset:49152
    ds_read_b64_tr_b16 v[154:155], v13 offset:50176
    ds_read_b64_tr_b16 v[156:157], v13 offset:57344
    ds_read_b64_tr_b16 v[158:159], v13 offset:58368
    ds_read_b64_tr_b16 v[160:161], v14 offset:0
    ds_read_b64_tr_b16 v[162:163], v14 offset:1024
    ds_read_b64_tr_b16 v[164:165], v14 offset:8192
    ds_read_b64_tr_b16 v[166:167], v14 offset:9216
    ds_read_b64_tr_b16 v[168:169], v14 offset:16384
    ds_read_b64_tr_b16 v[170:171], v14 offset:17408
    ds_read_b64_tr_b16 v[172:173], v14 offset:24576
    ds_read_b64_tr_b16 v[174:175], v14 offset:25600
    ds_read_b64_tr_b16 v[176:177], v14 offset:32768
    ds_read_b64_tr_b16 v[178:179], v14 offset:33792
    ds_read_b64_tr_b16 v[180:181], v14 offset:40960
    ds_read_b64_tr_b16 v[182:183], v14 offset:41984
    ds_read_b64_tr_b16 v[184:185], v14 offset:49152
    ds_read_b64_tr_b16 v[186:187], v14 offset:50176
    ds_read_b64_tr_b16 v[188:189], v14 offset:57344
    ds_read_b64_tr_b16 v[190:191], v14 offset:58368
    ds_read_b64_tr_b16 v[192:193], v13 offset:8
    ds_read_b64_tr_b16 v[194:195], v13 offset:1032
    ds_read_b64_tr_b16 v[196:197], v13 offset:8200
    ds_read_b64_tr_b16 v[198:199], v13 offset:9224
    ds_read_b64_tr_b16 v[200:201], v13 offset:16392
    ds_read_b64_tr_b16 v[202:203], v13 offset:17416
    ds_read_b64_tr_b16 v[204:205], v13 offset:24584
    ds_read_b64_tr_b16 v[206:207], v13 offset:25608
    ds_read_b64_tr_b16 v[208:209], v13 offset:32776
    ds_read_b64_tr_b16 v[210:211], v13 offset:33800
    ds_read_b64_tr_b16 v[212:213], v13 offset:40968
    ds_read_b64_tr_b16 v[214:215], v13 offset:41992
    ds_read_b64_tr_b16 v[216:217], v13 offset:49160
    ds_read_b64_tr_b16 v[218:219], v13 offset:50184
    ds_read_b64_tr_b16 v[220:221], v13 offset:57352
    ds_read_b64_tr_b16 v[222:223], v13 offset:58376
    ds_read_b64_tr_b16 v[224:225], v14 offset:8
    ds_read_b64_tr_b16 v[226:227], v14 offset:1032
    ds_read_b64_tr_b16 v[228:229], v14 offset:8200
    ds_read_b64_tr_b16 v[230:231], v14 offset:9224
    ds_read_b64_tr_b16 v[232:233], v14 offset:16392
    ds_read_b64_tr_b16 v[234:235], v14 offset:17416
    ds_read_b64_tr_b16 v[236:237], v14 offset:24584
    ds_read_b64_tr_b16 v[238:239], v14 offset:25608
    ds_read_b64_tr_b16 v[240:241], v14 offset:32776
    ds_read_b64_tr_b16 v[242:243], v14 offset:33800
    ds_read_b64_tr_b16 v[244:245], v14 offset:40968
    ds_read_b64_tr_b16 v[246:247], v14 offset:41992
    ds_read_b64_tr_b16 v[248:249], v14 offset:49160
    ds_read_b64_tr_b16 v[250:251], v14 offset:50184
    ds_read_b64_tr_b16 v[252:253], v14 offset:57352
    ds_read_b64_tr_b16 v[254:255], v14 offset:58376
    s_waitcnt lgkmcnt(0)
    s_barrier
    s_waitcnt vmcnt(0)
    ds_write_b128 v11, v[64:67] offset:0
    ds_write_b128 v11, v[68:71] offset:1024
    ds_write_b128 v11, v[72:75] offset:2048
    ds_write_b128 v11, v[76:79] offset:3072
    ds_write_b128 v11, v[80:83] offset:4096
    ds_write_b128 v11, v[84:87] offset:5120
    ds_write_b128 v11, v[88:91] offset:6144
    ds_write_b128 v11, v[92:95] offset:7168
    ds_write_b128 v11, v[96:99] offset:8192
    ds_write_b128 v11, v[100:103] offset:9216
    ds_write_b128 v11, v[104:107] offset:10240
    ds_write_b128 v11, v[108:111] offset:11264
    ds_write_b128 v11, v[112:115] offset:12288
    ds_write_b128 v11, v[116:119] offset:13312
    ds_write_b128 v11, v[120:123] offset:14336
    ds_write_b128 v11, v[124:127] offset:15360
    ds_write_b128 v11, a[0:3] offset:16384
    ds_write_b128 v11, a[4:7] offset:17408
    ds_write_b128 v11, a[8:11] offset:18432
    ds_write_b128 v11, a[12:15] offset:19456
    ds_write_b128 v11, a[16:19] offset:20480
    ds_write_b128 v11, a[20:23] offset:21504
    ds_write_b128 v11, a[24:27] offset:22528
    ds_write_b128 v11, a[28:31] offset:23552
    ds_write_b128 v11, a[32:35] offset:24576
    ds_write_b128 v11, a[36:39] offset:25600
    ds_write_b128 v11, a[40:43] offset:26624
    ds_write_b128 v11, a[44:47] offset:27648
    ds_write_b128 v11, a[48:51] offset:28672
    ds_write_b128 v11, a[52:55] offset:29696
    ds_write_b128 v11, a[56:59] offset:30720
    ds_write_b128 v11, a[60:63] offset:31744
    v_lshlrev_b32 v9, 8, v6
    v_lshl_add_u32 v9, v5, 4, v9
    v_lshl_add_u32 v9, v2, 6, v9
    v_lshl_add_u32 v10, v2, 5, v6
    v_lshlrev_b32 v10, 6, v10
    v_lshl_add_u32 v10, v5, 4, v10
    v_mov_b32 v28, 1
    v_add_u32 v29, 2048, v3
    v_add_u32 v31, 67584, v3
    s_lshl_b32 s35, s30, 7
    s_add_u32 s35, s35, s28
    s_lshl_b32 s35, s35, 13
    s_add_u32 s36, s35, 0x4000000
    s_add_u32 s37, s35, 0x3000000
    s_add_u32 s35, s35, 0x2000000
    s_lshl_b32 s38, s28, 6
    s_lshl_b32 s39, s30, 2
    s_add_u32 s38, s38, s39
    s_lshl_b32 s38, s38, 2
    s_add_u32 s38, s38, s29
    s_add_u32 s38, s38, 0x228000
    s_waitcnt lgkmcnt(0)
    s_barrier
    ds_read_b128 v[64:67], v29 offset:0
    ds_read_b128 v[68:71], v29 offset:1024
    ds_read_b128 v[72:75], v29 offset:2048
    ds_read_b128 v[76:79], v29 offset:3072
    ds_read_b128 v[80:83], v29 offset:4096
    ds_read_b128 v[84:87], v29 offset:5120
    ds_read_b128 v[88:91], v29 offset:6144
    ds_read_b128 v[92:95], v29 offset:7168
    ds_read_b128 v[96:99], v29 offset:8192
    ds_read_b128 v[100:103], v29 offset:9216
    ds_read_b128 v[104:107], v29 offset:10240
    ds_read_b128 v[108:111], v29 offset:11264
    ds_read_b128 v[112:115], v29 offset:12288
    ds_read_b128 v[116:119], v29 offset:13312
    ds_read_b128 v[120:123], v29 offset:14336
    ds_read_b128 v[124:127], v29 offset:15360
    s_waitcnt lgkmcnt(15)
    v_mfma_f32_16x16x32_bf16 v[48:51], a[128:131], v[64:67], 0
    v_mfma_f32_16x16x32_bf16 v[52:55], a[192:195], v[64:67], 0
    v_mfma_f32_16x16x32_bf16 v[56:59], v[64:67], v[128:131], 0
    v_mfma_f32_16x16x32_bf16 v[60:63], v[64:67], v[192:195], 0
    ds_read_b128 v[64:67], v29 offset:16384
    s_waitcnt lgkmcnt(15)
    v_mfma_f32_16x16x32_bf16 v[48:51], a[132:135], v[68:71], v[48:51]
    v_mfma_f32_16x16x32_bf16 v[52:55], a[196:199], v[68:71], v[52:55]
    v_mfma_f32_16x16x32_bf16 v[56:59], v[68:71], v[132:135], v[56:59]
    v_mfma_f32_16x16x32_bf16 v[60:63], v[68:71], v[196:199], v[60:63]
    ds_read_b128 v[68:71], v29 offset:17408
    s_waitcnt lgkmcnt(15)
    v_mfma_f32_16x16x32_bf16 v[48:51], a[136:139], v[72:75], v[48:51]
    v_mfma_f32_16x16x32_bf16 v[52:55], a[200:203], v[72:75], v[52:55]
    v_mfma_f32_16x16x32_bf16 v[56:59], v[72:75], v[136:139], v[56:59]
    v_mfma_f32_16x16x32_bf16 v[60:63], v[72:75], v[200:203], v[60:63]
    ds_read_b128 v[72:75], v29 offset:18432
    s_waitcnt lgkmcnt(15)
    v_mfma_f32_16x16x32_bf16 v[48:51], a[140:143], v[76:79], v[48:51]
    v_mfma_f32_16x16x32_bf16 v[52:55], a[204:207], v[76:79], v[52:55]
    v_mfma_f32_16x16x32_bf16 v[56:59], v[76:79], v[140:143], v[56:59]
    v_mfma_f32_16x16x32_bf16 v[60:63], v[76:79], v[204:207], v[60:63]
    ds_read_b128 v[76:79], v29 offset:19456
    s_waitcnt lgkmcnt(15)
    v_mfma_f32_16x16x32_bf16 v[48:51], a[144:147], v[80:83], v[48:51]
    v_mfma_f32_16x16x32_bf16 v[52:55], a[208:211], v[80:83], v[52:55]
    v_mfma_f32_16x16x32_bf16 v[56:59], v[80:83], v[144:147], v[56:59]
    v_mfma_f32_16x16x32_bf16 v[60:63], v[80:83], v[208:211], v[60:63]
    ds_read_b128 v[80:83], v29 offset:20480
    s_waitcnt lgkmcnt(15)
    v_mfma_f32_16x16x32_bf16 v[48:51], a[148:151], v[84:87], v[48:51]
    v_mfma_f32_16x16x32_bf16 v[52:55], a[212:215], v[84:87], v[52:55]
    v_mfma_f32_16x16x32_bf16 v[56:59], v[84:87], v[148:151], v[56:59]
    v_mfma_f32_16x16x32_bf16 v[60:63], v[84:87], v[212:215], v[60:63]
    ds_read_b128 v[84:87], v29 offset:21504
    s_waitcnt lgkmcnt(15)
    v_mfma_f32_16x16x32_bf16 v[48:51], a[152:155], v[88:91], v[48:51]
    v_mfma_f32_16x16x32_bf16 v[52:55], a[216:219], v[88:91], v[52:55]
    v_mfma_f32_16x16x32_bf16 v[56:59], v[88:91], v[152:155], v[56:59]
    v_mfma_f32_16x16x32_bf16 v[60:63], v[88:91], v[216:219], v[60:63]
    ds_read_b128 v[88:91], v29 offset:22528
    s_waitcnt lgkmcnt(15)
    v_mfma_f32_16x16x32_bf16 v[48:51], a[156:159], v[92:95], v[48:51]
    v_mfma_f32_16x16x32_bf16 v[52:55], a[220:223], v[92:95], v[52:55]
    v_mfma_f32_16x16x32_bf16 v[56:59], v[92:95], v[156:159], v[56:59]
    v_mfma_f32_16x16x32_bf16 v[60:63], v[92:95], v[220:223], v[60:63]
    ds_read_b128 v[92:95], v29 offset:23552
    s_waitcnt lgkmcnt(15)
    v_mfma_f32_16x16x32_bf16 v[48:51], a[160:163], v[96:99], v[48:51]
    v_mfma_f32_16x16x32_bf16 v[52:55], a[224:227], v[96:99], v[52:55]
    v_mfma_f32_16x16x32_bf16 v[56:59], v[96:99], v[160:163], v[56:59]
    v_mfma_f32_16x16x32_bf16 v[60:63], v[96:99], v[224:227], v[60:63]
    ds_read_b128 v[96:99], v29 offset:24576
    s_waitcnt lgkmcnt(15)
    v_mfma_f32_16x16x32_bf16 v[48:51], a[164:167], v[100:103], v[48:51]
    v_mfma_f32_16x16x32_bf16 v[52:55], a[228:231], v[100:103], v[52:55]
    v_mfma_f32_16x16x32_bf16 v[56:59], v[100:103], v[164:167], v[56:59]
    v_mfma_f32_16x16x32_bf16 v[60:63], v[100:103], v[228:231], v[60:63]
    ds_read_b128 v[100:103], v29 offset:25600
    s_waitcnt lgkmcnt(15)
    v_mfma_f32_16x16x32_bf16 v[48:51], a[168:171], v[104:107], v[48:51]
    v_mfma_f32_16x16x32_bf16 v[52:55], a[232:235], v[104:107], v[52:55]
    v_mfma_f32_16x16x32_bf16 v[56:59], v[104:107], v[168:171], v[56:59]
    v_mfma_f32_16x16x32_bf16 v[60:63], v[104:107], v[232:235], v[60:63]
    ds_read_b128 v[104:107], v29 offset:26624
    s_waitcnt lgkmcnt(15)
    v_mfma_f32_16x16x32_bf16 v[48:51], a[172:175], v[108:111], v[48:51]
    v_mfma_f32_16x16x32_bf16 v[52:55], a[236:239], v[108:111], v[52:55]
    v_mfma_f32_16x16x32_bf16 v[56:59], v[108:111], v[172:175], v[56:59]
    v_mfma_f32_16x16x32_bf16 v[60:63], v[108:111], v[236:239], v[60:63]
    ds_read_b128 v[108:111], v29 offset:27648
    s_waitcnt lgkmcnt(15)
    v_mfma_f32_16x16x32_bf16 v[48:51], a[176:179], v[112:115], v[48:51]
    v_mfma_f32_16x16x32_bf16 v[52:55], a[240:243], v[112:115], v[52:55]
    v_mfma_f32_16x16x32_bf16 v[56:59], v[112:115], v[176:179], v[56:59]
    v_mfma_f32_16x16x32_bf16 v[60:63], v[112:115], v[240:243], v[60:63]
    ds_read_b128 v[112:115], v29 offset:28672
    s_waitcnt lgkmcnt(15)
    v_mfma_f32_16x16x32_bf16 v[48:51], a[180:183], v[116:119], v[48:51]
    v_mfma_f32_16x16x32_bf16 v[52:55], a[244:247], v[116:119], v[52:55]
    v_mfma_f32_16x16x32_bf16 v[56:59], v[116:119], v[180:183], v[56:59]
    v_mfma_f32_16x16x32_bf16 v[60:63], v[116:119], v[244:247], v[60:63]
    ds_read_b128 v[116:119], v29 offset:29696
    s_waitcnt lgkmcnt(15)
    v_mfma_f32_16x16x32_bf16 v[48:51], a[184:187], v[120:123], v[48:51]
    v_mfma_f32_16x16x32_bf16 v[52:55], a[248:251], v[120:123], v[52:55]
    v_mfma_f32_16x16x32_bf16 v[56:59], v[120:123], v[184:187], v[56:59]
    v_mfma_f32_16x16x32_bf16 v[60:63], v[120:123], v[248:251], v[60:63]
    ds_read_b128 v[120:123], v29 offset:30720
    s_waitcnt lgkmcnt(15)
    v_mfma_f32_16x16x32_bf16 v[48:51], a[188:191], v[124:127], v[48:51]
    v_mfma_f32_16x16x32_bf16 v[52:55], a[252:255], v[124:127], v[52:55]
    v_mfma_f32_16x16x32_bf16 v[56:59], v[124:127], v[188:191], v[56:59]
    v_mfma_f32_16x16x32_bf16 v[60:63], v[124:127], v[252:255], v[60:63]
    ds_read_b128 v[124:127], v29 offset:31744
    s_nop 7
    v_cvt_pk_bf16_f32 v16, v48, v49
    v_cvt_pk_bf16_f32 v17, v50, v51
    v_cvt_pk_bf16_f32 v18, v52, v53
    v_cvt_pk_bf16_f32 v19, v54, v55
    buffer_store_dwordx4 v[16:19], v9, s[24:27], s37 offen offset:0 sc1
    v_cvt_pk_bf16_f32 v20, v56, v57
    v_cvt_pk_bf16_f32 v21, v58, v59
    v_cvt_pk_bf16_f32 v24, v60, v61
    v_cvt_pk_bf16_f32 v25, v62, v63
    s_nop 1
    s_waitcnt lgkmcnt(15)
    v_mfma_f32_16x16x32_bf16 v[48:51], a[128:131], v[64:67], 0
    v_mfma_f32_16x16x32_bf16 v[52:55], a[192:195], v[64:67], 0
    v_mfma_f32_16x16x32_bf16 v[56:59], v[64:67], v[128:131], 0
    v_mfma_f32_16x16x32_bf16 v[60:63], v[64:67], v[192:195], 0
    ds_read_b128 v[64:67], v29 offset:32768
    s_waitcnt lgkmcnt(15)
    v_mfma_f32_16x16x32_bf16 v[48:51], a[132:135], v[68:71], v[48:51]
    v_mfma_f32_16x16x32_bf16 v[52:55], a[196:199], v[68:71], v[52:55]
    v_mfma_f32_16x16x32_bf16 v[56:59], v[68:71], v[132:135], v[56:59]
    v_mfma_f32_16x16x32_bf16 v[60:63], v[68:71], v[196:199], v[60:63]
    ds_read_b128 v[68:71], v29 offset:33792
    s_waitcnt lgkmcnt(15)
    v_mfma_f32_16x16x32_bf16 v[48:51], a[136:139], v[72:75], v[48:51]
    v_mfma_f32_16x16x32_bf16 v[52:55], a[200:203], v[72:75], v[52:55]
    v_mfma_f32_16x16x32_bf16 v[56:59], v[72:75], v[136:139], v[56:59]
    v_mfma_f32_16x16x32_bf16 v[60:63], v[72:75], v[200:203], v[60:63]
    ds_read_b128 v[72:75], v29 offset:34816
    s_waitcnt lgkmcnt(15)
    v_mfma_f32_16x16x32_bf16 v[48:51], a[140:143], v[76:79], v[48:51]
    v_mfma_f32_16x16x32_bf16 v[52:55], a[204:207], v[76:79], v[52:55]
    v_mfma_f32_16x16x32_bf16 v[56:59], v[76:79], v[140:143], v[56:59]
    v_mfma_f32_16x16x32_bf16 v[60:63], v[76:79], v[204:207], v[60:63]
    ds_read_b128 v[76:79], v29 offset:35840
    s_waitcnt lgkmcnt(15)
    v_mfma_f32_16x16x32_bf16 v[48:51], a[144:147], v[80:83], v[48:51]
    v_mfma_f32_16x16x32_bf16 v[52:55], a[208:211], v[80:83], v[52:55]
    v_mfma_f32_16x16x32_bf16 v[56:59], v[80:83], v[144:147], v[56:59]
    v_mfma_f32_16x16x32_bf16 v[60:63], v[80:83], v[208:211], v[60:63]
    ds_read_b128 v[80:83], v29 offset:36864
    s_waitcnt lgkmcnt(15)
    v_mfma_f32_16x16x32_bf16 v[48:51], a[148:151], v[84:87], v[48:51]
    v_mfma_f32_16x16x32_bf16 v[52:55], a[212:215], v[84:87], v[52:55]
    v_mfma_f32_16x16x32_bf16 v[56:59], v[84:87], v[148:151], v[56:59]
    v_mfma_f32_16x16x32_bf16 v[60:63], v[84:87], v[212:215], v[60:63]
    ds_read_b128 v[84:87], v29 offset:37888
    s_waitcnt lgkmcnt(15)
    v_mfma_f32_16x16x32_bf16 v[48:51], a[152:155], v[88:91], v[48:51]
    v_mfma_f32_16x16x32_bf16 v[52:55], a[216:219], v[88:91], v[52:55]
    v_mfma_f32_16x16x32_bf16 v[56:59], v[88:91], v[152:155], v[56:59]
    v_mfma_f32_16x16x32_bf16 v[60:63], v[88:91], v[216:219], v[60:63]
    ds_read_b128 v[88:91], v29 offset:38912
    s_waitcnt lgkmcnt(15)
    v_mfma_f32_16x16x32_bf16 v[48:51], a[156:159], v[92:95], v[48:51]
    v_mfma_f32_16x16x32_bf16 v[52:55], a[220:223], v[92:95], v[52:55]
    v_mfma_f32_16x16x32_bf16 v[56:59], v[92:95], v[156:159], v[56:59]
    v_mfma_f32_16x16x32_bf16 v[60:63], v[92:95], v[220:223], v[60:63]
    ds_read_b128 v[92:95], v29 offset:39936
    s_waitcnt lgkmcnt(15)
    v_mfma_f32_16x16x32_bf16 v[48:51], a[160:163], v[96:99], v[48:51]
    v_mfma_f32_16x16x32_bf16 v[52:55], a[224:227], v[96:99], v[52:55]
    v_mfma_f32_16x16x32_bf16 v[56:59], v[96:99], v[160:163], v[56:59]
    v_mfma_f32_16x16x32_bf16 v[60:63], v[96:99], v[224:227], v[60:63]
    ds_read_b128 v[96:99], v29 offset:40960
    s_waitcnt lgkmcnt(15)
    v_mfma_f32_16x16x32_bf16 v[48:51], a[164:167], v[100:103], v[48:51]
    v_mfma_f32_16x16x32_bf16 v[52:55], a[228:231], v[100:103], v[52:55]
    v_mfma_f32_16x16x32_bf16 v[56:59], v[100:103], v[164:167], v[56:59]
    v_mfma_f32_16x16x32_bf16 v[60:63], v[100:103], v[228:231], v[60:63]
    ds_read_b128 v[100:103], v29 offset:41984
    s_waitcnt lgkmcnt(15)
    v_mfma_f32_16x16x32_bf16 v[48:51], a[168:171], v[104:107], v[48:51]
    v_mfma_f32_16x16x32_bf16 v[52:55], a[232:235], v[104:107], v[52:55]
    v_mfma_f32_16x16x32_bf16 v[56:59], v[104:107], v[168:171], v[56:59]
    v_mfma_f32_16x16x32_bf16 v[60:63], v[104:107], v[232:235], v[60:63]
    ds_read_b128 v[104:107], v29 offset:43008
    s_waitcnt lgkmcnt(15)
    v_mfma_f32_16x16x32_bf16 v[48:51], a[172:175], v[108:111], v[48:51]
    v_mfma_f32_16x16x32_bf16 v[52:55], a[236:239], v[108:111], v[52:55]
    v_mfma_f32_16x16x32_bf16 v[56:59], v[108:111], v[172:175], v[56:59]
    v_mfma_f32_16x16x32_bf16 v[60:63], v[108:111], v[236:239], v[60:63]
    ds_read_b128 v[108:111], v29 offset:44032
    s_waitcnt lgkmcnt(15)
    v_mfma_f32_16x16x32_bf16 v[48:51], a[176:179], v[112:115], v[48:51]
    v_mfma_f32_16x16x32_bf16 v[52:55], a[240:243], v[112:115], v[52:55]
    v_mfma_f32_16x16x32_bf16 v[56:59], v[112:115], v[176:179], v[56:59]
    v_mfma_f32_16x16x32_bf16 v[60:63], v[112:115], v[240:243], v[60:63]
    ds_read_b128 v[112:115], v29 offset:45056
    s_waitcnt lgkmcnt(15)
    v_mfma_f32_16x16x32_bf16 v[48:51], a[180:183], v[116:119], v[48:51]
    v_mfma_f32_16x16x32_bf16 v[52:55], a[244:247], v[116:119], v[52:55]
    v_mfma_f32_16x16x32_bf16 v[56:59], v[116:119], v[180:183], v[56:59]
    v_mfma_f32_16x16x32_bf16 v[60:63], v[116:119], v[244:247], v[60:63]
    ds_read_b128 v[116:119], v29 offset:46080
    s_waitcnt lgkmcnt(15)
    v_mfma_f32_16x16x32_bf16 v[48:51], a[184:187], v[120:123], v[48:51]
    v_mfma_f32_16x16x32_bf16 v[52:55], a[248:251], v[120:123], v[52:55]
    v_mfma_f32_16x16x32_bf16 v[56:59], v[120:123], v[184:187], v[56:59]
    v_mfma_f32_16x16x32_bf16 v[60:63], v[120:123], v[248:251], v[60:63]
    ds_read_b128 v[120:123], v29 offset:47104
    s_waitcnt lgkmcnt(15)
    v_mfma_f32_16x16x32_bf16 v[48:51], a[188:191], v[124:127], v[48:51]
    v_mfma_f32_16x16x32_bf16 v[52:55], a[252:255], v[124:127], v[52:55]
    v_mfma_f32_16x16x32_bf16 v[56:59], v[124:127], v[188:191], v[56:59]
    v_mfma_f32_16x16x32_bf16 v[60:63], v[124:127], v[252:255], v[60:63]
    ds_read_b128 v[124:127], v29 offset:48128
    s_nop 7
    v_cvt_pk_bf16_f32 v16, v48, v49
    v_cvt_pk_bf16_f32 v17, v50, v51
    v_cvt_pk_bf16_f32 v18, v52, v53
    v_cvt_pk_bf16_f32 v19, v54, v55
    buffer_store_dwordx4 v[16:19], v9, s[24:27], s37 offen offset:1024 sc1
    v_cvt_pk_bf16_f32 v22, v56, v57
    v_cvt_pk_bf16_f32 v23, v58, v59
    v_cvt_pk_bf16_f32 v26, v60, v61
    v_cvt_pk_bf16_f32 v27, v62, v63
    buffer_store_dwordx4 v[20:23], v10, s[24:27], s36 offen sc1
    buffer_store_dwordx4 v[24:27], v10, s[24:27], s36 offen offset:256 sc1
    s_waitcnt vmcnt(0)
    s_mov_b64 exec, 1
    buffer_store_byte v28, off, s[24:27], s38 sc1
    s_mov_b64 exec, -1
    s_add_u32 s38, s38, 4
    s_add_u32 s35, s35, 0x40000
    s_add_u32 s36, s36, 0x40000
    s_add_u32 s37, s37, 0x40000
    s_nop 1
    s_waitcnt lgkmcnt(15)
    v_mfma_f32_16x16x32_bf16 v[48:51], a[128:131], v[64:67], 0
    v_mfma_f32_16x16x32_bf16 v[52:55], a[192:195], v[64:67], 0
    v_mfma_f32_16x16x32_bf16 v[56:59], v[64:67], v[128:131], 0
    v_mfma_f32_16x16x32_bf16 v[60:63], v[64:67], v[192:195], 0
    ds_read_b128 v[64:67], v29 offset:49152
    s_waitcnt lgkmcnt(15)
    v_mfma_f32_16x16x32_bf16 v[48:51], a[132:135], v[68:71], v[48:51]
    v_mfma_f32_16x16x32_bf16 v[52:55], a[196:199], v[68:71], v[52:55]
    v_mfma_f32_16x16x32_bf16 v[56:59], v[68:71], v[132:135], v[56:59]
    v_mfma_f32_16x16x32_bf16 v[60:63], v[68:71], v[196:199], v[60:63]
    ds_read_b128 v[68:71], v29 offset:50176
    s_waitcnt lgkmcnt(15)
    v_mfma_f32_16x16x32_bf16 v[48:51], a[136:139], v[72:75], v[48:51]
    v_mfma_f32_16x16x32_bf16 v[52:55], a[200:203], v[72:75], v[52:55]
    v_mfma_f32_16x16x32_bf16 v[56:59], v[72:75], v[136:139], v[56:59]
    v_mfma_f32_16x16x32_bf16 v[60:63], v[72:75], v[200:203], v[60:63]
    ds_read_b128 v[72:75], v29 offset:51200
    s_waitcnt lgkmcnt(15)
    v_mfma_f32_16x16x32_bf16 v[48:51], a[140:143], v[76:79], v[48:51]
    v_mfma_f32_16x16x32_bf16 v[52:55], a[204:207], v[76:79], v[52:55]
    v_mfma_f32_16x16x32_bf16 v[56:59], v[76:79], v[140:143], v[56:59]
    v_mfma_f32_16x16x32_bf16 v[60:63], v[76:79], v[204:207], v[60:63]
    ds_read_b128 v[76:79], v29 offset:52224
    s_waitcnt lgkmcnt(15)
    v_mfma_f32_16x16x32_bf16 v[48:51], a[144:147], v[80:83], v[48:51]
    v_mfma_f32_16x16x32_bf16 v[52:55], a[208:211], v[80:83], v[52:55]
    v_mfma_f32_16x16x32_bf16 v[56:59], v[80:83], v[144:147], v[56:59]
    v_mfma_f32_16x16x32_bf16 v[60:63], v[80:83], v[208:211], v[60:63]
    ds_read_b128 v[80:83], v29 offset:53248
    s_waitcnt lgkmcnt(15)
    v_mfma_f32_16x16x32_bf16 v[48:51], a[148:151], v[84:87], v[48:51]
    v_mfma_f32_16x16x32_bf16 v[52:55], a[212:215], v[84:87], v[52:55]
    v_mfma_f32_16x16x32_bf16 v[56:59], v[84:87], v[148:151], v[56:59]
    v_mfma_f32_16x16x32_bf16 v[60:63], v[84:87], v[212:215], v[60:63]
    ds_read_b128 v[84:87], v29 offset:54272
    s_waitcnt lgkmcnt(15)
    v_mfma_f32_16x16x32_bf16 v[48:51], a[152:155], v[88:91], v[48:51]
    v_mfma_f32_16x16x32_bf16 v[52:55], a[216:219], v[88:91], v[52:55]
    v_mfma_f32_16x16x32_bf16 v[56:59], v[88:91], v[152:155], v[56:59]
    v_mfma_f32_16x16x32_bf16 v[60:63], v[88:91], v[216:219], v[60:63]
    ds_read_b128 v[88:91], v29 offset:55296
    s_waitcnt lgkmcnt(15)
    v_mfma_f32_16x16x32_bf16 v[48:51], a[156:159], v[92:95], v[48:51]
    v_mfma_f32_16x16x32_bf16 v[52:55], a[220:223], v[92:95], v[52:55]
    v_mfma_f32_16x16x32_bf16 v[56:59], v[92:95], v[156:159], v[56:59]
    v_mfma_f32_16x16x32_bf16 v[60:63], v[92:95], v[220:223], v[60:63]
    ds_read_b128 v[92:95], v29 offset:56320
    s_waitcnt lgkmcnt(15)
    v_mfma_f32_16x16x32_bf16 v[48:51], a[160:163], v[96:99], v[48:51]
    v_mfma_f32_16x16x32_bf16 v[52:55], a[224:227], v[96:99], v[52:55]
    v_mfma_f32_16x16x32_bf16 v[56:59], v[96:99], v[160:163], v[56:59]
    v_mfma_f32_16x16x32_bf16 v[60:63], v[96:99], v[224:227], v[60:63]
    ds_read_b128 v[96:99], v29 offset:57344
    s_waitcnt lgkmcnt(15)
    v_mfma_f32_16x16x32_bf16 v[48:51], a[164:167], v[100:103], v[48:51]
    v_mfma_f32_16x16x32_bf16 v[52:55], a[228:231], v[100:103], v[52:55]
    v_mfma_f32_16x16x32_bf16 v[56:59], v[100:103], v[164:167], v[56:59]
    v_mfma_f32_16x16x32_bf16 v[60:63], v[100:103], v[228:231], v[60:63]
    ds_read_b128 v[100:103], v29 offset:58368
    s_waitcnt lgkmcnt(15)
    v_mfma_f32_16x16x32_bf16 v[48:51], a[168:171], v[104:107], v[48:51]
    v_mfma_f32_16x16x32_bf16 v[52:55], a[232:235], v[104:107], v[52:55]
    v_mfma_f32_16x16x32_bf16 v[56:59], v[104:107], v[168:171], v[56:59]
    v_mfma_f32_16x16x32_bf16 v[60:63], v[104:107], v[232:235], v[60:63]
    ds_read_b128 v[104:107], v29 offset:59392
    s_waitcnt lgkmcnt(15)
    v_mfma_f32_16x16x32_bf16 v[48:51], a[172:175], v[108:111], v[48:51]
    v_mfma_f32_16x16x32_bf16 v[52:55], a[236:239], v[108:111], v[52:55]
    v_mfma_f32_16x16x32_bf16 v[56:59], v[108:111], v[172:175], v[56:59]
    v_mfma_f32_16x16x32_bf16 v[60:63], v[108:111], v[236:239], v[60:63]
    ds_read_b128 v[108:111], v29 offset:60416
    s_waitcnt lgkmcnt(15)
    v_mfma_f32_16x16x32_bf16 v[48:51], a[176:179], v[112:115], v[48:51]
    v_mfma_f32_16x16x32_bf16 v[52:55], a[240:243], v[112:115], v[52:55]
    v_mfma_f32_16x16x32_bf16 v[56:59], v[112:115], v[176:179], v[56:59]
    v_mfma_f32_16x16x32_bf16 v[60:63], v[112:115], v[240:243], v[60:63]
    ds_read_b128 v[112:115], v29 offset:61440
    s_waitcnt lgkmcnt(15)
    v_mfma_f32_16x16x32_bf16 v[48:51], a[180:183], v[116:119], v[48:51]
    v_mfma_f32_16x16x32_bf16 v[52:55], a[244:247], v[116:119], v[52:55]
    v_mfma_f32_16x16x32_bf16 v[56:59], v[116:119], v[180:183], v[56:59]
    v_mfma_f32_16x16x32_bf16 v[60:63], v[116:119], v[244:247], v[60:63]
    ds_read_b128 v[116:119], v29 offset:62464
    s_waitcnt lgkmcnt(15)
    v_mfma_f32_16x16x32_bf16 v[48:51], a[184:187], v[120:123], v[48:51]
    v_mfma_f32_16x16x32_bf16 v[52:55], a[248:251], v[120:123], v[52:55]
    v_mfma_f32_16x16x32_bf16 v[56:59], v[120:123], v[184:187], v[56:59]
    v_mfma_f32_16x16x32_bf16 v[60:63], v[120:123], v[248:251], v[60:63]
    ds_read_b128 v[120:123], v29 offset:63488
    s_waitcnt lgkmcnt(15)
    v_mfma_f32_16x16x32_bf16 v[48:51], a[188:191], v[124:127], v[48:51]
    v_mfma_f32_16x16x32_bf16 v[52:55], a[252:255], v[124:127], v[52:55]
    v_mfma_f32_16x16x32_bf16 v[56:59], v[124:127], v[188:191], v[56:59]
    v_mfma_f32_16x16x32_bf16 v[60:63], v[124:127], v[252:255], v[60:63]
    ds_read_b128 v[124:127], v29 offset:64512
    s_nop 7
    v_cvt_pk_bf16_f32 v16, v48, v49
    v_cvt_pk_bf16_f32 v17, v50, v51
    v_cvt_pk_bf16_f32 v18, v52, v53
    v_cvt_pk_bf16_f32 v19, v54, v55
    buffer_store_dwordx4 v[16:19], v9, s[24:27], s37 offen offset:0 sc1
    v_cvt_pk_bf16_f32 v20, v56, v57
    v_cvt_pk_bf16_f32 v21, v58, v59
    v_cvt_pk_bf16_f32 v24, v60, v61
    v_cvt_pk_bf16_f32 v25, v62, v63
    s_nop 1
    s_waitcnt lgkmcnt(15)
    v_mfma_f32_16x16x32_bf16 v[48:51], a[128:131], v[64:67], 0
    v_mfma_f32_16x16x32_bf16 v[52:55], a[192:195], v[64:67], 0
    v_mfma_f32_16x16x32_bf16 v[56:59], v[64:67], v[128:131], 0
    v_mfma_f32_16x16x32_bf16 v[60:63], v[64:67], v[192:195], 0
    ds_read_b128 v[64:67], v31 offset:0
    s_waitcnt lgkmcnt(15)
    v_mfma_f32_16x16x32_bf16 v[48:51], a[132:135], v[68:71], v[48:51]
    v_mfma_f32_16x16x32_bf16 v[52:55], a[196:199], v[68:71], v[52:55]
    v_mfma_f32_16x16x32_bf16 v[56:59], v[68:71], v[132:135], v[56:59]
    v_mfma_f32_16x16x32_bf16 v[60:63], v[68:71], v[196:199], v[60:63]
    ds_read_b128 v[68:71], v31 offset:1024
    s_waitcnt lgkmcnt(15)
    v_mfma_f32_16x16x32_bf16 v[48:51], a[136:139], v[72:75], v[48:51]
    v_mfma_f32_16x16x32_bf16 v[52:55], a[200:203], v[72:75], v[52:55]
    v_mfma_f32_16x16x32_bf16 v[56:59], v[72:75], v[136:139], v[56:59]
    v_mfma_f32_16x16x32_bf16 v[60:63], v[72:75], v[200:203], v[60:63]
    ds_read_b128 v[72:75], v31 offset:2048
    s_waitcnt lgkmcnt(15)
    v_mfma_f32_16x16x32_bf16 v[48:51], a[140:143], v[76:79], v[48:51]
    v_mfma_f32_16x16x32_bf16 v[52:55], a[204:207], v[76:79], v[52:55]
    v_mfma_f32_16x16x32_bf16 v[56:59], v[76:79], v[140:143], v[56:59]
    v_mfma_f32_16x16x32_bf16 v[60:63], v[76:79], v[204:207], v[60:63]
    ds_read_b128 v[76:79], v31 offset:3072
    s_waitcnt lgkmcnt(15)
    v_mfma_f32_16x16x32_bf16 v[48:51], a[144:147], v[80:83], v[48:51]
    v_mfma_f32_16x16x32_bf16 v[52:55], a[208:211], v[80:83], v[52:55]
    v_mfma_f32_16x16x32_bf16 v[56:59], v[80:83], v[144:147], v[56:59]
    v_mfma_f32_16x16x32_bf16 v[60:63], v[80:83], v[208:211], v[60:63]
    ds_read_b128 v[80:83], v31 offset:4096
    s_waitcnt lgkmcnt(15)
    v_mfma_f32_16x16x32_bf16 v[48:51], a[148:151], v[84:87], v[48:51]
    v_mfma_f32_16x16x32_bf16 v[52:55], a[212:215], v[84:87], v[52:55]
    v_mfma_f32_16x16x32_bf16 v[56:59], v[84:87], v[148:151], v[56:59]
    v_mfma_f32_16x16x32_bf16 v[60:63], v[84:87], v[212:215], v[60:63]
    ds_read_b128 v[84:87], v31 offset:5120
    s_waitcnt lgkmcnt(15)
    v_mfma_f32_16x16x32_bf16 v[48:51], a[152:155], v[88:91], v[48:51]
    v_mfma_f32_16x16x32_bf16 v[52:55], a[216:219], v[88:91], v[52:55]
    v_mfma_f32_16x16x32_bf16 v[56:59], v[88:91], v[152:155], v[56:59]
    v_mfma_f32_16x16x32_bf16 v[60:63], v[88:91], v[216:219], v[60:63]
    ds_read_b128 v[88:91], v31 offset:6144
    s_waitcnt lgkmcnt(15)
    v_mfma_f32_16x16x32_bf16 v[48:51], a[156:159], v[92:95], v[48:51]
    v_mfma_f32_16x16x32_bf16 v[52:55], a[220:223], v[92:95], v[52:55]
    v_mfma_f32_16x16x32_bf16 v[56:59], v[92:95], v[156:159], v[56:59]
    v_mfma_f32_16x16x32_bf16 v[60:63], v[92:95], v[220:223], v[60:63]
    ds_read_b128 v[92:95], v31 offset:7168
    s_waitcnt lgkmcnt(15)
    v_mfma_f32_16x16x32_bf16 v[48:51], a[160:163], v[96:99], v[48:51]
    v_mfma_f32_16x16x32_bf16 v[52:55], a[224:227], v[96:99], v[52:55]
    v_mfma_f32_16x16x32_bf16 v[56:59], v[96:99], v[160:163], v[56:59]
    v_mfma_f32_16x16x32_bf16 v[60:63], v[96:99], v[224:227], v[60:63]
    ds_read_b128 v[96:99], v31 offset:8192
    s_waitcnt lgkmcnt(15)
    v_mfma_f32_16x16x32_bf16 v[48:51], a[164:167], v[100:103], v[48:51]
    v_mfma_f32_16x16x32_bf16 v[52:55], a[228:231], v[100:103], v[52:55]
    v_mfma_f32_16x16x32_bf16 v[56:59], v[100:103], v[164:167], v[56:59]
    v_mfma_f32_16x16x32_bf16 v[60:63], v[100:103], v[228:231], v[60:63]
    ds_read_b128 v[100:103], v31 offset:9216
    s_waitcnt lgkmcnt(15)
    v_mfma_f32_16x16x32_bf16 v[48:51], a[168:171], v[104:107], v[48:51]
    v_mfma_f32_16x16x32_bf16 v[52:55], a[232:235], v[104:107], v[52:55]
    v_mfma_f32_16x16x32_bf16 v[56:59], v[104:107], v[168:171], v[56:59]
    v_mfma_f32_16x16x32_bf16 v[60:63], v[104:107], v[232:235], v[60:63]
    ds_read_b128 v[104:107], v31 offset:10240
    s_waitcnt lgkmcnt(15)
    v_mfma_f32_16x16x32_bf16 v[48:51], a[172:175], v[108:111], v[48:51]
    v_mfma_f32_16x16x32_bf16 v[52:55], a[236:239], v[108:111], v[52:55]
    v_mfma_f32_16x16x32_bf16 v[56:59], v[108:111], v[172:175], v[56:59]
    v_mfma_f32_16x16x32_bf16 v[60:63], v[108:111], v[236:239], v[60:63]
    ds_read_b128 v[108:111], v31 offset:11264
    s_waitcnt lgkmcnt(15)
    v_mfma_f32_16x16x32_bf16 v[48:51], a[176:179], v[112:115], v[48:51]
    v_mfma_f32_16x16x32_bf16 v[52:55], a[240:243], v[112:115], v[52:55]
    v_mfma_f32_16x16x32_bf16 v[56:59], v[112:115], v[176:179], v[56:59]
    v_mfma_f32_16x16x32_bf16 v[60:63], v[112:115], v[240:243], v[60:63]
    ds_read_b128 v[112:115], v31 offset:12288
    s_waitcnt lgkmcnt(15)
    v_mfma_f32_16x16x32_bf16 v[48:51], a[180:183], v[116:119], v[48:51]
    v_mfma_f32_16x16x32_bf16 v[52:55], a[244:247], v[116:119], v[52:55]
    v_mfma_f32_16x16x32_bf16 v[56:59], v[116:119], v[180:183], v[56:59]
    v_mfma_f32_16x16x32_bf16 v[60:63], v[116:119], v[244:247], v[60:63]
    ds_read_b128 v[116:119], v31 offset:13312
    s_waitcnt lgkmcnt(15)
    v_mfma_f32_16x16x32_bf16 v[48:51], a[184:187], v[120:123], v[48:51]
    v_mfma_f32_16x16x32_bf16 v[52:55], a[248:251], v[120:123], v[52:55]
    v_mfma_f32_16x16x32_bf16 v[56:59], v[120:123], v[184:187], v[56:59]
    v_mfma_f32_16x16x32_bf16 v[60:63], v[120:123], v[248:251], v[60:63]
    ds_read_b128 v[120:123], v31 offset:14336
    s_waitcnt lgkmcnt(15)
    v_mfma_f32_16x16x32_bf16 v[48:51], a[188:191], v[124:127], v[48:51]
    v_mfma_f32_16x16x32_bf16 v[52:55], a[252:255], v[124:127], v[52:55]
    v_mfma_f32_16x16x32_bf16 v[56:59], v[124:127], v[188:191], v[56:59]
    v_mfma_f32_16x16x32_bf16 v[60:63], v[124:127], v[252:255], v[60:63]
    ds_read_b128 v[124:127], v31 offset:15360
    s_nop 7
    v_cvt_pk_bf16_f32 v16, v48, v49
    v_cvt_pk_bf16_f32 v17, v50, v51
    v_cvt_pk_bf16_f32 v18, v52, v53
    v_cvt_pk_bf16_f32 v19, v54, v55
    buffer_store_dwordx4 v[16:19], v9, s[24:27], s37 offen offset:1024 sc1
    v_cvt_pk_bf16_f32 v22, v56, v57
    v_cvt_pk_bf16_f32 v23, v58, v59
    v_cvt_pk_bf16_f32 v26, v60, v61
    v_cvt_pk_bf16_f32 v27, v62, v63
    buffer_store_dwordx4 v[20:23], v10, s[24:27], s36 offen sc1
    buffer_store_dwordx4 v[24:27], v10, s[24:27], s36 offen offset:256 sc1
    s_add_u32 s35, s35, 0x40000
    s_add_u32 s36, s36, 0x40000
    s_add_u32 s37, s37, 0x40000
    s_nop 1
    s_waitcnt lgkmcnt(15)
    v_mfma_f32_16x16x32_bf16 v[48:51], a[128:131], v[64:67], 0
    v_mfma_f32_16x16x32_bf16 v[52:55], a[192:195], v[64:67], 0
    v_mfma_f32_16x16x32_bf16 v[56:59], v[64:67], v[128:131], 0
    v_mfma_f32_16x16x32_bf16 v[60:63], v[64:67], v[192:195], 0
    ds_read_b128 v[64:67], v31 offset:16384
    s_waitcnt lgkmcnt(15)
    v_mfma_f32_16x16x32_bf16 v[48:51], a[132:135], v[68:71], v[48:51]
    v_mfma_f32_16x16x32_bf16 v[52:55], a[196:199], v[68:71], v[52:55]
    v_mfma_f32_16x16x32_bf16 v[56:59], v[68:71], v[132:135], v[56:59]
    v_mfma_f32_16x16x32_bf16 v[60:63], v[68:71], v[196:199], v[60:63]
    ds_read_b128 v[68:71], v31 offset:17408
    s_waitcnt lgkmcnt(15)
    v_mfma_f32_16x16x32_bf16 v[48:51], a[136:139], v[72:75], v[48:51]
    v_mfma_f32_16x16x32_bf16 v[52:55], a[200:203], v[72:75], v[52:55]
    v_mfma_f32_16x16x32_bf16 v[56:59], v[72:75], v[136:139], v[56:59]
    v_mfma_f32_16x16x32_bf16 v[60:63], v[72:75], v[200:203], v[60:63]
    ds_read_b128 v[72:75], v31 offset:18432
    s_waitcnt lgkmcnt(15)
    v_mfma_f32_16x16x32_bf16 v[48:51], a[140:143], v[76:79], v[48:51]
    v_mfma_f32_16x16x32_bf16 v[52:55], a[204:207], v[76:79], v[52:55]
    v_mfma_f32_16x16x32_bf16 v[56:59], v[76:79], v[140:143], v[56:59]
    v_mfma_f32_16x16x32_bf16 v[60:63], v[76:79], v[204:207], v[60:63]
    ds_read_b128 v[76:79], v31 offset:19456
    s_waitcnt lgkmcnt(15)
    v_mfma_f32_16x16x32_bf16 v[48:51], a[144:147], v[80:83], v[48:51]
    v_mfma_f32_16x16x32_bf16 v[52:55], a[208:211], v[80:83], v[52:55]
    v_mfma_f32_16x16x32_bf16 v[56:59], v[80:83], v[144:147], v[56:59]
    v_mfma_f32_16x16x32_bf16 v[60:63], v[80:83], v[208:211], v[60:63]
    ds_read_b128 v[80:83], v31 offset:20480
    s_waitcnt lgkmcnt(15)
    v_mfma_f32_16x16x32_bf16 v[48:51], a[148:151], v[84:87], v[48:51]
    v_mfma_f32_16x16x32_bf16 v[52:55], a[212:215], v[84:87], v[52:55]
    v_mfma_f32_16x16x32_bf16 v[56:59], v[84:87], v[148:151], v[56:59]
    v_mfma_f32_16x16x32_bf16 v[60:63], v[84:87], v[212:215], v[60:63]
    ds_read_b128 v[84:87], v31 offset:21504
    s_waitcnt lgkmcnt(15)
    v_mfma_f32_16x16x32_bf16 v[48:51], a[152:155], v[88:91], v[48:51]
    v_mfma_f32_16x16x32_bf16 v[52:55], a[216:219], v[88:91], v[52:55]
    v_mfma_f32_16x16x32_bf16 v[56:59], v[88:91], v[152:155], v[56:59]
    v_mfma_f32_16x16x32_bf16 v[60:63], v[88:91], v[216:219], v[60:63]
    ds_read_b128 v[88:91], v31 offset:22528
    s_waitcnt lgkmcnt(15)
    v_mfma_f32_16x16x32_bf16 v[48:51], a[156:159], v[92:95], v[48:51]
    v_mfma_f32_16x16x32_bf16 v[52:55], a[220:223], v[92:95], v[52:55]
    v_mfma_f32_16x16x32_bf16 v[56:59], v[92:95], v[156:159], v[56:59]
    v_mfma_f32_16x16x32_bf16 v[60:63], v[92:95], v[220:223], v[60:63]
    ds_read_b128 v[92:95], v31 offset:23552
    s_waitcnt lgkmcnt(15)
    v_mfma_f32_16x16x32_bf16 v[48:51], a[160:163], v[96:99], v[48:51]
    v_mfma_f32_16x16x32_bf16 v[52:55], a[224:227], v[96:99], v[52:55]
    v_mfma_f32_16x16x32_bf16 v[56:59], v[96:99], v[160:163], v[56:59]
    v_mfma_f32_16x16x32_bf16 v[60:63], v[96:99], v[224:227], v[60:63]
    ds_read_b128 v[96:99], v31 offset:24576
    s_waitcnt lgkmcnt(15)
    v_mfma_f32_16x16x32_bf16 v[48:51], a[164:167], v[100:103], v[48:51]
    v_mfma_f32_16x16x32_bf16 v[52:55], a[228:231], v[100:103], v[52:55]
    v_mfma_f32_16x16x32_bf16 v[56:59], v[100:103], v[164:167], v[56:59]
    v_mfma_f32_16x16x32_bf16 v[60:63], v[100:103], v[228:231], v[60:63]
    ds_read_b128 v[100:103], v31 offset:25600
    s_waitcnt lgkmcnt(15)
    v_mfma_f32_16x16x32_bf16 v[48:51], a[168:171], v[104:107], v[48:51]
    v_mfma_f32_16x16x32_bf16 v[52:55], a[232:235], v[104:107], v[52:55]
    v_mfma_f32_16x16x32_bf16 v[56:59], v[104:107], v[168:171], v[56:59]
    v_mfma_f32_16x16x32_bf16 v[60:63], v[104:107], v[232:235], v[60:63]
    ds_read_b128 v[104:107], v31 offset:26624
    s_waitcnt lgkmcnt(15)
    v_mfma_f32_16x16x32_bf16 v[48:51], a[172:175], v[108:111], v[48:51]
    v_mfma_f32_16x16x32_bf16 v[52:55], a[236:239], v[108:111], v[52:55]
    v_mfma_f32_16x16x32_bf16 v[56:59], v[108:111], v[172:175], v[56:59]
    v_mfma_f32_16x16x32_bf16 v[60:63], v[108:111], v[236:239], v[60:63]
    ds_read_b128 v[108:111], v31 offset:27648
    s_waitcnt lgkmcnt(15)
    v_mfma_f32_16x16x32_bf16 v[48:51], a[176:179], v[112:115], v[48:51]
    v_mfma_f32_16x16x32_bf16 v[52:55], a[240:243], v[112:115], v[52:55]
    v_mfma_f32_16x16x32_bf16 v[56:59], v[112:115], v[176:179], v[56:59]
    v_mfma_f32_16x16x32_bf16 v[60:63], v[112:115], v[240:243], v[60:63]
    ds_read_b128 v[112:115], v31 offset:28672
    s_waitcnt lgkmcnt(15)
    v_mfma_f32_16x16x32_bf16 v[48:51], a[180:183], v[116:119], v[48:51]
    v_mfma_f32_16x16x32_bf16 v[52:55], a[244:247], v[116:119], v[52:55]
    v_mfma_f32_16x16x32_bf16 v[56:59], v[116:119], v[180:183], v[56:59]
    v_mfma_f32_16x16x32_bf16 v[60:63], v[116:119], v[244:247], v[60:63]
    ds_read_b128 v[116:119], v31 offset:29696
    s_waitcnt lgkmcnt(15)
    v_mfma_f32_16x16x32_bf16 v[48:51], a[184:187], v[120:123], v[48:51]
    v_mfma_f32_16x16x32_bf16 v[52:55], a[248:251], v[120:123], v[52:55]
    v_mfma_f32_16x16x32_bf16 v[56:59], v[120:123], v[184:187], v[56:59]
    v_mfma_f32_16x16x32_bf16 v[60:63], v[120:123], v[248:251], v[60:63]
    ds_read_b128 v[120:123], v31 offset:30720
    s_waitcnt lgkmcnt(15)
    v_mfma_f32_16x16x32_bf16 v[48:51], a[188:191], v[124:127], v[48:51]
    v_mfma_f32_16x16x32_bf16 v[52:55], a[252:255], v[124:127], v[52:55]
    v_mfma_f32_16x16x32_bf16 v[56:59], v[124:127], v[188:191], v[56:59]
    v_mfma_f32_16x16x32_bf16 v[60:63], v[124:127], v[252:255], v[60:63]
    ds_read_b128 v[124:127], v31 offset:31744
    s_waitcnt vmcnt(0)
    s_mov_b64 exec, 1
    buffer_store_byte v28, off, s[24:27], s38 sc1
    s_mov_b64 exec, -1
    s_add_u32 s38, s38, 4
    s_nop 7
    v_cvt_pk_bf16_f32 v16, v48, v49
    v_cvt_pk_bf16_f32 v17, v50, v51
    v_cvt_pk_bf16_f32 v18, v52, v53
    v_cvt_pk_bf16_f32 v19, v54, v55
    buffer_store_dwordx4 v[16:19], v9, s[24:27], s37 offen offset:0 sc1
    v_cvt_pk_bf16_f32 v20, v56, v57
    v_cvt_pk_bf16_f32 v21, v58, v59
    v_cvt_pk_bf16_f32 v24, v60, v61
    v_cvt_pk_bf16_f32 v25, v62, v63
    s_nop 1
    s_waitcnt lgkmcnt(15)
    v_mfma_f32_16x16x32_bf16 v[48:51], a[128:131], v[64:67], 0
    v_mfma_f32_16x16x32_bf16 v[52:55], a[192:195], v[64:67], 0
    v_mfma_f32_16x16x32_bf16 v[56:59], v[64:67], v[128:131], 0
    v_mfma_f32_16x16x32_bf16 v[60:63], v[64:67], v[192:195], 0
    ds_read_b128 v[64:67], v31 offset:32768
    s_waitcnt lgkmcnt(15)
    v_mfma_f32_16x16x32_bf16 v[48:51], a[132:135], v[68:71], v[48:51]
    v_mfma_f32_16x16x32_bf16 v[52:55], a[196:199], v[68:71], v[52:55]
    v_mfma_f32_16x16x32_bf16 v[56:59], v[68:71], v[132:135], v[56:59]
    v_mfma_f32_16x16x32_bf16 v[60:63], v[68:71], v[196:199], v[60:63]
    ds_read_b128 v[68:71], v31 offset:33792
    s_waitcnt lgkmcnt(15)
    v_mfma_f32_16x16x32_bf16 v[48:51], a[136:139], v[72:75], v[48:51]
    v_mfma_f32_16x16x32_bf16 v[52:55], a[200:203], v[72:75], v[52:55]
    v_mfma_f32_16x16x32_bf16 v[56:59], v[72:75], v[136:139], v[56:59]
    v_mfma_f32_16x16x32_bf16 v[60:63], v[72:75], v[200:203], v[60:63]
    ds_read_b128 v[72:75], v31 offset:34816
    s_waitcnt lgkmcnt(15)
    v_mfma_f32_16x16x32_bf16 v[48:51], a[140:143], v[76:79], v[48:51]
    v_mfma_f32_16x16x32_bf16 v[52:55], a[204:207], v[76:79], v[52:55]
    v_mfma_f32_16x16x32_bf16 v[56:59], v[76:79], v[140:143], v[56:59]
    v_mfma_f32_16x16x32_bf16 v[60:63], v[76:79], v[204:207], v[60:63]
    ds_read_b128 v[76:79], v31 offset:35840
    s_waitcnt lgkmcnt(15)
    v_mfma_f32_16x16x32_bf16 v[48:51], a[144:147], v[80:83], v[48:51]
    v_mfma_f32_16x16x32_bf16 v[52:55], a[208:211], v[80:83], v[52:55]
    v_mfma_f32_16x16x32_bf16 v[56:59], v[80:83], v[144:147], v[56:59]
    v_mfma_f32_16x16x32_bf16 v[60:63], v[80:83], v[208:211], v[60:63]
    ds_read_b128 v[80:83], v31 offset:36864
    s_waitcnt lgkmcnt(15)
    v_mfma_f32_16x16x32_bf16 v[48:51], a[148:151], v[84:87], v[48:51]
    v_mfma_f32_16x16x32_bf16 v[52:55], a[212:215], v[84:87], v[52:55]
    v_mfma_f32_16x16x32_bf16 v[56:59], v[84:87], v[148:151], v[56:59]
    v_mfma_f32_16x16x32_bf16 v[60:63], v[84:87], v[212:215], v[60:63]
    ds_read_b128 v[84:87], v31 offset:37888
    s_waitcnt lgkmcnt(15)
    v_mfma_f32_16x16x32_bf16 v[48:51], a[152:155], v[88:91], v[48:51]
    v_mfma_f32_16x16x32_bf16 v[52:55], a[216:219], v[88:91], v[52:55]
    v_mfma_f32_16x16x32_bf16 v[56:59], v[88:91], v[152:155], v[56:59]
    v_mfma_f32_16x16x32_bf16 v[60:63], v[88:91], v[216:219], v[60:63]
    ds_read_b128 v[88:91], v31 offset:38912
    s_waitcnt lgkmcnt(15)
    v_mfma_f32_16x16x32_bf16 v[48:51], a[156:159], v[92:95], v[48:51]
    v_mfma_f32_16x16x32_bf16 v[52:55], a[220:223], v[92:95], v[52:55]
    v_mfma_f32_16x16x32_bf16 v[56:59], v[92:95], v[156:159], v[56:59]
    v_mfma_f32_16x16x32_bf16 v[60:63], v[92:95], v[220:223], v[60:63]
    ds_read_b128 v[92:95], v31 offset:39936
    s_waitcnt lgkmcnt(15)
    v_mfma_f32_16x16x32_bf16 v[48:51], a[160:163], v[96:99], v[48:51]
    v_mfma_f32_16x16x32_bf16 v[52:55], a[224:227], v[96:99], v[52:55]
    v_mfma_f32_16x16x32_bf16 v[56:59], v[96:99], v[160:163], v[56:59]
    v_mfma_f32_16x16x32_bf16 v[60:63], v[96:99], v[224:227], v[60:63]
    ds_read_b128 v[96:99], v31 offset:40960
    s_waitcnt lgkmcnt(15)
    v_mfma_f32_16x16x32_bf16 v[48:51], a[164:167], v[100:103], v[48:51]
    v_mfma_f32_16x16x32_bf16 v[52:55], a[228:231], v[100:103], v[52:55]
    v_mfma_f32_16x16x32_bf16 v[56:59], v[100:103], v[164:167], v[56:59]
    v_mfma_f32_16x16x32_bf16 v[60:63], v[100:103], v[228:231], v[60:63]
    ds_read_b128 v[100:103], v31 offset:41984
    s_waitcnt lgkmcnt(15)
    v_mfma_f32_16x16x32_bf16 v[48:51], a[168:171], v[104:107], v[48:51]
    v_mfma_f32_16x16x32_bf16 v[52:55], a[232:235], v[104:107], v[52:55]
    v_mfma_f32_16x16x32_bf16 v[56:59], v[104:107], v[168:171], v[56:59]
    v_mfma_f32_16x16x32_bf16 v[60:63], v[104:107], v[232:235], v[60:63]
    ds_read_b128 v[104:107], v31 offset:43008
    s_waitcnt lgkmcnt(15)
    v_mfma_f32_16x16x32_bf16 v[48:51], a[172:175], v[108:111], v[48:51]
    v_mfma_f32_16x16x32_bf16 v[52:55], a[236:239], v[108:111], v[52:55]
    v_mfma_f32_16x16x32_bf16 v[56:59], v[108:111], v[172:175], v[56:59]
    v_mfma_f32_16x16x32_bf16 v[60:63], v[108:111], v[236:239], v[60:63]
    ds_read_b128 v[108:111], v31 offset:44032
    s_waitcnt lgkmcnt(15)
    v_mfma_f32_16x16x32_bf16 v[48:51], a[176:179], v[112:115], v[48:51]
    v_mfma_f32_16x16x32_bf16 v[52:55], a[240:243], v[112:115], v[52:55]
    v_mfma_f32_16x16x32_bf16 v[56:59], v[112:115], v[176:179], v[56:59]
    v_mfma_f32_16x16x32_bf16 v[60:63], v[112:115], v[240:243], v[60:63]
    ds_read_b128 v[112:115], v31 offset:45056
    s_waitcnt lgkmcnt(15)
    v_mfma_f32_16x16x32_bf16 v[48:51], a[180:183], v[116:119], v[48:51]
    v_mfma_f32_16x16x32_bf16 v[52:55], a[244:247], v[116:119], v[52:55]
    v_mfma_f32_16x16x32_bf16 v[56:59], v[116:119], v[180:183], v[56:59]
    v_mfma_f32_16x16x32_bf16 v[60:63], v[116:119], v[244:247], v[60:63]
    ds_read_b128 v[116:119], v31 offset:46080
    s_waitcnt lgkmcnt(15)
    v_mfma_f32_16x16x32_bf16 v[48:51], a[184:187], v[120:123], v[48:51]
    v_mfma_f32_16x16x32_bf16 v[52:55], a[248:251], v[120:123], v[52:55]
    v_mfma_f32_16x16x32_bf16 v[56:59], v[120:123], v[184:187], v[56:59]
    v_mfma_f32_16x16x32_bf16 v[60:63], v[120:123], v[248:251], v[60:63]
    ds_read_b128 v[120:123], v31 offset:47104
    s_waitcnt lgkmcnt(15)
    v_mfma_f32_16x16x32_bf16 v[48:51], a[188:191], v[124:127], v[48:51]
    v_mfma_f32_16x16x32_bf16 v[52:55], a[252:255], v[124:127], v[52:55]
    v_mfma_f32_16x16x32_bf16 v[56:59], v[124:127], v[188:191], v[56:59]
    v_mfma_f32_16x16x32_bf16 v[60:63], v[124:127], v[252:255], v[60:63]
    ds_read_b128 v[124:127], v31 offset:48128
    s_nop 7
    v_cvt_pk_bf16_f32 v16, v48, v49
    v_cvt_pk_bf16_f32 v17, v50, v51
    v_cvt_pk_bf16_f32 v18, v52, v53
    v_cvt_pk_bf16_f32 v19, v54, v55
    buffer_store_dwordx4 v[16:19], v9, s[24:27], s37 offen offset:1024 sc1
    v_cvt_pk_bf16_f32 v22, v56, v57
    v_cvt_pk_bf16_f32 v23, v58, v59
    v_cvt_pk_bf16_f32 v26, v60, v61
    v_cvt_pk_bf16_f32 v27, v62, v63
    buffer_store_dwordx4 v[20:23], v10, s[24:27], s36 offen sc1
    buffer_store_dwordx4 v[24:27], v10, s[24:27], s36 offen offset:256 sc1
    s_add_u32 s35, s35, 0x40000
    s_add_u32 s36, s36, 0x40000
    s_add_u32 s37, s37, 0x40000
    s_nop 1
    s_waitcnt lgkmcnt(15)
    v_mfma_f32_16x16x32_bf16 v[48:51], a[128:131], v[64:67], 0
    v_mfma_f32_16x16x32_bf16 v[52:55], a[192:195], v[64:67], 0
    v_mfma_f32_16x16x32_bf16 v[56:59], v[64:67], v[128:131], 0
    v_mfma_f32_16x16x32_bf16 v[60:63], v[64:67], v[192:195], 0
    ds_read_b128 v[64:67], v31 offset:49152
    s_waitcnt lgkmcnt(15)
    v_mfma_f32_16x16x32_bf16 v[48:51], a[132:135], v[68:71], v[48:51]
    v_mfma_f32_16x16x32_bf16 v[52:55], a[196:199], v[68:71], v[52:55]
    v_mfma_f32_16x16x32_bf16 v[56:59], v[68:71], v[132:135], v[56:59]
    v_mfma_f32_16x16x32_bf16 v[60:63], v[68:71], v[196:199], v[60:63]
    ds_read_b128 v[68:71], v31 offset:50176
    s_waitcnt lgkmcnt(15)
    v_mfma_f32_16x16x32_bf16 v[48:51], a[136:139], v[72:75], v[48:51]
    v_mfma_f32_16x16x32_bf16 v[52:55], a[200:203], v[72:75], v[52:55]
    v_mfma_f32_16x16x32_bf16 v[56:59], v[72:75], v[136:139], v[56:59]
    v_mfma_f32_16x16x32_bf16 v[60:63], v[72:75], v[200:203], v[60:63]
    ds_read_b128 v[72:75], v31 offset:51200
    s_waitcnt lgkmcnt(15)
    v_mfma_f32_16x16x32_bf16 v[48:51], a[140:143], v[76:79], v[48:51]
    v_mfma_f32_16x16x32_bf16 v[52:55], a[204:207], v[76:79], v[52:55]
    v_mfma_f32_16x16x32_bf16 v[56:59], v[76:79], v[140:143], v[56:59]
    v_mfma_f32_16x16x32_bf16 v[60:63], v[76:79], v[204:207], v[60:63]
    ds_read_b128 v[76:79], v31 offset:52224
    s_waitcnt lgkmcnt(15)
    v_mfma_f32_16x16x32_bf16 v[48:51], a[144:147], v[80:83], v[48:51]
    v_mfma_f32_16x16x32_bf16 v[52:55], a[208:211], v[80:83], v[52:55]
    v_mfma_f32_16x16x32_bf16 v[56:59], v[80:83], v[144:147], v[56:59]
    v_mfma_f32_16x16x32_bf16 v[60:63], v[80:83], v[208:211], v[60:63]
    ds_read_b128 v[80:83], v31 offset:53248
    s_waitcnt lgkmcnt(15)
    v_mfma_f32_16x16x32_bf16 v[48:51], a[148:151], v[84:87], v[48:51]
    v_mfma_f32_16x16x32_bf16 v[52:55], a[212:215], v[84:87], v[52:55]
    v_mfma_f32_16x16x32_bf16 v[56:59], v[84:87], v[148:151], v[56:59]
    v_mfma_f32_16x16x32_bf16 v[60:63], v[84:87], v[212:215], v[60:63]
    ds_read_b128 v[84:87], v31 offset:54272
    s_waitcnt lgkmcnt(15)
    v_mfma_f32_16x16x32_bf16 v[48:51], a[152:155], v[88:91], v[48:51]
    v_mfma_f32_16x16x32_bf16 v[52:55], a[216:219], v[88:91], v[52:55]
    v_mfma_f32_16x16x32_bf16 v[56:59], v[88:91], v[152:155], v[56:59]
    v_mfma_f32_16x16x32_bf16 v[60:63], v[88:91], v[216:219], v[60:63]
    ds_read_b128 v[88:91], v31 offset:55296
    s_waitcnt lgkmcnt(15)
    v_mfma_f32_16x16x32_bf16 v[48:51], a[156:159], v[92:95], v[48:51]
    v_mfma_f32_16x16x32_bf16 v[52:55], a[220:223], v[92:95], v[52:55]
    v_mfma_f32_16x16x32_bf16 v[56:59], v[92:95], v[156:159], v[56:59]
    v_mfma_f32_16x16x32_bf16 v[60:63], v[92:95], v[220:223], v[60:63]
    ds_read_b128 v[92:95], v31 offset:56320
    s_waitcnt lgkmcnt(15)
    v_mfma_f32_16x16x32_bf16 v[48:51], a[160:163], v[96:99], v[48:51]
    v_mfma_f32_16x16x32_bf16 v[52:55], a[224:227], v[96:99], v[52:55]
    v_mfma_f32_16x16x32_bf16 v[56:59], v[96:99], v[160:163], v[56:59]
    v_mfma_f32_16x16x32_bf16 v[60:63], v[96:99], v[224:227], v[60:63]
    ds_read_b128 v[96:99], v31 offset:57344
    s_waitcnt lgkmcnt(15)
    v_mfma_f32_16x16x32_bf16 v[48:51], a[164:167], v[100:103], v[48:51]
    v_mfma_f32_16x16x32_bf16 v[52:55], a[228:231], v[100:103], v[52:55]
    v_mfma_f32_16x16x32_bf16 v[56:59], v[100:103], v[164:167], v[56:59]
    v_mfma_f32_16x16x32_bf16 v[60:63], v[100:103], v[228:231], v[60:63]
    ds_read_b128 v[100:103], v31 offset:58368
    s_waitcnt lgkmcnt(15)
    v_mfma_f32_16x16x32_bf16 v[48:51], a[168:171], v[104:107], v[48:51]
    v_mfma_f32_16x16x32_bf16 v[52:55], a[232:235], v[104:107], v[52:55]
    v_mfma_f32_16x16x32_bf16 v[56:59], v[104:107], v[168:171], v[56:59]
    v_mfma_f32_16x16x32_bf16 v[60:63], v[104:107], v[232:235], v[60:63]
    ds_read_b128 v[104:107], v31 offset:59392
    s_waitcnt lgkmcnt(15)
    v_mfma_f32_16x16x32_bf16 v[48:51], a[172:175], v[108:111], v[48:51]
    v_mfma_f32_16x16x32_bf16 v[52:55], a[236:239], v[108:111], v[52:55]
    v_mfma_f32_16x16x32_bf16 v[56:59], v[108:111], v[172:175], v[56:59]
    v_mfma_f32_16x16x32_bf16 v[60:63], v[108:111], v[236:239], v[60:63]
    ds_read_b128 v[108:111], v31 offset:60416
    s_waitcnt lgkmcnt(15)
    v_mfma_f32_16x16x32_bf16 v[48:51], a[176:179], v[112:115], v[48:51]
    v_mfma_f32_16x16x32_bf16 v[52:55], a[240:243], v[112:115], v[52:55]
    v_mfma_f32_16x16x32_bf16 v[56:59], v[112:115], v[176:179], v[56:59]
    v_mfma_f32_16x16x32_bf16 v[60:63], v[112:115], v[240:243], v[60:63]
    ds_read_b128 v[112:115], v31 offset:61440
    s_waitcnt lgkmcnt(15)
    v_mfma_f32_16x16x32_bf16 v[48:51], a[180:183], v[116:119], v[48:51]
    v_mfma_f32_16x16x32_bf16 v[52:55], a[244:247], v[116:119], v[52:55]
    v_mfma_f32_16x16x32_bf16 v[56:59], v[116:119], v[180:183], v[56:59]
    v_mfma_f32_16x16x32_bf16 v[60:63], v[116:119], v[244:247], v[60:63]
    ds_read_b128 v[116:119], v31 offset:62464
    s_waitcnt lgkmcnt(15)
    v_mfma_f32_16x16x32_bf16 v[48:51], a[184:187], v[120:123], v[48:51]
    v_mfma_f32_16x16x32_bf16 v[52:55], a[248:251], v[120:123], v[52:55]
    v_mfma_f32_16x16x32_bf16 v[56:59], v[120:123], v[184:187], v[56:59]
    v_mfma_f32_16x16x32_bf16 v[60:63], v[120:123], v[248:251], v[60:63]
    ds_read_b128 v[120:123], v31 offset:63488
    s_waitcnt lgkmcnt(15)
    v_mfma_f32_16x16x32_bf16 v[48:51], a[188:191], v[124:127], v[48:51]
    v_mfma_f32_16x16x32_bf16 v[52:55], a[252:255], v[124:127], v[52:55]
    v_mfma_f32_16x16x32_bf16 v[56:59], v[124:127], v[188:191], v[56:59]
    v_mfma_f32_16x16x32_bf16 v[60:63], v[124:127], v[252:255], v[60:63]
    ds_read_b128 v[124:127], v31 offset:64512
    s_waitcnt vmcnt(0)
    s_mov_b64 exec, 1
    buffer_store_byte v28, off, s[24:27], s38 sc1
    s_mov_b64 exec, -1
    s_add_u32 s38, s38, 4
    s_nop 7
    v_cvt_pk_bf16_f32 v16, v48, v49
    v_cvt_pk_bf16_f32 v17, v50, v51
    v_cvt_pk_bf16_f32 v18, v52, v53
    v_cvt_pk_bf16_f32 v19, v54, v55
    buffer_store_dwordx4 v[16:19], v9, s[24:27], s37 offen offset:0 sc1
    v_cvt_pk_bf16_f32 v20, v56, v57
    v_cvt_pk_bf16_f32 v21, v58, v59
    v_cvt_pk_bf16_f32 v24, v60, v61
    v_cvt_pk_bf16_f32 v25, v62, v63
    s_nop 1
    s_waitcnt lgkmcnt(15)
    v_mfma_f32_16x16x32_bf16 v[48:51], a[128:131], v[64:67], 0
    v_mfma_f32_16x16x32_bf16 v[52:55], a[192:195], v[64:67], 0
    v_mfma_f32_16x16x32_bf16 v[56:59], v[64:67], v[128:131], 0
    v_mfma_f32_16x16x32_bf16 v[60:63], v[64:67], v[192:195], 0
    s_waitcnt lgkmcnt(14)
    v_mfma_f32_16x16x32_bf16 v[48:51], a[132:135], v[68:71], v[48:51]
    v_mfma_f32_16x16x32_bf16 v[52:55], a[196:199], v[68:71], v[52:55]
    v_mfma_f32_16x16x32_bf16 v[56:59], v[68:71], v[132:135], v[56:59]
    v_mfma_f32_16x16x32_bf16 v[60:63], v[68:71], v[196:199], v[60:63]
    s_waitcnt lgkmcnt(13)
    v_mfma_f32_16x16x32_bf16 v[48:51], a[136:139], v[72:75], v[48:51]
    v_mfma_f32_16x16x32_bf16 v[52:55], a[200:203], v[72:75], v[52:55]
    v_mfma_f32_16x16x32_bf16 v[56:59], v[72:75], v[136:139], v[56:59]
    v_mfma_f32_16x16x32_bf16 v[60:63], v[72:75], v[200:203], v[60:63]
    s_waitcnt lgkmcnt(12)
    v_mfma_f32_16x16x32_bf16 v[48:51], a[140:143], v[76:79], v[48:51]
    v_mfma_f32_16x16x32_bf16 v[52:55], a[204:207], v[76:79], v[52:55]
    v_mfma_f32_16x16x32_bf16 v[56:59], v[76:79], v[140:143], v[56:59]
    v_mfma_f32_16x16x32_bf16 v[60:63], v[76:79], v[204:207], v[60:63]
    s_waitcnt lgkmcnt(11)
    v_mfma_f32_16x16x32_bf16 v[48:51], a[144:147], v[80:83], v[48:51]
    v_mfma_f32_16x16x32_bf16 v[52:55], a[208:211], v[80:83], v[52:55]
    v_mfma_f32_16x16x32_bf16 v[56:59], v[80:83], v[144:147], v[56:59]
    v_mfma_f32_16x16x32_bf16 v[60:63], v[80:83], v[208:211], v[60:63]
    s_waitcnt lgkmcnt(10)
    v_mfma_f32_16x16x32_bf16 v[48:51], a[148:151], v[84:87], v[48:51]
    v_mfma_f32_16x16x32_bf16 v[52:55], a[212:215], v[84:87], v[52:55]
    v_mfma_f32_16x16x32_bf16 v[56:59], v[84:87], v[148:151], v[56:59]
    v_mfma_f32_16x16x32_bf16 v[60:63], v[84:87], v[212:215], v[60:63]
    s_waitcnt lgkmcnt(9)
    v_mfma_f32_16x16x32_bf16 v[48:51], a[152:155], v[88:91], v[48:51]
    v_mfma_f32_16x16x32_bf16 v[52:55], a[216:219], v[88:91], v[52:55]
    v_mfma_f32_16x16x32_bf16 v[56:59], v[88:91], v[152:155], v[56:59]
    v_mfma_f32_16x16x32_bf16 v[60:63], v[88:91], v[216:219], v[60:63]
    s_waitcnt lgkmcnt(8)
    v_mfma_f32_16x16x32_bf16 v[48:51], a[156:159], v[92:95], v[48:51]
    v_mfma_f32_16x16x32_bf16 v[52:55], a[220:223], v[92:95], v[52:55]
    v_mfma_f32_16x16x32_bf16 v[56:59], v[92:95], v[156:159], v[56:59]
    v_mfma_f32_16x16x32_bf16 v[60:63], v[92:95], v[220:223], v[60:63]
    s_waitcnt lgkmcnt(7)
    v_mfma_f32_16x16x32_bf16 v[48:51], a[160:163], v[96:99], v[48:51]
    v_mfma_f32_16x16x32_bf16 v[52:55], a[224:227], v[96:99], v[52:55]
    v_mfma_f32_16x16x32_bf16 v[56:59], v[96:99], v[160:163], v[56:59]
    v_mfma_f32_16x16x32_bf16 v[60:63], v[96:99], v[224:227], v[60:63]
    s_waitcnt lgkmcnt(6)
    v_mfma_f32_16x16x32_bf16 v[48:51], a[164:167], v[100:103], v[48:51]
    v_mfma_f32_16x16x32_bf16 v[52:55], a[228:231], v[100:103], v[52:55]
    v_mfma_f32_16x16x32_bf16 v[56:59], v[100:103], v[164:167], v[56:59]
    v_mfma_f32_16x16x32_bf16 v[60:63], v[100:103], v[228:231], v[60:63]
    s_waitcnt lgkmcnt(5)
    v_mfma_f32_16x16x32_bf16 v[48:51], a[168:171], v[104:107], v[48:51]
    v_mfma_f32_16x16x32_bf16 v[52:55], a[232:235], v[104:107], v[52:55]
    v_mfma_f32_16x16x32_bf16 v[56:59], v[104:107], v[168:171], v[56:59]
    v_mfma_f32_16x16x32_bf16 v[60:63], v[104:107], v[232:235], v[60:63]
    s_waitcnt lgkmcnt(4)
    v_mfma_f32_16x16x32_bf16 v[48:51], a[172:175], v[108:111], v[48:51]
    v_mfma_f32_16x16x32_bf16 v[52:55], a[236:239], v[108:111], v[52:55]
    v_mfma_f32_16x16x32_bf16 v[56:59], v[108:111], v[172:175], v[56:59]
    v_mfma_f32_16x16x32_bf16 v[60:63], v[108:111], v[236:239], v[60:63]
    s_waitcnt lgkmcnt(3)
    v_mfma_f32_16x16x32_bf16 v[48:51], a[176:179], v[112:115], v[48:51]
    v_mfma_f32_16x16x32_bf16 v[52:55], a[240:243], v[112:115], v[52:55]
    v_mfma_f32_16x16x32_bf16 v[56:59], v[112:115], v[176:179], v[56:59]
    v_mfma_f32_16x16x32_bf16 v[60:63], v[112:115], v[240:243], v[60:63]
    s_waitcnt lgkmcnt(2)
    v_mfma_f32_16x16x32_bf16 v[48:51], a[180:183], v[116:119], v[48:51]
    v_mfma_f32_16x16x32_bf16 v[52:55], a[244:247], v[116:119], v[52:55]
    v_mfma_f32_16x16x32_bf16 v[56:59], v[116:119], v[180:183], v[56:59]
    v_mfma_f32_16x16x32_bf16 v[60:63], v[116:119], v[244:247], v[60:63]
    s_waitcnt lgkmcnt(1)
    v_mfma_f32_16x16x32_bf16 v[48:51], a[184:187], v[120:123], v[48:51]
    v_mfma_f32_16x16x32_bf16 v[52:55], a[248:251], v[120:123], v[52:55]
    v_mfma_f32_16x16x32_bf16 v[56:59], v[120:123], v[184:187], v[56:59]
    v_mfma_f32_16x16x32_bf16 v[60:63], v[120:123], v[248:251], v[60:63]
    s_waitcnt lgkmcnt(0)
    v_mfma_f32_16x16x32_bf16 v[48:51], a[188:191], v[124:127], v[48:51]
    v_mfma_f32_16x16x32_bf16 v[52:55], a[252:255], v[124:127], v[52:55]
    v_mfma_f32_16x16x32_bf16 v[56:59], v[124:127], v[188:191], v[56:59]
    v_mfma_f32_16x16x32_bf16 v[60:63], v[124:127], v[252:255], v[60:63]
    s_nop 7
    v_cvt_pk_bf16_f32 v16, v48, v49
    v_cvt_pk_bf16_f32 v17, v50, v51
    v_cvt_pk_bf16_f32 v18, v52, v53
    v_cvt_pk_bf16_f32 v19, v54, v55
    buffer_store_dwordx4 v[16:19], v9, s[24:27], s37 offen offset:1024 sc1
    v_cvt_pk_bf16_f32 v22, v56, v57
    v_cvt_pk_bf16_f32 v23, v58, v59
    v_cvt_pk_bf16_f32 v26, v60, v61
    v_cvt_pk_bf16_f32 v27, v62, v63
    buffer_store_dwordx4 v[20:23], v10, s[24:27], s36 offen sc1
    buffer_store_dwordx4 v[24:27], v10, s[24:27], s36 offen offset:256 sc1
    s_add_u32 s35, s35, 0x40000
    s_add_u32 s36, s36, 0x40000
    s_add_u32 s37, s37, 0x40000
    s_nop 1
    s_waitcnt vmcnt(0)
    s_mov_b64 exec, 1
    buffer_store_byte v28, off, s[24:27], s38 sc1
    s_mov_b64 exec, -1
    s_branch W_LOOP
W_A:
    s_lshl_b32 s28, s32, 1
    s_lshr_b32 s33, s29, 1
    s_add_u32 s28, s28, s33
    s_and_b32 s33, s29, 1
    v_and_b32 v16, 15, v1
    v_lshrrev_b32 v17, 4, v1
    v_lshrrev_b32 v18, 2, v16
    v_and_b32 v19, 3, v16
    v_lshl_add_u32 v18, v18, 3, v19
    v_mov_b32 v20, 0x7ffffff0
    v_cmp_gt_u32 s[40:41], 8, v16
    v_cmp_gt_u32 s[42:43], 2, v17
    v_lshlrev_b32 v3, 8, v16
    v_lshl_add_u32 v3, v17, 4, v3
    v_lshlrev_b32 v4, 13, v16
    v_lshl_add_u32 v4, v17, 4, v4
    v_cndmask_b32 v4, v20, v4, s[40:41]
    v_lshlrev_b32 v5, 8, v18
    v_lshl_add_u32 v5, v17, 4, v5
    v_lshlrev_b32 v6, 6, v18
    v_lshl_add_u32 v6, v17, 4, v6
    v_lshlrev_b32 v7, 4, v18
    v_lshl_add_u32 v7, v17, 3, v7
    v_cndmask_b32 v7, v20, v7, s[42:43]
    v_lshlrev_b32 v8, 4, v1
    s_lshl_b32 s34, s30, 5
    s_add_u32 s34, s34, s28
    s_lshl_b32 s34, s34, 13
    s_lshl_b32 s35, s33, 12
    s_add_u32 s35, s35, s34
    s_add_u32 s44, s35, 0x2000000
    s_add_u32 s45, s35, 0x6000000
    s_add_u32 s46, s34, 0x3000000
    s_add_u32 s47, s34, 0x4000000
    s_lshl_b32 s35, s30, 16
    s_lshl_b32 s36, s28, 8
    s_add_u32 s36, s36, s35
    s_add_u32 s36, s36, 0x5000000
    s_lshl_b32 s37, s28, 11
    s_add_u32 s37, s37, s35
    s_add_u32 s37, s37, 0x5400000
    s_lshl_b32 s38, s28, 6
    s_add_u32 s38, s38, s30
    s_lshl_b32 s38, s38, 2
    s_add_u32 s39, s38, 0x230000
    s_mov_b32 s48, 0x228000
    s_cmp_lt_u32 s30, 4
    s_cselect_b32 s48, 0x22c000, s48
    s_add_u32 s38, s38, s48
    s_mov_b32 s54, 0x3db504f3
    s_mov_b32 s55, 0x3fb8aa3b
    s_mov_b32 s56, 0xff800000
    s_mov_b32 s57, 0x01010101
    s_mov_b32 s31, 0
PL_30:
    s_cmp_eq_u32 s31, 0
    s_cbranch_scc1 PB_31
    s_sleep 8
PB_31:
    buffer_load_dword v28, off, s[24:27], s38 sc1
    s_add_u32 s31, s31, 1
    s_cmp_gt_u32 s31, 0x200000
    s_cbranch_scc1 W_EXIT
    s_waitcnt vmcnt(0)
    v_readfirstlane_b32 s70, v28
    s_cmp_lg_u32 s70, s57
    s_cbranch_scc1 PL_30
    buffer_load_dwordx4 v[64:67], v3, s[24:27], s44 offen offset:0 sc1
    buffer_load_dwordx4 v[68:71], v3, s[24:27], s44 offen offset:64 sc1
    buffer_load_dwordx4 v[72:75], v3, s[24:27], s44 offen offset:128 sc1
    buffer_load_dwordx4 v[76:79], v3, s[24:27], s44 offen offset:192 sc1
    buffer_load_dwordx4 v[112:115], v5, s[24:27], s46 offen offset:0 sc1
    buffer_load_dwordx4 v[116:119], v5, s[24:27], s46 offen offset:64 sc1
    buffer_load_dwordx4 v[120:123], v5, s[24:27], s46 offen offset:128 sc1
    buffer_load_dwordx4 v[124:127], v5, s[24:27], s46 offen offset:192 sc1
    buffer_load_dwordx4 v[128:131], v5, s[24:27], s46 offen offset:1024 sc1
    buffer_load_dwordx4 v[132:135], v5, s[24:27], s46 offen offset:1088 sc1
    buffer_load_dwordx4 v[136:139], v5, s[24:27], s46 offen offset:1152 sc1
    buffer_load_dwordx4 v[140:143], v5, s[24:27], s46 offen offset:1216 sc1
    s_add_u32 s48, s47, 0
    buffer_load_dwordx4 v[144:147], v6, s[24:27], s48 offen sc1
    s_add_u32 s48, s47, 256
    buffer_load_dwordx4 v[148:151], v6, s[24:27], s48 offen sc1
    s_add_u32 s48, s47, 2048
    buffer_load_dwordx4 v[152:155], v6, s[24:27], s48 offen sc1
    s_add_u32 s48, s47, 2304
    buffer_load_dwordx4 v[156:159], v6, s[24:27], s48 offen sc1
    s_add_u32 s48, s47, 4096
    buffer_load_dwordx4 v[160:163], v6, s[24:27], s48 offen sc1
    s_add_u32 s48, s47, 4352
    buffer_load_dwordx4 v[164:167], v6, s[24:27], s48 offen sc1
    s_add_u32 s48, s47, 6144
    buffer_load_dwordx4 v[168:171], v6, s[24:27], s48 offen sc1
    s_add_u32 s48, s47, 6400
    buffer_load_dwordx4 v[172:175], v6, s[24:27], s48 offen sc1
    s_waitcnt vmcnt(8)
    v_mfma_f32_16x16x32_bf16 v[196:199], v[112:115], v[64:67], 0
    v_mfma_f32_16x16x32_bf16 v[196:199], v[116:119], v[68:71], v[196:199]
    v_mfma_f32_16x16x32_bf16 v[196:199], v[120:123], v[72:75], v[196:199]
    v_mfma_f32_16x16x32_bf16 v[196:199], v[124:127], v[76:79], v[196:199]
    v_mfma_f32_16x16x32_bf16 v[200:203], v[128:131], v[64:67], 0
    v_mfma_f32_16x16x32_bf16 v[200:203], v[132:135], v[68:71], v[200:203]
    v_mfma_f32_16x16x32_bf16 v[200:203], v[136:139], v[72:75], v[200:203]
    v_mfma_f32_16x16x32_bf16 v[200:203], v[140:143], v[76:79], v[200:203]
    s_cmp_ge_u32 s30, 62
    s_cbranch_scc1 W_AT
    s_mov_b32 s31, 0
PL_32:
    s_cmp_eq_u32 s31, 0
    s_cbranch_scc1 PB_33
    s_sleep 8
PB_33:
    buffer_load_dword v28, off, s[24:27], s39 sc1
    s_add_u32 s31, s31, 1
    s_cmp_gt_u32 s31, 0x200000
    s_cbranch_scc1 W_EXIT
    s_waitcnt vmcnt(0)
    v_readfirstlane_b32 s70, v28
    s_cmp_lg_u32 s70, s57
    s_cbranch_scc1 PL_32
    buffer_load_dwordx4 v[96:99], v4, s[24:27], s36 offen offset:0 sc1
    buffer_load_dwordx4 v[100:103], v4, s[24:27], s36 offen offset:64 sc1
    buffer_load_dwordx4 v[104:107], v4, s[24:27], s36 offen offset:128 sc1
    buffer_load_dwordx4 v[108:111], v4, s[24:27], s36 offen offset:192 sc1
    buffer_load_dwordx2 v[176:177], v7, s[24:27], s37 offen offset:0 sc1
    buffer_load_dwordx2 v[178:179], v7, s[24:27], s37 offen offset:64 sc1
    buffer_load_dwordx2 v[180:181], v7, s[24:27], s37 offen offset:512 sc1
    buffer_load_dwordx2 v[182:183], v7, s[24:27], s37 offen offset:576 sc1
    buffer_load_dwordx2 v[184:185], v7, s[24:27], s37 offen offset:1024 sc1
    buffer_load_dwordx2 v[186:187], v7, s[24:27], s37 offen offset:1088 sc1
    buffer_load_dwordx2 v[188:189], v7, s[24:27], s37 offen offset:1536 sc1
    buffer_load_dwordx2 v[190:191], v7, s[24:27], s37 offen offset:1600 sc1
    s_waitcnt vmcnt(8)
    s_branch W_AJ
W_AT:
    s_mov_b32 s31, 0
W_AT1:
    s_cmp_eq_u32 s31, 0
    s_cbranch_scc1 W_AT2
    s_sleep 2
W_AT2:
    buffer_load_dwordx4 v[96:99], v4, s[24:27], s36 offen offset:0 sc1
    buffer_load_dwordx4 v[100:103], v4, s[24:27], s36 offen offset:64 sc1
    buffer_load_dwordx4 v[104:107], v4, s[24:27], s36 offen offset:128 sc1
    buffer_load_dwordx4 v[108:111], v4, s[24:27], s36 offen offset:192 sc1
    buffer_load_dwordx2 v[176:177], v7, s[24:27], s37 offen offset:0 sc1
    buffer_load_dwordx2 v[178:179], v7, s[24:27], s37 offen offset:64 sc1
    buffer_load_dwordx2 v[180:181], v7, s[24:27], s37 offen offset:512 sc1
    buffer_load_dwordx2 v[182:183], v7, s[24:27], s37 offen offset:576 sc1
    buffer_load_dwordx2 v[184:185], v7, s[24:27], s37 offen offset:1024 sc1
    buffer_load_dwordx2 v[186:187], v7, s[24:27], s37 offen offset:1088 sc1
    buffer_load_dwordx2 v[188:189], v7, s[24:27], s37 offen offset:1536 sc1
    buffer_load_dwordx2 v[190:191], v7, s[24:27], s37 offen offset:1600 sc1
    s_add_u32 s31, s31, 1
    s_cmp_gt_u32 s31, 0x200000
    s_cbranch_scc1 W_EXIT
    s_waitcnt vmcnt(0)
    v_max3_u32 v22, v96, v97, v98
    v_max3_u32 v22, v22, v99, v100
    v_max3_u32 v22, v22, v101, v102
    v_max3_u32 v22, v22, v103, v104
    v_max3_u32 v22, v22, v105, v106
    v_max3_u32 v22, v22, v107, v108
    v_max3_u32 v22, v22, v109, v110
    v_max3_u32 v22, v22, v111, v176
    v_max3_u32 v22, v22, v177, v178
    v_max3_u32 v22, v22, v179, v180
    v_max3_u32 v22, v22, v181, v182
    v_max3_u32 v22, v22, v183, v184
    v_max3_u32 v22, v22, v185, v186
    v_max3_u32 v22, v22, v187, v188
    v_max3_u32 v22, v22, v189, v190
    v_max_u32 v22, v22, v191
    v_cmp_eq_u32 vcc, -1, v22
    s_cbranch_vccnz W_AT1
W_AJ:
    v_mfma_f32_16x16x32_bf16 v[192:195], v[96:99], v[64:67], 0
    v_mfma_f32_16x16x32_bf16 v[192:195], v[100:103], v[68:71], v[192:195]
    v_mfma_f32_16x16x32_bf16 v[192:195], v[104:107], v[72:75], v[192:195]
    v_mfma_f32_16x16x32_bf16 v[192:195], v[108:111], v[76:79], v[192:195]
    v_lshlrev_b32 v21, 3, v17
    v_sub_u32 v21, v16, v21
    s_lshl_b32 s48, s33, 4
    v_add_u32 v21, s48, v21
    v_mov_b32 v100, s56
    s_nop 7
    v_cvt_pk_bf16_f32 v22, v192, v193
    v_lshlrev_b32 v192, 16, v22
    v_and_b32 v193, 0xffff0000, v22
    v_mul_f32 v192, s54, v192
    v_mul_f32 v193, s54, v193
    v_cvt_pk_bf16_f32 v22, v192, v193
    v_lshlrev_b32 v192, 16, v22
    v_and_b32 v193, 0xffff0000, v22
    v_cvt_pk_bf16_f32 v22, v194, v195
    v_lshlrev_b32 v194, 16, v22
    v_and_b32 v195, 0xffff0000, v22
    v_mul_f32 v194, s54, v194
    v_mul_f32 v195, s54, v195
    v_cvt_pk_bf16_f32 v22, v194, v195
    v_lshlrev_b32 v194, 16, v22
    v_and_b32 v195, 0xffff0000, v22
    v_cvt_pk_bf16_f32 v22, v196, v197
    v_lshlrev_b32 v196, 16, v22
    v_and_b32 v197, 0xffff0000, v22
    v_mul_f32 v196, s54, v196
    v_mul_f32 v197, s54, v197
    v_cvt_pk_bf16_f32 v22, v196, v197
    v_lshlrev_b32 v196, 16, v22
    v_and_b32 v197, 0xffff0000, v22
    v_cvt_pk_bf16_f32 v22, v198, v199
    v_lshlrev_b32 v198, 16, v22
    v_and_b32 v199, 0xffff0000, v22
    v_mul_f32 v198, s54, v198
    v_mul_f32 v199, s54, v199
    v_cvt_pk_bf16_f32 v22, v198, v199
    v_lshlrev_b32 v198, 16, v22
    v_and_b32 v199, 0xffff0000, v22
    v_cvt_pk_bf16_f32 v22, v200, v201
    v_lshlrev_b32 v200, 16, v22
    v_and_b32 v201, 0xffff0000, v22
    v_mul_f32 v200, s54, v200
    v_mul_f32 v201, s54, v201
    v_cvt_pk_bf16_f32 v22, v200, v201
    v_lshlrev_b32 v200, 16, v22
    v_and_b32 v201, 0xffff0000, v22
    v_cvt_pk_bf16_f32 v22, v202, v203
    v_lshlrev_b32 v202, 16, v22
    v_and_b32 v203, 0xffff0000, v22
    v_mul_f32 v202, s54, v202
    v_mul_f32 v203, s54, v203
    v_cvt_pk_bf16_f32 v22, v202, v203
    v_lshlrev_b32 v202, 16, v22
    v_and_b32 v203, 0xffff0000, v22
    v_cndmask_b32 v192, v100, v192, s[42:43]
    v_cndmask_b32 v193, v100, v193, s[42:43]
    v_cndmask_b32 v194, v100, v194, s[42:43]
    v_cndmask_b32 v195, v100, v195, s[42:43]
    v_cmp_le_i32 vcc, 0, v21
    s_nop 1
    v_cndmask_b32 v196, v100, v196, vcc
    v_cmp_le_i32 vcc, 1, v21
    s_nop 1
    v_cndmask_b32 v197, v100, v197, vcc
    v_cmp_le_i32 vcc, 2, v21
    s_nop 1
    v_cndmask_b32 v198, v100, v198, vcc
    v_cmp_le_i32 vcc, 3, v21
    s_nop 1
    v_cndmask_b32 v199, v100, v199, vcc
    v_cmp_le_i32 vcc, 4, v21
    s_nop 1
    v_cndmask_b32 v200, v100, v200, vcc
    v_cmp_le_i32 vcc, 5, v21
    s_nop 1
    v_cndmask_b32 v201, v100, v201, vcc
    v_cmp_le_i32 vcc, 6, v21
    s_nop 1
    v_cndmask_b32 v202, v100, v202, vcc
    v_cmp_le_i32 vcc, 7, v21
    s_nop 1
    v_cndmask_b32 v203, v100, v203, vcc
    v_max3_f32 v22, v192, v193, v194
    v_max3_f32 v22, v22, v195, v196
    v_max3_f32 v22, v22, v197, v198
    v_max3_f32 v22, v22, v199, v200
    v_max3_f32 v22, v22, v201, v202
    v_max_f32 v22, v22, v203
    v_mov_b32 v23, v22
    s_nop 1
    v_permlane16_swap_b32 v22, v23
    s_nop 1
    v_max_f32 v22, v22, v23
    v_mov_b32 v23, v22
    s_nop 1
    v_permlane32_swap_b32 v22, v23
    s_nop 1
    v_max_f32 v22, v22, v23
    v_mul_f32 v22, s55, v22
    v_fma_f32 v192, v192, s55, -v22
    v_fma_f32 v193, v193, s55, -v22
    v_fma_f32 v194, v194, s55, -v22
    v_fma_f32 v195, v195, s55, -v22
    v_fma_f32 v196, v196, s55, -v22
    v_fma_f32 v197, v197, s55, -v22
    v_fma_f32 v198, v198, s55, -v22
    v_fma_f32 v199, v199, s55, -v22
    v_fma_f32 v200, v200, s55, -v22
    v_fma_f32 v201, v201, s55, -v22
    v_fma_f32 v202, v202, s55, -v22
    v_fma_f32 v203, v203, s55, -v22
    v_exp_f32 v192, v192
    v_exp_f32 v193, v193
    v_exp_f32 v194, v194
    v_exp_f32 v195, v195
    v_exp_f32 v196, v196
    v_exp_f32 v197, v197
    v_exp_f32 v198, v198
    v_exp_f32 v199, v199
    v_exp_f32 v200, v200
    v_exp_f32 v201, v201
    v_exp_f32 v202, v202
    v_exp_f32 v203, v203
    s_nop 0
    v_add_f32 v22, v192, v193
    v_add_f32 v22, v22, v194
    v_add_f32 v22, v22, v195
    v_add_f32 v22, v22, v196
    v_add_f32 v22, v22, v197
    v_add_f32 v22, v22, v198
    v_add_f32 v22, v22, v199
    v_add_f32 v22, v22, v200
    v_add_f32 v22, v22, v201
    v_add_f32 v22, v22, v202
    v_add_f32 v22, v22, v203
    v_mov_b32 v23, v22
    s_nop 1
    v_permlane16_swap_b32 v22, v23
    s_nop 1
    v_add_f32 v22, v22, v23
    v_mov_b32 v23, v22
    s_nop 1
    v_permlane32_swap_b32 v22, v23
    s_nop 1
    v_add_f32 v22, v22, v23
    v_rcp_f32 v22, v22
    s_nop 0
    v_mul_f32 v192, v192, v22
    v_mul_f32 v193, v193, v22
    v_mul_f32 v194, v194, v22
    v_mul_f32 v195, v195, v22
    v_mul_f32 v196, v196, v22
    v_mul_f32 v197, v197, v22
    v_mul_f32 v198, v198, v22
    v_mul_f32 v199, v199, v22
    v_mul_f32 v200, v200, v22
    v_mul_f32 v201, v201, v22
    v_mul_f32 v202, v202, v22
    v_mul_f32 v203, v203, v22
    v_cvt_pk_bf16_f32 v216, v192, v193
    v_cvt_pk_bf16_f32 v217, v194, v195
    v_cvt_pk_bf16_f32 v218, v196, v197
    v_cvt_pk_bf16_f32 v219, v198, v199
    v_cvt_pk_bf16_f32 v220, v200, v201
    v_cvt_pk_bf16_f32 v221, v202, v203
    s_waitcnt vmcnt(0)
    s_nop 1
    v_mfma_f32_16x16x32_bf16 v[64:67], v[144:147], v[218:221], 0
    v_mfma_f32_16x16x32_bf16 v[68:71], v[148:151], v[218:221], 0
    v_mfma_f32_16x16x32_bf16 v[72:75], v[152:155], v[218:221], 0
    v_mfma_f32_16x16x32_bf16 v[76:79], v[156:159], v[218:221], 0
    v_mfma_f32_16x16x32_bf16 v[80:83], v[160:163], v[218:221], 0
    v_mfma_f32_16x16x32_bf16 v[84:87], v[164:167], v[218:221], 0
    v_mfma_f32_16x16x32_bf16 v[88:91], v[168:171], v[218:221], 0
    v_mfma_f32_16x16x32_bf16 v[92:95], v[172:175], v[218:221], 0
    v_mfma_f32_16x16x16_bf16 v[64:67], v[176:177], v[216:217], v[64:67]
    v_mfma_f32_16x16x16_bf16 v[68:71], v[178:179], v[216:217], v[68:71]
    v_mfma_f32_16x16x16_bf16 v[72:75], v[180:181], v[216:217], v[72:75]
    v_mfma_f32_16x16x16_bf16 v[76:79], v[182:183], v[216:217], v[76:79]
    v_mfma_f32_16x16x16_bf16 v[80:83], v[184:185], v[216:217], v[80:83]
    v_mfma_f32_16x16x16_bf16 v[84:87], v[186:187], v[216:217], v[84:87]
    v_mfma_f32_16x16x16_bf16 v[88:91], v[188:189], v[216:217], v[88:91]
    v_mfma_f32_16x16x16_bf16 v[92:95], v[190:191], v[216:217], v[92:95]
    s_nop 7
    v_cvt_pk_bf16_f32 v192, v64, v65
    v_cvt_pk_bf16_f32 v193, v66, v67
    v_cvt_pk_bf16_f32 v194, v68, v69
    v_cvt_pk_bf16_f32 v195, v70, v71
    buffer_store_dwordx4 v[192:195], v8, s[24:27], s45 offen offset:0 sc1
    v_cvt_pk_bf16_f32 v196, v72, v73
    v_cvt_pk_bf16_f32 v197, v74, v75
    v_cvt_pk_bf16_f32 v198, v76, v77
    v_cvt_pk_bf16_f32 v199, v78, v79
    buffer_store_dwordx4 v[196:199], v8, s[24:27], s45 offen offset:1024 sc1
    v_cvt_pk_bf16_f32 v200, v80, v81
    v_cvt_pk_bf16_f32 v201, v82, v83
    v_cvt_pk_bf16_f32 v202, v84, v85
    v_cvt_pk_bf16_f32 v203, v86, v87
    buffer_store_dwordx4 v[200:203], v8, s[24:27], s45 offen offset:2048 sc1
    v_cvt_pk_bf16_f32 v204, v88, v89
    v_cvt_pk_bf16_f32 v205, v90, v91
    v_cvt_pk_bf16_f32 v206, v92, v93
    v_cvt_pk_bf16_f32 v207, v94, v95
    buffer_store_dwordx4 v[204:207], v8, s[24:27], s45 offen offset:3072 sc1
    s_lshl_b32 s48, s30, 4
    s_add_u32 s48, s48, s32
    s_add_u32 s48, s48, 0x238000
    s_waitcnt vmcnt(0)
    s_barrier
    s_cmp_lg_u32 s29, 0
    s_cbranch_scc1 W_AE
    s_mov_b64 exec, 1
    v_mov_b32 v28, 1
    buffer_store_byte v28, off, s[24:27], s48 sc1
    s_mov_b64 exec, -1
W_AE:
    s_cmp_eq_u32 s69, 0
    s_cbranch_scc1 W_LOOP
    s_sub_u32 s30, s69, 1
    s_mov_b32 s69, 0
    s_branch W_GB
W_GH:
    s_and_b32 s33, s32, 1
    s_lshr_b32 s32, s32, 1
    s_mov_b32 s67, 0
    s_branch W_G
W_GB:
    s_mov_b32 s33, 0
    s_mov_b32 s67, 1
W_G:
    v_and_b32 v16, 15, v1
    v_lshrrev_b32 v17, 4, v1
    v_lshlrev_b32 v3, 4, v1
    s_bitcmp1_b32 s78, 1
    s_cbranch_scc1 W_G1
    s_cmp_lg_u32 s29, 0
    s_cbranch_scc1 W0_34
    s_mov_b32 s31, 0
PD_35:
    s_cmp_eq_u32 s31, 0
    s_cbranch_scc1 PB_36
    s_sleep 8
PB_36:
    buffer_load_dword v24, off, s[12:15], 0 offset:236 sc1
    buffer_load_dword v25, off, s[12:15], 0 offset:244 sc1
    s_add_u32 s31, s31, 1
    s_cmp_gt_u32 s31, 0x200000
    s_cbranch_scc1 W_EXIT
    s_waitcnt vmcnt(0)
    v_readfirstlane_b32 s70, v24
    v_readfirstlane_b32 s71, v25
    s_cmp_lg_u32 s70, 4
    s_cbranch_scc1 PD_35
    s_cmp_lg_u32 s71, 64
    s_cbranch_scc1 PD_35
W0_34:
    s_barrier
    s_or_b32 s78, s78, 2
W_G1:
    s_lshl_b32 s41, s30, 5
    s_lshl_b32 s42, s33, 4
    s_add_u32 s41, s41, s42
    v_add_u32 v5, s41, v16
    s_mov_b32 s43, 0x224000
    buffer_load_dwordx4 v[64:67], off, s[24:27], s43 sc1
    buffer_load_dwordx4 v[68:71], off, s[24:27], s43 offset:16 sc1
    v_lshlrev_b32 v8, 4, v17
    v_lshl_add_u32 v9, v5, 10, v8
    s_lshl_b32 s42, s32, 6
    s_add_u32 s44, s42, 16384
    s_add_u32 s43, s42, 0x220000
    s_waitcnt vmcnt(0)
    buffer_load_dwordx4 v[48:51], v9, s[16:19], s42 offen
    buffer_load_dwordx4 v[52:55], v9, s[24:27], s42 offen
    v_mov_b32 v10, 0x7ffffff0
    v_cmp_eq_u32 vcc, v64, v5
    v_mov_b32 v7, 0
    s_nop 0
    v_cndmask_b32 v10, v10, v7, vcc
    v_cmp_eq_u32 vcc, v65, v5
    v_mov_b32 v7, 1024
    s_nop 0
    v_cndmask_b32 v10, v10, v7, vcc
    v_cmp_eq_u32 vcc, v66, v5
    v_mov_b32 v7, 2048
    s_nop 0
    v_cndmask_b32 v10, v10, v7, vcc
    v_cmp_eq_u32 vcc, v67, v5
    v_mov_b32 v7, 3072
    s_nop 0
    v_cndmask_b32 v10, v10, v7, vcc
    v_cmp_eq_u32 vcc, v68, v5
    v_mov_b32 v7, 4096
    s_nop 0
    v_cndmask_b32 v10, v10, v7, vcc
    v_cmp_eq_u32 vcc, v69, v5
    v_mov_b32 v7, 5120
    s_nop 0
    v_cndmask_b32 v10, v10, v7, vcc
    v_cmp_eq_u32 vcc, v70, v5
    v_mov_b32 v7, 6144
    s_nop 0
    v_cndmask_b32 v10, v10, v7, vcc
    v_cmp_eq_u32 vcc, v71, v5
    v_mov_b32 v7, 7168
    s_nop 0
    v_cndmask_b32 v10, v10, v7, vcc
    v_add_u32 v10, v10, v8
    buffer_load_dwordx4 v[56:59], v10, s[24:27], s43 offen sc1
    s_cmp_eq_u32 s67, 0
    s_cbranch_scc1 W_G2
    v_add_u32 v5, 16, v5
    buffer_load_dwordx4 v[232:235], v9, s[16:19], s44 offen
    buffer_load_dwordx4 v[236:239], v9, s[24:27], s44 offen
    v_mov_b32 v10, 0x7ffffff0
    v_cmp_eq_u32 vcc, v64, v5
    v_mov_b32 v7, 0
    s_nop 0
    v_cndmask_b32 v10, v10, v7, vcc
    v_cmp_eq_u32 vcc, v65, v5
    v_mov_b32 v7, 1024
    s_nop 0
    v_cndmask_b32 v10, v10, v7, vcc
    v_cmp_eq_u32 vcc, v66, v5
    v_mov_b32 v7, 2048
    s_nop 0
    v_cndmask_b32 v10, v10, v7, vcc
    v_cmp_eq_u32 vcc, v67, v5
    v_mov_b32 v7, 3072
    s_nop 0
    v_cndmask_b32 v10, v10, v7, vcc
    v_cmp_eq_u32 vcc, v68, v5
    v_mov_b32 v7, 4096
    s_nop 0
    v_cndmask_b32 v10, v10, v7, vcc
    v_cmp_eq_u32 vcc, v69, v5
    v_mov_b32 v7, 5120
    s_nop 0
    v_cndmask_b32 v10, v10, v7, vcc
    v_cmp_eq_u32 vcc, v70, v5
    v_mov_b32 v7, 6144
    s_nop 0
    v_cndmask_b32 v10, v10, v7, vcc
    v_cmp_eq_u32 vcc, v71, v5
    v_mov_b32 v7, 7168
    s_nop 0
    v_cndmask_b32 v10, v10, v7, vcc
    v_add_u32 v10, v10, v8
    buffer_load_dwordx4 v[240:243], v10, s[24:27], s43 offen sc1
W_G2:
    s_lshl_b32 s34, s32, 8
    s_lshl_b32 s35, s29, 5
    s_add_u32 s34, s34, s35
    s_lshl_b32 s34, s34, 10
    s_add_u32 s34, s34, 0x1000000
    s_add_u32 s35, s34, 0
    buffer_load_dwordx4 a[0:3], v3, s[24:27], s35 offen offset:0
    buffer_load_dwordx4 a[4:7], v3, s[24:27], s35 offen offset:1024
    buffer_load_dwordx4 a[8:11], v3, s[24:27], s35 offen offset:2048
    buffer_load_dwordx4 a[12:15], v3, s[24:27], s35 offen offset:3072
    s_add_u32 s35, s35, 4096
    buffer_load_dwordx4 a[16:19], v3, s[24:27], s35 offen offset:0
    buffer_load_dwordx4 a[20:23], v3, s[24:27], s35 offen offset:1024
    buffer_load_dwordx4 a[24:27], v3, s[24:27], s35 offen offset:2048
    buffer_load_dwordx4 a[28:31], v3, s[24:27], s35 offen offset:3072
    s_add_u32 s35, s35, 4096
    buffer_load_dwordx4 a[32:35], v3, s[24:27], s35 offen offset:0
    buffer_load_dwordx4 a[36:39], v3, s[24:27], s35 offen offset:1024
    buffer_load_dwordx4 a[40:43], v3, s[24:27], s35 offen offset:2048
    buffer_load_dwordx4 a[44:47], v3, s[24:27], s35 offen offset:3072
    s_add_u32 s35, s35, 4096
    buffer_load_dwordx4 a[48:51], v3, s[24:27], s35 offen offset:0
    buffer_load_dwordx4 a[52:55], v3, s[24:27], s35 offen offset:1024
    buffer_load_dwordx4 a[56:59], v3, s[24:27], s35 offen offset:2048
    buffer_load_dwordx4 a[60:63], v3, s[24:27], s35 offen offset:3072
    s_add_u32 s35, s35, 4096
    buffer_load_dwordx4 a[64:67], v3, s[24:27], s35 offen offset:0
    buffer_load_dwordx4 a[68:71], v3, s[24:27], s35 offen offset:1024
    buffer_load_dwordx4 a[72:75], v3, s[24:27], s35 offen offset:2048
    buffer_load_dwordx4 a[76:79], v3, s[24:27], s35 offen offset:3072
    s_add_u32 s35, s35, 4096
    buffer_load_dwordx4 a[80:83], v3, s[24:27], s35 offen offset:0
    buffer_load_dwordx4 a[84:87], v3, s[24:27], s35 offen offset:1024
    buffer_load_dwordx4 a[88:91], v3, s[24:27], s35 offen offset:2048
    buffer_load_dwordx4 a[92:95], v3, s[24:27], s35 offen offset:3072
    s_add_u32 s35, s35, 4096
    buffer_load_dwordx4 a[96:99], v3, s[24:27], s35 offen offset:0
    buffer_load_dwordx4 a[100:103], v3, s[24:27], s35 offen offset:1024
    buffer_load_dwordx4 a[104:107], v3, s[24:27], s35 offen offset:2048
    buffer_load_dwordx4 a[108:111], v3, s[24:27], s35 offen offset:3072
    s_add_u32 s35, s35, 4096
    buffer_load_dwordx4 a[112:115], v3, s[24:27], s35 offen offset:0
    buffer_load_dwordx4 a[116:119], v3, s[24:27], s35 offen offset:1024
    buffer_load_dwordx4 a[120:123], v3, s[24:27], s35 offen offset:2048
    buffer_load_dwordx4 a[124:127], v3, s[24:27], s35 offen offset:3072
    s_add_u32 s35, s35, 4096
    s_add_u32 s35, s34, 131072
    buffer_load_dwordx4 a[128:131], v3, s[24:27], s35 offen offset:0
    buffer_load_dwordx4 a[132:135], v3, s[24:27], s35 offen offset:1024
    buffer_load_dwordx4 a[136:139], v3, s[24:27], s35 offen offset:2048
    buffer_load_dwordx4 a[140:143], v3, s[24:27], s35 offen offset:3072
    s_add_u32 s35, s35, 4096
    buffer_load_dwordx4 a[144:147], v3, s[24:27], s35 offen offset:0
    buffer_load_dwordx4 a[148:151], v3, s[24:27], s35 offen offset:1024
    buffer_load_dwordx4 a[152:155], v3, s[24:27], s35 offen offset:2048
    buffer_load_dwordx4 a[156:159], v3, s[24:27], s35 offen offset:3072
    s_add_u32 s35, s35, 4096
    buffer_load_dwordx4 a[160:163], v3, s[24:27], s35 offen offset:0
    buffer_load_dwordx4 a[164:167], v3, s[24:27], s35 offen offset:1024
    buffer_load_dwordx4 a[168:171], v3, s[24:27], s35 offen offset:2048
    buffer_load_dwordx4 a[172:175], v3, s[24:27], s35 offen offset:3072
    s_add_u32 s35, s35, 4096
    buffer_load_dwordx4 a[176:179], v3, s[24:27], s35 offen offset:0
    buffer_load_dwordx4 a[180:183], v3, s[24:27], s35 offen offset:1024
    buffer_load_dwordx4 a[184:187], v3, s[24:27], s35 offen offset:2048
    buffer_load_dwordx4 a[188:191], v3, s[24:27], s35 offen offset:3072
    s_add_u32 s35, s35, 4096
    buffer_load_dwordx4 a[192:195], v3, s[24:27], s35 offen offset:0
    buffer_load_dwordx4 a[196:199], v3, s[24:27], s35 offen offset:1024
    buffer_load_dwordx4 a[200:203], v3, s[24:27], s35 offen offset:2048
    buffer_load_dwordx4 a[204:207], v3, s[24:27], s35 offen offset:3072
    s_add_u32 s35, s35, 4096
    buffer_load_dwordx4 a[208:211], v3, s[24:27], s35 offen offset:0
    buffer_load_dwordx4 a[212:215], v3, s[24:27], s35 offen offset:1024
    buffer_load_dwordx4 a[216:219], v3, s[24:27], s35 offen offset:2048
    buffer_load_dwordx4 a[220:223], v3, s[24:27], s35 offen offset:3072
    s_add_u32 s35, s35, 4096
    buffer_load_dwordx4 a[224:227], v3, s[24:27], s35 offen offset:0
    buffer_load_dwordx4 a[228:231], v3, s[24:27], s35 offen offset:1024
    buffer_load_dwordx4 a[232:235], v3, s[24:27], s35 offen offset:2048
    buffer_load_dwordx4 a[236:239], v3, s[24:27], s35 offen offset:3072
    s_add_u32 s35, s35, 4096
    buffer_load_dwordx4 a[240:243], v3, s[24:27], s35 offen offset:0
    buffer_load_dwordx4 a[244:247], v3, s[24:27], s35 offen offset:1024
    buffer_load_dwordx4 a[248:251], v3, s[24:27], s35 offen offset:2048
    buffer_load_dwordx4 a[252:255], v3, s[24:27], s35 offen offset:3072
    s_add_u32 s35, s35, 4096
    v_lshlrev_b32 v4, 4, v1
    s_lshl_b32 s36, s30, 5
    s_lshl_b32 s37, s29, 3
    s_add_u32 s36, s36, s37
    s_lshl_b32 s36, s36, 13
    s_lshl_b32 s37, s33, 12
    s_add_u32 s36, s36, s37
    s_add_u32 s36, s36, 0x6000000
    s_lshl_b32 s38, s30, 4
    s_add_u32 s38, s38, 0x238000
    s_cmp_ge_u32 s30, 62
    s_cbranch_scc1 W_GT
    s_cmp_lg_u32 s29, 0
    s_cbranch_scc1 W0_37
    s_mov_b32 s31, 0
GP_38:
    s_cmp_eq_u32 s31, 0
    s_cbranch_scc1 PB_39
    s_sleep 8
PB_39:
    buffer_load_dwordx4 v[24:27], off, s[24:27], s38 sc1
    s_add_u32 s31, s31, 1
    s_cmp_gt_u32 s31, 0x200000
    s_cbranch_scc1 W_EXIT
    s_waitcnt vmcnt(0)
    v_and_b32 v24, v24, v25
    v_and_b32 v26, v26, v27
    v_and_b32 v24, v24, v26
    s_nop 0
    v_readfirstlane_b32 s70, v24
    s_cmp_lg_u32 s70, 0x01010101
    s_cbranch_scc1 GP_38
W0_37:
    s_barrier
    s_mov_b32 s37, s36
    buffer_load_dwordx4 v[64:67], v4, s[24:27], s37 offen offset:0 sc1
    buffer_load_dwordx4 v[68:71], v4, s[24:27], s37 offen offset:1024 sc1
    buffer_load_dwordx4 v[72:75], v4, s[24:27], s37 offen offset:2048 sc1
    buffer_load_dwordx4 v[76:79], v4, s[24:27], s37 offen offset:3072 sc1
    s_add_u32 s37, s37, 8192
    buffer_load_dwordx4 v[80:83], v4, s[24:27], s37 offen offset:0 sc1
    buffer_load_dwordx4 v[84:87], v4, s[24:27], s37 offen offset:1024 sc1
    buffer_load_dwordx4 v[88:91], v4, s[24:27], s37 offen offset:2048 sc1
    buffer_load_dwordx4 v[92:95], v4, s[24:27], s37 offen offset:3072 sc1
    s_add_u32 s37, s37, 8192
    buffer_load_dwordx4 v[96:99], v4, s[24:27], s37 offen offset:0 sc1
    buffer_load_dwordx4 v[100:103], v4, s[24:27], s37 offen offset:1024 sc1
    buffer_load_dwordx4 v[104:107], v4, s[24:27], s37 offen offset:2048 sc1
    buffer_load_dwordx4 v[108:111], v4, s[24:27], s37 offen offset:3072 sc1
    s_add_u32 s37, s37, 8192
    buffer_load_dwordx4 v[112:115], v4, s[24:27], s37 offen offset:0 sc1
    buffer_load_dwordx4 v[116:119], v4, s[24:27], s37 offen offset:1024 sc1
    buffer_load_dwordx4 v[120:123], v4, s[24:27], s37 offen offset:2048 sc1
    buffer_load_dwordx4 v[124:127], v4, s[24:27], s37 offen offset:3072 sc1
    s_add_u32 s37, s37, 8192
    buffer_load_dwordx4 v[128:131], v4, s[24:27], s37 offen offset:0 sc1
    buffer_load_dwordx4 v[132:135], v4, s[24:27], s37 offen offset:1024 sc1
    buffer_load_dwordx4 v[136:139], v4, s[24:27], s37 offen offset:2048 sc1
    buffer_load_dwordx4 v[140:143], v4, s[24:27], s37 offen offset:3072 sc1
    s_add_u32 s37, s37, 8192
    buffer_load_dwordx4 v[144:147], v4, s[24:27], s37 offen offset:0 sc1
    buffer_load_dwordx4 v[148:151], v4, s[24:27], s37 offen offset:1024 sc1
    buffer_load_dwordx4 v[152:155], v4, s[24:27], s37 offen offset:2048 sc1
    buffer_load_dwordx4 v[156:159], v4, s[24:27], s37 offen offset:3072 sc1
    s_add_u32 s37, s37, 8192
    buffer_load_dwordx4 v[160:163], v4, s[24:27], s37 offen offset:0 sc1
    buffer_load_dwordx4 v[164:167], v4, s[24:27], s37 offen offset:1024 sc1
    buffer_load_dwordx4 v[168:171], v4, s[24:27], s37 offen offset:2048 sc1
    buffer_load_dwordx4 v[172:175], v4, s[24:27], s37 offen offset:3072 sc1
    s_add_u32 s37, s37, 8192
    buffer_load_dwordx4 v[176:179], v4, s[24:27], s37 offen offset:0 sc1
    buffer_load_dwordx4 v[180:183], v4, s[24:27], s37 offen offset:1024 sc1
    buffer_load_dwordx4 v[184:187], v4, s[24:27], s37 offen offset:2048 sc1
    buffer_load_dwordx4 v[188:191], v4, s[24:27], s37 offen offset:3072 sc1
    s_add_u32 s37, s37, 8192
    s_waitcnt vmcnt(31)
    v_mfma_f32_16x16x32_bf16 v[32:35], a[0:3], v[64:67], 0
    v_mfma_f32_16x16x32_bf16 v[36:39], a[128:131], v[64:67], 0
    s_waitcnt vmcnt(30)
    v_mfma_f32_16x16x32_bf16 v[32:35], a[4:7], v[68:71], v[32:35]
    v_mfma_f32_16x16x32_bf16 v[36:39], a[132:135], v[68:71], v[36:39]
    s_waitcnt vmcnt(29)
    v_mfma_f32_16x16x32_bf16 v[32:35], a[8:11], v[72:75], v[32:35]
    v_mfma_f32_16x16x32_bf16 v[36:39], a[136:139], v[72:75], v[36:39]
    s_waitcnt vmcnt(28)
    v_mfma_f32_16x16x32_bf16 v[32:35], a[12:15], v[76:79], v[32:35]
    v_mfma_f32_16x16x32_bf16 v[36:39], a[140:143], v[76:79], v[36:39]
    s_waitcnt vmcnt(27)
    v_mfma_f32_16x16x32_bf16 v[32:35], a[16:19], v[80:83], v[32:35]
    v_mfma_f32_16x16x32_bf16 v[36:39], a[144:147], v[80:83], v[36:39]
    s_waitcnt vmcnt(26)
    v_mfma_f32_16x16x32_bf16 v[32:35], a[20:23], v[84:87], v[32:35]
    v_mfma_f32_16x16x32_bf16 v[36:39], a[148:151], v[84:87], v[36:39]
    s_waitcnt vmcnt(25)
    v_mfma_f32_16x16x32_bf16 v[32:35], a[24:27], v[88:91], v[32:35]
    v_mfma_f32_16x16x32_bf16 v[36:39], a[152:155], v[88:91], v[36:39]
    s_waitcnt vmcnt(24)
    v_mfma_f32_16x16x32_bf16 v[32:35], a[28:31], v[92:95], v[32:35]
    v_mfma_f32_16x16x32_bf16 v[36:39], a[156:159], v[92:95], v[36:39]
    s_waitcnt vmcnt(23)
    v_mfma_f32_16x16x32_bf16 v[32:35], a[32:35], v[96:99], v[32:35]
    v_mfma_f32_16x16x32_bf16 v[36:39], a[160:163], v[96:99], v[36:39]
    s_waitcnt vmcnt(22)
    v_mfma_f32_16x16x32_bf16 v[32:35], a[36:39], v[100:103], v[32:35]
    v_mfma_f32_16x16x32_bf16 v[36:39], a[164:167], v[100:103], v[36:39]
    s_waitcnt vmcnt(21)
    v_mfma_f32_16x16x32_bf16 v[32:35], a[40:43], v[104:107], v[32:35]
    v_mfma_f32_16x16x32_bf16 v[36:39], a[168:171], v[104:107], v[36:39]
    s_waitcnt vmcnt(20)
    v_mfma_f32_16x16x32_bf16 v[32:35], a[44:47], v[108:111], v[32:35]
    v_mfma_f32_16x16x32_bf16 v[36:39], a[172:175], v[108:111], v[36:39]
    s_waitcnt vmcnt(19)
    v_mfma_f32_16x16x32_bf16 v[32:35], a[48:51], v[112:115], v[32:35]
    v_mfma_f32_16x16x32_bf16 v[36:39], a[176:179], v[112:115], v[36:39]
    s_waitcnt vmcnt(18)
    v_mfma_f32_16x16x32_bf16 v[32:35], a[52:55], v[116:119], v[32:35]
    v_mfma_f32_16x16x32_bf16 v[36:39], a[180:183], v[116:119], v[36:39]
    s_waitcnt vmcnt(17)
    v_mfma_f32_16x16x32_bf16 v[32:35], a[56:59], v[120:123], v[32:35]
    v_mfma_f32_16x16x32_bf16 v[36:39], a[184:187], v[120:123], v[36:39]
    s_waitcnt vmcnt(16)
    v_mfma_f32_16x16x32_bf16 v[32:35], a[60:63], v[124:127], v[32:35]
    v_mfma_f32_16x16x32_bf16 v[36:39], a[188:191], v[124:127], v[36:39]
    s_waitcnt vmcnt(15)
    v_mfma_f32_16x16x32_bf16 v[32:35], a[64:67], v[128:131], v[32:35]
    v_mfma_f32_16x16x32_bf16 v[36:39], a[192:195], v[128:131], v[36:39]
    s_waitcnt vmcnt(14)
    v_mfma_f32_16x16x32_bf16 v[32:35], a[68:71], v[132:135], v[32:35]
    v_mfma_f32_16x16x32_bf16 v[36:39], a[196:199], v[132:135], v[36:39]
    s_waitcnt vmcnt(13)
    v_mfma_f32_16x16x32_bf16 v[32:35], a[72:75], v[136:139], v[32:35]
    v_mfma_f32_16x16x32_bf16 v[36:39], a[200:203], v[136:139], v[36:39]
    s_waitcnt vmcnt(12)
    v_mfma_f32_16x16x32_bf16 v[32:35], a[76:79], v[140:143], v[32:35]
    v_mfma_f32_16x16x32_bf16 v[36:39], a[204:207], v[140:143], v[36:39]
    s_waitcnt vmcnt(11)
    v_mfma_f32_16x16x32_bf16 v[32:35], a[80:83], v[144:147], v[32:35]
    v_mfma_f32_16x16x32_bf16 v[36:39], a[208:211], v[144:147], v[36:39]
    s_waitcnt vmcnt(10)
    v_mfma_f32_16x16x32_bf16 v[32:35], a[84:87], v[148:151], v[32:35]
    v_mfma_f32_16x16x32_bf16 v[36:39], a[212:215], v[148:151], v[36:39]
    s_waitcnt vmcnt(9)
    v_mfma_f32_16x16x32_bf16 v[32:35], a[88:91], v[152:155], v[32:35]
    v_mfma_f32_16x16x32_bf16 v[36:39], a[216:219], v[152:155], v[36:39]
    s_waitcnt vmcnt(8)
    v_mfma_f32_16x16x32_bf16 v[32:35], a[92:95], v[156:159], v[32:35]
    v_mfma_f32_16x16x32_bf16 v[36:39], a[220:223], v[156:159], v[36:39]
    s_waitcnt vmcnt(7)
    v_mfma_f32_16x16x32_bf16 v[32:35], a[96:99], v[160:163], v[32:35]
    v_mfma_f32_16x16x32_bf16 v[36:39], a[224:227], v[160:163], v[36:39]
    s_waitcnt vmcnt(6)
    v_mfma_f32_16x16x32_bf16 v[32:35], a[100:103], v[164:167], v[32:35]
    v_mfma_f32_16x16x32_bf16 v[36:39], a[228:231], v[164:167], v[36:39]
    s_waitcnt vmcnt(5)
    v_mfma_f32_16x16x32_bf16 v[32:35], a[104:107], v[168:171], v[32:35]
    v_mfma_f32_16x16x32_bf16 v[36:39], a[232:235], v[168:171], v[36:39]
    s_waitcnt vmcnt(4)
    v_mfma_f32_16x16x32_bf16 v[32:35], a[108:111], v[172:175], v[32:35]
    v_mfma_f32_16x16x32_bf16 v[36:39], a[236:239], v[172:175], v[36:39]
    s_waitcnt vmcnt(3)
    v_mfma_f32_16x16x32_bf16 v[32:35], a[112:115], v[176:179], v[32:35]
    v_mfma_f32_16x16x32_bf16 v[36:39], a[240:243], v[176:179], v[36:39]
    s_waitcnt vmcnt(2)
    v_mfma_f32_16x16x32_bf16 v[32:35], a[116:119], v[180:183], v[32:35]
    v_mfma_f32_16x16x32_bf16 v[36:39], a[244:247], v[180:183], v[36:39]
    s_waitcnt vmcnt(1)
    v_mfma_f32_16x16x32_bf16 v[32:35], a[120:123], v[184:187], v[32:35]
    v_mfma_f32_16x16x32_bf16 v[36:39], a[248:251], v[184:187], v[36:39]
    s_waitcnt vmcnt(0)
    v_mfma_f32_16x16x32_bf16 v[32:35], a[124:127], v[188:191], v[32:35]
    v_mfma_f32_16x16x32_bf16 v[36:39], a[252:255], v[188:191], v[36:39]
    s_nop 7
    s_cmp_eq_u32 s67, 0
    s_cbranch_scc1 W_G3
    s_add_u32 s36, s36, 4096
    s_mov_b32 s37, s36
    buffer_load_dwordx4 v[64:67], v4, s[24:27], s37 offen offset:0 sc1
    buffer_load_dwordx4 v[68:71], v4, s[24:27], s37 offen offset:1024 sc1
    buffer_load_dwordx4 v[72:75], v4, s[24:27], s37 offen offset:2048 sc1
    buffer_load_dwordx4 v[76:79], v4, s[24:27], s37 offen offset:3072 sc1
    s_add_u32 s37, s37, 8192
    buffer_load_dwordx4 v[80:83], v4, s[24:27], s37 offen offset:0 sc1
    buffer_load_dwordx4 v[84:87], v4, s[24:27], s37 offen offset:1024 sc1
    buffer_load_dwordx4 v[88:91], v4, s[24:27], s37 offen offset:2048 sc1
    buffer_load_dwordx4 v[92:95], v4, s[24:27], s37 offen offset:3072 sc1
    s_add_u32 s37, s37, 8192
    buffer_load_dwordx4 v[96:99], v4, s[24:27], s37 offen offset:0 sc1
    buffer_load_dwordx4 v[100:103], v4, s[24:27], s37 offen offset:1024 sc1
    buffer_load_dwordx4 v[104:107], v4, s[24:27], s37 offen offset:2048 sc1
    buffer_load_dwordx4 v[108:111], v4, s[24:27], s37 offen offset:3072 sc1
    s_add_u32 s37, s37, 8192
    buffer_load_dwordx4 v[112:115], v4, s[24:27], s37 offen offset:0 sc1
    buffer_load_dwordx4 v[116:119], v4, s[24:27], s37 offen offset:1024 sc1
    buffer_load_dwordx4 v[120:123], v4, s[24:27], s37 offen offset:2048 sc1
    buffer_load_dwordx4 v[124:127], v4, s[24:27], s37 offen offset:3072 sc1
    s_add_u32 s37, s37, 8192
    buffer_load_dwordx4 v[128:131], v4, s[24:27], s37 offen offset:0 sc1
    buffer_load_dwordx4 v[132:135], v4, s[24:27], s37 offen offset:1024 sc1
    buffer_load_dwordx4 v[136:139], v4, s[24:27], s37 offen offset:2048 sc1
    buffer_load_dwordx4 v[140:143], v4, s[24:27], s37 offen offset:3072 sc1
    s_add_u32 s37, s37, 8192
    buffer_load_dwordx4 v[144:147], v4, s[24:27], s37 offen offset:0 sc1
    buffer_load_dwordx4 v[148:151], v4, s[24:27], s37 offen offset:1024 sc1
    buffer_load_dwordx4 v[152:155], v4, s[24:27], s37 offen offset:2048 sc1
    buffer_load_dwordx4 v[156:159], v4, s[24:27], s37 offen offset:3072 sc1
    s_add_u32 s37, s37, 8192
    buffer_load_dwordx4 v[160:163], v4, s[24:27], s37 offen offset:0 sc1
    buffer_load_dwordx4 v[164:167], v4, s[24:27], s37 offen offset:1024 sc1
    buffer_load_dwordx4 v[168:171], v4, s[24:27], s37 offen offset:2048 sc1
    buffer_load_dwordx4 v[172:175], v4, s[24:27], s37 offen offset:3072 sc1
    s_add_u32 s37, s37, 8192
    buffer_load_dwordx4 v[176:179], v4, s[24:27], s37 offen offset:0 sc1
    buffer_load_dwordx4 v[180:183], v4, s[24:27], s37 offen offset:1024 sc1
    buffer_load_dwordx4 v[184:187], v4, s[24:27], s37 offen offset:2048 sc1
    buffer_load_dwordx4 v[188:191], v4, s[24:27], s37 offen offset:3072 sc1
    s_add_u32 s37, s37, 8192
    v_lshl_add_u32 v6, v2, 11, v3
    v_add_u32 v6, 1024, v6
    ds_write_b128 v6, v[32:35] offset:0
    ds_write_b128 v6, v[36:39] offset:1024
    s_waitcnt lgkmcnt(0)
    s_barrier
    s_cmp_ge_u32 s29, 1
    s_cbranch_scc1 GE_40
    v_add_u32 v6, 1024, v3
    ds_read_b128 v[192:195], v6 offset:0
    ds_read_b128 v[196:199], v6 offset:2048
    ds_read_b128 v[200:203], v6 offset:4096
    ds_read_b128 v[204:207], v6 offset:6144
    ds_read_b128 v[208:211], v6 offset:1024
    ds_read_b128 v[212:215], v6 offset:3072
    ds_read_b128 v[216:219], v6 offset:5120
    ds_read_b128 v[220:223], v6 offset:7168
    s_waitcnt lgkmcnt(0)
    v_add_f32 v192, v192, v196
    v_add_f32 v200, v200, v204
    v_add_f32 v193, v193, v197
    v_add_f32 v201, v201, v205
    v_add_f32 v194, v194, v198
    v_add_f32 v202, v202, v206
    v_add_f32 v195, v195, v199
    v_add_f32 v203, v203, v207
    v_add_f32 v192, v192, v200
    v_add_f32 v193, v193, v201
    v_add_f32 v194, v194, v202
    v_add_f32 v195, v195, v203
    v_add_f32 v208, v208, v212
    v_add_f32 v216, v216, v220
    v_add_f32 v209, v209, v213
    v_add_f32 v217, v217, v221
    v_add_f32 v210, v210, v214
    v_add_f32 v218, v218, v222
    v_add_f32 v211, v211, v215
    v_add_f32 v219, v219, v223
    v_add_f32 v208, v208, v216
    v_add_f32 v209, v209, v217
    v_add_f32 v210, v210, v218
    v_add_f32 v211, v211, v219
    v_cvt_pk_bf16_f32 v224, v192, v193
    v_cvt_pk_bf16_f32 v225, v194, v195
    v_cvt_pk_bf16_f32 v226, v208, v209
    v_cvt_pk_bf16_f32 v227, v210, v211
    v_lshlrev_b32 v40, 16, v224
    v_and_b32 v41, 0xffff0000, v224
    v_lshlrev_b32 v42, 16, v48
    v_and_b32 v43, 0xffff0000, v48
    v_add_f32 v40, v42, v40
    v_add_f32 v41, v43, v41
    v_cvt_pk_bf16_f32 v44, v40, v41
    v_lshlrev_b32 v40, 16, v52
    v_and_b32 v41, 0xffff0000, v52
    v_lshlrev_b32 v42, 16, v56
    v_and_b32 v43, 0xffff0000, v56
    v_add_f32 v40, v40, v42
    v_add_f32 v41, v41, v43
    v_cvt_pk_bf16_f32 v45, v40, v41
    v_lshlrev_b32 v40, 16, v44
    v_and_b32 v41, 0xffff0000, v44
    v_lshlrev_b32 v42, 16, v45
    v_and_b32 v43, 0xffff0000, v45
    v_add_f32 v40, v40, v42
    v_add_f32 v41, v41, v43
    v_cvt_pk_bf16_f32 v228, v40, v41
    v_lshlrev_b32 v40, 16, v225
    v_and_b32 v41, 0xffff0000, v225
    v_lshlrev_b32 v42, 16, v49
    v_and_b32 v43, 0xffff0000, v49
    v_add_f32 v40, v42, v40
    v_add_f32 v41, v43, v41
    v_cvt_pk_bf16_f32 v44, v40, v41
    v_lshlrev_b32 v40, 16, v53
    v_and_b32 v41, 0xffff0000, v53
    v_lshlrev_b32 v42, 16, v57
    v_and_b32 v43, 0xffff0000, v57
    v_add_f32 v40, v40, v42
    v_add_f32 v41, v41, v43
    v_cvt_pk_bf16_f32 v45, v40, v41
    v_lshlrev_b32 v40, 16, v44
    v_and_b32 v41, 0xffff0000, v44
    v_lshlrev_b32 v42, 16, v45
    v_and_b32 v43, 0xffff0000, v45
    v_add_f32 v40, v40, v42
    v_add_f32 v41, v41, v43
    v_cvt_pk_bf16_f32 v229, v40, v41
    v_lshlrev_b32 v40, 16, v226
    v_and_b32 v41, 0xffff0000, v226
    v_lshlrev_b32 v42, 16, v50
    v_and_b32 v43, 0xffff0000, v50
    v_add_f32 v40, v42, v40
    v_add_f32 v41, v43, v41
    v_cvt_pk_bf16_f32 v44, v40, v41
    v_lshlrev_b32 v40, 16, v54
    v_and_b32 v41, 0xffff0000, v54
    v_lshlrev_b32 v42, 16, v58
    v_and_b32 v43, 0xffff0000, v58
    v_add_f32 v40, v40, v42
    v_add_f32 v41, v41, v43
    v_cvt_pk_bf16_f32 v45, v40, v41
    v_lshlrev_b32 v40, 16, v44
    v_and_b32 v41, 0xffff0000, v44
    v_lshlrev_b32 v42, 16, v45
    v_and_b32 v43, 0xffff0000, v45
    v_add_f32 v40, v40, v42
    v_add_f32 v41, v41, v43
    v_cvt_pk_bf16_f32 v230, v40, v41
    v_lshlrev_b32 v40, 16, v227
    v_and_b32 v41, 0xffff0000, v227
    v_lshlrev_b32 v42, 16, v51
    v_and_b32 v43, 0xffff0000, v51
    v_add_f32 v40, v42, v40
    v_add_f32 v41, v43, v41
    v_cvt_pk_bf16_f32 v44, v40, v41
    v_lshlrev_b32 v40, 16, v55
    v_and_b32 v41, 0xffff0000, v55
    v_lshlrev_b32 v42, 16, v59
    v_and_b32 v43, 0xffff0000, v59
    v_add_f32 v40, v40, v42
    v_add_f32 v41, v41, v43
    v_cvt_pk_bf16_f32 v45, v40, v41
    v_lshlrev_b32 v40, 16, v44
    v_and_b32 v41, 0xffff0000, v44
    v_lshlrev_b32 v42, 16, v45
    v_and_b32 v43, 0xffff0000, v45
    v_add_f32 v40, v40, v42
    v_add_f32 v41, v41, v43
    v_cvt_pk_bf16_f32 v231, v40, v41
    buffer_store_dwordx4 v[228:231], v9, s[20:23], s42 offen
GE_40:
    s_waitcnt vmcnt(31)
    v_mfma_f32_16x16x32_bf16 v[32:35], a[0:3], v[64:67], 0
    v_mfma_f32_16x16x32_bf16 v[36:39], a[128:131], v[64:67], 0
    s_waitcnt vmcnt(30)
    v_mfma_f32_16x16x32_bf16 v[32:35], a[4:7], v[68:71], v[32:35]
    v_mfma_f32_16x16x32_bf16 v[36:39], a[132:135], v[68:71], v[36:39]
    s_waitcnt vmcnt(29)
    v_mfma_f32_16x16x32_bf16 v[32:35], a[8:11], v[72:75], v[32:35]
    v_mfma_f32_16x16x32_bf16 v[36:39], a[136:139], v[72:75], v[36:39]
    s_waitcnt vmcnt(28)
    v_mfma_f32_16x16x32_bf16 v[32:35], a[12:15], v[76:79], v[32:35]
    v_mfma_f32_16x16x32_bf16 v[36:39], a[140:143], v[76:79], v[36:39]
    s_waitcnt vmcnt(27)
    v_mfma_f32_16x16x32_bf16 v[32:35], a[16:19], v[80:83], v[32:35]
    v_mfma_f32_16x16x32_bf16 v[36:39], a[144:147], v[80:83], v[36:39]
    s_waitcnt vmcnt(26)
    v_mfma_f32_16x16x32_bf16 v[32:35], a[20:23], v[84:87], v[32:35]
    v_mfma_f32_16x16x32_bf16 v[36:39], a[148:151], v[84:87], v[36:39]
    s_waitcnt vmcnt(25)
    v_mfma_f32_16x16x32_bf16 v[32:35], a[24:27], v[88:91], v[32:35]
    v_mfma_f32_16x16x32_bf16 v[36:39], a[152:155], v[88:91], v[36:39]
    s_waitcnt vmcnt(24)
    v_mfma_f32_16x16x32_bf16 v[32:35], a[28:31], v[92:95], v[32:35]
    v_mfma_f32_16x16x32_bf16 v[36:39], a[156:159], v[92:95], v[36:39]
    s_waitcnt vmcnt(23)
    v_mfma_f32_16x16x32_bf16 v[32:35], a[32:35], v[96:99], v[32:35]
    v_mfma_f32_16x16x32_bf16 v[36:39], a[160:163], v[96:99], v[36:39]
    s_waitcnt vmcnt(22)
    v_mfma_f32_16x16x32_bf16 v[32:35], a[36:39], v[100:103], v[32:35]
    v_mfma_f32_16x16x32_bf16 v[36:39], a[164:167], v[100:103], v[36:39]
    s_waitcnt vmcnt(21)
    v_mfma_f32_16x16x32_bf16 v[32:35], a[40:43], v[104:107], v[32:35]
    v_mfma_f32_16x16x32_bf16 v[36:39], a[168:171], v[104:107], v[36:39]
    s_waitcnt vmcnt(20)
    v_mfma_f32_16x16x32_bf16 v[32:35], a[44:47], v[108:111], v[32:35]
    v_mfma_f32_16x16x32_bf16 v[36:39], a[172:175], v[108:111], v[36:39]
    s_waitcnt vmcnt(19)
    v_mfma_f32_16x16x32_bf16 v[32:35], a[48:51], v[112:115], v[32:35]
    v_mfma_f32_16x16x32_bf16 v[36:39], a[176:179], v[112:115], v[36:39]
    s_waitcnt vmcnt(18)
    v_mfma_f32_16x16x32_bf16 v[32:35], a[52:55], v[116:119], v[32:35]
    v_mfma_f32_16x16x32_bf16 v[36:39], a[180:183], v[116:119], v[36:39]
    s_waitcnt vmcnt(17)
    v_mfma_f32_16x16x32_bf16 v[32:35], a[56:59], v[120:123], v[32:35]
    v_mfma_f32_16x16x32_bf16 v[36:39], a[184:187], v[120:123], v[36:39]
    s_waitcnt vmcnt(16)
    v_mfma_f32_16x16x32_bf16 v[32:35], a[60:63], v[124:127], v[32:35]
    v_mfma_f32_16x16x32_bf16 v[36:39], a[188:191], v[124:127], v[36:39]
    s_waitcnt vmcnt(15)
    v_mfma_f32_16x16x32_bf16 v[32:35], a[64:67], v[128:131], v[32:35]
    v_mfma_f32_16x16x32_bf16 v[36:39], a[192:195], v[128:131], v[36:39]
    s_waitcnt vmcnt(14)
    v_mfma_f32_16x16x32_bf16 v[32:35], a[68:71], v[132:135], v[32:35]
    v_mfma_f32_16x16x32_bf16 v[36:39], a[196:199], v[132:135], v[36:39]
    s_waitcnt vmcnt(13)
    v_mfma_f32_16x16x32_bf16 v[32:35], a[72:75], v[136:139], v[32:35]
    v_mfma_f32_16x16x32_bf16 v[36:39], a[200:203], v[136:139], v[36:39]
    s_waitcnt vmcnt(12)
    v_mfma_f32_16x16x32_bf16 v[32:35], a[76:79], v[140:143], v[32:35]
    v_mfma_f32_16x16x32_bf16 v[36:39], a[204:207], v[140:143], v[36:39]
    s_waitcnt vmcnt(11)
    v_mfma_f32_16x16x32_bf16 v[32:35], a[80:83], v[144:147], v[32:35]
    v_mfma_f32_16x16x32_bf16 v[36:39], a[208:211], v[144:147], v[36:39]
    s_waitcnt vmcnt(10)
    v_mfma_f32_16x16x32_bf16 v[32:35], a[84:87], v[148:151], v[32:35]
    v_mfma_f32_16x16x32_bf16 v[36:39], a[212:215], v[148:151], v[36:39]
    s_waitcnt vmcnt(9)
    v_mfma_f32_16x16x32_bf16 v[32:35], a[88:91], v[152:155], v[32:35]
    v_mfma_f32_16x16x32_bf16 v[36:39], a[216:219], v[152:155], v[36:39]
    s_waitcnt vmcnt(8)
    v_mfma_f32_16x16x32_bf16 v[32:35], a[92:95], v[156:159], v[32:35]
    v_mfma_f32_16x16x32_bf16 v[36:39], a[220:223], v[156:159], v[36:39]
    s_waitcnt vmcnt(7)
    v_mfma_f32_16x16x32_bf16 v[32:35], a[96:99], v[160:163], v[32:35]
    v_mfma_f32_16x16x32_bf16 v[36:39], a[224:227], v[160:163], v[36:39]
    s_waitcnt vmcnt(6)
    v_mfma_f32_16x16x32_bf16 v[32:35], a[100:103], v[164:167], v[32:35]
    v_mfma_f32_16x16x32_bf16 v[36:39], a[228:231], v[164:167], v[36:39]
    s_waitcnt vmcnt(5)
    v_mfma_f32_16x16x32_bf16 v[32:35], a[104:107], v[168:171], v[32:35]
    v_mfma_f32_16x16x32_bf16 v[36:39], a[232:235], v[168:171], v[36:39]
    s_waitcnt vmcnt(4)
    v_mfma_f32_16x16x32_bf16 v[32:35], a[108:111], v[172:175], v[32:35]
    v_mfma_f32_16x16x32_bf16 v[36:39], a[236:239], v[172:175], v[36:39]
    s_waitcnt vmcnt(3)
    v_mfma_f32_16x16x32_bf16 v[32:35], a[112:115], v[176:179], v[32:35]
    v_mfma_f32_16x16x32_bf16 v[36:39], a[240:243], v[176:179], v[36:39]
    s_waitcnt vmcnt(2)
    v_mfma_f32_16x16x32_bf16 v[32:35], a[116:119], v[180:183], v[32:35]
    v_mfma_f32_16x16x32_bf16 v[36:39], a[244:247], v[180:183], v[36:39]
    s_waitcnt vmcnt(1)
    v_mfma_f32_16x16x32_bf16 v[32:35], a[120:123], v[184:187], v[32:35]
    v_mfma_f32_16x16x32_bf16 v[36:39], a[248:251], v[184:187], v[36:39]
    s_waitcnt vmcnt(0)
    v_mfma_f32_16x16x32_bf16 v[32:35], a[124:127], v[188:191], v[32:35]
    v_mfma_f32_16x16x32_bf16 v[36:39], a[252:255], v[188:191], v[36:39]
    s_nop 7
    v_lshl_add_u32 v6, v2, 11, v3
    v_add_u32 v6, 9216, v6
    ds_write_b128 v6, v[32:35] offset:0
    ds_write_b128 v6, v[36:39] offset:1024
    s_waitcnt lgkmcnt(0)
    s_barrier
    s_cmp_ge_u32 s29, 1
    s_cbranch_scc1 GE_41
    v_add_u32 v6, 9216, v3
    ds_read_b128 v[192:195], v6 offset:0
    ds_read_b128 v[196:199], v6 offset:2048
    ds_read_b128 v[200:203], v6 offset:4096
    ds_read_b128 v[204:207], v6 offset:6144
    ds_read_b128 v[208:211], v6 offset:1024
    ds_read_b128 v[212:215], v6 offset:3072
    ds_read_b128 v[216:219], v6 offset:5120
    ds_read_b128 v[220:223], v6 offset:7168
    s_waitcnt lgkmcnt(0)
    v_add_f32 v192, v192, v196
    v_add_f32 v200, v200, v204
    v_add_f32 v193, v193, v197
    v_add_f32 v201, v201, v205
    v_add_f32 v194, v194, v198
    v_add_f32 v202, v202, v206
    v_add_f32 v195, v195, v199
    v_add_f32 v203, v203, v207
    v_add_f32 v192, v192, v200
    v_add_f32 v193, v193, v201
    v_add_f32 v194, v194, v202
    v_add_f32 v195, v195, v203
    v_add_f32 v208, v208, v212
    v_add_f32 v216, v216, v220
    v_add_f32 v209, v209, v213
    v_add_f32 v217, v217, v221
    v_add_f32 v210, v210, v214
    v_add_f32 v218, v218, v222
    v_add_f32 v211, v211, v215
    v_add_f32 v219, v219, v223
    v_add_f32 v208, v208, v216
    v_add_f32 v209, v209, v217
    v_add_f32 v210, v210, v218
    v_add_f32 v211, v211, v219
    v_cvt_pk_bf16_f32 v224, v192, v193
    v_cvt_pk_bf16_f32 v225, v194, v195
    v_cvt_pk_bf16_f32 v226, v208, v209
    v_cvt_pk_bf16_f32 v227, v210, v211
    v_lshlrev_b32 v40, 16, v224
    v_and_b32 v41, 0xffff0000, v224
    v_lshlrev_b32 v42, 16, v232
    v_and_b32 v43, 0xffff0000, v232
    v_add_f32 v40, v42, v40
    v_add_f32 v41, v43, v41
    v_cvt_pk_bf16_f32 v44, v40, v41
    v_lshlrev_b32 v40, 16, v236
    v_and_b32 v41, 0xffff0000, v236
    v_lshlrev_b32 v42, 16, v240
    v_and_b32 v43, 0xffff0000, v240
    v_add_f32 v40, v40, v42
    v_add_f32 v41, v41, v43
    v_cvt_pk_bf16_f32 v45, v40, v41
    v_lshlrev_b32 v40, 16, v44
    v_and_b32 v41, 0xffff0000, v44
    v_lshlrev_b32 v42, 16, v45
    v_and_b32 v43, 0xffff0000, v45
    v_add_f32 v40, v40, v42
    v_add_f32 v41, v41, v43
    v_cvt_pk_bf16_f32 v228, v40, v41
    v_lshlrev_b32 v40, 16, v225
    v_and_b32 v41, 0xffff0000, v225
    v_lshlrev_b32 v42, 16, v233
    v_and_b32 v43, 0xffff0000, v233
    v_add_f32 v40, v42, v40
    v_add_f32 v41, v43, v41
    v_cvt_pk_bf16_f32 v44, v40, v41
    v_lshlrev_b32 v40, 16, v237
    v_and_b32 v41, 0xffff0000, v237
    v_lshlrev_b32 v42, 16, v241
    v_and_b32 v43, 0xffff0000, v241
    v_add_f32 v40, v40, v42
    v_add_f32 v41, v41, v43
    v_cvt_pk_bf16_f32 v45, v40, v41
    v_lshlrev_b32 v40, 16, v44
    v_and_b32 v41, 0xffff0000, v44
    v_lshlrev_b32 v42, 16, v45
    v_and_b32 v43, 0xffff0000, v45
    v_add_f32 v40, v40, v42
    v_add_f32 v41, v41, v43
    v_cvt_pk_bf16_f32 v229, v40, v41
    v_lshlrev_b32 v40, 16, v226
    v_and_b32 v41, 0xffff0000, v226
    v_lshlrev_b32 v42, 16, v234
    v_and_b32 v43, 0xffff0000, v234
    v_add_f32 v40, v42, v40
    v_add_f32 v41, v43, v41
    v_cvt_pk_bf16_f32 v44, v40, v41
    v_lshlrev_b32 v40, 16, v238
    v_and_b32 v41, 0xffff0000, v238
    v_lshlrev_b32 v42, 16, v242
    v_and_b32 v43, 0xffff0000, v242
    v_add_f32 v40, v40, v42
    v_add_f32 v41, v41, v43
    v_cvt_pk_bf16_f32 v45, v40, v41
    v_lshlrev_b32 v40, 16, v44
    v_and_b32 v41, 0xffff0000, v44
    v_lshlrev_b32 v42, 16, v45
    v_and_b32 v43, 0xffff0000, v45
    v_add_f32 v40, v40, v42
    v_add_f32 v41, v41, v43
    v_cvt_pk_bf16_f32 v230, v40, v41
    v_lshlrev_b32 v40, 16, v227
    v_and_b32 v41, 0xffff0000, v227
    v_lshlrev_b32 v42, 16, v235
    v_and_b32 v43, 0xffff0000, v235
    v_add_f32 v40, v42, v40
    v_add_f32 v41, v43, v41
    v_cvt_pk_bf16_f32 v44, v40, v41
    v_lshlrev_b32 v40, 16, v239
    v_and_b32 v41, 0xffff0000, v239
    v_lshlrev_b32 v42, 16, v243
    v_and_b32 v43, 0xffff0000, v243
    v_add_f32 v40, v40, v42
    v_add_f32 v41, v41, v43
    v_cvt_pk_bf16_f32 v45, v40, v41
    v_lshlrev_b32 v40, 16, v44
    v_and_b32 v41, 0xffff0000, v44
    v_lshlrev_b32 v42, 16, v45
    v_and_b32 v43, 0xffff0000, v45
    v_add_f32 v40, v40, v42
    v_add_f32 v41, v41, v43
    v_cvt_pk_bf16_f32 v231, v40, v41
    buffer_store_dwordx4 v[228:231], v9, s[20:23], s44 offen
GE_41:
    s_branch W_LOOP
W_G3:
    v_lshl_add_u32 v6, v2, 11, v3
    v_add_u32 v6, 1024, v6
    ds_write_b128 v6, v[32:35] offset:0
    ds_write_b128 v6, v[36:39] offset:1024
    s_waitcnt lgkmcnt(0)
    s_barrier
    s_cmp_ge_u32 s29, 1
    s_cbranch_scc1 GE_42
    v_add_u32 v6, 1024, v3
    ds_read_b128 v[192:195], v6 offset:0
    ds_read_b128 v[196:199], v6 offset:2048
    ds_read_b128 v[200:203], v6 offset:4096
    ds_read_b128 v[204:207], v6 offset:6144
    ds_read_b128 v[208:211], v6 offset:1024
    ds_read_b128 v[212:215], v6 offset:3072
    ds_read_b128 v[216:219], v6 offset:5120
    ds_read_b128 v[220:223], v6 offset:7168
    s_waitcnt lgkmcnt(0)
    v_add_f32 v192, v192, v196
    v_add_f32 v200, v200, v204
    v_add_f32 v193, v193, v197
    v_add_f32 v201, v201, v205
    v_add_f32 v194, v194, v198
    v_add_f32 v202, v202, v206
    v_add_f32 v195, v195, v199
    v_add_f32 v203, v203, v207
    v_add_f32 v192, v192, v200
    v_add_f32 v193, v193, v201
    v_add_f32 v194, v194, v202
    v_add_f32 v195, v195, v203
    v_add_f32 v208, v208, v212
    v_add_f32 v216, v216, v220
    v_add_f32 v209, v209, v213
    v_add_f32 v217, v217, v221
    v_add_f32 v210, v210, v214
    v_add_f32 v218, v218, v222
    v_add_f32 v211, v211, v215
    v_add_f32 v219, v219, v223
    v_add_f32 v208, v208, v216
    v_add_f32 v209, v209, v217
    v_add_f32 v210, v210, v218
    v_add_f32 v211, v211, v219
    v_cvt_pk_bf16_f32 v224, v192, v193
    v_cvt_pk_bf16_f32 v225, v194, v195
    v_cvt_pk_bf16_f32 v226, v208, v209
    v_cvt_pk_bf16_f32 v227, v210, v211
    v_lshlrev_b32 v40, 16, v224
    v_and_b32 v41, 0xffff0000, v224
    v_lshlrev_b32 v42, 16, v48
    v_and_b32 v43, 0xffff0000, v48
    v_add_f32 v40, v42, v40
    v_add_f32 v41, v43, v41
    v_cvt_pk_bf16_f32 v44, v40, v41
    v_lshlrev_b32 v40, 16, v52
    v_and_b32 v41, 0xffff0000, v52
    v_lshlrev_b32 v42, 16, v56
    v_and_b32 v43, 0xffff0000, v56
    v_add_f32 v40, v40, v42
    v_add_f32 v41, v41, v43
    v_cvt_pk_bf16_f32 v45, v40, v41
    v_lshlrev_b32 v40, 16, v44
    v_and_b32 v41, 0xffff0000, v44
    v_lshlrev_b32 v42, 16, v45
    v_and_b32 v43, 0xffff0000, v45
    v_add_f32 v40, v40, v42
    v_add_f32 v41, v41, v43
    v_cvt_pk_bf16_f32 v228, v40, v41
    v_lshlrev_b32 v40, 16, v225
    v_and_b32 v41, 0xffff0000, v225
    v_lshlrev_b32 v42, 16, v49
    v_and_b32 v43, 0xffff0000, v49
    v_add_f32 v40, v42, v40
    v_add_f32 v41, v43, v41
    v_cvt_pk_bf16_f32 v44, v40, v41
    v_lshlrev_b32 v40, 16, v53
    v_and_b32 v41, 0xffff0000, v53
    v_lshlrev_b32 v42, 16, v57
    v_and_b32 v43, 0xffff0000, v57
    v_add_f32 v40, v40, v42
    v_add_f32 v41, v41, v43
    v_cvt_pk_bf16_f32 v45, v40, v41
    v_lshlrev_b32 v40, 16, v44
    v_and_b32 v41, 0xffff0000, v44
    v_lshlrev_b32 v42, 16, v45
    v_and_b32 v43, 0xffff0000, v45
    v_add_f32 v40, v40, v42
    v_add_f32 v41, v41, v43
    v_cvt_pk_bf16_f32 v229, v40, v41
    v_lshlrev_b32 v40, 16, v226
    v_and_b32 v41, 0xffff0000, v226
    v_lshlrev_b32 v42, 16, v50
    v_and_b32 v43, 0xffff0000, v50
    v_add_f32 v40, v42, v40
    v_add_f32 v41, v43, v41
    v_cvt_pk_bf16_f32 v44, v40, v41
    v_lshlrev_b32 v40, 16, v54
    v_and_b32 v41, 0xffff0000, v54
    v_lshlrev_b32 v42, 16, v58
    v_and_b32 v43, 0xffff0000, v58
    v_add_f32 v40, v40, v42
    v_add_f32 v41, v41, v43
    v_cvt_pk_bf16_f32 v45, v40, v41
    v_lshlrev_b32 v40, 16, v44
    v_and_b32 v41, 0xffff0000, v44
    v_lshlrev_b32 v42, 16, v45
    v_and_b32 v43, 0xffff0000, v45
    v_add_f32 v40, v40, v42
    v_add_f32 v41, v41, v43
    v_cvt_pk_bf16_f32 v230, v40, v41
    v_lshlrev_b32 v40, 16, v227
    v_and_b32 v41, 0xffff0000, v227
    v_lshlrev_b32 v42, 16, v51
    v_and_b32 v43, 0xffff0000, v51
    v_add_f32 v40, v42, v40
    v_add_f32 v41, v43, v41
    v_cvt_pk_bf16_f32 v44, v40, v41
    v_lshlrev_b32 v40, 16, v55
    v_and_b32 v41, 0xffff0000, v55
    v_lshlrev_b32 v42, 16, v59
    v_and_b32 v43, 0xffff0000, v59
    v_add_f32 v40, v40, v42
    v_add_f32 v41, v41, v43
    v_cvt_pk_bf16_f32 v45, v40, v41
    v_lshlrev_b32 v40, 16, v44
    v_and_b32 v41, 0xffff0000, v44
    v_lshlrev_b32 v42, 16, v45
    v_and_b32 v43, 0xffff0000, v45
    v_add_f32 v40, v40, v42
    v_add_f32 v41, v41, v43
    v_cvt_pk_bf16_f32 v231, v40, v41
    buffer_store_dwordx4 v[228:231], v9, s[20:23], s42 offen
GE_42:
    s_branch W_LOOP
W_GT:
    s_mov_b32 s31, 0
W_GT1:
    s_cmp_eq_u32 s31, 0
    s_cbranch_scc1 W_GT2
    s_sleep 2
W_GT2:
    s_mov_b32 s37, s36
    buffer_load_dwordx4 v[76:79], v4, s[24:27], s37 offen offset:3072 sc1
    s_add_u32 s37, s37, 8192
    buffer_load_dwordx4 v[92:95], v4, s[24:27], s37 offen offset:3072 sc1
    s_add_u32 s37, s37, 8192
    buffer_load_dwordx4 v[108:111], v4, s[24:27], s37 offen offset:3072 sc1
    s_add_u32 s37, s37, 8192
    buffer_load_dwordx4 v[124:127], v4, s[24:27], s37 offen offset:3072 sc1
    s_add_u32 s37, s37, 8192
    buffer_load_dwordx4 v[140:143], v4, s[24:27], s37 offen offset:3072 sc1
    s_add_u32 s37, s37, 8192
    buffer_load_dwordx4 v[156:159], v4, s[24:27], s37 offen offset:3072 sc1
    s_add_u32 s37, s37, 8192
    buffer_load_dwordx4 v[172:175], v4, s[24:27], s37 offen offset:3072 sc1
    s_add_u32 s37, s37, 8192
    buffer_load_dwordx4 v[188:191], v4, s[24:27], s37 offen offset:3072 sc1
    s_add_u32 s37, s37, 8192
    s_add_u32 s31, s31, 1
    s_cmp_gt_u32 s31, 0x200000
    s_cbranch_scc1 W_EXIT
    s_waitcnt vmcnt(0)
    v_max3_u32 v22, v76, v77, v78
    v_max3_u32 v22, v22, v79, v92
    v_max3_u32 v22, v22, v93, v94
    v_max3_u32 v22, v22, v95, v108
    v_max3_u32 v22, v22, v109, v110
    v_max3_u32 v22, v22, v111, v124
    v_max3_u32 v22, v22, v125, v126
    v_max3_u32 v22, v22, v127, v140
    v_max3_u32 v22, v22, v141, v142
    v_max3_u32 v22, v22, v143, v156
    v_max3_u32 v22, v22, v157, v158
    v_max3_u32 v22, v22, v159, v172
    v_max3_u32 v22, v22, v173, v174
    v_max3_u32 v22, v22, v175, v188
    v_max3_u32 v22, v22, v189, v190
    v_max_u32 v22, v22, v191
    v_cmp_eq_u32 vcc, -1, v22
    s_cbranch_vccnz W_GT1
W_GT3:
    s_mov_b32 s37, s36
    buffer_load_dwordx4 v[64:67], v4, s[24:27], s37 offen offset:0 sc1
    buffer_load_dwordx4 v[68:71], v4, s[24:27], s37 offen offset:1024 sc1
    buffer_load_dwordx4 v[72:75], v4, s[24:27], s37 offen offset:2048 sc1
    s_add_u32 s37, s37, 8192
    buffer_load_dwordx4 v[80:83], v4, s[24:27], s37 offen offset:0 sc1
    buffer_load_dwordx4 v[84:87], v4, s[24:27], s37 offen offset:1024 sc1
    buffer_load_dwordx4 v[88:91], v4, s[24:27], s37 offen offset:2048 sc1
    s_add_u32 s37, s37, 8192
    buffer_load_dwordx4 v[96:99], v4, s[24:27], s37 offen offset:0 sc1
    buffer_load_dwordx4 v[100:103], v4, s[24:27], s37 offen offset:1024 sc1
    buffer_load_dwordx4 v[104:107], v4, s[24:27], s37 offen offset:2048 sc1
    s_add_u32 s37, s37, 8192
    buffer_load_dwordx4 v[112:115], v4, s[24:27], s37 offen offset:0 sc1
    buffer_load_dwordx4 v[116:119], v4, s[24:27], s37 offen offset:1024 sc1
    buffer_load_dwordx4 v[120:123], v4, s[24:27], s37 offen offset:2048 sc1
    s_add_u32 s37, s37, 8192
    buffer_load_dwordx4 v[128:131], v4, s[24:27], s37 offen offset:0 sc1
    buffer_load_dwordx4 v[132:135], v4, s[24:27], s37 offen offset:1024 sc1
    buffer_load_dwordx4 v[136:139], v4, s[24:27], s37 offen offset:2048 sc1
    s_add_u32 s37, s37, 8192
    buffer_load_dwordx4 v[144:147], v4, s[24:27], s37 offen offset:0 sc1
    buffer_load_dwordx4 v[148:151], v4, s[24:27], s37 offen offset:1024 sc1
    buffer_load_dwordx4 v[152:155], v4, s[24:27], s37 offen offset:2048 sc1
    s_add_u32 s37, s37, 8192
    buffer_load_dwordx4 v[160:163], v4, s[24:27], s37 offen offset:0 sc1
    buffer_load_dwordx4 v[164:167], v4, s[24:27], s37 offen offset:1024 sc1
    buffer_load_dwordx4 v[168:171], v4, s[24:27], s37 offen offset:2048 sc1
    s_add_u32 s37, s37, 8192
    buffer_load_dwordx4 v[176:179], v4, s[24:27], s37 offen offset:0 sc1
    buffer_load_dwordx4 v[180:183], v4, s[24:27], s37 offen offset:1024 sc1
    buffer_load_dwordx4 v[184:187], v4, s[24:27], s37 offen offset:2048 sc1
    s_add_u32 s37, s37, 8192
    s_add_u32 s31, s31, 1
    s_cmp_gt_u32 s31, 0x200000
    s_cbranch_scc1 W_EXIT
    s_waitcnt vmcnt(0)
    v_max3_u32 v22, v64, v65, v66
    v_max3_u32 v22, v22, v67, v68
    v_max3_u32 v22, v22, v69, v70
    v_max3_u32 v22, v22, v71, v72
    v_max3_u32 v22, v22, v73, v74
    v_max3_u32 v22, v22, v75, v80
    v_max3_u32 v22, v22, v81, v82
    v_max3_u32 v22, v22, v83, v84
    v_max3_u32 v22, v22, v85, v86
    v_max3_u32 v22, v22, v87, v88
    v_max3_u32 v22, v22, v89, v90
    v_max3_u32 v22, v22, v91, v96
    v_max3_u32 v22, v22, v97, v98
    v_max3_u32 v22, v22, v99, v100
    v_max3_u32 v22, v22, v101, v102
    v_max3_u32 v22, v22, v103, v104
    v_max3_u32 v22, v22, v105, v106
    v_max3_u32 v22, v22, v107, v112
    v_max3_u32 v22, v22, v113, v114
    v_max3_u32 v22, v22, v115, v116
    v_max3_u32 v22, v22, v117, v118
    v_max3_u32 v22, v22, v119, v120
    v_max3_u32 v22, v22, v121, v122
    v_max3_u32 v22, v22, v123, v128
    v_max3_u32 v22, v22, v129, v130
    v_max3_u32 v22, v22, v131, v132
    v_max3_u32 v22, v22, v133, v134
    v_max3_u32 v22, v22, v135, v136
    v_max3_u32 v22, v22, v137, v138
    v_max3_u32 v22, v22, v139, v144
    v_max3_u32 v22, v22, v145, v146
    v_max3_u32 v22, v22, v147, v148
    v_max3_u32 v22, v22, v149, v150
    v_max3_u32 v22, v22, v151, v152
    v_max3_u32 v22, v22, v153, v154
    v_max3_u32 v22, v22, v155, v160
    v_max3_u32 v22, v22, v161, v162
    v_max3_u32 v22, v22, v163, v164
    v_max3_u32 v22, v22, v165, v166
    v_max3_u32 v22, v22, v167, v168
    v_max3_u32 v22, v22, v169, v170
    v_max3_u32 v22, v22, v171, v176
    v_max3_u32 v22, v22, v177, v178
    v_max3_u32 v22, v22, v179, v180
    v_max3_u32 v22, v22, v181, v182
    v_max3_u32 v22, v22, v183, v184
    v_max3_u32 v22, v22, v185, v186
    v_max_u32 v22, v22, v187
    v_cmp_eq_u32 vcc, -1, v22
    s_cbranch_vccnz W_GT3
    v_mfma_f32_16x16x32_bf16 v[32:35], a[0:3], v[64:67], 0
    v_mfma_f32_16x16x32_bf16 v[36:39], a[128:131], v[64:67], 0
    v_mfma_f32_16x16x32_bf16 v[32:35], a[4:7], v[68:71], v[32:35]
    v_mfma_f32_16x16x32_bf16 v[36:39], a[132:135], v[68:71], v[36:39]
    v_mfma_f32_16x16x32_bf16 v[32:35], a[8:11], v[72:75], v[32:35]
    v_mfma_f32_16x16x32_bf16 v[36:39], a[136:139], v[72:75], v[36:39]
    v_mfma_f32_16x16x32_bf16 v[32:35], a[12:15], v[76:79], v[32:35]
    v_mfma_f32_16x16x32_bf16 v[36:39], a[140:143], v[76:79], v[36:39]
    v_mfma_f32_16x16x32_bf16 v[32:35], a[16:19], v[80:83], v[32:35]
    v_mfma_f32_16x16x32_bf16 v[36:39], a[144:147], v[80:83], v[36:39]
    v_mfma_f32_16x16x32_bf16 v[32:35], a[20:23], v[84:87], v[32:35]
    v_mfma_f32_16x16x32_bf16 v[36:39], a[148:151], v[84:87], v[36:39]
    v_mfma_f32_16x16x32_bf16 v[32:35], a[24:27], v[88:91], v[32:35]
    v_mfma_f32_16x16x32_bf16 v[36:39], a[152:155], v[88:91], v[36:39]
    v_mfma_f32_16x16x32_bf16 v[32:35], a[28:31], v[92:95], v[32:35]
    v_mfma_f32_16x16x32_bf16 v[36:39], a[156:159], v[92:95], v[36:39]
    v_mfma_f32_16x16x32_bf16 v[32:35], a[32:35], v[96:99], v[32:35]
    v_mfma_f32_16x16x32_bf16 v[36:39], a[160:163], v[96:99], v[36:39]
    v_mfma_f32_16x16x32_bf16 v[32:35], a[36:39], v[100:103], v[32:35]
    v_mfma_f32_16x16x32_bf16 v[36:39], a[164:167], v[100:103], v[36:39]
    v_mfma_f32_16x16x32_bf16 v[32:35], a[40:43], v[104:107], v[32:35]
    v_mfma_f32_16x16x32_bf16 v[36:39], a[168:171], v[104:107], v[36:39]
    v_mfma_f32_16x16x32_bf16 v[32:35], a[44:47], v[108:111], v[32:35]
    v_mfma_f32_16x16x32_bf16 v[36:39], a[172:175], v[108:111], v[36:39]
    v_mfma_f32_16x16x32_bf16 v[32:35], a[48:51], v[112:115], v[32:35]
    v_mfma_f32_16x16x32_bf16 v[36:39], a[176:179], v[112:115], v[36:39]
    v_mfma_f32_16x16x32_bf16 v[32:35], a[52:55], v[116:119], v[32:35]
    v_mfma_f32_16x16x32_bf16 v[36:39], a[180:183], v[116:119], v[36:39]
    v_mfma_f32_16x16x32_bf16 v[32:35], a[56:59], v[120:123], v[32:35]
    v_mfma_f32_16x16x32_bf16 v[36:39], a[184:187], v[120:123], v[36:39]
    v_mfma_f32_16x16x32_bf16 v[32:35], a[60:63], v[124:127], v[32:35]
    v_mfma_f32_16x16x32_bf16 v[36:39], a[188:191], v[124:127], v[36:39]
    v_mfma_f32_16x16x32_bf16 v[32:35], a[64:67], v[128:131], v[32:35]
    v_mfma_f32_16x16x32_bf16 v[36:39], a[192:195], v[128:131], v[36:39]
    v_mfma_f32_16x16x32_bf16 v[32:35], a[68:71], v[132:135], v[32:35]
    v_mfma_f32_16x16x32_bf16 v[36:39], a[196:199], v[132:135], v[36:39]
    v_mfma_f32_16x16x32_bf16 v[32:35], a[72:75], v[136:139], v[32:35]
    v_mfma_f32_16x16x32_bf16 v[36:39], a[200:203], v[136:139], v[36:39]
    v_mfma_f32_16x16x32_bf16 v[32:35], a[76:79], v[140:143], v[32:35]
    v_mfma_f32_16x16x32_bf16 v[36:39], a[204:207], v[140:143], v[36:39]
    v_mfma_f32_16x16x32_bf16 v[32:35], a[80:83], v[144:147], v[32:35]
    v_mfma_f32_16x16x32_bf16 v[36:39], a[208:211], v[144:147], v[36:39]
    v_mfma_f32_16x16x32_bf16 v[32:35], a[84:87], v[148:151], v[32:35]
    v_mfma_f32_16x16x32_bf16 v[36:39], a[212:215], v[148:151], v[36:39]
    v_mfma_f32_16x16x32_bf16 v[32:35], a[88:91], v[152:155], v[32:35]
    v_mfma_f32_16x16x32_bf16 v[36:39], a[216:219], v[152:155], v[36:39]
    v_mfma_f32_16x16x32_bf16 v[32:35], a[92:95], v[156:159], v[32:35]
    v_mfma_f32_16x16x32_bf16 v[36:39], a[220:223], v[156:159], v[36:39]
    v_mfma_f32_16x16x32_bf16 v[32:35], a[96:99], v[160:163], v[32:35]
    v_mfma_f32_16x16x32_bf16 v[36:39], a[224:227], v[160:163], v[36:39]
    v_mfma_f32_16x16x32_bf16 v[32:35], a[100:103], v[164:167], v[32:35]
    v_mfma_f32_16x16x32_bf16 v[36:39], a[228:231], v[164:167], v[36:39]
    v_mfma_f32_16x16x32_bf16 v[32:35], a[104:107], v[168:171], v[32:35]
    v_mfma_f32_16x16x32_bf16 v[36:39], a[232:235], v[168:171], v[36:39]
    v_mfma_f32_16x16x32_bf16 v[32:35], a[108:111], v[172:175], v[32:35]
    v_mfma_f32_16x16x32_bf16 v[36:39], a[236:239], v[172:175], v[36:39]
    v_mfma_f32_16x16x32_bf16 v[32:35], a[112:115], v[176:179], v[32:35]
    v_mfma_f32_16x16x32_bf16 v[36:39], a[240:243], v[176:179], v[36:39]
    v_mfma_f32_16x16x32_bf16 v[32:35], a[116:119], v[180:183], v[32:35]
    v_mfma_f32_16x16x32_bf16 v[36:39], a[244:247], v[180:183], v[36:39]
    v_mfma_f32_16x16x32_bf16 v[32:35], a[120:123], v[184:187], v[32:35]
    v_mfma_f32_16x16x32_bf16 v[36:39], a[248:251], v[184:187], v[36:39]
    v_mfma_f32_16x16x32_bf16 v[32:35], a[124:127], v[188:191], v[32:35]
    v_mfma_f32_16x16x32_bf16 v[36:39], a[252:255], v[188:191], v[36:39]
    s_nop 7
    s_branch W_G3
W_F1:
    s_load_dwordx4 s[40:43], s[0:1], 72
    v_lshlrev_b32 v3, 4, v1
    v_lshrrev_b32 v10, 4, v1
    v_and_b32 v15, 15, v1
    v_lshlrev_b32 v9, 4, v15
    v_lshl_add_u32 v9, v10, 13, v9
    v_lshlrev_b32 v12, 2, v10
    v_xor_b32 v12, v12, v15
    v_lshlrev_b32 v12, 4, v12
    v_lshl_add_u32 v12, v10, 8, v12
    v_lshl_add_u32 v12, v2, 15, v12
    v_add_u32 v12, 2048, v12
    v_bfe_u32 v15, v1, 2, 2
    v_lshl_add_u32 v13, v10, 3, v15
    v_lshlrev_b32 v13, 8, v13
    v_xor_b32 v15, v15, v2
    v_lshl_add_u32 v13, v15, 6, v13
    v_and_b32 v15, 3, v1
    v_lshl_add_u32 v13, v15, 4, v13
    v_add_u32 v13, 2048, v13
    v_add_u32 v14, 0x10000, v13
    v_lshrrev_b32 v10, 4, v1
    v_and_b32 v15, 15, v1
    s_movk_i32 s35, 3584
    v_mul_lo_u32 v9, v10, s35
    v_lshl_add_u32 v9, v15, 4, v9
    s_lshl_b32 s32, s30, 8
    s_mul_i32 s33, s29, 458752
    s_add_u32 s32, s32, s33
    s_waitcnt lgkmcnt(0)
    s_mov_b32 s48, s40
    s_and_b32 s49, s41, 0xffff
    s_mov_b32 s50, 0x1c0000
    s_mov_b32 s51, 0x00020000
    s_mov_b32 s52, s42
    s_and_b32 s53, s43, 0xffff
    s_mov_b32 s54, 0x1c0000
    s_mov_b32 s55, 0x00020000
    s_mov_b32 s33, s32
    buffer_load_dwordx4 a[0:3], v9, s[48:51], s33 offen
    s_add_u32 s33, s33, 14336
    buffer_load_dwordx4 a[4:7], v9, s[48:51], s33 offen
    s_add_u32 s33, s33, 14336
    buffer_load_dwordx4 a[8:11], v9, s[48:51], s33 offen
    s_add_u32 s33, s33, 14336
    buffer_load_dwordx4 a[12:15], v9, s[48:51], s33 offen
    s_add_u32 s33, s33, 14336
    buffer_load_dwordx4 a[16:19], v9, s[48:51], s33 offen
    s_add_u32 s33, s33, 14336
    buffer_load_dwordx4 a[20:23], v9, s[48:51], s33 offen
    s_add_u32 s33, s33, 14336
    buffer_load_dwordx4 a[24:27], v9, s[48:51], s33 offen
    s_add_u32 s33, s33, 14336
    buffer_load_dwordx4 a[28:31], v9, s[48:51], s33 offen
    s_add_u32 s33, s33, 14336
    buffer_load_dwordx4 a[32:35], v9, s[48:51], s33 offen
    s_add_u32 s33, s33, 14336
    buffer_load_dwordx4 a[36:39], v9, s[48:51], s33 offen
    s_add_u32 s33, s33, 14336
    buffer_load_dwordx4 a[40:43], v9, s[48:51], s33 offen
    s_add_u32 s33, s33, 14336
    buffer_load_dwordx4 a[44:47], v9, s[48:51], s33 offen
    s_add_u32 s33, s33, 14336
    buffer_load_dwordx4 a[48:51], v9, s[48:51], s33 offen
    s_add_u32 s33, s33, 14336
    buffer_load_dwordx4 a[52:55], v9, s[48:51], s33 offen
    s_add_u32 s33, s33, 14336
    buffer_load_dwordx4 a[56:59], v9, s[48:51], s33 offen
    s_add_u32 s33, s33, 14336
    buffer_load_dwordx4 a[60:63], v9, s[48:51], s33 offen
    s_add_u32 s33, s33, 14336
    buffer_load_dwordx4 a[64:67], v9, s[48:51], s33 offen
    s_add_u32 s33, s33, 14336
    buffer_load_dwordx4 a[68:71], v9, s[48:51], s33 offen
    s_add_u32 s33, s33, 14336
    buffer_load_dwordx4 a[72:75], v9, s[48:51], s33 offen
    s_add_u32 s33, s33, 14336
    buffer_load_dwordx4 a[76:79], v9, s[48:51], s33 offen
    s_add_u32 s33, s33, 14336
    buffer_load_dwordx4 a[80:83], v9, s[48:51], s33 offen
    s_add_u32 s33, s33, 14336
    buffer_load_dwordx4 a[84:87], v9, s[48:51], s33 offen
    s_add_u32 s33, s33, 14336
    buffer_load_dwordx4 a[88:91], v9, s[48:51], s33 offen
    s_add_u32 s33, s33, 14336
    buffer_load_dwordx4 a[92:95], v9, s[48:51], s33 offen
    s_add_u32 s33, s33, 14336
    buffer_load_dwordx4 a[96:99], v9, s[48:51], s33 offen
    s_add_u32 s33, s33, 14336
    buffer_load_dwordx4 a[100:103], v9, s[48:51], s33 offen
    s_add_u32 s33, s33, 14336
    buffer_load_dwordx4 a[104:107], v9, s[48:51], s33 offen
    s_add_u32 s33, s33, 14336
    buffer_load_dwordx4 a[108:111], v9, s[48:51], s33 offen
    s_add_u32 s33, s33, 14336
    buffer_load_dwordx4 a[112:115], v9, s[48:51], s33 offen
    s_add_u32 s33, s33, 14336
    buffer_load_dwordx4 a[116:119], v9, s[48:51], s33 offen
    s_add_u32 s33, s33, 14336
    buffer_load_dwordx4 a[120:123], v9, s[48:51], s33 offen
    s_add_u32 s33, s33, 14336
    buffer_load_dwordx4 a[124:127], v9, s[48:51], s33 offen
    s_add_u32 s33, s33, 14336
    s_mov_b32 s33, s32
    buffer_load_dwordx4 a[128:131], v9, s[52:55], s33 offen
    s_add_u32 s33, s33, 14336
    buffer_load_dwordx4 a[132:135], v9, s[52:55], s33 offen
    s_add_u32 s33, s33, 14336
    buffer_load_dwordx4 a[136:139], v9, s[52:55], s33 offen
    s_add_u32 s33, s33, 14336
    buffer_load_dwordx4 a[140:143], v9, s[52:55], s33 offen
    s_add_u32 s33, s33, 14336
    buffer_load_dwordx4 a[144:147], v9, s[52:55], s33 offen
    s_add_u32 s33, s33, 14336
    buffer_load_dwordx4 a[148:151], v9, s[52:55], s33 offen
    s_add_u32 s33, s33, 14336
    buffer_load_dwordx4 a[152:155], v9, s[52:55], s33 offen
    s_add_u32 s33, s33, 14336
    buffer_load_dwordx4 a[156:159], v9, s[52:55], s33 offen
    s_add_u32 s33, s33, 14336
    buffer_load_dwordx4 a[160:163], v9, s[52:55], s33 offen
    s_add_u32 s33, s33, 14336
    buffer_load_dwordx4 a[164:167], v9, s[52:55], s33 offen
    s_add_u32 s33, s33, 14336
    buffer_load_dwordx4 a[168:171], v9, s[52:55], s33 offen
    s_add_u32 s33, s33, 14336
    buffer_load_dwordx4 a[172:175], v9, s[52:55], s33 offen
    s_add_u32 s33, s33, 14336
    buffer_load_dwordx4 a[176:179], v9, s[52:55], s33 offen
    s_add_u32 s33, s33, 14336
    buffer_load_dwordx4 a[180:183], v9, s[52:55], s33 offen
    s_add_u32 s33, s33, 14336
    buffer_load_dwordx4 a[184:187], v9, s[52:55], s33 offen
    s_add_u32 s33, s33, 14336
    buffer_load_dwordx4 a[188:191], v9, s[52:55], s33 offen
    s_add_u32 s33, s33, 14336
    buffer_load_dwordx4 a[192:195], v9, s[52:55], s33 offen
    s_add_u32 s33, s33, 14336
    buffer_load_dwordx4 a[196:199], v9, s[52:55], s33 offen
    s_add_u32 s33, s33, 14336
    buffer_load_dwordx4 a[200:203], v9, s[52:55], s33 offen
    s_add_u32 s33, s33, 14336
    buffer_load_dwordx4 a[204:207], v9, s[52:55], s33 offen
    s_add_u32 s33, s33, 14336
    buffer_load_dwordx4 a[208:211], v9, s[52:55], s33 offen
    s_add_u32 s33, s33, 14336
    buffer_load_dwordx4 a[212:215], v9, s[52:55], s33 offen
    s_add_u32 s33, s33, 14336
    buffer_load_dwordx4 a[216:219], v9, s[52:55], s33 offen
    s_add_u32 s33, s33, 14336
    buffer_load_dwordx4 a[220:223], v9, s[52:55], s33 offen
    s_add_u32 s33, s33, 14336
    buffer_load_dwordx4 a[224:227], v9, s[52:55], s33 offen
    s_add_u32 s33, s33, 14336
    buffer_load_dwordx4 a[228:231], v9, s[52:55], s33 offen
    s_add_u32 s33, s33, 14336
    buffer_load_dwordx4 a[232:235], v9, s[52:55], s33 offen
    s_add_u32 s33, s33, 14336
    buffer_load_dwordx4 a[236:239], v9, s[52:55], s33 offen
    s_add_u32 s33, s33, 14336
    buffer_load_dwordx4 a[240:243], v9, s[52:55], s33 offen
    s_add_u32 s33, s33, 14336
    buffer_load_dwordx4 a[244:247], v9, s[52:55], s33 offen
    s_add_u32 s33, s33, 14336
    buffer_load_dwordx4 a[248:251], v9, s[52:55], s33 offen
    s_add_u32 s33, s33, 14336
    buffer_load_dwordx4 a[252:255], v9, s[52:55], s33 offen
    s_add_u32 s33, s33, 14336
    s_lshl_b32 s30, s30, 2
    s_add_u32 s30, s30, s29
    v_lshlrev_b32 v4, 7, v1
    s_waitcnt vmcnt(32)
    ds_write_b128 v12, a[0:3] offset:0
    ds_write_b128 v12, a[4:7] offset:1024
    ds_write_b128 v12, a[8:11] offset:2048
    ds_write_b128 v12, a[12:15] offset:3072
    ds_write_b128 v12, a[16:19] offset:4096
    ds_write_b128 v12, a[20:23] offset:5120
    ds_write_b128 v12, a[24:27] offset:6144
    ds_write_b128 v12, a[28:31] offset:7168
    ds_write_b128 v12, a[32:35] offset:8192
    ds_write_b128 v12, a[36:39] offset:9216
    ds_write_b128 v12, a[40:43] offset:10240
    ds_write_b128 v12, a[44:47] offset:11264
    ds_write_b128 v12, a[48:51] offset:12288
    ds_write_b128 v12, a[52:55] offset:13312
    ds_write_b128 v12, a[56:59] offset:14336
    ds_write_b128 v12, a[60:63] offset:15360
    ds_write_b128 v12, a[64:67] offset:16384
    ds_write_b128 v12, a[68:71] offset:17408
    ds_write_b128 v12, a[72:75] offset:18432
    ds_write_b128 v12, a[76:79] offset:19456
    ds_write_b128 v12, a[80:83] offset:20480
    ds_write_b128 v12, a[84:87] offset:21504
    ds_write_b128 v12, a[88:91] offset:22528
    ds_write_b128 v12, a[92:95] offset:23552
    ds_write_b128 v12, a[96:99] offset:24576
    ds_write_b128 v12, a[100:103] offset:25600
    ds_write_b128 v12, a[104:107] offset:26624
    ds_write_b128 v12, a[108:111] offset:27648
    ds_write_b128 v12, a[112:115] offset:28672
    ds_write_b128 v12, a[116:119] offset:29696
    ds_write_b128 v12, a[120:123] offset:30720
    ds_write_b128 v12, a[124:127] offset:31744
    s_waitcnt lgkmcnt(0)
    s_barrier
    ds_read_b64_tr_b16 a[0:1], v13 offset:0
    ds_read_b64_tr_b16 a[2:3], v13 offset:1024
    ds_read_b64_tr_b16 a[4:5], v13 offset:8192
    ds_read_b64_tr_b16 a[6:7], v13 offset:9216
    ds_read_b64_tr_b16 a[8:9], v13 offset:16384
    ds_read_b64_tr_b16 a[10:11], v13 offset:17408
    ds_read_b64_tr_b16 a[12:13], v13 offset:24576
    ds_read_b64_tr_b16 a[14:15], v13 offset:25600
    ds_read_b64_tr_b16 a[16:17], v13 offset:32768
    ds_read_b64_tr_b16 a[18:19], v13 offset:33792
    ds_read_b64_tr_b16 a[20:21], v13 offset:40960
    ds_read_b64_tr_b16 a[22:23], v13 offset:41984
    ds_read_b64_tr_b16 a[24:25], v13 offset:49152
    ds_read_b64_tr_b16 a[26:27], v13 offset:50176
    ds_read_b64_tr_b16 a[28:29], v13 offset:57344
    ds_read_b64_tr_b16 a[30:31], v13 offset:58368
    ds_read_b64_tr_b16 a[32:33], v14 offset:0
    ds_read_b64_tr_b16 a[34:35], v14 offset:1024
    ds_read_b64_tr_b16 a[36:37], v14 offset:8192
    ds_read_b64_tr_b16 a[38:39], v14 offset:9216
    ds_read_b64_tr_b16 a[40:41], v14 offset:16384
    ds_read_b64_tr_b16 a[42:43], v14 offset:17408
    ds_read_b64_tr_b16 a[44:45], v14 offset:24576
    ds_read_b64_tr_b16 a[46:47], v14 offset:25600
    ds_read_b64_tr_b16 a[48:49], v14 offset:32768
    ds_read_b64_tr_b16 a[50:51], v14 offset:33792
    ds_read_b64_tr_b16 a[52:53], v14 offset:40960
    ds_read_b64_tr_b16 a[54:55], v14 offset:41984
    ds_read_b64_tr_b16 a[56:57], v14 offset:49152
    ds_read_b64_tr_b16 a[58:59], v14 offset:50176
    ds_read_b64_tr_b16 a[60:61], v14 offset:57344
    ds_read_b64_tr_b16 a[62:63], v14 offset:58368
    ds_read_b64_tr_b16 a[64:65], v13 offset:8
    ds_read_b64_tr_b16 a[66:67], v13 offset:1032
    ds_read_b64_tr_b16 a[68:69], v13 offset:8200
    ds_read_b64_tr_b16 a[70:71], v13 offset:9224
    ds_read_b64_tr_b16 a[72:73], v13 offset:16392
    ds_read_b64_tr_b16 a[74:75], v13 offset:17416
    ds_read_b64_tr_b16 a[76:77], v13 offset:24584
    ds_read_b64_tr_b16 a[78:79], v13 offset:25608
    ds_read_b64_tr_b16 a[80:81], v13 offset:32776
    ds_read_b64_tr_b16 a[82:83], v13 offset:33800
    ds_read_b64_tr_b16 a[84:85], v13 offset:40968
    ds_read_b64_tr_b16 a[86:87], v13 offset:41992
    ds_read_b64_tr_b16 a[88:89], v13 offset:49160
    ds_read_b64_tr_b16 a[90:91], v13 offset:50184
    ds_read_b64_tr_b16 a[92:93], v13 offset:57352
    ds_read_b64_tr_b16 a[94:95], v13 offset:58376
    ds_read_b64_tr_b16 a[96:97], v14 offset:8
    ds_read_b64_tr_b16 a[98:99], v14 offset:1032
    ds_read_b64_tr_b16 a[100:101], v14 offset:8200
    ds_read_b64_tr_b16 a[102:103], v14 offset:9224
    ds_read_b64_tr_b16 a[104:105], v14 offset:16392
    ds_read_b64_tr_b16 a[106:107], v14 offset:17416
    ds_read_b64_tr_b16 a[108:109], v14 offset:24584
    ds_read_b64_tr_b16 a[110:111], v14 offset:25608
    ds_read_b64_tr_b16 a[112:113], v14 offset:32776
    ds_read_b64_tr_b16 a[114:115], v14 offset:33800
    ds_read_b64_tr_b16 a[116:117], v14 offset:40968
    ds_read_b64_tr_b16 a[118:119], v14 offset:41992
    ds_read_b64_tr_b16 a[120:121], v14 offset:49160
    ds_read_b64_tr_b16 a[122:123], v14 offset:50184
    ds_read_b64_tr_b16 a[124:125], v14 offset:57352
    ds_read_b64_tr_b16 a[126:127], v14 offset:58376
    s_waitcnt lgkmcnt(0)
    s_barrier
    s_waitcnt vmcnt(0)
    ds_write_b128 v12, a[128:131] offset:0
    ds_write_b128 v12, a[132:135] offset:1024
    ds_write_b128 v12, a[136:139] offset:2048
    ds_write_b128 v12, a[140:143] offset:3072
    ds_write_b128 v12, a[144:147] offset:4096
    ds_write_b128 v12, a[148:151] offset:5120
    ds_write_b128 v12, a[152:155] offset:6144
    ds_write_b128 v12, a[156:159] offset:7168
    ds_write_b128 v12, a[160:163] offset:8192
    ds_write_b128 v12, a[164:167] offset:9216
    ds_write_b128 v12, a[168:171] offset:10240
    ds_write_b128 v12, a[172:175] offset:11264
    ds_write_b128 v12, a[176:179] offset:12288
    ds_write_b128 v12, a[180:183] offset:13312
    ds_write_b128 v12, a[184:187] offset:14336
    ds_write_b128 v12, a[188:191] offset:15360
    ds_write_b128 v12, a[192:195] offset:16384
    ds_write_b128 v12, a[196:199] offset:17408
    ds_write_b128 v12, a[200:203] offset:18432
    ds_write_b128 v12, a[204:207] offset:19456
    ds_write_b128 v12, a[208:211] offset:20480
    ds_write_b128 v12, a[212:215] offset:21504
    ds_write_b128 v12, a[216:219] offset:22528
    ds_write_b128 v12, a[220:223] offset:23552
    ds_write_b128 v12, a[224:227] offset:24576
    ds_write_b128 v12, a[228:231] offset:25600
    ds_write_b128 v12, a[232:235] offset:26624
    ds_write_b128 v12, a[236:239] offset:27648
    ds_write_b128 v12, a[240:243] offset:28672
    ds_write_b128 v12, a[244:247] offset:29696
    ds_write_b128 v12, a[248:251] offset:30720
    ds_write_b128 v12, a[252:255] offset:31744
    s_waitcnt lgkmcnt(0)
    s_barrier
    ds_read_b64_tr_b16 a[128:129], v13 offset:0
    ds_read_b64_tr_b16 a[130:131], v13 offset:1024
    ds_read_b64_tr_b16 a[132:133], v13 offset:8192
    ds_read_b64_tr_b16 a[134:135], v13 offset:9216
    ds_read_b64_tr_b16 a[136:137], v13 offset:16384
    ds_read_b64_tr_b16 a[138:139], v13 offset:17408
    ds_read_b64_tr_b16 a[140:141], v13 offset:24576
    ds_read_b64_tr_b16 a[142:143], v13 offset:25600
    ds_read_b64_tr_b16 a[144:145], v13 offset:32768
    ds_read_b64_tr_b16 a[146:147], v13 offset:33792
    ds_read_b64_tr_b16 a[148:149], v13 offset:40960
    ds_read_b64_tr_b16 a[150:151], v13 offset:41984
    ds_read_b64_tr_b16 a[152:153], v13 offset:49152
    ds_read_b64_tr_b16 a[154:155], v13 offset:50176
    ds_read_b64_tr_b16 a[156:157], v13 offset:57344
    ds_read_b64_tr_b16 a[158:159], v13 offset:58368
    ds_read_b64_tr_b16 a[160:161], v14 offset:0
    ds_read_b64_tr_b16 a[162:163], v14 offset:1024
    ds_read_b64_tr_b16 a[164:165], v14 offset:8192
    ds_read_b64_tr_b16 a[166:167], v14 offset:9216
    ds_read_b64_tr_b16 a[168:169], v14 offset:16384
    ds_read_b64_tr_b16 a[170:171], v14 offset:17408
    ds_read_b64_tr_b16 a[172:173], v14 offset:24576
    ds_read_b64_tr_b16 a[174:175], v14 offset:25600
    ds_read_b64_tr_b16 a[176:177], v14 offset:32768
    ds_read_b64_tr_b16 a[178:179], v14 offset:33792
    ds_read_b64_tr_b16 a[180:181], v14 offset:40960
    ds_read_b64_tr_b16 a[182:183], v14 offset:41984
    ds_read_b64_tr_b16 a[184:185], v14 offset:49152
    ds_read_b64_tr_b16 a[186:187], v14 offset:50176
    ds_read_b64_tr_b16 a[188:189], v14 offset:57344
    ds_read_b64_tr_b16 a[190:191], v14 offset:58368
    ds_read_b64_tr_b16 a[192:193], v13 offset:8
    ds_read_b64_tr_b16 a[194:195], v13 offset:1032
    ds_read_b64_tr_b16 a[196:197], v13 offset:8200
    ds_read_b64_tr_b16 a[198:199], v13 offset:9224
    ds_read_b64_tr_b16 a[200:201], v13 offset:16392
    ds_read_b64_tr_b16 a[202:203], v13 offset:17416
    ds_read_b64_tr_b16 a[204:205], v13 offset:24584
    ds_read_b64_tr_b16 a[206:207], v13 offset:25608
    ds_read_b64_tr_b16 a[208:209], v13 offset:32776
    ds_read_b64_tr_b16 a[210:211], v13 offset:33800
    ds_read_b64_tr_b16 a[212:213], v13 offset:40968
    ds_read_b64_tr_b16 a[214:215], v13 offset:41992
    ds_read_b64_tr_b16 a[216:217], v13 offset:49160
    ds_read_b64_tr_b16 a[218:219], v13 offset:50184
    ds_read_b64_tr_b16 a[220:221], v13 offset:57352
    ds_read_b64_tr_b16 a[222:223], v13 offset:58376
    ds_read_b64_tr_b16 a[224:225], v14 offset:8
    ds_read_b64_tr_b16 a[226:227], v14 offset:1032
    ds_read_b64_tr_b16 a[228:229], v14 offset:8200
    ds_read_b64_tr_b16 a[230:231], v14 offset:9224
    ds_read_b64_tr_b16 a[232:233], v14 offset:16392
    ds_read_b64_tr_b16 a[234:235], v14 offset:17416
    ds_read_b64_tr_b16 a[236:237], v14 offset:24584
    ds_read_b64_tr_b16 a[238:239], v14 offset:25608
    ds_read_b64_tr_b16 a[240:241], v14 offset:32776
    ds_read_b64_tr_b16 a[242:243], v14 offset:33800
    ds_read_b64_tr_b16 a[244:245], v14 offset:40968
    ds_read_b64_tr_b16 a[246:247], v14 offset:41992
    ds_read_b64_tr_b16 a[248:249], v14 offset:49160
    ds_read_b64_tr_b16 a[250:251], v14 offset:50184
    ds_read_b64_tr_b16 a[252:253], v14 offset:57352
    ds_read_b64_tr_b16 a[254:255], v14 offset:58376
    s_waitcnt lgkmcnt(0)
    s_barrier
    s_cmp_lg_u32 s29, 0
    s_cbranch_scc1 W0_43
    s_mov_b32 s31, 0
PD_44:
    s_cmp_eq_u32 s31, 0
    s_cbranch_scc1 PB_45
    s_sleep 8
PB_45:
    buffer_load_dword v24, off, s[12:15], 0 offset:68 sc1
    buffer_load_dword v25, off, s[12:15], 0 offset:72 sc1
    buffer_load_dword v26, off, s[12:15], 0 offset:76 sc1
    buffer_load_dword v27, off, s[12:15], 0 offset:80 sc1
    s_add_u32 s31, s31, 1
    s_cmp_gt_u32 s31, 0x200000
    s_cbranch_scc1 W_EXIT
    s_waitcnt vmcnt(0)
    v_readfirstlane_b32 s70, v24
    v_readfirstlane_b32 s71, v25
    v_readfirstlane_b32 s72, v26
    v_readfirstlane_b32 s73, v27
    s_cmp_lg_u32 s70, 0x04040404
    s_cbranch_scc1 PD_44
    s_cmp_lg_u32 s71, 0x04040404
    s_cbranch_scc1 PD_44
    s_cmp_lg_u32 s72, 0x04040404
    s_cbranch_scc1 PD_44
    s_cmp_lg_u32 s73, 0x04040404
    s_cbranch_scc1 PD_44
W0_43:
    s_barrier
    s_mov_b32 s73, -1
    s_mov_b32 s31, 0x200000
    buffer_load_dwordx4 v[64:67], v4, s[24:27], s31 offen offset:0 sc1
    buffer_load_dwordx4 v[68:71], v4, s[24:27], s31 offen offset:16 sc1
    buffer_load_dwordx4 v[72:75], v4, s[24:27], s31 offen offset:32 sc1
    buffer_load_dwordx4 v[76:79], v4, s[24:27], s31 offen offset:48 sc1
    buffer_load_dwordx4 v[80:83], v4, s[24:27], s31 offen offset:64 sc1
    buffer_load_dwordx4 v[84:87], v4, s[24:27], s31 offen offset:80 sc1
    buffer_load_dwordx4 v[88:91], v4, s[24:27], s31 offen offset:96 sc1
    buffer_load_dwordx4 v[92:95], v4, s[24:27], s31 offen offset:112 sc1
    s_waitcnt vmcnt(0)
    v_lshlrev_b32 v5, 5, v1
    v_sub_u32 v5, 2047, v5
    v_ashrrev_i32 v6, 31, v64
    v_or_b32 v6, 0x80000000, v6
    v_xor_b32 v64, v64, v6
    v_and_b32 v64, 0xffff0000, v64
    v_subrev_u32 v6, 0, v5
    v_or_b32 v64, v64, v6
    v_ashrrev_i32 v6, 31, v65
    v_or_b32 v6, 0x80000000, v6
    v_xor_b32 v65, v65, v6
    v_and_b32 v65, 0xffff0000, v65
    v_subrev_u32 v6, 1, v5
    v_or_b32 v65, v65, v6
    v_ashrrev_i32 v6, 31, v66
    v_or_b32 v6, 0x80000000, v6
    v_xor_b32 v66, v66, v6
    v_and_b32 v66, 0xffff0000, v66
    v_subrev_u32 v6, 2, v5
    v_or_b32 v66, v66, v6
    v_ashrrev_i32 v6, 31, v67
    v_or_b32 v6, 0x80000000, v6
    v_xor_b32 v67, v67, v6
    v_and_b32 v67, 0xffff0000, v67
    v_subrev_u32 v6, 3, v5
    v_or_b32 v67, v67, v6
    v_ashrrev_i32 v6, 31, v68
    v_or_b32 v6, 0x80000000, v6
    v_xor_b32 v68, v68, v6
    v_and_b32 v68, 0xffff0000, v68
    v_subrev_u32 v6, 4, v5
    v_or_b32 v68, v68, v6
    v_ashrrev_i32 v6, 31, v69
    v_or_b32 v6, 0x80000000, v6
    v_xor_b32 v69, v69, v6
    v_and_b32 v69, 0xffff0000, v69
    v_subrev_u32 v6, 5, v5
    v_or_b32 v69, v69, v6
    v_ashrrev_i32 v6, 31, v70
    v_or_b32 v6, 0x80000000, v6
    v_xor_b32 v70, v70, v6
    v_and_b32 v70, 0xffff0000, v70
    v_subrev_u32 v6, 6, v5
    v_or_b32 v70, v70, v6
    v_ashrrev_i32 v6, 31, v71
    v_or_b32 v6, 0x80000000, v6
    v_xor_b32 v71, v71, v6
    v_and_b32 v71, 0xffff0000, v71
    v_subrev_u32 v6, 7, v5
    v_or_b32 v71, v71, v6
    v_ashrrev_i32 v6, 31, v72
    v_or_b32 v6, 0x80000000, v6
    v_xor_b32 v72, v72, v6
    v_and_b32 v72, 0xffff0000, v72
    v_subrev_u32 v6, 8, v5
    v_or_b32 v72, v72, v6
    v_ashrrev_i32 v6, 31, v73
    v_or_b32 v6, 0x80000000, v6
    v_xor_b32 v73, v73, v6
    v_and_b32 v73, 0xffff0000, v73
    v_subrev_u32 v6, 9, v5
    v_or_b32 v73, v73, v6
    v_ashrrev_i32 v6, 31, v74
    v_or_b32 v6, 0x80000000, v6
    v_xor_b32 v74, v74, v6
    v_and_b32 v74, 0xffff0000, v74
    v_subrev_u32 v6, 10, v5
    v_or_b32 v74, v74, v6
    v_ashrrev_i32 v6, 31, v75
    v_or_b32 v6, 0x80000000, v6
    v_xor_b32 v75, v75, v6
    v_and_b32 v75, 0xffff0000, v75
    v_subrev_u32 v6, 11, v5
    v_or_b32 v75, v75, v6
    v_ashrrev_i32 v6, 31, v76
    v_or_b32 v6, 0x80000000, v6
    v_xor_b32 v76, v76, v6
    v_and_b32 v76, 0xffff0000, v76
    v_subrev_u32 v6, 12, v5
    v_or_b32 v76, v76, v6
    v_ashrrev_i32 v6, 31, v77
    v_or_b32 v6, 0x80000000, v6
    v_xor_b32 v77, v77, v6
    v_and_b32 v77, 0xffff0000, v77
    v_subrev_u32 v6, 13, v5
    v_or_b32 v77, v77, v6
    v_ashrrev_i32 v6, 31, v78
    v_or_b32 v6, 0x80000000, v6
    v_xor_b32 v78, v78, v6
    v_and_b32 v78, 0xffff0000, v78
    v_subrev_u32 v6, 14, v5
    v_or_b32 v78, v78, v6
    v_ashrrev_i32 v6, 31, v79
    v_or_b32 v6, 0x80000000, v6
    v_xor_b32 v79, v79, v6
    v_and_b32 v79, 0xffff0000, v79
    v_subrev_u32 v6, 15, v5
    v_or_b32 v79, v79, v6
    v_ashrrev_i32 v6, 31, v80
    v_or_b32 v6, 0x80000000, v6
    v_xor_b32 v80, v80, v6
    v_and_b32 v80, 0xffff0000, v80
    v_subrev_u32 v6, 16, v5
    v_or_b32 v80, v80, v6
    v_ashrrev_i32 v6, 31, v81
    v_or_b32 v6, 0x80000000, v6
    v_xor_b32 v81, v81, v6
    v_and_b32 v81, 0xffff0000, v81
    v_subrev_u32 v6, 17, v5
    v_or_b32 v81, v81, v6
    v_ashrrev_i32 v6, 31, v82
    v_or_b32 v6, 0x80000000, v6
    v_xor_b32 v82, v82, v6
    v_and_b32 v82, 0xffff0000, v82
    v_subrev_u32 v6, 18, v5
    v_or_b32 v82, v82, v6
    v_ashrrev_i32 v6, 31, v83
    v_or_b32 v6, 0x80000000, v6
    v_xor_b32 v83, v83, v6
    v_and_b32 v83, 0xffff0000, v83
    v_subrev_u32 v6, 19, v5
    v_or_b32 v83, v83, v6
    v_ashrrev_i32 v6, 31, v84
    v_or_b32 v6, 0x80000000, v6
    v_xor_b32 v84, v84, v6
    v_and_b32 v84, 0xffff0000, v84
    v_subrev_u32 v6, 20, v5
    v_or_b32 v84, v84, v6
    v_ashrrev_i32 v6, 31, v85
    v_or_b32 v6, 0x80000000, v6
    v_xor_b32 v85, v85, v6
    v_and_b32 v85, 0xffff0000, v85
    v_subrev_u32 v6, 21, v5
    v_or_b32 v85, v85, v6
    v_ashrrev_i32 v6, 31, v86
    v_or_b32 v6, 0x80000000, v6
    v_xor_b32 v86, v86, v6
    v_and_b32 v86, 0xffff0000, v86
    v_subrev_u32 v6, 22, v5
    v_or_b32 v86, v86, v6
    v_ashrrev_i32 v6, 31, v87
    v_or_b32 v6, 0x80000000, v6
    v_xor_b32 v87, v87, v6
    v_and_b32 v87, 0xffff0000, v87
    v_subrev_u32 v6, 23, v5
    v_or_b32 v87, v87, v6
    v_ashrrev_i32 v6, 31, v88
    v_or_b32 v6, 0x80000000, v6
    v_xor_b32 v88, v88, v6
    v_and_b32 v88, 0xffff0000, v88
    v_subrev_u32 v6, 24, v5
    v_or_b32 v88, v88, v6
    v_ashrrev_i32 v6, 31, v89
    v_or_b32 v6, 0x80000000, v6
    v_xor_b32 v89, v89, v6
    v_and_b32 v89, 0xffff0000, v89
    v_subrev_u32 v6, 25, v5
    v_or_b32 v89, v89, v6
    v_ashrrev_i32 v6, 31, v90
    v_or_b32 v6, 0x80000000, v6
    v_xor_b32 v90, v90, v6
    v_and_b32 v90, 0xffff0000, v90
    v_subrev_u32 v6, 26, v5
    v_or_b32 v90, v90, v6
    v_ashrrev_i32 v6, 31, v91
    v_or_b32 v6, 0x80000000, v6
    v_xor_b32 v91, v91, v6
    v_and_b32 v91, 0xffff0000, v91
    v_subrev_u32 v6, 27, v5
    v_or_b32 v91, v91, v6
    v_ashrrev_i32 v6, 31, v92
    v_or_b32 v6, 0x80000000, v6
    v_xor_b32 v92, v92, v6
    v_and_b32 v92, 0xffff0000, v92
    v_subrev_u32 v6, 28, v5
    v_or_b32 v92, v92, v6
    v_ashrrev_i32 v6, 31, v93
    v_or_b32 v6, 0x80000000, v6
    v_xor_b32 v93, v93, v6
    v_and_b32 v93, 0xffff0000, v93
    v_subrev_u32 v6, 29, v5
    v_or_b32 v93, v93, v6
    v_ashrrev_i32 v6, 31, v94
    v_or_b32 v6, 0x80000000, v6
    v_xor_b32 v94, v94, v6
    v_and_b32 v94, 0xffff0000, v94
    v_subrev_u32 v6, 30, v5
    v_or_b32 v94, v94, v6
    v_ashrrev_i32 v6, 31, v95
    v_or_b32 v6, 0x80000000, v6
    v_xor_b32 v95, v95, v6
    v_and_b32 v95, 0xffff0000, v95
    v_subrev_u32 v6, 31, v5
    v_or_b32 v95, v95, v6
    v_mov_b32 v10, -1
    v_mov_b32 v8, 0
    v_cmp_lt_u32 vcc, v64, v10
    s_nop 1
    v_cndmask_b32 v6, 0, v64, vcc
    v_max_u32 v8, v8, v6
    v_cmp_lt_u32 vcc, v65, v10
    s_nop 1
    v_cndmask_b32 v6, 0, v65, vcc
    v_max_u32 v8, v8, v6
    v_cmp_lt_u32 vcc, v66, v10
    s_nop 1
    v_cndmask_b32 v6, 0, v66, vcc
    v_max_u32 v8, v8, v6
    v_cmp_lt_u32 vcc, v67, v10
    s_nop 1
    v_cndmask_b32 v6, 0, v67, vcc
    v_max_u32 v8, v8, v6
    v_cmp_lt_u32 vcc, v68, v10
    s_nop 1
    v_cndmask_b32 v6, 0, v68, vcc
    v_max_u32 v8, v8, v6
    v_cmp_lt_u32 vcc, v69, v10
    s_nop 1
    v_cndmask_b32 v6, 0, v69, vcc
    v_max_u32 v8, v8, v6
    v_cmp_lt_u32 vcc, v70, v10
    s_nop 1
    v_cndmask_b32 v6, 0, v70, vcc
    v_max_u32 v8, v8, v6
    v_cmp_lt_u32 vcc, v71, v10
    s_nop 1
    v_cndmask_b32 v6, 0, v71, vcc
    v_max_u32 v8, v8, v6
    v_cmp_lt_u32 vcc, v72, v10
    s_nop 1
    v_cndmask_b32 v6, 0, v72, vcc
    v_max_u32 v8, v8, v6
    v_cmp_lt_u32 vcc, v73, v10
    s_nop 1
    v_cndmask_b32 v6, 0, v73, vcc
    v_max_u32 v8, v8, v6
    v_cmp_lt_u32 vcc, v74, v10
    s_nop 1
    v_cndmask_b32 v6, 0, v74, vcc
    v_max_u32 v8, v8, v6
    v_cmp_lt_u32 vcc, v75, v10
    s_nop 1
    v_cndmask_b32 v6, 0, v75, vcc
    v_max_u32 v8, v8, v6
    v_cmp_lt_u32 vcc, v76, v10
    s_nop 1
    v_cndmask_b32 v6, 0, v76, vcc
    v_max_u32 v8, v8, v6
    v_cmp_lt_u32 vcc, v77, v10
    s_nop 1
    v_cndmask_b32 v6, 0, v77, vcc
    v_max_u32 v8, v8, v6
    v_cmp_lt_u32 vcc, v78, v10
    s_nop 1
    v_cndmask_b32 v6, 0, v78, vcc
    v_max_u32 v8, v8, v6
    v_cmp_lt_u32 vcc, v79, v10
    s_nop 1
    v_cndmask_b32 v6, 0, v79, vcc
    v_max_u32 v8, v8, v6
    v_cmp_lt_u32 vcc, v80, v10
    s_nop 1
    v_cndmask_b32 v6, 0, v80, vcc
    v_max_u32 v8, v8, v6
    v_cmp_lt_u32 vcc, v81, v10
    s_nop 1
    v_cndmask_b32 v6, 0, v81, vcc
    v_max_u32 v8, v8, v6
    v_cmp_lt_u32 vcc, v82, v10
    s_nop 1
    v_cndmask_b32 v6, 0, v82, vcc
    v_max_u32 v8, v8, v6
    v_cmp_lt_u32 vcc, v83, v10
    s_nop 1
    v_cndmask_b32 v6, 0, v83, vcc
    v_max_u32 v8, v8, v6
    v_cmp_lt_u32 vcc, v84, v10
    s_nop 1
    v_cndmask_b32 v6, 0, v84, vcc
    v_max_u32 v8, v8, v6
    v_cmp_lt_u32 vcc, v85, v10
    s_nop 1
    v_cndmask_b32 v6, 0, v85, vcc
    v_max_u32 v8, v8, v6
    v_cmp_lt_u32 vcc, v86, v10
    s_nop 1
    v_cndmask_b32 v6, 0, v86, vcc
    v_max_u32 v8, v8, v6
    v_cmp_lt_u32 vcc, v87, v10
    s_nop 1
    v_cndmask_b32 v6, 0, v87, vcc
    v_max_u32 v8, v8, v6
    v_cmp_lt_u32 vcc, v88, v10
    s_nop 1
    v_cndmask_b32 v6, 0, v88, vcc
    v_max_u32 v8, v8, v6
    v_cmp_lt_u32 vcc, v89, v10
    s_nop 1
    v_cndmask_b32 v6, 0, v89, vcc
    v_max_u32 v8, v8, v6
    v_cmp_lt_u32 vcc, v90, v10
    s_nop 1
    v_cndmask_b32 v6, 0, v90, vcc
    v_max_u32 v8, v8, v6
    v_cmp_lt_u32 vcc, v91, v10
    s_nop 1
    v_cndmask_b32 v6, 0, v91, vcc
    v_max_u32 v8, v8, v6
    v_cmp_lt_u32 vcc, v92, v10
    s_nop 1
    v_cndmask_b32 v6, 0, v92, vcc
    v_max_u32 v8, v8, v6
    v_cmp_lt_u32 vcc, v93, v10
    s_nop 1
    v_cndmask_b32 v6, 0, v93, vcc
    v_max_u32 v8, v8, v6
    v_cmp_lt_u32 vcc, v94, v10
    s_nop 1
    v_cndmask_b32 v6, 0, v94, vcc
    v_max_u32 v8, v8, v6
    v_cmp_lt_u32 vcc, v95, v10
    s_nop 1
    v_cndmask_b32 v6, 0, v95, vcc
    v_max_u32 v8, v8, v6
    s_nop 1
    v_max_u32_dpp v9, v8, v8 quad_perm:[1,0,3,2] row_mask:0xf bank_mask:0xf
    s_nop 1
    v_max_u32_dpp v8, v9, v9 quad_perm:[2,3,0,1] row_mask:0xf bank_mask:0xf
    s_nop 1
    v_max_u32_dpp v9, v8, v8 row_half_mirror row_mask:0xf bank_mask:0xf
    s_nop 1
    v_max_u32_dpp v8, v9, v9 row_mirror row_mask:0xf bank_mask:0xf
    v_mov_b32 v9, v8
    s_nop 1
    v_permlane16_swap_b32 v8, v9
    s_nop 1
    v_max_u32 v8, v8, v9
    v_mov_b32 v9, v8
    s_nop 1
    v_permlane32_swap_b32 v8, v9
    s_nop 1
    v_max_u32 v8, v8, v9
    v_mov_b32 v10, v8
    s_nop 0
    v_readfirstlane_b32 s40, v8
    v_mov_b32 v8, 0
    v_cmp_lt_u32 vcc, v64, v10
    s_nop 1
    v_cndmask_b32 v6, 0, v64, vcc
    v_max_u32 v8, v8, v6
    v_cmp_lt_u32 vcc, v65, v10
    s_nop 1
    v_cndmask_b32 v6, 0, v65, vcc
    v_max_u32 v8, v8, v6
    v_cmp_lt_u32 vcc, v66, v10
    s_nop 1
    v_cndmask_b32 v6, 0, v66, vcc
    v_max_u32 v8, v8, v6
    v_cmp_lt_u32 vcc, v67, v10
    s_nop 1
    v_cndmask_b32 v6, 0, v67, vcc
    v_max_u32 v8, v8, v6
    v_cmp_lt_u32 vcc, v68, v10
    s_nop 1
    v_cndmask_b32 v6, 0, v68, vcc
    v_max_u32 v8, v8, v6
    v_cmp_lt_u32 vcc, v69, v10
    s_nop 1
    v_cndmask_b32 v6, 0, v69, vcc
    v_max_u32 v8, v8, v6
    v_cmp_lt_u32 vcc, v70, v10
    s_nop 1
    v_cndmask_b32 v6, 0, v70, vcc
    v_max_u32 v8, v8, v6
    v_cmp_lt_u32 vcc, v71, v10
    s_nop 1
    v_cndmask_b32 v6, 0, v71, vcc
    v_max_u32 v8, v8, v6
    v_cmp_lt_u32 vcc, v72, v10
    s_nop 1
    v_cndmask_b32 v6, 0, v72, vcc
    v_max_u32 v8, v8, v6
    v_cmp_lt_u32 vcc, v73, v10
    s_nop 1
    v_cndmask_b32 v6, 0, v73, vcc
    v_max_u32 v8, v8, v6
    v_cmp_lt_u32 vcc, v74, v10
    s_nop 1
    v_cndmask_b32 v6, 0, v74, vcc
    v_max_u32 v8, v8, v6
    v_cmp_lt_u32 vcc, v75, v10
    s_nop 1
    v_cndmask_b32 v6, 0, v75, vcc
    v_max_u32 v8, v8, v6
    v_cmp_lt_u32 vcc, v76, v10
    s_nop 1
    v_cndmask_b32 v6, 0, v76, vcc
    v_max_u32 v8, v8, v6
    v_cmp_lt_u32 vcc, v77, v10
    s_nop 1
    v_cndmask_b32 v6, 0, v77, vcc
    v_max_u32 v8, v8, v6
    v_cmp_lt_u32 vcc, v78, v10
    s_nop 1
    v_cndmask_b32 v6, 0, v78, vcc
    v_max_u32 v8, v8, v6
    v_cmp_lt_u32 vcc, v79, v10
    s_nop 1
    v_cndmask_b32 v6, 0, v79, vcc
    v_max_u32 v8, v8, v6
    v_cmp_lt_u32 vcc, v80, v10
    s_nop 1
    v_cndmask_b32 v6, 0, v80, vcc
    v_max_u32 v8, v8, v6
    v_cmp_lt_u32 vcc, v81, v10
    s_nop 1
    v_cndmask_b32 v6, 0, v81, vcc
    v_max_u32 v8, v8, v6
    v_cmp_lt_u32 vcc, v82, v10
    s_nop 1
    v_cndmask_b32 v6, 0, v82, vcc
    v_max_u32 v8, v8, v6
    v_cmp_lt_u32 vcc, v83, v10
    s_nop 1
    v_cndmask_b32 v6, 0, v83, vcc
    v_max_u32 v8, v8, v6
    v_cmp_lt_u32 vcc, v84, v10
    s_nop 1
    v_cndmask_b32 v6, 0, v84, vcc
    v_max_u32 v8, v8, v6
    v_cmp_lt_u32 vcc, v85, v10
    s_nop 1
    v_cndmask_b32 v6, 0, v85, vcc
    v_max_u32 v8, v8, v6
    v_cmp_lt_u32 vcc, v86, v10
    s_nop 1
    v_cndmask_b32 v6, 0, v86, vcc
    v_max_u32 v8, v8, v6
    v_cmp_lt_u32 vcc, v87, v10
    s_nop 1
    v_cndmask_b32 v6, 0, v87, vcc
    v_max_u32 v8, v8, v6
    v_cmp_lt_u32 vcc, v88, v10
    s_nop 1
    v_cndmask_b32 v6, 0, v88, vcc
    v_max_u32 v8, v8, v6
    v_cmp_lt_u32 vcc, v89, v10
    s_nop 1
    v_cndmask_b32 v6, 0, v89, vcc
    v_max_u32 v8, v8, v6
    v_cmp_lt_u32 vcc, v90, v10
    s_nop 1
    v_cndmask_b32 v6, 0, v90, vcc
    v_max_u32 v8, v8, v6
    v_cmp_lt_u32 vcc, v91, v10
    s_nop 1
    v_cndmask_b32 v6, 0, v91, vcc
    v_max_u32 v8, v8, v6
    v_cmp_lt_u32 vcc, v92, v10
    s_nop 1
    v_cndmask_b32 v6, 0, v92, vcc
    v_max_u32 v8, v8, v6
    v_cmp_lt_u32 vcc, v93, v10
    s_nop 1
    v_cndmask_b32 v6, 0, v93, vcc
    v_max_u32 v8, v8, v6
    v_cmp_lt_u32 vcc, v94, v10
    s_nop 1
    v_cndmask_b32 v6, 0, v94, vcc
    v_max_u32 v8, v8, v6
    v_cmp_lt_u32 vcc, v95, v10
    s_nop 1
    v_cndmask_b32 v6, 0, v95, vcc
    v_max_u32 v8, v8, v6
    s_nop 1
    v_max_u32_dpp v9, v8, v8 quad_perm:[1,0,3,2] row_mask:0xf bank_mask:0xf
    s_nop 1
    v_max_u32_dpp v8, v9, v9 quad_perm:[2,3,0,1] row_mask:0xf bank_mask:0xf
    s_nop 1
    v_max_u32_dpp v9, v8, v8 row_half_mirror row_mask:0xf bank_mask:0xf
    s_nop 1
    v_max_u32_dpp v8, v9, v9 row_mirror row_mask:0xf bank_mask:0xf
    v_mov_b32 v9, v8
    s_nop 1
    v_permlane16_swap_b32 v8, v9
    s_nop 1
    v_max_u32 v8, v8, v9
    v_mov_b32 v9, v8
    s_nop 1
    v_permlane32_swap_b32 v8, v9
    s_nop 1
    v_max_u32 v8, v8, v9
    v_mov_b32 v10, v8
    s_nop 0
    v_readfirstlane_b32 s41, v8
    v_mov_b32 v8, 0
    v_cmp_lt_u32 vcc, v64, v10
    s_nop 1
    v_cndmask_b32 v6, 0, v64, vcc
    v_max_u32 v8, v8, v6
    v_cmp_lt_u32 vcc, v65, v10
    s_nop 1
    v_cndmask_b32 v6, 0, v65, vcc
    v_max_u32 v8, v8, v6
    v_cmp_lt_u32 vcc, v66, v10
    s_nop 1
    v_cndmask_b32 v6, 0, v66, vcc
    v_max_u32 v8, v8, v6
    v_cmp_lt_u32 vcc, v67, v10
    s_nop 1
    v_cndmask_b32 v6, 0, v67, vcc
    v_max_u32 v8, v8, v6
    v_cmp_lt_u32 vcc, v68, v10
    s_nop 1
    v_cndmask_b32 v6, 0, v68, vcc
    v_max_u32 v8, v8, v6
    v_cmp_lt_u32 vcc, v69, v10
    s_nop 1
    v_cndmask_b32 v6, 0, v69, vcc
    v_max_u32 v8, v8, v6
    v_cmp_lt_u32 vcc, v70, v10
    s_nop 1
    v_cndmask_b32 v6, 0, v70, vcc
    v_max_u32 v8, v8, v6
    v_cmp_lt_u32 vcc, v71, v10
    s_nop 1
    v_cndmask_b32 v6, 0, v71, vcc
    v_max_u32 v8, v8, v6
    v_cmp_lt_u32 vcc, v72, v10
    s_nop 1
    v_cndmask_b32 v6, 0, v72, vcc
    v_max_u32 v8, v8, v6
    v_cmp_lt_u32 vcc, v73, v10
    s_nop 1
    v_cndmask_b32 v6, 0, v73, vcc
    v_max_u32 v8, v8, v6
    v_cmp_lt_u32 vcc, v74, v10
    s_nop 1
    v_cndmask_b32 v6, 0, v74, vcc
    v_max_u32 v8, v8, v6
    v_cmp_lt_u32 vcc, v75, v10
    s_nop 1
    v_cndmask_b32 v6, 0, v75, vcc
    v_max_u32 v8, v8, v6
    v_cmp_lt_u32 vcc, v76, v10
    s_nop 1
    v_cndmask_b32 v6, 0, v76, vcc
    v_max_u32 v8, v8, v6
    v_cmp_lt_u32 vcc, v77, v10
    s_nop 1
    v_cndmask_b32 v6, 0, v77, vcc
    v_max_u32 v8, v8, v6
    v_cmp_lt_u32 vcc, v78, v10
    s_nop 1
    v_cndmask_b32 v6, 0, v78, vcc
    v_max_u32 v8, v8, v6
    v_cmp_lt_u32 vcc, v79, v10
    s_nop 1
    v_cndmask_b32 v6, 0, v79, vcc
    v_max_u32 v8, v8, v6
    v_cmp_lt_u32 vcc, v80, v10
    s_nop 1
    v_cndmask_b32 v6, 0, v80, vcc
    v_max_u32 v8, v8, v6
    v_cmp_lt_u32 vcc, v81, v10
    s_nop 1
    v_cndmask_b32 v6, 0, v81, vcc
    v_max_u32 v8, v8, v6
    v_cmp_lt_u32 vcc, v82, v10
    s_nop 1
    v_cndmask_b32 v6, 0, v82, vcc
    v_max_u32 v8, v8, v6
    v_cmp_lt_u32 vcc, v83, v10
    s_nop 1
    v_cndmask_b32 v6, 0, v83, vcc
    v_max_u32 v8, v8, v6
    v_cmp_lt_u32 vcc, v84, v10
    s_nop 1
    v_cndmask_b32 v6, 0, v84, vcc
    v_max_u32 v8, v8, v6
    v_cmp_lt_u32 vcc, v85, v10
    s_nop 1
    v_cndmask_b32 v6, 0, v85, vcc
    v_max_u32 v8, v8, v6
    v_cmp_lt_u32 vcc, v86, v10
    s_nop 1
    v_cndmask_b32 v6, 0, v86, vcc
    v_max_u32 v8, v8, v6
    v_cmp_lt_u32 vcc, v87, v10
    s_nop 1
    v_cndmask_b32 v6, 0, v87, vcc
    v_max_u32 v8, v8, v6
    v_cmp_lt_u32 vcc, v88, v10
    s_nop 1
    v_cndmask_b32 v6, 0, v88, vcc
    v_max_u32 v8, v8, v6
    v_cmp_lt_u32 vcc, v89, v10
    s_nop 1
    v_cndmask_b32 v6, 0, v89, vcc
    v_max_u32 v8, v8, v6
    v_cmp_lt_u32 vcc, v90, v10
    s_nop 1
    v_cndmask_b32 v6, 0, v90, vcc
    v_max_u32 v8, v8, v6
    v_cmp_lt_u32 vcc, v91, v10
    s_nop 1
    v_cndmask_b32 v6, 0, v91, vcc
    v_max_u32 v8, v8, v6
    v_cmp_lt_u32 vcc, v92, v10
    s_nop 1
    v_cndmask_b32 v6, 0, v92, vcc
    v_max_u32 v8, v8, v6
    v_cmp_lt_u32 vcc, v93, v10
    s_nop 1
    v_cndmask_b32 v6, 0, v93, vcc
    v_max_u32 v8, v8, v6
    v_cmp_lt_u32 vcc, v94, v10
    s_nop 1
    v_cndmask_b32 v6, 0, v94, vcc
    v_max_u32 v8, v8, v6
    v_cmp_lt_u32 vcc, v95, v10
    s_nop 1
    v_cndmask_b32 v6, 0, v95, vcc
    v_max_u32 v8, v8, v6
    s_nop 1
    v_max_u32_dpp v9, v8, v8 quad_perm:[1,0,3,2] row_mask:0xf bank_mask:0xf
    s_nop 1
    v_max_u32_dpp v8, v9, v9 quad_perm:[2,3,0,1] row_mask:0xf bank_mask:0xf
    s_nop 1
    v_max_u32_dpp v9, v8, v8 row_half_mirror row_mask:0xf bank_mask:0xf
    s_nop 1
    v_max_u32_dpp v8, v9, v9 row_mirror row_mask:0xf bank_mask:0xf
    v_mov_b32 v9, v8
    s_nop 1
    v_permlane16_swap_b32 v8, v9
    s_nop 1
    v_max_u32 v8, v8, v9
    v_mov_b32 v9, v8
    s_nop 1
    v_permlane32_swap_b32 v8, v9
    s_nop 1
    v_max_u32 v8, v8, v9
    v_mov_b32 v10, v8
    s_nop 0
    v_readfirstlane_b32 s42, v8
    v_mov_b32 v8, 0
    v_cmp_lt_u32 vcc, v64, v10
    s_nop 1
    v_cndmask_b32 v6, 0, v64, vcc
    v_max_u32 v8, v8, v6
    v_cmp_lt_u32 vcc, v65, v10
    s_nop 1
    v_cndmask_b32 v6, 0, v65, vcc
    v_max_u32 v8, v8, v6
    v_cmp_lt_u32 vcc, v66, v10
    s_nop 1
    v_cndmask_b32 v6, 0, v66, vcc
    v_max_u32 v8, v8, v6
    v_cmp_lt_u32 vcc, v67, v10
    s_nop 1
    v_cndmask_b32 v6, 0, v67, vcc
    v_max_u32 v8, v8, v6
    v_cmp_lt_u32 vcc, v68, v10
    s_nop 1
    v_cndmask_b32 v6, 0, v68, vcc
    v_max_u32 v8, v8, v6
    v_cmp_lt_u32 vcc, v69, v10
    s_nop 1
    v_cndmask_b32 v6, 0, v69, vcc
    v_max_u32 v8, v8, v6
    v_cmp_lt_u32 vcc, v70, v10
    s_nop 1
    v_cndmask_b32 v6, 0, v70, vcc
    v_max_u32 v8, v8, v6
    v_cmp_lt_u32 vcc, v71, v10
    s_nop 1
    v_cndmask_b32 v6, 0, v71, vcc
    v_max_u32 v8, v8, v6
    v_cmp_lt_u32 vcc, v72, v10
    s_nop 1
    v_cndmask_b32 v6, 0, v72, vcc
    v_max_u32 v8, v8, v6
    v_cmp_lt_u32 vcc, v73, v10
    s_nop 1
    v_cndmask_b32 v6, 0, v73, vcc
    v_max_u32 v8, v8, v6
    v_cmp_lt_u32 vcc, v74, v10
    s_nop 1
    v_cndmask_b32 v6, 0, v74, vcc
    v_max_u32 v8, v8, v6
    v_cmp_lt_u32 vcc, v75, v10
    s_nop 1
    v_cndmask_b32 v6, 0, v75, vcc
    v_max_u32 v8, v8, v6
    v_cmp_lt_u32 vcc, v76, v10
    s_nop 1
    v_cndmask_b32 v6, 0, v76, vcc
    v_max_u32 v8, v8, v6
    v_cmp_lt_u32 vcc, v77, v10
    s_nop 1
    v_cndmask_b32 v6, 0, v77, vcc
    v_max_u32 v8, v8, v6
    v_cmp_lt_u32 vcc, v78, v10
    s_nop 1
    v_cndmask_b32 v6, 0, v78, vcc
    v_max_u32 v8, v8, v6
    v_cmp_lt_u32 vcc, v79, v10
    s_nop 1
    v_cndmask_b32 v6, 0, v79, vcc
    v_max_u32 v8, v8, v6
    v_cmp_lt_u32 vcc, v80, v10
    s_nop 1
    v_cndmask_b32 v6, 0, v80, vcc
    v_max_u32 v8, v8, v6
    v_cmp_lt_u32 vcc, v81, v10
    s_nop 1
    v_cndmask_b32 v6, 0, v81, vcc
    v_max_u32 v8, v8, v6
    v_cmp_lt_u32 vcc, v82, v10
    s_nop 1
    v_cndmask_b32 v6, 0, v82, vcc
    v_max_u32 v8, v8, v6
    v_cmp_lt_u32 vcc, v83, v10
    s_nop 1
    v_cndmask_b32 v6, 0, v83, vcc
    v_max_u32 v8, v8, v6
    v_cmp_lt_u32 vcc, v84, v10
    s_nop 1
    v_cndmask_b32 v6, 0, v84, vcc
    v_max_u32 v8, v8, v6
    v_cmp_lt_u32 vcc, v85, v10
    s_nop 1
    v_cndmask_b32 v6, 0, v85, vcc
    v_max_u32 v8, v8, v6
    v_cmp_lt_u32 vcc, v86, v10
    s_nop 1
    v_cndmask_b32 v6, 0, v86, vcc
    v_max_u32 v8, v8, v6
    v_cmp_lt_u32 vcc, v87, v10
    s_nop 1
    v_cndmask_b32 v6, 0, v87, vcc
    v_max_u32 v8, v8, v6
    v_cmp_lt_u32 vcc, v88, v10
    s_nop 1
    v_cndmask_b32 v6, 0, v88, vcc
    v_max_u32 v8, v8, v6
    v_cmp_lt_u32 vcc, v89, v10
    s_nop 1
    v_cndmask_b32 v6, 0, v89, vcc
    v_max_u32 v8, v8, v6
    v_cmp_lt_u32 vcc, v90, v10
    s_nop 1
    v_cndmask_b32 v6, 0, v90, vcc
    v_max_u32 v8, v8, v6
    v_cmp_lt_u32 vcc, v91, v10
    s_nop 1
    v_cndmask_b32 v6, 0, v91, vcc
    v_max_u32 v8, v8, v6
    v_cmp_lt_u32 vcc, v92, v10
    s_nop 1
    v_cndmask_b32 v6, 0, v92, vcc
    v_max_u32 v8, v8, v6
    v_cmp_lt_u32 vcc, v93, v10
    s_nop 1
    v_cndmask_b32 v6, 0, v93, vcc
    v_max_u32 v8, v8, v6
    v_cmp_lt_u32 vcc, v94, v10
    s_nop 1
    v_cndmask_b32 v6, 0, v94, vcc
    v_max_u32 v8, v8, v6
    v_cmp_lt_u32 vcc, v95, v10
    s_nop 1
    v_cndmask_b32 v6, 0, v95, vcc
    v_max_u32 v8, v8, v6
    s_nop 1
    v_max_u32_dpp v9, v8, v8 quad_perm:[1,0,3,2] row_mask:0xf bank_mask:0xf
    s_nop 1
    v_max_u32_dpp v8, v9, v9 quad_perm:[2,3,0,1] row_mask:0xf bank_mask:0xf
    s_nop 1
    v_max_u32_dpp v9, v8, v8 row_half_mirror row_mask:0xf bank_mask:0xf
    s_nop 1
    v_max_u32_dpp v8, v9, v9 row_mirror row_mask:0xf bank_mask:0xf
    v_mov_b32 v9, v8
    s_nop 1
    v_permlane16_swap_b32 v8, v9
    s_nop 1
    v_max_u32 v8, v8, v9
    v_mov_b32 v9, v8
    s_nop 1
    v_permlane32_swap_b32 v8, v9
    s_nop 1
    v_max_u32 v8, v8, v9
    v_mov_b32 v10, v8
    s_nop 0
    v_readfirstlane_b32 s43, v8
    v_mov_b32 v8, 0
    v_cmp_lt_u32 vcc, v64, v10
    s_nop 1
    v_cndmask_b32 v6, 0, v64, vcc
    v_max_u32 v8, v8, v6
    v_cmp_lt_u32 vcc, v65, v10
    s_nop 1
    v_cndmask_b32 v6, 0, v65, vcc
    v_max_u32 v8, v8, v6
    v_cmp_lt_u32 vcc, v66, v10
    s_nop 1
    v_cndmask_b32 v6, 0, v66, vcc
    v_max_u32 v8, v8, v6
    v_cmp_lt_u32 vcc, v67, v10
    s_nop 1
    v_cndmask_b32 v6, 0, v67, vcc
    v_max_u32 v8, v8, v6
    v_cmp_lt_u32 vcc, v68, v10
    s_nop 1
    v_cndmask_b32 v6, 0, v68, vcc
    v_max_u32 v8, v8, v6
    v_cmp_lt_u32 vcc, v69, v10
    s_nop 1
    v_cndmask_b32 v6, 0, v69, vcc
    v_max_u32 v8, v8, v6
    v_cmp_lt_u32 vcc, v70, v10
    s_nop 1
    v_cndmask_b32 v6, 0, v70, vcc
    v_max_u32 v8, v8, v6
    v_cmp_lt_u32 vcc, v71, v10
    s_nop 1
    v_cndmask_b32 v6, 0, v71, vcc
    v_max_u32 v8, v8, v6
    v_cmp_lt_u32 vcc, v72, v10
    s_nop 1
    v_cndmask_b32 v6, 0, v72, vcc
    v_max_u32 v8, v8, v6
    v_cmp_lt_u32 vcc, v73, v10
    s_nop 1
    v_cndmask_b32 v6, 0, v73, vcc
    v_max_u32 v8, v8, v6
    v_cmp_lt_u32 vcc, v74, v10
    s_nop 1
    v_cndmask_b32 v6, 0, v74, vcc
    v_max_u32 v8, v8, v6
    v_cmp_lt_u32 vcc, v75, v10
    s_nop 1
    v_cndmask_b32 v6, 0, v75, vcc
    v_max_u32 v8, v8, v6
    v_cmp_lt_u32 vcc, v76, v10
    s_nop 1
    v_cndmask_b32 v6, 0, v76, vcc
    v_max_u32 v8, v8, v6
    v_cmp_lt_u32 vcc, v77, v10
    s_nop 1
    v_cndmask_b32 v6, 0, v77, vcc
    v_max_u32 v8, v8, v6
    v_cmp_lt_u32 vcc, v78, v10
    s_nop 1
    v_cndmask_b32 v6, 0, v78, vcc
    v_max_u32 v8, v8, v6
    v_cmp_lt_u32 vcc, v79, v10
    s_nop 1
    v_cndmask_b32 v6, 0, v79, vcc
    v_max_u32 v8, v8, v6
    v_cmp_lt_u32 vcc, v80, v10
    s_nop 1
    v_cndmask_b32 v6, 0, v80, vcc
    v_max_u32 v8, v8, v6
    v_cmp_lt_u32 vcc, v81, v10
    s_nop 1
    v_cndmask_b32 v6, 0, v81, vcc
    v_max_u32 v8, v8, v6
    v_cmp_lt_u32 vcc, v82, v10
    s_nop 1
    v_cndmask_b32 v6, 0, v82, vcc
    v_max_u32 v8, v8, v6
    v_cmp_lt_u32 vcc, v83, v10
    s_nop 1
    v_cndmask_b32 v6, 0, v83, vcc
    v_max_u32 v8, v8, v6
    v_cmp_lt_u32 vcc, v84, v10
    s_nop 1
    v_cndmask_b32 v6, 0, v84, vcc
    v_max_u32 v8, v8, v6
    v_cmp_lt_u32 vcc, v85, v10
    s_nop 1
    v_cndmask_b32 v6, 0, v85, vcc
    v_max_u32 v8, v8, v6
    v_cmp_lt_u32 vcc, v86, v10
    s_nop 1
    v_cndmask_b32 v6, 0, v86, vcc
    v_max_u32 v8, v8, v6
    v_cmp_lt_u32 vcc, v87, v10
    s_nop 1
    v_cndmask_b32 v6, 0, v87, vcc
    v_max_u32 v8, v8, v6
    v_cmp_lt_u32 vcc, v88, v10
    s_nop 1
    v_cndmask_b32 v6, 0, v88, vcc
    v_max_u32 v8, v8, v6
    v_cmp_lt_u32 vcc, v89, v10
    s_nop 1
    v_cndmask_b32 v6, 0, v89, vcc
    v_max_u32 v8, v8, v6
    v_cmp_lt_u32 vcc, v90, v10
    s_nop 1
    v_cndmask_b32 v6, 0, v90, vcc
    v_max_u32 v8, v8, v6
    v_cmp_lt_u32 vcc, v91, v10
    s_nop 1
    v_cndmask_b32 v6, 0, v91, vcc
    v_max_u32 v8, v8, v6
    v_cmp_lt_u32 vcc, v92, v10
    s_nop 1
    v_cndmask_b32 v6, 0, v92, vcc
    v_max_u32 v8, v8, v6
    v_cmp_lt_u32 vcc, v93, v10
    s_nop 1
    v_cndmask_b32 v6, 0, v93, vcc
    v_max_u32 v8, v8, v6
    v_cmp_lt_u32 vcc, v94, v10
    s_nop 1
    v_cndmask_b32 v6, 0, v94, vcc
    v_max_u32 v8, v8, v6
    v_cmp_lt_u32 vcc, v95, v10
    s_nop 1
    v_cndmask_b32 v6, 0, v95, vcc
    v_max_u32 v8, v8, v6
    s_nop 1
    v_max_u32_dpp v9, v8, v8 quad_perm:[1,0,3,2] row_mask:0xf bank_mask:0xf
    s_nop 1
    v_max_u32_dpp v8, v9, v9 quad_perm:[2,3,0,1] row_mask:0xf bank_mask:0xf
    s_nop 1
    v_max_u32_dpp v9, v8, v8 row_half_mirror row_mask:0xf bank_mask:0xf
    s_nop 1
    v_max_u32_dpp v8, v9, v9 row_mirror row_mask:0xf bank_mask:0xf
    v_mov_b32 v9, v8
    s_nop 1
    v_permlane16_swap_b32 v8, v9
    s_nop 1
    v_max_u32 v8, v8, v9
    v_mov_b32 v9, v8
    s_nop 1
    v_permlane32_swap_b32 v8, v9
    s_nop 1
    v_max_u32 v8, v8, v9
    v_mov_b32 v10, v8
    s_nop 0
    v_readfirstlane_b32 s44, v8
    v_mov_b32 v8, 0
    v_cmp_lt_u32 vcc, v64, v10
    s_nop 1
    v_cndmask_b32 v6, 0, v64, vcc
    v_max_u32 v8, v8, v6
    v_cmp_lt_u32 vcc, v65, v10
    s_nop 1
    v_cndmask_b32 v6, 0, v65, vcc
    v_max_u32 v8, v8, v6
    v_cmp_lt_u32 vcc, v66, v10
    s_nop 1
    v_cndmask_b32 v6, 0, v66, vcc
    v_max_u32 v8, v8, v6
    v_cmp_lt_u32 vcc, v67, v10
    s_nop 1
    v_cndmask_b32 v6, 0, v67, vcc
    v_max_u32 v8, v8, v6
    v_cmp_lt_u32 vcc, v68, v10
    s_nop 1
    v_cndmask_b32 v6, 0, v68, vcc
    v_max_u32 v8, v8, v6
    v_cmp_lt_u32 vcc, v69, v10
    s_nop 1
    v_cndmask_b32 v6, 0, v69, vcc
    v_max_u32 v8, v8, v6
    v_cmp_lt_u32 vcc, v70, v10
    s_nop 1
    v_cndmask_b32 v6, 0, v70, vcc
    v_max_u32 v8, v8, v6
    v_cmp_lt_u32 vcc, v71, v10
    s_nop 1
    v_cndmask_b32 v6, 0, v71, vcc
    v_max_u32 v8, v8, v6
    v_cmp_lt_u32 vcc, v72, v10
    s_nop 1
    v_cndmask_b32 v6, 0, v72, vcc
    v_max_u32 v8, v8, v6
    v_cmp_lt_u32 vcc, v73, v10
    s_nop 1
    v_cndmask_b32 v6, 0, v73, vcc
    v_max_u32 v8, v8, v6
    v_cmp_lt_u32 vcc, v74, v10
    s_nop 1
    v_cndmask_b32 v6, 0, v74, vcc
    v_max_u32 v8, v8, v6
    v_cmp_lt_u32 vcc, v75, v10
    s_nop 1
    v_cndmask_b32 v6, 0, v75, vcc
    v_max_u32 v8, v8, v6
    v_cmp_lt_u32 vcc, v76, v10
    s_nop 1
    v_cndmask_b32 v6, 0, v76, vcc
    v_max_u32 v8, v8, v6
    v_cmp_lt_u32 vcc, v77, v10
    s_nop 1
    v_cndmask_b32 v6, 0, v77, vcc
    v_max_u32 v8, v8, v6
    v_cmp_lt_u32 vcc, v78, v10
    s_nop 1
    v_cndmask_b32 v6, 0, v78, vcc
    v_max_u32 v8, v8, v6
    v_cmp_lt_u32 vcc, v79, v10
    s_nop 1
    v_cndmask_b32 v6, 0, v79, vcc
    v_max_u32 v8, v8, v6
    v_cmp_lt_u32 vcc, v80, v10
    s_nop 1
    v_cndmask_b32 v6, 0, v80, vcc
    v_max_u32 v8, v8, v6
    v_cmp_lt_u32 vcc, v81, v10
    s_nop 1
    v_cndmask_b32 v6, 0, v81, vcc
    v_max_u32 v8, v8, v6
    v_cmp_lt_u32 vcc, v82, v10
    s_nop 1
    v_cndmask_b32 v6, 0, v82, vcc
    v_max_u32 v8, v8, v6
    v_cmp_lt_u32 vcc, v83, v10
    s_nop 1
    v_cndmask_b32 v6, 0, v83, vcc
    v_max_u32 v8, v8, v6
    v_cmp_lt_u32 vcc, v84, v10
    s_nop 1
    v_cndmask_b32 v6, 0, v84, vcc
    v_max_u32 v8, v8, v6
    v_cmp_lt_u32 vcc, v85, v10
    s_nop 1
    v_cndmask_b32 v6, 0, v85, vcc
    v_max_u32 v8, v8, v6
    v_cmp_lt_u32 vcc, v86, v10
    s_nop 1
    v_cndmask_b32 v6, 0, v86, vcc
    v_max_u32 v8, v8, v6
    v_cmp_lt_u32 vcc, v87, v10
    s_nop 1
    v_cndmask_b32 v6, 0, v87, vcc
    v_max_u32 v8, v8, v6
    v_cmp_lt_u32 vcc, v88, v10
    s_nop 1
    v_cndmask_b32 v6, 0, v88, vcc
    v_max_u32 v8, v8, v6
    v_cmp_lt_u32 vcc, v89, v10
    s_nop 1
    v_cndmask_b32 v6, 0, v89, vcc
    v_max_u32 v8, v8, v6
    v_cmp_lt_u32 vcc, v90, v10
    s_nop 1
    v_cndmask_b32 v6, 0, v90, vcc
    v_max_u32 v8, v8, v6
    v_cmp_lt_u32 vcc, v91, v10
    s_nop 1
    v_cndmask_b32 v6, 0, v91, vcc
    v_max_u32 v8, v8, v6
    v_cmp_lt_u32 vcc, v92, v10
    s_nop 1
    v_cndmask_b32 v6, 0, v92, vcc
    v_max_u32 v8, v8, v6
    v_cmp_lt_u32 vcc, v93, v10
    s_nop 1
    v_cndmask_b32 v6, 0, v93, vcc
    v_max_u32 v8, v8, v6
    v_cmp_lt_u32 vcc, v94, v10
    s_nop 1
    v_cndmask_b32 v6, 0, v94, vcc
    v_max_u32 v8, v8, v6
    v_cmp_lt_u32 vcc, v95, v10
    s_nop 1
    v_cndmask_b32 v6, 0, v95, vcc
    v_max_u32 v8, v8, v6
    s_nop 1
    v_max_u32_dpp v9, v8, v8 quad_perm:[1,0,3,2] row_mask:0xf bank_mask:0xf
    s_nop 1
    v_max_u32_dpp v8, v9, v9 quad_perm:[2,3,0,1] row_mask:0xf bank_mask:0xf
    s_nop 1
    v_max_u32_dpp v9, v8, v8 row_half_mirror row_mask:0xf bank_mask:0xf
    s_nop 1
    v_max_u32_dpp v8, v9, v9 row_mirror row_mask:0xf bank_mask:0xf
    v_mov_b32 v9, v8
    s_nop 1
    v_permlane16_swap_b32 v8, v9
    s_nop 1
    v_max_u32 v8, v8, v9
    v_mov_b32 v9, v8
    s_nop 1
    v_permlane32_swap_b32 v8, v9
    s_nop 1
    v_max_u32 v8, v8, v9
    v_mov_b32 v10, v8
    s_nop 0
    v_readfirstlane_b32 s45, v8
    v_mov_b32 v8, 0
    v_cmp_lt_u32 vcc, v64, v10
    s_nop 1
    v_cndmask_b32 v6, 0, v64, vcc
    v_max_u32 v8, v8, v6
    v_cmp_lt_u32 vcc, v65, v10
    s_nop 1
    v_cndmask_b32 v6, 0, v65, vcc
    v_max_u32 v8, v8, v6
    v_cmp_lt_u32 vcc, v66, v10
    s_nop 1
    v_cndmask_b32 v6, 0, v66, vcc
    v_max_u32 v8, v8, v6
    v_cmp_lt_u32 vcc, v67, v10
    s_nop 1
    v_cndmask_b32 v6, 0, v67, vcc
    v_max_u32 v8, v8, v6
    v_cmp_lt_u32 vcc, v68, v10
    s_nop 1
    v_cndmask_b32 v6, 0, v68, vcc
    v_max_u32 v8, v8, v6
    v_cmp_lt_u32 vcc, v69, v10
    s_nop 1
    v_cndmask_b32 v6, 0, v69, vcc
    v_max_u32 v8, v8, v6
    v_cmp_lt_u32 vcc, v70, v10
    s_nop 1
    v_cndmask_b32 v6, 0, v70, vcc
    v_max_u32 v8, v8, v6
    v_cmp_lt_u32 vcc, v71, v10
    s_nop 1
    v_cndmask_b32 v6, 0, v71, vcc
    v_max_u32 v8, v8, v6
    v_cmp_lt_u32 vcc, v72, v10
    s_nop 1
    v_cndmask_b32 v6, 0, v72, vcc
    v_max_u32 v8, v8, v6
    v_cmp_lt_u32 vcc, v73, v10
    s_nop 1
    v_cndmask_b32 v6, 0, v73, vcc
    v_max_u32 v8, v8, v6
    v_cmp_lt_u32 vcc, v74, v10
    s_nop 1
    v_cndmask_b32 v6, 0, v74, vcc
    v_max_u32 v8, v8, v6
    v_cmp_lt_u32 vcc, v75, v10
    s_nop 1
    v_cndmask_b32 v6, 0, v75, vcc
    v_max_u32 v8, v8, v6
    v_cmp_lt_u32 vcc, v76, v10
    s_nop 1
    v_cndmask_b32 v6, 0, v76, vcc
    v_max_u32 v8, v8, v6
    v_cmp_lt_u32 vcc, v77, v10
    s_nop 1
    v_cndmask_b32 v6, 0, v77, vcc
    v_max_u32 v8, v8, v6
    v_cmp_lt_u32 vcc, v78, v10
    s_nop 1
    v_cndmask_b32 v6, 0, v78, vcc
    v_max_u32 v8, v8, v6
    v_cmp_lt_u32 vcc, v79, v10
    s_nop 1
    v_cndmask_b32 v6, 0, v79, vcc
    v_max_u32 v8, v8, v6
    v_cmp_lt_u32 vcc, v80, v10
    s_nop 1
    v_cndmask_b32 v6, 0, v80, vcc
    v_max_u32 v8, v8, v6
    v_cmp_lt_u32 vcc, v81, v10
    s_nop 1
    v_cndmask_b32 v6, 0, v81, vcc
    v_max_u32 v8, v8, v6
    v_cmp_lt_u32 vcc, v82, v10
    s_nop 1
    v_cndmask_b32 v6, 0, v82, vcc
    v_max_u32 v8, v8, v6
    v_cmp_lt_u32 vcc, v83, v10
    s_nop 1
    v_cndmask_b32 v6, 0, v83, vcc
    v_max_u32 v8, v8, v6
    v_cmp_lt_u32 vcc, v84, v10
    s_nop 1
    v_cndmask_b32 v6, 0, v84, vcc
    v_max_u32 v8, v8, v6
    v_cmp_lt_u32 vcc, v85, v10
    s_nop 1
    v_cndmask_b32 v6, 0, v85, vcc
    v_max_u32 v8, v8, v6
    v_cmp_lt_u32 vcc, v86, v10
    s_nop 1
    v_cndmask_b32 v6, 0, v86, vcc
    v_max_u32 v8, v8, v6
    v_cmp_lt_u32 vcc, v87, v10
    s_nop 1
    v_cndmask_b32 v6, 0, v87, vcc
    v_max_u32 v8, v8, v6
    v_cmp_lt_u32 vcc, v88, v10
    s_nop 1
    v_cndmask_b32 v6, 0, v88, vcc
    v_max_u32 v8, v8, v6
    v_cmp_lt_u32 vcc, v89, v10
    s_nop 1
    v_cndmask_b32 v6, 0, v89, vcc
    v_max_u32 v8, v8, v6
    v_cmp_lt_u32 vcc, v90, v10
    s_nop 1
    v_cndmask_b32 v6, 0, v90, vcc
    v_max_u32 v8, v8, v6
    v_cmp_lt_u32 vcc, v91, v10
    s_nop 1
    v_cndmask_b32 v6, 0, v91, vcc
    v_max_u32 v8, v8, v6
    v_cmp_lt_u32 vcc, v92, v10
    s_nop 1
    v_cndmask_b32 v6, 0, v92, vcc
    v_max_u32 v8, v8, v6
    v_cmp_lt_u32 vcc, v93, v10
    s_nop 1
    v_cndmask_b32 v6, 0, v93, vcc
    v_max_u32 v8, v8, v6
    v_cmp_lt_u32 vcc, v94, v10
    s_nop 1
    v_cndmask_b32 v6, 0, v94, vcc
    v_max_u32 v8, v8, v6
    v_cmp_lt_u32 vcc, v95, v10
    s_nop 1
    v_cndmask_b32 v6, 0, v95, vcc
    v_max_u32 v8, v8, v6
    s_nop 1
    v_max_u32_dpp v9, v8, v8 quad_perm:[1,0,3,2] row_mask:0xf bank_mask:0xf
    s_nop 1
    v_max_u32_dpp v8, v9, v9 quad_perm:[2,3,0,1] row_mask:0xf bank_mask:0xf
    s_nop 1
    v_max_u32_dpp v9, v8, v8 row_half_mirror row_mask:0xf bank_mask:0xf
    s_nop 1
    v_max_u32_dpp v8, v9, v9 row_mirror row_mask:0xf bank_mask:0xf
    v_mov_b32 v9, v8
    s_nop 1
    v_permlane16_swap_b32 v8, v9
    s_nop 1
    v_max_u32 v8, v8, v9
    v_mov_b32 v9, v8
    s_nop 1
    v_permlane32_swap_b32 v8, v9
    s_nop 1
    v_max_u32 v8, v8, v9
    v_mov_b32 v10, v8
    s_nop 0
    v_readfirstlane_b32 s46, v8
    v_mov_b32 v8, 0
    v_cmp_lt_u32 vcc, v64, v10
    s_nop 1
    v_cndmask_b32 v6, 0, v64, vcc
    v_max_u32 v8, v8, v6
    v_cmp_lt_u32 vcc, v65, v10
    s_nop 1
    v_cndmask_b32 v6, 0, v65, vcc
    v_max_u32 v8, v8, v6
    v_cmp_lt_u32 vcc, v66, v10
    s_nop 1
    v_cndmask_b32 v6, 0, v66, vcc
    v_max_u32 v8, v8, v6
    v_cmp_lt_u32 vcc, v67, v10
    s_nop 1
    v_cndmask_b32 v6, 0, v67, vcc
    v_max_u32 v8, v8, v6
    v_cmp_lt_u32 vcc, v68, v10
    s_nop 1
    v_cndmask_b32 v6, 0, v68, vcc
    v_max_u32 v8, v8, v6
    v_cmp_lt_u32 vcc, v69, v10
    s_nop 1
    v_cndmask_b32 v6, 0, v69, vcc
    v_max_u32 v8, v8, v6
    v_cmp_lt_u32 vcc, v70, v10
    s_nop 1
    v_cndmask_b32 v6, 0, v70, vcc
    v_max_u32 v8, v8, v6
    v_cmp_lt_u32 vcc, v71, v10
    s_nop 1
    v_cndmask_b32 v6, 0, v71, vcc
    v_max_u32 v8, v8, v6
    v_cmp_lt_u32 vcc, v72, v10
    s_nop 1
    v_cndmask_b32 v6, 0, v72, vcc
    v_max_u32 v8, v8, v6
    v_cmp_lt_u32 vcc, v73, v10
    s_nop 1
    v_cndmask_b32 v6, 0, v73, vcc
    v_max_u32 v8, v8, v6
    v_cmp_lt_u32 vcc, v74, v10
    s_nop 1
    v_cndmask_b32 v6, 0, v74, vcc
    v_max_u32 v8, v8, v6
    v_cmp_lt_u32 vcc, v75, v10
    s_nop 1
    v_cndmask_b32 v6, 0, v75, vcc
    v_max_u32 v8, v8, v6
    v_cmp_lt_u32 vcc, v76, v10
    s_nop 1
    v_cndmask_b32 v6, 0, v76, vcc
    v_max_u32 v8, v8, v6
    v_cmp_lt_u32 vcc, v77, v10
    s_nop 1
    v_cndmask_b32 v6, 0, v77, vcc
    v_max_u32 v8, v8, v6
    v_cmp_lt_u32 vcc, v78, v10
    s_nop 1
    v_cndmask_b32 v6, 0, v78, vcc
    v_max_u32 v8, v8, v6
    v_cmp_lt_u32 vcc, v79, v10
    s_nop 1
    v_cndmask_b32 v6, 0, v79, vcc
    v_max_u32 v8, v8, v6
    v_cmp_lt_u32 vcc, v80, v10
    s_nop 1
    v_cndmask_b32 v6, 0, v80, vcc
    v_max_u32 v8, v8, v6
    v_cmp_lt_u32 vcc, v81, v10
    s_nop 1
    v_cndmask_b32 v6, 0, v81, vcc
    v_max_u32 v8, v8, v6
    v_cmp_lt_u32 vcc, v82, v10
    s_nop 1
    v_cndmask_b32 v6, 0, v82, vcc
    v_max_u32 v8, v8, v6
    v_cmp_lt_u32 vcc, v83, v10
    s_nop 1
    v_cndmask_b32 v6, 0, v83, vcc
    v_max_u32 v8, v8, v6
    v_cmp_lt_u32 vcc, v84, v10
    s_nop 1
    v_cndmask_b32 v6, 0, v84, vcc
    v_max_u32 v8, v8, v6
    v_cmp_lt_u32 vcc, v85, v10
    s_nop 1
    v_cndmask_b32 v6, 0, v85, vcc
    v_max_u32 v8, v8, v6
    v_cmp_lt_u32 vcc, v86, v10
    s_nop 1
    v_cndmask_b32 v6, 0, v86, vcc
    v_max_u32 v8, v8, v6
    v_cmp_lt_u32 vcc, v87, v10
    s_nop 1
    v_cndmask_b32 v6, 0, v87, vcc
    v_max_u32 v8, v8, v6
    v_cmp_lt_u32 vcc, v88, v10
    s_nop 1
    v_cndmask_b32 v6, 0, v88, vcc
    v_max_u32 v8, v8, v6
    v_cmp_lt_u32 vcc, v89, v10
    s_nop 1
    v_cndmask_b32 v6, 0, v89, vcc
    v_max_u32 v8, v8, v6
    v_cmp_lt_u32 vcc, v90, v10
    s_nop 1
    v_cndmask_b32 v6, 0, v90, vcc
    v_max_u32 v8, v8, v6
    v_cmp_lt_u32 vcc, v91, v10
    s_nop 1
    v_cndmask_b32 v6, 0, v91, vcc
    v_max_u32 v8, v8, v6
    v_cmp_lt_u32 vcc, v92, v10
    s_nop 1
    v_cndmask_b32 v6, 0, v92, vcc
    v_max_u32 v8, v8, v6
    v_cmp_lt_u32 vcc, v93, v10
    s_nop 1
    v_cndmask_b32 v6, 0, v93, vcc
    v_max_u32 v8, v8, v6
    v_cmp_lt_u32 vcc, v94, v10
    s_nop 1
    v_cndmask_b32 v6, 0, v94, vcc
    v_max_u32 v8, v8, v6
    v_cmp_lt_u32 vcc, v95, v10
    s_nop 1
    v_cndmask_b32 v6, 0, v95, vcc
    v_max_u32 v8, v8, v6
    s_nop 1
    v_max_u32_dpp v9, v8, v8 quad_perm:[1,0,3,2] row_mask:0xf bank_mask:0xf
    s_nop 1
    v_max_u32_dpp v8, v9, v9 quad_perm:[2,3,0,1] row_mask:0xf bank_mask:0xf
    s_nop 1
    v_max_u32_dpp v9, v8, v8 row_half_mirror row_mask:0xf bank_mask:0xf
    s_nop 1
    v_max_u32_dpp v8, v9, v9 row_mirror row_mask:0xf bank_mask:0xf
    v_mov_b32 v9, v8
    s_nop 1
    v_permlane16_swap_b32 v8, v9
    s_nop 1
    v_max_u32 v8, v8, v9
    v_mov_b32 v9, v8
    s_nop 1
    v_permlane32_swap_b32 v8, v9
    s_nop 1
    v_max_u32 v8, v8, v9
    v_mov_b32 v10, v8
    s_nop 0
    v_readfirstlane_b32 s47, v8
    s_and_b32 s40, s40, 0x7ff
    s_sub_u32 s40, 2047, s40
    s_and_b32 s41, s41, 0x7ff
    s_sub_u32 s41, 2047, s41
    s_and_b32 s42, s42, 0x7ff
    s_sub_u32 s42, 2047, s42
    s_and_b32 s43, s43, 0x7ff
    s_sub_u32 s43, 2047, s43
    s_and_b32 s44, s44, 0x7ff
    s_sub_u32 s44, 2047, s44
    s_and_b32 s45, s45, 0x7ff
    s_sub_u32 s45, 2047, s45
    s_and_b32 s46, s46, 0x7ff
    s_sub_u32 s46, 2047, s46
    s_and_b32 s47, s47, 0x7ff
    s_sub_u32 s47, 2047, s47
    v_and_b32 v16, 15, v1
    v_lshrrev_b32 v17, 4, v1
    v_and_b32 v18, 7, v16
    v_mov_b32 v11, s40
    v_cmp_eq_u32 vcc, 1, v18
    v_mov_b32 v12, s41
    s_nop 0
    v_cndmask_b32 v11, v11, v12, vcc
    v_cmp_eq_u32 vcc, 2, v18
    v_mov_b32 v12, s42
    s_nop 0
    v_cndmask_b32 v11, v11, v12, vcc
    v_cmp_eq_u32 vcc, 3, v18
    v_mov_b32 v12, s43
    s_nop 0
    v_cndmask_b32 v11, v11, v12, vcc
    v_cmp_eq_u32 vcc, 4, v18
    v_mov_b32 v12, s44
    s_nop 0
    v_cndmask_b32 v11, v11, v12, vcc
    v_cmp_eq_u32 vcc, 5, v18
    v_mov_b32 v12, s45
    s_nop 0
    v_cndmask_b32 v11, v11, v12, vcc
    v_cmp_eq_u32 vcc, 6, v18
    v_mov_b32 v12, s46
    s_nop 0
    v_cndmask_b32 v11, v11, v12, vcc
    v_cmp_eq_u32 vcc, 7, v18
    v_mov_b32 v12, s47
    s_nop 0
    v_cndmask_b32 v11, v11, v12, vcc
    s_cmp_lg_u32 s30, 0
    s_cbranch_scc1 W_F1A
    v_lshlrev_b32 v12, 2, v11
    buffer_load_dword v13, v12, s[24:27], s31 offen sc1
    v_lshlrev_b32 v12, 2, v18
    s_mov_b32 s32, 0x224000
    buffer_store_dword v11, v12, s[24:27], s32 offen sc1
    s_waitcnt vmcnt(0)
    buffer_store_dword v13, v12, s[24:27], s32 offen offset:32 sc1
W_F1A:
    v_lshlrev_b32 v12, 10, v11
    v_lshl_add_u32 v12, v17, 4, v12
    buffer_load_dwordx4 v[64:67], v12, s[24:27], 0 offen offset:0 sc1
    buffer_load_dwordx4 v[68:71], v12, s[24:27], 0 offen offset:64 sc1
    buffer_load_dwordx4 v[72:75], v12, s[24:27], 0 offen offset:128 sc1
    buffer_load_dwordx4 v[76:79], v12, s[24:27], 0 offen offset:192 sc1
    buffer_load_dwordx4 v[80:83], v12, s[24:27], 0 offen offset:256 sc1
    buffer_load_dwordx4 v[84:87], v12, s[24:27], 0 offen offset:320 sc1
    buffer_load_dwordx4 v[88:91], v12, s[24:27], 0 offen offset:384 sc1
    buffer_load_dwordx4 v[92:95], v12, s[24:27], 0 offen offset:448 sc1
    buffer_load_dwordx4 v[96:99], v12, s[24:27], 0 offen offset:512 sc1
    buffer_load_dwordx4 v[100:103], v12, s[24:27], 0 offen offset:576 sc1
    buffer_load_dwordx4 v[104:107], v12, s[24:27], 0 offen offset:640 sc1
    buffer_load_dwordx4 v[108:111], v12, s[24:27], 0 offen offset:704 sc1
    buffer_load_dwordx4 v[112:115], v12, s[24:27], 0 offen offset:768 sc1
    buffer_load_dwordx4 v[116:119], v12, s[24:27], 0 offen offset:832 sc1
    buffer_load_dwordx4 v[120:123], v12, s[24:27], 0 offen offset:896 sc1
    buffer_load_dwordx4 v[124:127], v12, s[24:27], 0 offen offset:960 sc1
    s_waitcnt vmcnt(0)
    v_mfma_f32_16x16x32_bf16 v[40:43], a[0:3], v[64:67], 0
    v_mfma_f32_16x16x32_bf16 v[44:47], a[64:67], v[64:67], 0
    v_mfma_f32_16x16x32_bf16 v[48:51], a[128:131], v[64:67], 0
    v_mfma_f32_16x16x32_bf16 v[52:55], a[192:195], v[64:67], 0
    v_mfma_f32_16x16x32_bf16 v[40:43], a[4:7], v[68:71], v[40:43]
    v_mfma_f32_16x16x32_bf16 v[44:47], a[68:71], v[68:71], v[44:47]
    v_mfma_f32_16x16x32_bf16 v[48:51], a[132:135], v[68:71], v[48:51]
    v_mfma_f32_16x16x32_bf16 v[52:55], a[196:199], v[68:71], v[52:55]
    v_mfma_f32_16x16x32_bf16 v[40:43], a[8:11], v[72:75], v[40:43]
    v_mfma_f32_16x16x32_bf16 v[44:47], a[72:75], v[72:75], v[44:47]
    v_mfma_f32_16x16x32_bf16 v[48:51], a[136:139], v[72:75], v[48:51]
    v_mfma_f32_16x16x32_bf16 v[52:55], a[200:203], v[72:75], v[52:55]
    v_mfma_f32_16x16x32_bf16 v[40:43], a[12:15], v[76:79], v[40:43]
    v_mfma_f32_16x16x32_bf16 v[44:47], a[76:79], v[76:79], v[44:47]
    v_mfma_f32_16x16x32_bf16 v[48:51], a[140:143], v[76:79], v[48:51]
    v_mfma_f32_16x16x32_bf16 v[52:55], a[204:207], v[76:79], v[52:55]
    v_mfma_f32_16x16x32_bf16 v[40:43], a[16:19], v[80:83], v[40:43]
    v_mfma_f32_16x16x32_bf16 v[44:47], a[80:83], v[80:83], v[44:47]
    v_mfma_f32_16x16x32_bf16 v[48:51], a[144:147], v[80:83], v[48:51]
    v_mfma_f32_16x16x32_bf16 v[52:55], a[208:211], v[80:83], v[52:55]
    v_mfma_f32_16x16x32_bf16 v[40:43], a[20:23], v[84:87], v[40:43]
    v_mfma_f32_16x16x32_bf16 v[44:47], a[84:87], v[84:87], v[44:47]
    v_mfma_f32_16x16x32_bf16 v[48:51], a[148:151], v[84:87], v[48:51]
    v_mfma_f32_16x16x32_bf16 v[52:55], a[212:215], v[84:87], v[52:55]
    v_mfma_f32_16x16x32_bf16 v[40:43], a[24:27], v[88:91], v[40:43]
    v_mfma_f32_16x16x32_bf16 v[44:47], a[88:91], v[88:91], v[44:47]
    v_mfma_f32_16x16x32_bf16 v[48:51], a[152:155], v[88:91], v[48:51]
    v_mfma_f32_16x16x32_bf16 v[52:55], a[216:219], v[88:91], v[52:55]
    v_mfma_f32_16x16x32_bf16 v[40:43], a[28:31], v[92:95], v[40:43]
    v_mfma_f32_16x16x32_bf16 v[44:47], a[92:95], v[92:95], v[44:47]
    v_mfma_f32_16x16x32_bf16 v[48:51], a[156:159], v[92:95], v[48:51]
    v_mfma_f32_16x16x32_bf16 v[52:55], a[220:223], v[92:95], v[52:55]
    v_mfma_f32_16x16x32_bf16 v[40:43], a[32:35], v[96:99], v[40:43]
    v_mfma_f32_16x16x32_bf16 v[44:47], a[96:99], v[96:99], v[44:47]
    v_mfma_f32_16x16x32_bf16 v[48:51], a[160:163], v[96:99], v[48:51]
    v_mfma_f32_16x16x32_bf16 v[52:55], a[224:227], v[96:99], v[52:55]
    v_mfma_f32_16x16x32_bf16 v[40:43], a[36:39], v[100:103], v[40:43]
    v_mfma_f32_16x16x32_bf16 v[44:47], a[100:103], v[100:103], v[44:47]
    v_mfma_f32_16x16x32_bf16 v[48:51], a[164:167], v[100:103], v[48:51]
    v_mfma_f32_16x16x32_bf16 v[52:55], a[228:231], v[100:103], v[52:55]
    v_mfma_f32_16x16x32_bf16 v[40:43], a[40:43], v[104:107], v[40:43]
    v_mfma_f32_16x16x32_bf16 v[44:47], a[104:107], v[104:107], v[44:47]
    v_mfma_f32_16x16x32_bf16 v[48:51], a[168:171], v[104:107], v[48:51]
    v_mfma_f32_16x16x32_bf16 v[52:55], a[232:235], v[104:107], v[52:55]
    v_mfma_f32_16x16x32_bf16 v[40:43], a[44:47], v[108:111], v[40:43]
    v_mfma_f32_16x16x32_bf16 v[44:47], a[108:111], v[108:111], v[44:47]
    v_mfma_f32_16x16x32_bf16 v[48:51], a[172:175], v[108:111], v[48:51]
    v_mfma_f32_16x16x32_bf16 v[52:55], a[236:239], v[108:111], v[52:55]
    v_mfma_f32_16x16x32_bf16 v[40:43], a[48:51], v[112:115], v[40:43]
    v_mfma_f32_16x16x32_bf16 v[44:47], a[112:115], v[112:115], v[44:47]
    v_mfma_f32_16x16x32_bf16 v[48:51], a[176:179], v[112:115], v[48:51]
    v_mfma_f32_16x16x32_bf16 v[52:55], a[240:243], v[112:115], v[52:55]
    v_mfma_f32_16x16x32_bf16 v[40:43], a[52:55], v[116:119], v[40:43]
    v_mfma_f32_16x16x32_bf16 v[44:47], a[116:119], v[116:119], v[44:47]
    v_mfma_f32_16x16x32_bf16 v[48:51], a[180:183], v[116:119], v[48:51]
    v_mfma_f32_16x16x32_bf16 v[52:55], a[244:247], v[116:119], v[52:55]
    v_mfma_f32_16x16x32_bf16 v[40:43], a[56:59], v[120:123], v[40:43]
    v_mfma_f32_16x16x32_bf16 v[44:47], a[120:123], v[120:123], v[44:47]
    v_mfma_f32_16x16x32_bf16 v[48:51], a[184:187], v[120:123], v[48:51]
    v_mfma_f32_16x16x32_bf16 v[52:55], a[248:251], v[120:123], v[52:55]
    v_mfma_f32_16x16x32_bf16 v[40:43], a[60:63], v[124:127], v[40:43]
    v_mfma_f32_16x16x32_bf16 v[44:47], a[124:127], v[124:127], v[44:47]
    v_mfma_f32_16x16x32_bf16 v[48:51], a[188:191], v[124:127], v[48:51]
    v_mfma_f32_16x16x32_bf16 v[52:55], a[252:255], v[124:127], v[52:55]
    s_nop 7
    s_mov_b32 s35, 0xbfb8aa3b
    v_cvt_pk_bf16_f32 v4, v40, v41
    v_lshlrev_b32 v5, 16, v4
    v_and_b32 v6, 0xffff0000, v4
    v_mul_f32 v7, s35, v5
    v_exp_f32 v7, v7
    s_nop 0
    v_add_f32 v7, 1.0, v7
    v_rcp_f32 v7, v7
    s_nop 0
    v_mul_f32 v5, v5, v7
    v_mul_f32 v7, s35, v6
    v_exp_f32 v7, v7
    s_nop 0
    v_add_f32 v7, 1.0, v7
    v_rcp_f32 v7, v7
    s_nop 0
    v_mul_f32 v6, v6, v7
    v_cvt_pk_bf16_f32 v4, v5, v6
    v_lshlrev_b32 v5, 16, v4
    v_and_b32 v6, 0xffff0000, v4
    v_cvt_pk_bf16_f32 v4, v48, v49
    v_lshlrev_b32 v7, 16, v4
    v_and_b32 v8, 0xffff0000, v4
    v_mul_f32 v5, v5, v7
    v_mul_f32 v6, v6, v8
    v_cvt_pk_bf16_f32 v56, v5, v6
    v_cvt_pk_bf16_f32 v4, v42, v43
    v_lshlrev_b32 v5, 16, v4
    v_and_b32 v6, 0xffff0000, v4
    v_mul_f32 v7, s35, v5
    v_exp_f32 v7, v7
    s_nop 0
    v_add_f32 v7, 1.0, v7
    v_rcp_f32 v7, v7
    s_nop 0
    v_mul_f32 v5, v5, v7
    v_mul_f32 v7, s35, v6
    v_exp_f32 v7, v7
    s_nop 0
    v_add_f32 v7, 1.0, v7
    v_rcp_f32 v7, v7
    s_nop 0
    v_mul_f32 v6, v6, v7
    v_cvt_pk_bf16_f32 v4, v5, v6
    v_lshlrev_b32 v5, 16, v4
    v_and_b32 v6, 0xffff0000, v4
    v_cvt_pk_bf16_f32 v4, v50, v51
    v_lshlrev_b32 v7, 16, v4
    v_and_b32 v8, 0xffff0000, v4
    v_mul_f32 v5, v5, v7
    v_mul_f32 v6, v6, v8
    v_cvt_pk_bf16_f32 v57, v5, v6
    v_cvt_pk_bf16_f32 v4, v44, v45
    v_lshlrev_b32 v5, 16, v4
    v_and_b32 v6, 0xffff0000, v4
    v_mul_f32 v7, s35, v5
    v_exp_f32 v7, v7
    s_nop 0
    v_add_f32 v7, 1.0, v7
    v_rcp_f32 v7, v7
    s_nop 0
    v_mul_f32 v5, v5, v7
    v_mul_f32 v7, s35, v6
    v_exp_f32 v7, v7
    s_nop 0
    v_add_f32 v7, 1.0, v7
    v_rcp_f32 v7, v7
    s_nop 0
    v_mul_f32 v6, v6, v7
    v_cvt_pk_bf16_f32 v4, v5, v6
    v_lshlrev_b32 v5, 16, v4
    v_and_b32 v6, 0xffff0000, v4
    v_cvt_pk_bf16_f32 v4, v52, v53
    v_lshlrev_b32 v7, 16, v4
    v_and_b32 v8, 0xffff0000, v4
    v_mul_f32 v5, v5, v7
    v_mul_f32 v6, v6, v8
    v_cvt_pk_bf16_f32 v58, v5, v6
    v_cvt_pk_bf16_f32 v4, v46, v47
    v_lshlrev_b32 v5, 16, v4
    v_and_b32 v6, 0xffff0000, v4
    v_mul_f32 v7, s35, v5
    v_exp_f32 v7, v7
    s_nop 0
    v_add_f32 v7, 1.0, v7
    v_rcp_f32 v7, v7
    s_nop 0
    v_mul_f32 v5, v5, v7
    v_mul_f32 v7, s35, v6
    v_exp_f32 v7, v7
    s_nop 0
    v_add_f32 v7, 1.0, v7
    v_rcp_f32 v7, v7
    s_nop 0
    v_mul_f32 v6, v6, v7
    v_cvt_pk_bf16_f32 v4, v5, v6
    v_lshlrev_b32 v5, 16, v4
    v_and_b32 v6, 0xffff0000, v4
    v_cvt_pk_bf16_f32 v4, v54, v55
    v_lshlrev_b32 v7, 16, v4
    v_and_b32 v8, 0xffff0000, v4
    v_mul_f32 v5, v5, v7
    v_mul_f32 v6, v6, v8
    v_cvt_pk_bf16_f32 v59, v5, v6
    s_movk_i32 s35, 3584
    v_mul_lo_u32 v4, v16, s35
    v_lshl_add_u32 v4, v17, 4, v4
    v_mov_b32 v5, 0x7ffffff0
    v_cmp_gt_u32 vcc, 8, v16
    s_nop 1
    v_cndmask_b32 v4, v5, v4, vcc
    s_lshl_b32 s36, s30, 6
    s_add_u32 s36, s36, 0x210000
    buffer_store_dwordx4 v[56:59], v4, s[24:27], s36 offen sc1
    s_waitcnt vmcnt(0)
    s_barrier
    s_cmp_lg_u32 s29, 0
    s_cbranch_scc1 DA_46
    s_mov_b64 exec, 1
    v_mov_b32 v28, 1
    buffer_atomic_add v28, off, s[12:15], 0 offset:248 sc1
    s_mov_b64 exec, -1
DA_46:
    s_branch W_LOOP
W_F2:
    v_and_b32 v16, 15, v1
    v_lshrrev_b32 v17, 4, v1
    v_mov_b32 v20, 0x7ffffff0
    v_cmp_gt_u32 s[40:41], 8, v16
    s_lshl_b32 s30, s30, 2
    s_add_u32 s30, s30, s29
    v_and_b32 v3, 7, v16
    s_movk_i32 s31, 3584
    v_mul_lo_u32 v3, v3, s31
    v_lshl_add_u32 v3, v17, 4, v3
    v_lshlrev_b32 v4, 4, v1
    s_mul_i32 s32, s30, 114688
    s_add_u32 s32, s32, 0x1800000
    s_add_u32 s33, s32, 57344
    s_mov_b32 s34, 0x210000
    s_cmp_lg_u32 s29, 0
    s_cbranch_scc1 W0_47
    s_mov_b32 s31, 0
PD_48:
    s_cmp_eq_u32 s31, 0
    s_cbranch_scc1 PB_49
    s_sleep 8
PB_49:
    buffer_load_dword v24, off, s[12:15], 0 offset:248 sc1
    buffer_load_dword v25, off, s[12:15], 0 offset:252 sc1
    s_add_u32 s31, s31, 1
    s_cmp_gt_u32 s31, 0x200000
    s_cbranch_scc1 W_EXIT
    s_waitcnt vmcnt(0)
    v_readfirstlane_b32 s70, v24
    v_readfirstlane_b32 s71, v25
    s_cmp_lg_u32 s70, 14
    s_cbranch_scc1 PD_48
    s_cmp_lg_u32 s71, 28
    s_cbranch_scc1 PD_48
W0_47:
    s_barrier
    v_mov_b32 v40, 0
    v_mov_b32 v41, 0
    v_mov_b32 v42, 0
    v_mov_b32 v43, 0
    v_mov_b32 v44, 0
    v_mov_b32 v45, 0
    v_mov_b32 v46, 0
    v_mov_b32 v47, 0
    s_mov_b32 s35, 0
W_F2L:
    buffer_load_dwordx4 v[64:67], v3, s[24:27], s34 offen offset:0 sc1
    buffer_load_dwordx4 v[68:71], v4, s[24:27], s32 offen offset:0 sc1
    buffer_load_dwordx4 v[72:75], v4, s[24:27], s33 offen offset:0 sc1
    buffer_load_dwordx4 v[76:79], v3, s[24:27], s34 offen offset:64 sc1
    buffer_load_dwordx4 v[80:83], v4, s[24:27], s32 offen offset:1024 sc1
    buffer_load_dwordx4 v[84:87], v4, s[24:27], s33 offen offset:1024 sc1
    buffer_load_dwordx4 v[88:91], v3, s[24:27], s34 offen offset:128 sc1
    buffer_load_dwordx4 v[92:95], v4, s[24:27], s32 offen offset:2048 sc1
    buffer_load_dwordx4 v[96:99], v4, s[24:27], s33 offen offset:2048 sc1
    buffer_load_dwordx4 v[100:103], v3, s[24:27], s34 offen offset:192 sc1
    buffer_load_dwordx4 v[104:107], v4, s[24:27], s32 offen offset:3072 sc1
    buffer_load_dwordx4 v[108:111], v4, s[24:27], s33 offen offset:3072 sc1
    s_waitcnt vmcnt(9)
    v_mfma_f32_16x16x32_bf16 v[40:43], v[68:71], v[64:67], v[40:43]
    v_mfma_f32_16x16x32_bf16 v[44:47], v[72:75], v[64:67], v[44:47]
    s_waitcnt vmcnt(6)
    v_mfma_f32_16x16x32_bf16 v[40:43], v[80:83], v[76:79], v[40:43]
    v_mfma_f32_16x16x32_bf16 v[44:47], v[84:87], v[76:79], v[44:47]
    s_waitcnt vmcnt(3)
    v_mfma_f32_16x16x32_bf16 v[40:43], v[92:95], v[88:91], v[40:43]
    v_mfma_f32_16x16x32_bf16 v[44:47], v[96:99], v[88:91], v[44:47]
    s_waitcnt vmcnt(0)
    v_mfma_f32_16x16x32_bf16 v[40:43], v[104:107], v[100:103], v[40:43]
    v_mfma_f32_16x16x32_bf16 v[44:47], v[108:111], v[100:103], v[44:47]
    s_add_u32 s34, s34, 256
    s_add_u32 s32, s32, 4096
    s_add_u32 s33, s33, 4096
    s_add_u32 s35, s35, 1
    s_cmp_lt_u32 s35, 14
    s_cbranch_scc1 W_F2L
    v_and_b32 v5, 7, v16
    v_lshlrev_b32 v5, 2, v5
    s_mov_b32 s36, 0x224020
    buffer_load_dword v6, v5, s[24:27], s36 offen sc1
    s_mov_b32 s55, 0xbfb8aa3b
    s_waitcnt vmcnt(0)
    v_mul_f32 v6, s55, v6
    v_exp_f32 v6, v6
    s_nop 0
    v_add_f32 v6, 1.0, v6
    v_rcp_f32 v6, v6
    s_nop 0
    v_cvt_pk_bf16_f32 v6, v6, v6
    v_lshlrev_b32 v6, 16, v6
    v_cvt_pk_bf16_f32 v7, v40, v41
    v_lshlrev_b32 v8, 16, v7
    v_and_b32 v9, 0xffff0000, v7
    v_mul_f32 v8, v8, v6
    v_mul_f32 v9, v9, v6
    v_cvt_pk_bf16_f32 v48, v8, v9
    v_cvt_pk_bf16_f32 v7, v42, v43
    v_lshlrev_b32 v8, 16, v7
    v_and_b32 v9, 0xffff0000, v7
    v_mul_f32 v8, v8, v6
    v_mul_f32 v9, v9, v6
    v_cvt_pk_bf16_f32 v49, v8, v9
    v_cvt_pk_bf16_f32 v7, v44, v45
    v_lshlrev_b32 v8, 16, v7
    v_and_b32 v9, 0xffff0000, v7
    v_mul_f32 v8, v8, v6
    v_mul_f32 v9, v9, v6
    v_cvt_pk_bf16_f32 v50, v8, v9
    v_cvt_pk_bf16_f32 v7, v46, v47
    v_lshlrev_b32 v8, 16, v7
    v_and_b32 v9, 0xffff0000, v7
    v_mul_f32 v8, v8, v6
    v_mul_f32 v9, v9, v6
    v_cvt_pk_bf16_f32 v51, v8, v9
    v_lshlrev_b32 v5, 10, v16
    v_lshl_add_u32 v5, v17, 4, v5
    v_cndmask_b32 v5, v20, v5, s[40:41]
    s_lshl_b32 s36, s30, 6
    s_add_u32 s36, s36, 0x220000
    buffer_store_dwordx4 v[48:51], v5, s[24:27], s36 offen sc1
    s_waitcnt vmcnt(0)
    s_barrier
    s_cmp_lg_u32 s29, 0
    s_cbranch_scc1 DA_50
    s_mov_b64 exec, 1
    v_mov_b32 v28, 1
    buffer_atomic_add v28, off, s[12:15], 0 offset:236 sc1
    s_mov_b64 exec, -1
DA_50:
    s_branch W_LOOP
W_INIT:
    s_mov_b32 s38, -1
    s_lshl_b32 s36, s30, 17
    s_add_u32 s36, s36, 0x240000
    s_mov_b32 s39, 32
    s_cmp_lt_u32 s30, 14
    s_cbranch_scc1 W_INIT2
    s_sub_u32 s36, s30, 15
    s_lshl_b32 s36, s36, 17
    s_add_u32 s36, s36, 0x6f80000
    s_cmp_eq_u32 s30, 19
    s_cselect_b32 s36, 0x53e0000, s36
    s_cmp_eq_u32 s30, 20
    s_cselect_b32 s36, 0x57e0000, s36
    s_cmp_gt_u32 s30, 14
    s_cbranch_scc1 W_INIT2
    s_mov_b32 s38, 0
    s_mov_b32 s36, 0x228000
    s_mov_b32 s39, 24
W_INIT2:
    v_lshlrev_b32 v3, 4, v0
    v_mov_b32 v4, s38
    v_mov_b32 v5, s38
    v_mov_b32 v6, s38
    v_mov_b32 v7, s38
W_INIT3:
    buffer_store_dwordx4 v[4:7], v3, s[24:27], s36 offen sc1
    s_add_u32 s36, s36, 4096
    buffer_store_dwordx4 v[4:7], v3, s[24:27], s36 offen sc1
    s_add_u32 s36, s36, 4096
    buffer_store_dwordx4 v[4:7], v3, s[24:27], s36 offen sc1
    s_add_u32 s36, s36, 4096
    buffer_store_dwordx4 v[4:7], v3, s[24:27], s36 offen sc1
    s_add_u32 s36, s36, 4096
    buffer_store_dwordx4 v[4:7], v3, s[24:27], s36 offen sc1
    s_add_u32 s36, s36, 4096
    buffer_store_dwordx4 v[4:7], v3, s[24:27], s36 offen sc1
    s_add_u32 s36, s36, 4096
    buffer_store_dwordx4 v[4:7], v3, s[24:27], s36 offen sc1
    s_add_u32 s36, s36, 4096
    buffer_store_dwordx4 v[4:7], v3, s[24:27], s36 offen sc1
    s_add_u32 s36, s36, 4096
    s_sub_u32 s39, s39, 8
    s_cmp_lg_u32 s39, 0
    s_cbranch_scc1 W_INIT3
    s_waitcnt vmcnt(0)
    s_barrier
    s_cmp_lg_u32 s29, 0
    s_cbranch_scc1 DA_51
    s_mov_b64 exec, 1
    v_mov_b32 v28, 1
    buffer_atomic_add v28, off, s[12:15], 0 offset:240 sc1
    s_mov_b64 exec, -1
DA_51:
    s_branch W_LOOP
W_PFW:
    s_mul_i32 s30, s30, 1
    s_lshr_b32 s31, s30, 4
    s_lshl_b32 s31, s31, 3
    s_add_u32 s31, s31, 16
    s_load_dwordx2 s[40:41], s[0:1], s31
    s_and_b32 s32, s30, 15
    s_lshl_b32 s32, s32, 18
    s_mul_i32 s33, s29, 65536
    s_add_u32 s32, s32, s33
    v_lshlrev_b32 v3, 4, v1
    s_waitcnt lgkmcnt(0)
    s_mov_b32 s44, s40
    s_and_b32 s45, s41, 0xffff
    s_mov_b32 s46, 0x400000
    s_mov_b32 s47, 0x00020000
    buffer_load_dwordx4 v[64:67], v3, s[44:47], s32 offen offset:0
    buffer_load_dwordx4 v[68:71], v3, s[44:47], s32 offen offset:1024
    buffer_load_dwordx4 v[72:75], v3, s[44:47], s32 offen offset:2048
    buffer_load_dwordx4 v[76:79], v3, s[44:47], s32 offen offset:3072
    s_add_u32 s32, s32, 4096
    buffer_load_dwordx4 v[80:83], v3, s[44:47], s32 offen offset:0
    buffer_load_dwordx4 v[84:87], v3, s[44:47], s32 offen offset:1024
    buffer_load_dwordx4 v[88:91], v3, s[44:47], s32 offen offset:2048
    buffer_load_dwordx4 v[92:95], v3, s[44:47], s32 offen offset:3072
    s_add_u32 s32, s32, 4096
    buffer_load_dwordx4 v[96:99], v3, s[44:47], s32 offen offset:0
    buffer_load_dwordx4 v[100:103], v3, s[44:47], s32 offen offset:1024
    buffer_load_dwordx4 v[104:107], v3, s[44:47], s32 offen offset:2048
    buffer_load_dwordx4 v[108:111], v3, s[44:47], s32 offen offset:3072
    s_add_u32 s32, s32, 4096
    buffer_load_dwordx4 v[112:115], v3, s[44:47], s32 offen offset:0
    buffer_load_dwordx4 v[116:119], v3, s[44:47], s32 offen offset:1024
    buffer_load_dwordx4 v[120:123], v3, s[44:47], s32 offen offset:2048
    buffer_load_dwordx4 v[124:127], v3, s[44:47], s32 offen offset:3072
    s_add_u32 s32, s32, 4096
    buffer_load_dwordx4 v[128:131], v3, s[44:47], s32 offen offset:0
    buffer_load_dwordx4 v[132:135], v3, s[44:47], s32 offen offset:1024
    buffer_load_dwordx4 v[136:139], v3, s[44:47], s32 offen offset:2048
    buffer_load_dwordx4 v[140:143], v3, s[44:47], s32 offen offset:3072
    s_add_u32 s32, s32, 4096
    buffer_load_dwordx4 v[144:147], v3, s[44:47], s32 offen offset:0
    buffer_load_dwordx4 v[148:151], v3, s[44:47], s32 offen offset:1024
    buffer_load_dwordx4 v[152:155], v3, s[44:47], s32 offen offset:2048
    buffer_load_dwordx4 v[156:159], v3, s[44:47], s32 offen offset:3072
    s_add_u32 s32, s32, 4096
    buffer_load_dwordx4 v[160:163], v3, s[44:47], s32 offen offset:0
    buffer_load_dwordx4 v[164:167], v3, s[44:47], s32 offen offset:1024
    buffer_load_dwordx4 v[168:171], v3, s[44:47], s32 offen offset:2048
    buffer_load_dwordx4 v[172:175], v3, s[44:47], s32 offen offset:3072
    s_add_u32 s32, s32, 4096
    buffer_load_dwordx4 v[176:179], v3, s[44:47], s32 offen offset:0
    buffer_load_dwordx4 v[180:183], v3, s[44:47], s32 offen offset:1024
    buffer_load_dwordx4 v[184:187], v3, s[44:47], s32 offen offset:2048
    buffer_load_dwordx4 v[188:191], v3, s[44:47], s32 offen offset:3072
    s_add_u32 s32, s32, 4096
    buffer_load_dwordx4 v[64:67], v3, s[44:47], s32 offen offset:0
    buffer_load_dwordx4 v[68:71], v3, s[44:47], s32 offen offset:1024
    buffer_load_dwordx4 v[72:75], v3, s[44:47], s32 offen offset:2048
    buffer_load_dwordx4 v[76:79], v3, s[44:47], s32 offen offset:3072
    s_add_u32 s32, s32, 4096
    buffer_load_dwordx4 v[80:83], v3, s[44:47], s32 offen offset:0
    buffer_load_dwordx4 v[84:87], v3, s[44:47], s32 offen offset:1024
    buffer_load_dwordx4 v[88:91], v3, s[44:47], s32 offen offset:2048
    buffer_load_dwordx4 v[92:95], v3, s[44:47], s32 offen offset:3072
    s_add_u32 s32, s32, 4096
    buffer_load_dwordx4 v[96:99], v3, s[44:47], s32 offen offset:0
    buffer_load_dwordx4 v[100:103], v3, s[44:47], s32 offen offset:1024
    buffer_load_dwordx4 v[104:107], v3, s[44:47], s32 offen offset:2048
    buffer_load_dwordx4 v[108:111], v3, s[44:47], s32 offen offset:3072
    s_add_u32 s32, s32, 4096
    buffer_load_dwordx4 v[112:115], v3, s[44:47], s32 offen offset:0
    buffer_load_dwordx4 v[116:119], v3, s[44:47], s32 offen offset:1024
    buffer_load_dwordx4 v[120:123], v3, s[44:47], s32 offen offset:2048
    buffer_load_dwordx4 v[124:127], v3, s[44:47], s32 offen offset:3072
    s_add_u32 s32, s32, 4096
    buffer_load_dwordx4 v[128:131], v3, s[44:47], s32 offen offset:0
    buffer_load_dwordx4 v[132:135], v3, s[44:47], s32 offen offset:1024
    buffer_load_dwordx4 v[136:139], v3, s[44:47], s32 offen offset:2048
    buffer_load_dwordx4 v[140:143], v3, s[44:47], s32 offen offset:3072
    s_add_u32 s32, s32, 4096
    buffer_load_dwordx4 v[144:147], v3, s[44:47], s32 offen offset:0
    buffer_load_dwordx4 v[148:151], v3, s[44:47], s32 offen offset:1024
    buffer_load_dwordx4 v[152:155], v3, s[44:47], s32 offen offset:2048
    buffer_load_dwordx4 v[156:159], v3, s[44:47], s32 offen offset:3072
    s_add_u32 s32, s32, 4096
    buffer_load_dwordx4 v[160:163], v3, s[44:47], s32 offen offset:0
    buffer_load_dwordx4 v[164:167], v3, s[44:47], s32 offen offset:1024
    buffer_load_dwordx4 v[168:171], v3, s[44:47], s32 offen offset:2048
    buffer_load_dwordx4 v[172:175], v3, s[44:47], s32 offen offset:3072
    s_add_u32 s32, s32, 4096
    buffer_load_dwordx4 v[176:179], v3, s[44:47], s32 offen offset:0
    buffer_load_dwordx4 v[180:183], v3, s[44:47], s32 offen offset:1024
    buffer_load_dwordx4 v[184:187], v3, s[44:47], s32 offen offset:2048
    buffer_load_dwordx4 v[188:191], v3, s[44:47], s32 offen offset:3072
    s_add_u32 s32, s32, 4096
    s_waitcnt vmcnt(0)
    s_branch W_LOOP
W_LN:
    s_load_dwordx2 s[40:41], s[0:1], 64
    s_lshl_b32 s36, s30, 5
    s_mov_b32 s45, 0
    v_lshlrev_b32 v3, 4, v1
    v_lshl_add_u32 v4, v2, 12, v3
    s_lshl_b32 s37, s36, 10
    buffer_load_dwordx4 v[12:15], v4, s[16:19], s37 offen offset:0
    buffer_load_dwordx4 v[16:19], v4, s[16:19], s37 offen offset:1024
    buffer_load_dwordx4 v[20:23], v4, s[16:19], s37 offen offset:2048
    buffer_load_dwordx4 v[24:27], v4, s[16:19], s37 offen offset:3072
    s_waitcnt lgkmcnt(0)
    s_mov_b32 s32, s40
    s_and_b32 s33, s41, 0xffff
    s_mov_b32 s34, 0x400
    s_mov_b32 s35, 0x00020000
    buffer_load_dwordx4 v[8:11], v3, s[32:35], 0 offen
    s_add_u32 s37, s37, 16384
    buffer_load_dwordx4 v[84:87], v4, s[16:19], s37 offen offset:0
    buffer_load_dwordx4 v[88:91], v4, s[16:19], s37 offen offset:1024
    buffer_load_dwordx4 v[92:95], v4, s[16:19], s37 offen offset:2048
    buffer_load_dwordx4 v[96:99], v4, s[16:19], s37 offen offset:3072
    s_sub_u32 s37, s37, 16384
    s_waitcnt vmcnt(4)
    v_lshlrev_b32 v40, 16, v8
    v_and_b32 v41, 0xffff0000, v8
    v_lshlrev_b32 v42, 16, v9
    v_and_b32 v43, 0xffff0000, v9
    v_lshlrev_b32 v44, 16, v10
    v_and_b32 v45, 0xffff0000, v10
    v_lshlrev_b32 v46, 16, v11
    v_and_b32 v47, 0xffff0000, v11
    s_mov_b32 s38, 0x3b000000
    s_mov_b32 s39, 0x3727c5ac
W_LN2:
    v_lshlrev_b32 v48, 16, v12
    v_and_b32 v49, 0xffff0000, v12
    v_lshlrev_b32 v50, 16, v13
    v_and_b32 v51, 0xffff0000, v13
    v_lshlrev_b32 v52, 16, v14
    v_and_b32 v53, 0xffff0000, v14
    v_lshlrev_b32 v54, 16, v15
    v_and_b32 v55, 0xffff0000, v15
    v_add_f32 v56, v48, v49
    v_add_f32 v56, v56, v50
    v_add_f32 v56, v56, v51
    v_add_f32 v56, v56, v52
    v_add_f32 v56, v56, v53
    v_add_f32 v56, v56, v54
    v_add_f32 v56, v56, v55
    s_nop 1
    v_add_f32_dpp v57, v56, v56 quad_perm:[1,0,3,2] row_mask:0xf bank_mask:0xf
    s_nop 1
    v_add_f32_dpp v56, v57, v57 quad_perm:[2,3,0,1] row_mask:0xf bank_mask:0xf
    s_nop 1
    v_add_f32_dpp v57, v56, v56 row_half_mirror row_mask:0xf bank_mask:0xf
    s_nop 1
    v_add_f32_dpp v56, v57, v57 row_mirror row_mask:0xf bank_mask:0xf
    v_mov_b32 v57, v56
    s_nop 1
    v_permlane16_swap_b32 v56, v57
    s_nop 1
    v_add_f32 v56, v56, v57
    v_mov_b32 v57, v56
    s_nop 1
    v_permlane32_swap_b32 v56, v57
    s_nop 1
    v_add_f32 v56, v56, v57
    v_mul_f32 v56, s38, v56
    v_sub_f32 v58, v48, v56
    v_mul_f32 v59, v58, v58
    v_sub_f32 v58, v49, v56
    v_fmac_f32 v59, v58, v58
    v_sub_f32 v58, v50, v56
    v_fmac_f32 v59, v58, v58
    v_sub_f32 v58, v51, v56
    v_fmac_f32 v59, v58, v58
    v_sub_f32 v58, v52, v56
    v_fmac_f32 v59, v58, v58
    v_sub_f32 v58, v53, v56
    v_fmac_f32 v59, v58, v58
    v_sub_f32 v58, v54, v56
    v_fmac_f32 v59, v58, v58
    v_sub_f32 v58, v55, v56
    v_fmac_f32 v59, v58, v58
    s_nop 1
    v_add_f32_dpp v57, v59, v59 quad_perm:[1,0,3,2] row_mask:0xf bank_mask:0xf
    s_nop 1
    v_add_f32_dpp v59, v57, v57 quad_perm:[2,3,0,1] row_mask:0xf bank_mask:0xf
    s_nop 1
    v_add_f32_dpp v57, v59, v59 row_half_mirror row_mask:0xf bank_mask:0xf
    s_nop 1
    v_add_f32_dpp v59, v57, v57 row_mirror row_mask:0xf bank_mask:0xf
    v_mov_b32 v57, v59
    s_nop 1
    v_permlane16_swap_b32 v59, v57
    s_nop 1
    v_add_f32 v59, v59, v57
    v_mov_b32 v57, v59
    s_nop 1
    v_permlane32_swap_b32 v59, v57
    s_nop 1
    v_add_f32 v59, v59, v57
    v_mul_f32 v59, s38, v59
    v_cvt_pk_bf16_f32 v58, v56, v59
    v_lshlrev_b32 v56, 16, v58
    v_and_b32 v59, 0xffff0000, v58
    v_add_f32 v59, s39, v59
    v_cvt_pk_bf16_f32 v59, v59, v59
    v_lshlrev_b32 v59, 16, v59
    v_sqrt_f32 v59, v59
    s_nop 0
    v_cvt_pk_bf16_f32 v59, v59, v59
    v_lshlrev_b32 v59, 16, v59
    v_rcp_f32 v58, v59
    s_nop 0
    v_sub_f32 v60, v48, v56
    v_sub_f32 v61, v49, v56
    v_cvt_pk_bf16_f32 v60, v60, v61
    v_and_b32 v61, 0xffff0000, v60
    v_lshlrev_b32 v60, 16, v60
    v_mul_f32 v62, v60, v58
    v_mul_f32 v63, v61, v58
    v_fma_f32 v60, -v62, v59, v60
    v_fma_f32 v61, -v63, v59, v61
    v_fma_f32 v62, v60, v58, v62
    v_fma_f32 v63, v61, v58, v63
    v_cvt_pk_bf16_f32 v64, v62, v63
    v_sub_f32 v60, v50, v56
    v_sub_f32 v61, v51, v56
    v_cvt_pk_bf16_f32 v60, v60, v61
    v_and_b32 v61, 0xffff0000, v60
    v_lshlrev_b32 v60, 16, v60
    v_mul_f32 v62, v60, v58
    v_mul_f32 v63, v61, v58
    v_fma_f32 v60, -v62, v59, v60
    v_fma_f32 v61, -v63, v59, v61
    v_fma_f32 v62, v60, v58, v62
    v_fma_f32 v63, v61, v58, v63
    v_cvt_pk_bf16_f32 v65, v62, v63
    v_sub_f32 v60, v52, v56
    v_sub_f32 v61, v53, v56
    v_cvt_pk_bf16_f32 v60, v60, v61
    v_and_b32 v61, 0xffff0000, v60
    v_lshlrev_b32 v60, 16, v60
    v_mul_f32 v62, v60, v58
    v_mul_f32 v63, v61, v58
    v_fma_f32 v60, -v62, v59, v60
    v_fma_f32 v61, -v63, v59, v61
    v_fma_f32 v62, v60, v58, v62
    v_fma_f32 v63, v61, v58, v63
    v_cvt_pk_bf16_f32 v66, v62, v63
    v_sub_f32 v60, v54, v56
    v_sub_f32 v61, v55, v56
    v_cvt_pk_bf16_f32 v60, v60, v61
    v_and_b32 v61, 0xffff0000, v60
    v_lshlrev_b32 v60, 16, v60
    v_mul_f32 v62, v60, v58
    v_mul_f32 v63, v61, v58
    v_fma_f32 v60, -v62, v59, v60
    v_fma_f32 v61, -v63, v59, v61
    v_fma_f32 v62, v60, v58, v62
    v_fma_f32 v63, v61, v58, v63
    v_cvt_pk_bf16_f32 v67, v62, v63
    v_mov_b32 v60, 0
    v_lshlrev_b32 v61, 16, v64
    v_and_b32 v62, 0xffff0000, v64
    v_fmac_f32 v60, v61, v40
    v_fmac_f32 v60, v62, v41
    v_lshlrev_b32 v61, 16, v65
    v_and_b32 v62, 0xffff0000, v65
    v_fmac_f32 v60, v61, v42
    v_fmac_f32 v60, v62, v43
    v_lshlrev_b32 v61, 16, v66
    v_and_b32 v62, 0xffff0000, v66
    v_fmac_f32 v60, v61, v44
    v_fmac_f32 v60, v62, v45
    v_lshlrev_b32 v61, 16, v67
    v_and_b32 v62, 0xffff0000, v67
    v_fmac_f32 v60, v61, v46
    v_fmac_f32 v60, v62, v47
    buffer_store_dwordx4 v[64:67], v4, s[24:27], s37 offen offset:0 sc1
    s_nop 1
    v_add_f32_dpp v57, v60, v60 quad_perm:[1,0,3,2] row_mask:0xf bank_mask:0xf
    s_nop 1
    v_add_f32_dpp v60, v57, v57 quad_perm:[2,3,0,1] row_mask:0xf bank_mask:0xf
    s_nop 1
    v_add_f32_dpp v57, v60, v60 row_half_mirror row_mask:0xf bank_mask:0xf
    s_nop 1
    v_add_f32_dpp v60, v57, v57 row_mirror row_mask:0xf bank_mask:0xf
    v_mov_b32 v57, v60
    s_nop 1
    v_permlane16_swap_b32 v60, v57
    s_nop 1
    v_add_f32 v60, v60, v57
    v_mov_b32 v57, v60
    s_nop 1
    v_permlane32_swap_b32 v60, v57
    s_nop 1
    v_add_f32 v60, v60, v57
    v_cvt_pk_bf16_f32 v60, v60, v60
    v_lshlrev_b32 v80, 16, v60
    v_lshlrev_b32 v48, 16, v16
    v_and_b32 v49, 0xffff0000, v16
    v_lshlrev_b32 v50, 16, v17
    v_and_b32 v51, 0xffff0000, v17
    v_lshlrev_b32 v52, 16, v18
    v_and_b32 v53, 0xffff0000, v18
    v_lshlrev_b32 v54, 16, v19
    v_and_b32 v55, 0xffff0000, v19
    v_add_f32 v56, v48, v49
    v_add_f32 v56, v56, v50
    v_add_f32 v56, v56, v51
    v_add_f32 v56, v56, v52
    v_add_f32 v56, v56, v53
    v_add_f32 v56, v56, v54
    v_add_f32 v56, v56, v55
    s_nop 1
    v_add_f32_dpp v57, v56, v56 quad_perm:[1,0,3,2] row_mask:0xf bank_mask:0xf
    s_nop 1
    v_add_f32_dpp v56, v57, v57 quad_perm:[2,3,0,1] row_mask:0xf bank_mask:0xf
    s_nop 1
    v_add_f32_dpp v57, v56, v56 row_half_mirror row_mask:0xf bank_mask:0xf
    s_nop 1
    v_add_f32_dpp v56, v57, v57 row_mirror row_mask:0xf bank_mask:0xf
    v_mov_b32 v57, v56
    s_nop 1
    v_permlane16_swap_b32 v56, v57
    s_nop 1
    v_add_f32 v56, v56, v57
    v_mov_b32 v57, v56
    s_nop 1
    v_permlane32_swap_b32 v56, v57
    s_nop 1
    v_add_f32 v56, v56, v57
    v_mul_f32 v56, s38, v56
    v_sub_f32 v58, v48, v56
    v_mul_f32 v59, v58, v58
    v_sub_f32 v58, v49, v56
    v_fmac_f32 v59, v58, v58
    v_sub_f32 v58, v50, v56
    v_fmac_f32 v59, v58, v58
    v_sub_f32 v58, v51, v56
    v_fmac_f32 v59, v58, v58
    v_sub_f32 v58, v52, v56
    v_fmac_f32 v59, v58, v58
    v_sub_f32 v58, v53, v56
    v_fmac_f32 v59, v58, v58
    v_sub_f32 v58, v54, v56
    v_fmac_f32 v59, v58, v58
    v_sub_f32 v58, v55, v56
    v_fmac_f32 v59, v58, v58
    s_nop 1
    v_add_f32_dpp v57, v59, v59 quad_perm:[1,0,3,2] row_mask:0xf bank_mask:0xf
    s_nop 1
    v_add_f32_dpp v59, v57, v57 quad_perm:[2,3,0,1] row_mask:0xf bank_mask:0xf
    s_nop 1
    v_add_f32_dpp v57, v59, v59 row_half_mirror row_mask:0xf bank_mask:0xf
    s_nop 1
    v_add_f32_dpp v59, v57, v57 row_mirror row_mask:0xf bank_mask:0xf
    v_mov_b32 v57, v59
    s_nop 1
    v_permlane16_swap_b32 v59, v57
    s_nop 1
    v_add_f32 v59, v59, v57
    v_mov_b32 v57, v59
    s_nop 1
    v_permlane32_swap_b32 v59, v57
    s_nop 1
    v_add_f32 v59, v59, v57
    v_mul_f32 v59, s38, v59
    v_cvt_pk_bf16_f32 v58, v56, v59
    v_lshlrev_b32 v56, 16, v58
    v_and_b32 v59, 0xffff0000, v58
    v_add_f32 v59, s39, v59
    v_cvt_pk_bf16_f32 v59, v59, v59
    v_lshlrev_b32 v59, 16, v59
    v_sqrt_f32 v59, v59
    s_nop 0
    v_cvt_pk_bf16_f32 v59, v59, v59
    v_lshlrev_b32 v59, 16, v59
    v_rcp_f32 v58, v59
    s_nop 0
    v_sub_f32 v60, v48, v56
    v_sub_f32 v61, v49, v56
    v_cvt_pk_bf16_f32 v60, v60, v61
    v_and_b32 v61, 0xffff0000, v60
    v_lshlrev_b32 v60, 16, v60
    v_mul_f32 v62, v60, v58
    v_mul_f32 v63, v61, v58
    v_fma_f32 v60, -v62, v59, v60
    v_fma_f32 v61, -v63, v59, v61
    v_fma_f32 v62, v60, v58, v62
    v_fma_f32 v63, v61, v58, v63
    v_cvt_pk_bf16_f32 v68, v62, v63
    v_sub_f32 v60, v50, v56
    v_sub_f32 v61, v51, v56
    v_cvt_pk_bf16_f32 v60, v60, v61
    v_and_b32 v61, 0xffff0000, v60
    v_lshlrev_b32 v60, 16, v60
    v_mul_f32 v62, v60, v58
    v_mul_f32 v63, v61, v58
    v_fma_f32 v60, -v62, v59, v60
    v_fma_f32 v61, -v63, v59, v61
    v_fma_f32 v62, v60, v58, v62
    v_fma_f32 v63, v61, v58, v63
    v_cvt_pk_bf16_f32 v69, v62, v63
    v_sub_f32 v60, v52, v56
    v_sub_f32 v61, v53, v56
    v_cvt_pk_bf16_f32 v60, v60, v61
    v_and_b32 v61, 0xffff0000, v60
    v_lshlrev_b32 v60, 16, v60
    v_mul_f32 v62, v60, v58
    v_mul_f32 v63, v61, v58
    v_fma_f32 v60, -v62, v59, v60
    v_fma_f32 v61, -v63, v59, v61
    v_fma_f32 v62, v60, v58, v62
    v_fma_f32 v63, v61, v58, v63
    v_cvt_pk_bf16_f32 v70, v62, v63
    v_sub_f32 v60, v54, v56
    v_sub_f32 v61, v55, v56
    v_cvt_pk_bf16_f32 v60, v60, v61
    v_and_b32 v61, 0xffff0000, v60
    v_lshlrev_b32 v60, 16, v60
    v_mul_f32 v62, v60, v58
    v_mul_f32 v63, v61, v58
    v_fma_f32 v60, -v62, v59, v60
    v_fma_f32 v61, -v63, v59, v61
    v_fma_f32 v62, v60, v58, v62
    v_fma_f32 v63, v61, v58, v63
    v_cvt_pk_bf16_f32 v71, v62, v63
    v_mov_b32 v60, 0
    v_lshlrev_b32 v61, 16, v68
    v_and_b32 v62, 0xffff0000, v68
    v_fmac_f32 v60, v61, v40
    v_fmac_f32 v60, v62, v41
    v_lshlrev_b32 v61, 16, v69
    v_and_b32 v62, 0xffff0000, v69
    v_fmac_f32 v60, v61, v42
    v_fmac_f32 v60, v62, v43
    v_lshlrev_b32 v61, 16, v70
    v_and_b32 v62, 0xffff0000, v70
    v_fmac_f32 v60, v61, v44
    v_fmac_f32 v60, v62, v45
    v_lshlrev_b32 v61, 16, v71
    v_and_b32 v62, 0xffff0000, v71
    v_fmac_f32 v60, v61, v46
    v_fmac_f32 v60, v62, v47
    buffer_store_dwordx4 v[68:71], v4, s[24:27], s37 offen offset:1024 sc1
    s_nop 1
    v_add_f32_dpp v57, v60, v60 quad_perm:[1,0,3,2] row_mask:0xf bank_mask:0xf
    s_nop 1
    v_add_f32_dpp v60, v57, v57 quad_perm:[2,3,0,1] row_mask:0xf bank_mask:0xf
    s_nop 1
    v_add_f32_dpp v57, v60, v60 row_half_mirror row_mask:0xf bank_mask:0xf
    s_nop 1
    v_add_f32_dpp v60, v57, v57 row_mirror row_mask:0xf bank_mask:0xf
    v_mov_b32 v57, v60
    s_nop 1
    v_permlane16_swap_b32 v60, v57
    s_nop 1
    v_add_f32 v60, v60, v57
    v_mov_b32 v57, v60
    s_nop 1
    v_permlane32_swap_b32 v60, v57
    s_nop 1
    v_add_f32 v60, v60, v57
    v_cvt_pk_bf16_f32 v60, v60, v60
    v_lshlrev_b32 v81, 16, v60
    v_lshlrev_b32 v48, 16, v20
    v_and_b32 v49, 0xffff0000, v20
    v_lshlrev_b32 v50, 16, v21
    v_and_b32 v51, 0xffff0000, v21
    v_lshlrev_b32 v52, 16, v22
    v_and_b32 v53, 0xffff0000, v22
    v_lshlrev_b32 v54, 16, v23
    v_and_b32 v55, 0xffff0000, v23
    v_add_f32 v56, v48, v49
    v_add_f32 v56, v56, v50
    v_add_f32 v56, v56, v51
    v_add_f32 v56, v56, v52
    v_add_f32 v56, v56, v53
    v_add_f32 v56, v56, v54
    v_add_f32 v56, v56, v55
    s_nop 1
    v_add_f32_dpp v57, v56, v56 quad_perm:[1,0,3,2] row_mask:0xf bank_mask:0xf
    s_nop 1
    v_add_f32_dpp v56, v57, v57 quad_perm:[2,3,0,1] row_mask:0xf bank_mask:0xf
    s_nop 1
    v_add_f32_dpp v57, v56, v56 row_half_mirror row_mask:0xf bank_mask:0xf
    s_nop 1
    v_add_f32_dpp v56, v57, v57 row_mirror row_mask:0xf bank_mask:0xf
    v_mov_b32 v57, v56
    s_nop 1
    v_permlane16_swap_b32 v56, v57
    s_nop 1
    v_add_f32 v56, v56, v57
    v_mov_b32 v57, v56
    s_nop 1
    v_permlane32_swap_b32 v56, v57
    s_nop 1
    v_add_f32 v56, v56, v57
    v_mul_f32 v56, s38, v56
    v_sub_f32 v58, v48, v56
    v_mul_f32 v59, v58, v58
    v_sub_f32 v58, v49, v56
    v_fmac_f32 v59, v58, v58
    v_sub_f32 v58, v50, v56
    v_fmac_f32 v59, v58, v58
    v_sub_f32 v58, v51, v56
    v_fmac_f32 v59, v58, v58
    v_sub_f32 v58, v52, v56
    v_fmac_f32 v59, v58, v58
    v_sub_f32 v58, v53, v56
    v_fmac_f32 v59, v58, v58
    v_sub_f32 v58, v54, v56
    v_fmac_f32 v59, v58, v58
    v_sub_f32 v58, v55, v56
    v_fmac_f32 v59, v58, v58
    s_nop 1
    v_add_f32_dpp v57, v59, v59 quad_perm:[1,0,3,2] row_mask:0xf bank_mask:0xf
    s_nop 1
    v_add_f32_dpp v59, v57, v57 quad_perm:[2,3,0,1] row_mask:0xf bank_mask:0xf
    s_nop 1
    v_add_f32_dpp v57, v59, v59 row_half_mirror row_mask:0xf bank_mask:0xf
    s_nop 1
    v_add_f32_dpp v59, v57, v57 row_mirror row_mask:0xf bank_mask:0xf
    v_mov_b32 v57, v59
    s_nop 1
    v_permlane16_swap_b32 v59, v57
    s_nop 1
    v_add_f32 v59, v59, v57
    v_mov_b32 v57, v59
    s_nop 1
    v_permlane32_swap_b32 v59, v57
    s_nop 1
    v_add_f32 v59, v59, v57
    v_mul_f32 v59, s38, v59
    v_cvt_pk_bf16_f32 v58, v56, v59
    v_lshlrev_b32 v56, 16, v58
    v_and_b32 v59, 0xffff0000, v58
    v_add_f32 v59, s39, v59
    v_cvt_pk_bf16_f32 v59, v59, v59
    v_lshlrev_b32 v59, 16, v59
    v_sqrt_f32 v59, v59
    s_nop 0
    v_cvt_pk_bf16_f32 v59, v59, v59
    v_lshlrev_b32 v59, 16, v59
    v_rcp_f32 v58, v59
    s_nop 0
    v_sub_f32 v60, v48, v56
    v_sub_f32 v61, v49, v56
    v_cvt_pk_bf16_f32 v60, v60, v61
    v_and_b32 v61, 0xffff0000, v60
    v_lshlrev_b32 v60, 16, v60
    v_mul_f32 v62, v60, v58
    v_mul_f32 v63, v61, v58
    v_fma_f32 v60, -v62, v59, v60
    v_fma_f32 v61, -v63, v59, v61
    v_fma_f32 v62, v60, v58, v62
    v_fma_f32 v63, v61, v58, v63
    v_cvt_pk_bf16_f32 v72, v62, v63
    v_sub_f32 v60, v50, v56
    v_sub_f32 v61, v51, v56
    v_cvt_pk_bf16_f32 v60, v60, v61
    v_and_b32 v61, 0xffff0000, v60
    v_lshlrev_b32 v60, 16, v60
    v_mul_f32 v62, v60, v58
    v_mul_f32 v63, v61, v58
    v_fma_f32 v60, -v62, v59, v60
    v_fma_f32 v61, -v63, v59, v61
    v_fma_f32 v62, v60, v58, v62
    v_fma_f32 v63, v61, v58, v63
    v_cvt_pk_bf16_f32 v73, v62, v63
    v_sub_f32 v60, v52, v56
    v_sub_f32 v61, v53, v56
    v_cvt_pk_bf16_f32 v60, v60, v61
    v_and_b32 v61, 0xffff0000, v60
    v_lshlrev_b32 v60, 16, v60
    v_mul_f32 v62, v60, v58
    v_mul_f32 v63, v61, v58
    v_fma_f32 v60, -v62, v59, v60
    v_fma_f32 v61, -v63, v59, v61
    v_fma_f32 v62, v60, v58, v62
    v_fma_f32 v63, v61, v58, v63
    v_cvt_pk_bf16_f32 v74, v62, v63
    v_sub_f32 v60, v54, v56
    v_sub_f32 v61, v55, v56
    v_cvt_pk_bf16_f32 v60, v60, v61
    v_and_b32 v61, 0xffff0000, v60
    v_lshlrev_b32 v60, 16, v60
    v_mul_f32 v62, v60, v58
    v_mul_f32 v63, v61, v58
    v_fma_f32 v60, -v62, v59, v60
    v_fma_f32 v61, -v63, v59, v61
    v_fma_f32 v62, v60, v58, v62
    v_fma_f32 v63, v61, v58, v63
    v_cvt_pk_bf16_f32 v75, v62, v63
    v_mov_b32 v60, 0
    v_lshlrev_b32 v61, 16, v72
    v_and_b32 v62, 0xffff0000, v72
    v_fmac_f32 v60, v61, v40
    v_fmac_f32 v60, v62, v41
    v_lshlrev_b32 v61, 16, v73
    v_and_b32 v62, 0xffff0000, v73
    v_fmac_f32 v60, v61, v42
    v_fmac_f32 v60, v62, v43
    v_lshlrev_b32 v61, 16, v74
    v_and_b32 v62, 0xffff0000, v74
    v_fmac_f32 v60, v61, v44
    v_fmac_f32 v60, v62, v45
    v_lshlrev_b32 v61, 16, v75
    v_and_b32 v62, 0xffff0000, v75
    v_fmac_f32 v60, v61, v46
    v_fmac_f32 v60, v62, v47
    buffer_store_dwordx4 v[72:75], v4, s[24:27], s37 offen offset:2048 sc1
    s_nop 1
    v_add_f32_dpp v57, v60, v60 quad_perm:[1,0,3,2] row_mask:0xf bank_mask:0xf
    s_nop 1
    v_add_f32_dpp v60, v57, v57 quad_perm:[2,3,0,1] row_mask:0xf bank_mask:0xf
    s_nop 1
    v_add_f32_dpp v57, v60, v60 row_half_mirror row_mask:0xf bank_mask:0xf
    s_nop 1
    v_add_f32_dpp v60, v57, v57 row_mirror row_mask:0xf bank_mask:0xf
    v_mov_b32 v57, v60
    s_nop 1
    v_permlane16_swap_b32 v60, v57
    s_nop 1
    v_add_f32 v60, v60, v57
    v_mov_b32 v57, v60
    s_nop 1
    v_permlane32_swap_b32 v60, v57
    s_nop 1
    v_add_f32 v60, v60, v57
    v_cvt_pk_bf16_f32 v60, v60, v60
    v_lshlrev_b32 v82, 16, v60
    v_lshlrev_b32 v48, 16, v24
    v_and_b32 v49, 0xffff0000, v24
    v_lshlrev_b32 v50, 16, v25
    v_and_b32 v51, 0xffff0000, v25
    v_lshlrev_b32 v52, 16, v26
    v_and_b32 v53, 0xffff0000, v26
    v_lshlrev_b32 v54, 16, v27
    v_and_b32 v55, 0xffff0000, v27
    v_add_f32 v56, v48, v49
    v_add_f32 v56, v56, v50
    v_add_f32 v56, v56, v51
    v_add_f32 v56, v56, v52
    v_add_f32 v56, v56, v53
    v_add_f32 v56, v56, v54
    v_add_f32 v56, v56, v55
    s_nop 1
    v_add_f32_dpp v57, v56, v56 quad_perm:[1,0,3,2] row_mask:0xf bank_mask:0xf
    s_nop 1
    v_add_f32_dpp v56, v57, v57 quad_perm:[2,3,0,1] row_mask:0xf bank_mask:0xf
    s_nop 1
    v_add_f32_dpp v57, v56, v56 row_half_mirror row_mask:0xf bank_mask:0xf
    s_nop 1
    v_add_f32_dpp v56, v57, v57 row_mirror row_mask:0xf bank_mask:0xf
    v_mov_b32 v57, v56
    s_nop 1
    v_permlane16_swap_b32 v56, v57
    s_nop 1
    v_add_f32 v56, v56, v57
    v_mov_b32 v57, v56
    s_nop 1
    v_permlane32_swap_b32 v56, v57
    s_nop 1
    v_add_f32 v56, v56, v57
    v_mul_f32 v56, s38, v56
    v_sub_f32 v58, v48, v56
    v_mul_f32 v59, v58, v58
    v_sub_f32 v58, v49, v56
    v_fmac_f32 v59, v58, v58
    v_sub_f32 v58, v50, v56
    v_fmac_f32 v59, v58, v58
    v_sub_f32 v58, v51, v56
    v_fmac_f32 v59, v58, v58
    v_sub_f32 v58, v52, v56
    v_fmac_f32 v59, v58, v58
    v_sub_f32 v58, v53, v56
    v_fmac_f32 v59, v58, v58
    v_sub_f32 v58, v54, v56
    v_fmac_f32 v59, v58, v58
    v_sub_f32 v58, v55, v56
    v_fmac_f32 v59, v58, v58
    s_nop 1
    v_add_f32_dpp v57, v59, v59 quad_perm:[1,0,3,2] row_mask:0xf bank_mask:0xf
    s_nop 1
    v_add_f32_dpp v59, v57, v57 quad_perm:[2,3,0,1] row_mask:0xf bank_mask:0xf
    s_nop 1
    v_add_f32_dpp v57, v59, v59 row_half_mirror row_mask:0xf bank_mask:0xf
    s_nop 1
    v_add_f32_dpp v59, v57, v57 row_mirror row_mask:0xf bank_mask:0xf
    v_mov_b32 v57, v59
    s_nop 1
    v_permlane16_swap_b32 v59, v57
    s_nop 1
    v_add_f32 v59, v59, v57
    v_mov_b32 v57, v59
    s_nop 1
    v_permlane32_swap_b32 v59, v57
    s_nop 1
    v_add_f32 v59, v59, v57
    v_mul_f32 v59, s38, v59
    v_cvt_pk_bf16_f32 v58, v56, v59
    v_lshlrev_b32 v56, 16, v58
    v_and_b32 v59, 0xffff0000, v58
    v_add_f32 v59, s39, v59
    v_cvt_pk_bf16_f32 v59, v59, v59
    v_lshlrev_b32 v59, 16, v59
    v_sqrt_f32 v59, v59
    s_nop 0
    v_cvt_pk_bf16_f32 v59, v59, v59
    v_lshlrev_b32 v59, 16, v59
    v_rcp_f32 v58, v59
    s_nop 0
    v_sub_f32 v60, v48, v56
    v_sub_f32 v61, v49, v56
    v_cvt_pk_bf16_f32 v60, v60, v61
    v_and_b32 v61, 0xffff0000, v60
    v_lshlrev_b32 v60, 16, v60
    v_mul_f32 v62, v60, v58
    v_mul_f32 v63, v61, v58
    v_fma_f32 v60, -v62, v59, v60
    v_fma_f32 v61, -v63, v59, v61
    v_fma_f32 v62, v60, v58, v62
    v_fma_f32 v63, v61, v58, v63
    v_cvt_pk_bf16_f32 v76, v62, v63
    v_sub_f32 v60, v50, v56
    v_sub_f32 v61, v51, v56
    v_cvt_pk_bf16_f32 v60, v60, v61
    v_and_b32 v61, 0xffff0000, v60
    v_lshlrev_b32 v60, 16, v60
    v_mul_f32 v62, v60, v58
    v_mul_f32 v63, v61, v58
    v_fma_f32 v60, -v62, v59, v60
    v_fma_f32 v61, -v63, v59, v61
    v_fma_f32 v62, v60, v58, v62
    v_fma_f32 v63, v61, v58, v63
    v_cvt_pk_bf16_f32 v77, v62, v63
    v_sub_f32 v60, v52, v56
    v_sub_f32 v61, v53, v56
    v_cvt_pk_bf16_f32 v60, v60, v61
    v_and_b32 v61, 0xffff0000, v60
    v_lshlrev_b32 v60, 16, v60
    v_mul_f32 v62, v60, v58
    v_mul_f32 v63, v61, v58
    v_fma_f32 v60, -v62, v59, v60
    v_fma_f32 v61, -v63, v59, v61
    v_fma_f32 v62, v60, v58, v62
    v_fma_f32 v63, v61, v58, v63
    v_cvt_pk_bf16_f32 v78, v62, v63
    v_sub_f32 v60, v54, v56
    v_sub_f32 v61, v55, v56
    v_cvt_pk_bf16_f32 v60, v60, v61
    v_and_b32 v61, 0xffff0000, v60
    v_lshlrev_b32 v60, 16, v60
    v_mul_f32 v62, v60, v58
    v_mul_f32 v63, v61, v58
    v_fma_f32 v60, -v62, v59, v60
    v_fma_f32 v61, -v63, v59, v61
    v_fma_f32 v62, v60, v58, v62
    v_fma_f32 v63, v61, v58, v63
    v_cvt_pk_bf16_f32 v79, v62, v63
    v_mov_b32 v60, 0
    v_lshlrev_b32 v61, 16, v76
    v_and_b32 v62, 0xffff0000, v76
    v_fmac_f32 v60, v61, v40
    v_fmac_f32 v60, v62, v41
    v_lshlrev_b32 v61, 16, v77
    v_and_b32 v62, 0xffff0000, v77
    v_fmac_f32 v60, v61, v42
    v_fmac_f32 v60, v62, v43
    v_lshlrev_b32 v61, 16, v78
    v_and_b32 v62, 0xffff0000, v78
    v_fmac_f32 v60, v61, v44
    v_fmac_f32 v60, v62, v45
    v_lshlrev_b32 v61, 16, v79
    v_and_b32 v62, 0xffff0000, v79
    v_fmac_f32 v60, v61, v46
    v_fmac_f32 v60, v62, v47
    buffer_store_dwordx4 v[76:79], v4, s[24:27], s37 offen offset:3072 sc1
    s_nop 1
    v_add_f32_dpp v57, v60, v60 quad_perm:[1,0,3,2] row_mask:0xf bank_mask:0xf
    s_nop 1
    v_add_f32_dpp v60, v57, v57 quad_perm:[2,3,0,1] row_mask:0xf bank_mask:0xf
    s_nop 1
    v_add_f32_dpp v57, v60, v60 row_half_mirror row_mask:0xf bank_mask:0xf
    s_nop 1
    v_add_f32_dpp v60, v57, v57 row_mirror row_mask:0xf bank_mask:0xf
    v_mov_b32 v57, v60
    s_nop 1
    v_permlane16_swap_b32 v60, v57
    s_nop 1
    v_add_f32 v60, v60, v57
    v_mov_b32 v57, v60
    s_nop 1
    v_permlane32_swap_b32 v60, v57
    s_nop 1
    v_add_f32 v60, v60, v57
    v_cvt_pk_bf16_f32 v60, v60, v60
    v_lshlrev_b32 v83, 16, v60
    v_lshlrev_b32 v61, 4, v2
    s_lshl_b32 s40, s36, 2
    s_add_u32 s40, s40, 0x200000
    s_mov_b64 exec, 1
    buffer_store_dwordx4 v[80:83], v61, s[24:27], s40 offen sc1
    s_mov_b64 exec, -1
    s_cmp_lg_u32 s45, 0
    s_cbranch_scc1 W_LN3
    s_mov_b32 s45, 1
    s_add_u32 s36, s36, 16
    s_add_u32 s37, s37, 16384
    s_waitcnt vmcnt(5)
    v_mov_b32 v12, v84
    v_mov_b32 v13, v85
    v_mov_b32 v14, v86
    v_mov_b32 v15, v87
    v_mov_b32 v16, v88
    v_mov_b32 v17, v89
    v_mov_b32 v18, v90
    v_mov_b32 v19, v91
    v_mov_b32 v20, v92
    v_mov_b32 v21, v93
    v_mov_b32 v22, v94
    v_mov_b32 v23, v95
    v_mov_b32 v24, v96
    v_mov_b32 v25, v97
    v_mov_b32 v26, v98
    v_mov_b32 v27, v99
    s_branch W_LN2
W_LN3:
    s_lshr_b32 s41, s30, 2
    s_and_b32 s42, s41, 3
    s_lshl_b32 s42, s42, 3
    s_lshl_b32 s42, 1, s42
    s_lshr_b32 s41, s41, 2
    s_lshl_b32 s41, s41, 2
    s_waitcnt vmcnt(0)
    s_barrier
    s_cmp_lg_u32 s29, 0
    s_cbranch_scc1 DA_52
    s_mov_b64 exec, 1
    v_mov_b32 v28, s42
    buffer_atomic_add v28, off, s[12:15], s41 offset:68 sc1
    s_mov_b64 exec, -1
DA_52:
    s_branch W_LOOP
W_PKO:
    s_mov_b32 s33, s30
    s_mov_b32 s32, 128
    s_mov_b32 s35, 0x400000
    s_mov_b32 s31, 0x1000000
    s_mov_b32 s38, 40
    s_mov_b32 s47, 244
    s_branch W_PKG0
W_PKD:
    s_mov_b32 s33, s30
    s_mov_b32 s32, 56
    s_mov_b32 s35, 0x1c0000
    s_mov_b32 s31, 0x1800000
    s_mov_b32 s38, 88
    s_mov_b32 s47, 252
W_PKG0:
    s_mov_b32 s46, 1024
    s_mov_b32 s34, 0
W_PKGO:
    s_load_dwordx2 s[36:37], s[0:1], s38
    s_waitcnt lgkmcnt(0)
    s_mov_b32 s40, s36
    s_and_b32 s41, s37, 0xffff
    s_mov_b32 s42, s35
    s_mov_b32 s43, 0x00020000
    s_lshl_b32 s44, s33, 6
    s_mul_i32 s44, s44, s46
    s_lshl_b32 s45, s34, 9
    s_add_u32 s44, s44, s45
    s_lshl_b32 s45, s46, 3
    v_lshrrev_b32 v3, 5, v0
    v_and_b32 v4, 31, v0
    v_lshlrev_b32 v4, 4, v4
    v_mul_lo_u32 v5, v3, s46
    v_add_u32 v5, v5, v4
    s_movk_i32 s48, 528
    v_mul_lo_u32 v6, v3, s48
    v_add_u32 v6, v6, v4
    v_add_u32 v6, 2048, v6
    buffer_load_dwordx4 v[64:67], v5, s[40:43], s44 offen
    s_add_u32 s44, s44, s45
    buffer_load_dwordx4 v[68:71], v5, s[40:43], s44 offen
    s_add_u32 s44, s44, s45
    buffer_load_dwordx4 v[72:75], v5, s[40:43], s44 offen
    s_add_u32 s44, s44, s45
    buffer_load_dwordx4 v[76:79], v5, s[40:43], s44 offen
    s_add_u32 s44, s44, s45
    buffer_load_dwordx4 v[80:83], v5, s[40:43], s44 offen
    s_add_u32 s44, s44, s45
    buffer_load_dwordx4 v[84:87], v5, s[40:43], s44 offen
    s_add_u32 s44, s44, s45
    buffer_load_dwordx4 v[88:91], v5, s[40:43], s44 offen
    s_add_u32 s44, s44, s45
    buffer_load_dwordx4 v[92:95], v5, s[40:43], s44 offen
    s_waitcnt vmcnt(7)
    ds_write_b128 v6, v[64:67] offset:0
    s_waitcnt vmcnt(6)
    ds_write_b128 v6, v[68:71] offset:4224
    s_waitcnt vmcnt(5)
    ds_write_b128 v6, v[72:75] offset:8448
    s_waitcnt vmcnt(4)
    ds_write_b128 v6, v[76:79] offset:12672
    s_waitcnt vmcnt(3)
    ds_write_b128 v6, v[80:83] offset:16896
    s_waitcnt vmcnt(2)
    ds_write_b128 v6, v[84:87] offset:21120
    s_waitcnt vmcnt(1)
    ds_write_b128 v6, v[88:91] offset:25344
    s_waitcnt vmcnt(0)
    ds_write_b128 v6, v[92:95] offset:29568
    s_waitcnt lgkmcnt(0)
    s_barrier
    v_lshrrev_b32 v7, 4, v1
    v_bfe_u32 v3, v1, 2, 2
    v_lshl_add_u32 v3, v7, 3, v3
    v_mul_lo_u32 v3, v3, s48
    v_and_b32 v4, 3, v1
    v_lshl_add_u32 v3, v4, 4, v3
    v_lshl_add_u32 v3, v2, 7, v3
    v_add_u32 v3, 2048, v3
    s_lshl_b32 s49, s32, 12
    v_mul_lo_u32 v4, v2, s49
    v_lshl_add_u32 v4, v1, 4, v4
    s_lshl_b32 s50, s34, 4
    s_mul_i32 s50, s50, s32
    s_lshl_b32 s51, s33, 1
    s_add_u32 s50, s50, s51
    s_lshl_b32 s50, s50, 10
    s_add_u32 s50, s50, s31
    s_lshl_b32 s52, s32, 10
    ds_read_b64_tr_b16 v[64:65], v3 offset:0
    ds_read_b64_tr_b16 v[66:67], v3 offset:2112
    ds_read_b64_tr_b16 v[68:69], v3 offset:16896
    ds_read_b64_tr_b16 v[70:71], v3 offset:19008
    ds_read_b64_tr_b16 v[72:73], v3 offset:8
    ds_read_b64_tr_b16 v[74:75], v3 offset:2120
    ds_read_b64_tr_b16 v[76:77], v3 offset:16904
    ds_read_b64_tr_b16 v[78:79], v3 offset:19016
    ds_read_b64_tr_b16 v[80:81], v3 offset:64
    ds_read_b64_tr_b16 v[82:83], v3 offset:2176
    ds_read_b64_tr_b16 v[84:85], v3 offset:16960
    ds_read_b64_tr_b16 v[86:87], v3 offset:19072
    ds_read_b64_tr_b16 v[88:89], v3 offset:72
    ds_read_b64_tr_b16 v[90:91], v3 offset:2184
    ds_read_b64_tr_b16 v[92:93], v3 offset:16968
    ds_read_b64_tr_b16 v[94:95], v3 offset:19080
    s_mul_i32 s51, s52, 0
    s_add_u32 s51, s51, s50
    s_add_u32 s53, s51, 1024
    s_waitcnt lgkmcnt(14)
    buffer_store_dwordx4 v[64:67], v4, s[24:27], s51 offen sc1
    s_waitcnt lgkmcnt(12)
    buffer_store_dwordx4 v[68:71], v4, s[24:27], s53 offen sc1
    s_mul_i32 s51, s52, 1
    s_add_u32 s51, s51, s50
    s_add_u32 s53, s51, 1024
    s_waitcnt lgkmcnt(10)
    buffer_store_dwordx4 v[72:75], v4, s[24:27], s51 offen sc1
    s_waitcnt lgkmcnt(8)
    buffer_store_dwordx4 v[76:79], v4, s[24:27], s53 offen sc1
    s_mul_i32 s51, s52, 2
    s_add_u32 s51, s51, s50
    s_add_u32 s53, s51, 1024
    s_waitcnt lgkmcnt(6)
    buffer_store_dwordx4 v[80:83], v4, s[24:27], s51 offen sc1
    s_waitcnt lgkmcnt(4)
    buffer_store_dwordx4 v[84:87], v4, s[24:27], s53 offen sc1
    s_mul_i32 s51, s52, 3
    s_add_u32 s51, s51, s50
    s_add_u32 s53, s51, 1024
    s_waitcnt lgkmcnt(2)
    buffer_store_dwordx4 v[88:91], v4, s[24:27], s51 offen sc1
    s_waitcnt lgkmcnt(0)
    buffer_store_dwordx4 v[92:95], v4, s[24:27], s53 offen sc1
    s_cmp_lg_u32 s34, 0
    s_cbranch_scc1 W_PKE
    s_mov_b32 s34, 1
    s_barrier
    s_branch W_PKGO
W_PKE:
    s_waitcnt vmcnt(0)
    s_barrier
    s_cmp_lg_u32 s29, 0
    s_cbranch_scc1 DA_53
    s_mov_b64 exec, 1
    v_mov_b32 v28, 1
    buffer_atomic_add v28, off, s[12:15], s47 offset:0 sc1
    s_mov_b64 exec, -1
DA_53:
    s_branch W_LOOP
W_EXIT:
    s_endpgm
.section .rodata,"a"
.p2align 6
.amdhsa_kernel k23_kernel
  .amdhsa_next_free_vgpr 512
  .amdhsa_next_free_sgpr 102
  .amdhsa_accum_offset 256
  .amdhsa_group_segment_fixed_size 0
  .amdhsa_kernarg_size 120
  .amdhsa_user_sgpr_count 2
  .amdhsa_user_sgpr_kernarg_segment_ptr 1
  .amdhsa_system_sgpr_workgroup_id_x 1
.end_amdhsa_kernel
```
